```python
import torch

def _softmax(x, axis=-1):
    return torch.softmax(x, dim=axis)
def _gelu(x):
    return torch.nn.functional.gelu(x, approximate="tanh")
def _silu(x):
    return torch.nn.functional.silu(x)
def _sigmoid(x):
    return torch.sigmoid(x)
def _layernorm(x, axis=-1, eps=1e-5):
    m = x.mean(dim=axis, keepdim=True)
    v = x.var(dim=axis, keepdim=True, unbiased=False)
    return (x - m) / torch.sqrt(v + eps)
def _scatter_add(tgt, idx, src, axis=0):
    return tgt.clone().index_add_(axis, idx, src)
def _segment_sum(src, seg, n):
    out = torch.zeros((n,) + src.shape[1:], dtype=src.dtype)
    return out.index_add_(0, seg, src)
def _pad(x, pw):
    flat = tuple(v for pair in reversed(pw) for v in pair)
    return torch.nn.functional.pad(x, flat)

kernel_name = 'recurrent_scan__linear_kernel_hedgehog__dense_activation_silu__prompt'

def setup_inputs():

    _w = (lambda a: (lambda t: t.to(torch.bfloat16) if t.is_floating_point() else t)(torch.as_tensor(a)))
    def _A_setup():
        B, S, D, H = 1, 2048, 1024, 32
        Dh = D // H
        return {
            "x": _w((lambda *s: torch.randn(*s, dtype=torch.bfloat16) * 0.05)(B, S, D)),
            "wqkv": _w((lambda *s: torch.randn(*s, dtype=torch.bfloat16) * 0.4)(D, 3 * D)),
            "w_phi": _w((lambda *s: torch.randn(*s, dtype=torch.bfloat16) * 0.4)(H, Dh, Dh) * (Dh ** -0.5)),
            "wo": _w((lambda *s: torch.randn(*s, dtype=torch.bfloat16) * 0.2)(D, D)),
        }
    _A_in = _A_setup()

    def _B_setup():
        B, S, D, F = 1, 2048, 1024, 3584
        return {
            "x": _w((lambda *s: torch.randn(*s, dtype=torch.bfloat16) * 0.05)(B, S, D)),
            "w1": _w((lambda *s: torch.randn(*s, dtype=torch.bfloat16) * 0.4)(D, F) * (D ** -0.5)),
            "w2": _w((lambda *s: torch.randn(*s, dtype=torch.bfloat16) * 0.1)(F, D) * (F ** -0.5)),
        }
    _B_in = _B_setup()

    return {
        "A_x": _A_in["x"],
        "A_wqkv": _A_in["wqkv"],
        "A_w_phi": _A_in["w_phi"],
        "A_wo": _A_in["wo"],
        "B_x": _B_in["x"],
        "B_w1": _B_in["w1"],
        "B_w2": _B_in["w2"],
    }

def reference(A_x, A_wqkv, A_w_phi, A_wo, B_x, B_w1, B_w2):
    def _A_ref(x, wqkv, w_phi, wo):
        B, S, D = x.shape
        H = 32; Dh = D // H
        qkv = (lambda x, *d: x.permute(*d))((x @ wqkv).reshape(B, S, 3, H, Dh), 2, 0, 3, 1, 4)
        q, k, v = qkv[0], qkv[1], qkv[2]
        pq = torch.einsum("bhsd,hdf->bhsf", q, w_phi)
        pk = torch.einsum("bhsd,hdf->bhsf", k, w_phi)
        phi_q = torch.concatenate([_softmax(pq, axis=-1), _softmax(-pq, axis=-1)], axis=-1)
        phi_k = torch.concatenate([_softmax(pk, axis=-1), _softmax(-pk, axis=-1)], axis=-1)
        kv = torch.einsum("bhsf,bhsd->bhfd", phi_k, v)
        z  = torch.einsum("bhsf->bhf", phi_k)
        num = torch.einsum("bhqf,bhfd->bhqd", phi_q, kv)
        den = torch.einsum("bhqf,bhf->bhq", phi_q, z)[..., None] + 1e-6
        o = num / den
        return (lambda x, *d: x.permute(*d))(o, 0, 2, 1, 3).reshape(B, S, D) @ wo

    def _B_ref(x, w1, w2):
        h = torch.einsum("bsd,df->bsf", x, w1)
        h = _silu(h)
        out = torch.einsum("bsf,fd->bsd", h, w2)
        return out

    x = A_x
    xn = _layernorm(x, axis=-1)
    s = _A_ref(xn, A_wqkv, A_w_phi, A_wo)
    g = _silu(_B_ref(xn, B_w1, B_w2))
    return x + s * g
```

```asm
; @launch grid=(256,1,1) block=(256,1,1) lds=159744
.amdgcn_target "amdgcn-amd-amdhsa--gfx950"
.macro MV d,a,b
v_mfma_f32_16x16x32_bf16 v[\d:\d+3], a[\a:\a+3], a[\b:\b+3], v[\d:\d+3]
.endm
.macro MA d,a,b
v_mfma_f32_16x16x32_bf16 a[\d:\d+3], a[\a:\a+3], a[\b:\b+3], a[\d:\d+3]
.endm
.macro RT d,v,o
ds_read_b64_tr_b16 a[\d:\d+1], v\v offset:\o
.endm
.text
.globl recurrent_scan__linear_kernel_hedgehog__dense_activation_silu__prompt_kernel
.p2align 8
.type recurrent_scan__linear_kernel_hedgehog__dense_activation_silu__prompt_kernel,@function
recurrent_scan__linear_kernel_hedgehog__dense_activation_silu__prompt_kernel:
    s_cmp_ge_u32 s2, 256
    s_cbranch_scc1 L_end
    s_load_dwordx2 s[20:21], s[0:1], 0
    s_load_dwordx2 s[8:9], s[0:1], 72
    s_getpc_b64 s[48:49]
L_cpc:
    s_sub_u32 s48, s48, L_cpc-recurrent_scan__linear_kernel_hedgehog__dense_activation_silu__prompt_kernel
    s_subb_u32 s49, s49, 0
    s_mov_b32 s31, L_role_h-recurrent_scan__linear_kernel_hedgehog__dense_activation_silu__prompt_kernel
    s_cmp_ge_u32 s2, 128
    s_cselect_b32 s31, s31, L_role_q-recurrent_scan__linear_kernel_hedgehog__dense_activation_silu__prompt_kernel
    v_lshrrev_b32 v24, 2, v0
    v_lshl_add_u32 v25, v24, 7, s31
    global_load_dword v29, v25, s[48:49]
    s_lshr_b32 s3, s2, 3
    s_lshl_b32 s31, s3, 5
    v_lshrrev_b32 v24, 1, v24
    v_add_u32 v24, s31, v24
    v_min_u32 v24, (L_code_end-recurrent_scan__linear_kernel_hedgehog__dense_activation_silu__prompt_kernel)/128-1, v24
    v_lshlrev_b32 v30, 7, v24
    global_load_dword v29, v30, s[48:49]
    s_load_dwordx2 s[44:45], s[0:1], 64
    s_load_dwordx2 s[34:35], s[0:1], 48
    s_load_dwordx2 s[36:37], s[0:1], 24
    s_load_dwordx2 s[38:39], s[0:1], 56
    s_load_dwordx2 s[58:59], s[0:1], 16
    s_lshr_b32 s3, s2, 3
    s_cmp_ge_u32 s2, 128
    s_cselect_b32 s60, 1, 0
    s_cselect_b32 s30, 40, 8
    s_load_dwordx2 s[12:13], s[0:1], s30
    v_lshrrev_b32 v1, 6, v0
    v_lshrrev_b32 v14, 5, v0
    v_readfirstlane_b32 s27, v1
    v_and_b32 v15, 31, v0
    v_lshlrev_b32 v16, 11, v14
    v_lshl_add_u32 v16, v15, 4, v16
    s_and_b32 s28, s3, 7
    s_and_b32 s31, s2, 7
    s_and_b32 s33, s2, 1
    s_lshr_b32 s55, s31, 1
    s_lshl_b32 s55, s55, 2
    s_lshr_b32 s30, s3, 3
    s_lshl_b32 s29, s31, 1
    s_and_b32 s56, s30, 1
    s_add_u32 s29, s29, s56
    s_lshl_b32 s56, s33, 1
    s_xor_b32 s56, s56, s30
    s_add_u32 s55, s55, s56
    s_and_b32 s56, s3, 7
    s_lshl_b32 s57, s31, 2
    s_add_u32 s57, s57, s30
    s_lshl_b32 s30, s28, 5
    s_add_u32 s57, s57, s30
    s_lshl_b32 s30, s57, 14
    s_mov_b32 s22, 4194304
    s_mov_b32 s23, 0x00020000
    s_mov_b32 s10, 268435456
    s_mov_b32 s11, 0x00020000
    s_mov_b32 s46, 256
    s_mov_b32 s47, 0x00020000
    s_mov_b32 s15, 0x00020000
    v_and_b32 v10, 63, v0
    v_lshrrev_b32 v11, 4, v10
    v_bfe_u32 v12, v10, 2, 2
    v_and_b32 v13, 3, v10
    v_lshlrev_b32 v1, 4, v10
    s_waitcnt lgkmcnt(0)
    s_and_b32 s32, s57, 31
    s_or_b32 s32, s32, s27
    v_mov_b32 v31, 0
    s_cmp_lg_u32 s32, 0
    s_cbranch_scc1 L_nolead_c
    v_mov_b32 v96, 0
    v_mov_b32 v97, 0
    v_mov_b32 v98, 0
    v_mov_b32 v99, 0
    s_lshl_b32 s31, s28, 11
    s_add_u32 s31, s31, 28311552
    buffer_store_dwordx4 v[96:99], v1, s[8:11], s31 offen offset:0 sc1
    buffer_store_dwordx4 v[96:99], v1, s[8:11], s31 offen offset:1024 sc1
L_nolead_c:
    buffer_load_dwordx4 v[64:67], v16, s[20:23], s30 offen offset:0 nt
    buffer_load_dwordx4 v[68:71], v16, s[20:23], s30 offen offset:512 nt
    buffer_load_dwordx4 v[72:75], v16, s[20:23], s30 offen offset:1024 nt
    buffer_load_dwordx4 v[76:79], v16, s[20:23], s30 offen offset:1536 nt
    s_cmp_eq_u32 s60, 1
    s_cbranch_scc0 L_role_q
    s_getpc_b64 s[30:31]
L_pc:
    s_add_u32 s30, s30, L_role_h-L_pc
    s_addc_u32 s31, s31, 0
    s_setpc_b64 s[30:31]
L_end:
    s_endpgm
L_role_q:
    s_mov_b32 s14, 6291456
    s_movk_i32 s30, 2731
    s_movk_i32 s31, 6144
    v_add_u32 v24, 0, v10
    v_mul_u32_u24 v25, s30, v24
    v_lshrrev_b32 v25, 16, v25
    v_mul_u32_u24 v26, 24, v25
    v_sub_u32 v26, v24, v26
    v_and_b32 v27, 2, v25
    v_lshrrev_b32 v28, 1, v25
    v_and_or_b32 v27, v28, 4, v27
    v_xor_b32 v26, v26, v27
    v_lshrrev_b32 v27, 3, v26
    v_and_b32 v26, 7, v26
    v_lshlrev_b32 v27, 11, v27
    v_lshl_add_u32 v26, v26, 4, v27
    v_mad_u32_u24 v2, v25, s31, v26
    v_add_u32 v24, 64, v10
    v_mul_u32_u24 v25, s30, v24
    v_lshrrev_b32 v25, 16, v25
    v_mul_u32_u24 v26, 24, v25
    v_sub_u32 v26, v24, v26
    v_and_b32 v27, 2, v25
    v_lshrrev_b32 v28, 1, v25
    v_and_or_b32 v27, v28, 4, v27
    v_xor_b32 v26, v26, v27
    v_lshrrev_b32 v27, 3, v26
    v_and_b32 v26, 7, v26
    v_lshlrev_b32 v27, 11, v27
    v_lshl_add_u32 v26, v26, 4, v27
    v_mad_u32_u24 v3, v25, s31, v26
    v_subrev_u32 v3, 1024, v3
    v_add_u32 v24, 128, v10
    v_mul_u32_u24 v25, s30, v24
    v_lshrrev_b32 v25, 16, v25
    v_mul_u32_u24 v26, 24, v25
    v_sub_u32 v26, v24, v26
    v_and_b32 v27, 2, v25
    v_lshrrev_b32 v28, 1, v25
    v_and_or_b32 v27, v28, 4, v27
    v_xor_b32 v26, v26, v27
    v_lshrrev_b32 v27, 3, v26
    v_and_b32 v26, 7, v26
    v_lshlrev_b32 v27, 11, v27
    v_lshl_add_u32 v26, v26, 4, v27
    v_mad_u32_u24 v4, v25, s31, v26
    v_subrev_u32 v4, 2048, v4
    v_add_u32 v24, 192, v10
    v_mul_u32_u24 v25, s30, v24
    v_lshrrev_b32 v25, 16, v25
    v_mul_u32_u24 v26, 24, v25
    v_sub_u32 v26, v24, v26
    v_and_b32 v27, 2, v25
    v_lshrrev_b32 v28, 1, v25
    v_and_or_b32 v27, v28, 4, v27
    v_xor_b32 v26, v26, v27
    v_lshrrev_b32 v27, 3, v26
    v_and_b32 v26, 7, v26
    v_lshlrev_b32 v27, 11, v27
    v_lshl_add_u32 v26, v26, 4, v27
    v_mad_u32_u24 v5, v25, s31, v26
    v_subrev_u32 v5, 3072, v5
    v_add_u32 v24, 256, v10
    v_mul_u32_u24 v25, s30, v24
    v_lshrrev_b32 v25, 16, v25
    v_mul_u32_u24 v26, 24, v25
    v_sub_u32 v26, v24, v26
    v_and_b32 v27, 2, v25
    v_lshrrev_b32 v28, 1, v25
    v_and_or_b32 v27, v28, 4, v27
    v_xor_b32 v26, v26, v27
    v_lshrrev_b32 v27, 3, v26
    v_and_b32 v26, 7, v26
    v_lshlrev_b32 v27, 11, v27
    v_lshl_add_u32 v26, v26, 4, v27
    v_mad_u32_u24 v6, v25, s31, v26
    v_add_u32 v24, 320, v10
    v_mul_u32_u24 v25, s30, v24
    v_lshrrev_b32 v25, 16, v25
    v_mul_u32_u24 v26, 24, v25
    v_sub_u32 v26, v24, v26
    v_and_b32 v27, 2, v25
    v_lshrrev_b32 v28, 1, v25
    v_and_or_b32 v27, v28, 4, v27
    v_xor_b32 v26, v26, v27
    v_lshrrev_b32 v27, 3, v26
    v_and_b32 v26, 7, v26
    v_lshlrev_b32 v27, 11, v27
    v_lshl_add_u32 v26, v26, 4, v27
    v_mad_u32_u24 v7, v25, s31, v26
    v_subrev_u32 v7, 1024, v7
    s_mul_i32 s26, s27, 6144
    s_mul_i32 s25, s27, 98304
    s_mul_i32 s30, s29, 128
    s_add_u32 s25, s25, s30
    v_add_u32 v2, s25, v2
    v_add_u32 v3, s25, v3
    v_add_u32 v4, s25, v4
    v_add_u32 v5, s25, v5
    v_add_u32 v6, s25, v6
    v_add_u32 v7, s25, v7
    s_add_u32 m0, s26, 49152
    s_nop 0
    global_load_lds_dwordx4 v2, s[12:13] offset:0
    v_add_u32 v2, 393216, v2
    global_load_lds_dwordx4 v3, s[12:13] offset:1024
    v_add_u32 v3, 393216, v3
    global_load_lds_dwordx4 v4, s[12:13] offset:2048
    v_add_u32 v4, 393216, v4
    global_load_lds_dwordx4 v5, s[12:13] offset:3072
    v_add_u32 v5, 393216, v5
    s_add_u32 m0, s26, 53248
    s_nop 0
    global_load_lds_dwordx4 v6, s[12:13] offset:0
    v_add_u32 v6, 393216, v6
    global_load_lds_dwordx4 v7, s[12:13] offset:1024
    v_add_u32 v7, 393216, v7
    v_bfe_u32 v24, v10, 3, 1
    v_lshlrev_b32 v24, 6, v24
    v_bfe_u32 v25, v10, 2, 1
    v_add_u32 v24, v24, v25
    v_mul_u32_u24 v24, s31, v24
    v_min_u32 v25, 2, v13
    v_lshl_add_u32 v28, v25, 11, v24
    s_lshl_b32 s30, s28, 2
    s_add_u32 s30, s30, s27
    s_add_u32 s30, s30, 64
    s_mul_i32 s65, s30, 12288
    s_mul_i32 s30, s29, 128
    s_and_b32 s30, s30, 0xffffff80
    s_add_u32 s65, s65, s30
    s_add_u32 s65, s65, 0
    s_and_b32 s30, s29, 7
    s_cmp_eq_u32 s30, 3
    s_cselect_b32 s65, s65, 0x70000000
    s_mov_b32 s16, s58
    s_mov_b32 s17, s59
    s_mov_b32 s18, 65536
    s_mov_b32 s19, 0x00020000
    s_lshl_b32 s31, s29, 12
    s_lshl_b32 s30, s27, 10
    s_add_u32 s31, s31, s30
    s_add_u32 m0, s30, 122880
    s_nop 0
    buffer_load_dwordx4 v1, s[16:19], s31 offen lds
    s_lshl_b32 s30, s28, 2
    s_add_u32 s30, s30, s27
    s_lshl_b32 s30, s30, 7
    s_lshl_b32 s31, s29, 2
    s_add_u32 s62, s30, s31
    s_add_u32 s62, s62, 28311616
    s_lshl_b32 s30, s2, 4
    s_lshl_b32 s31, s27, 2
    s_add_u32 s30, s30, s31
    s_add_u32 s51, s30, 28319744
    s_lshl_b32 s30, s29, 7
    s_lshl_b32 s31, s27, 5
    s_add_u32 s30, s30, s31
    s_lshl_b32 s31, s28, 2
    s_add_u32 s30, s30, s31
    s_add_u32 s63, s30, 28315648
    s_add_u32 s64, s30, 28317696
    s_lshl_b32 s24, s28, 2
    s_add_u32 s24, s24, s27
    s_lshl_b32 s24, s24, 17
    v_add_u32 v63, s24, v1
    v_and_b32 v80, 7, v15
    v_xor_b32 v80, v80, v14
    v_lshlrev_b32 v80, 4, v80
    v_lshl_add_u32 v80, v15, 7, v80
    v_add_u32 v80, 143360, v80
    v_lshlrev_b32 v81, 4, v0
    v_add_u32 v81, 143360, v81
    v_lshrrev_b32 v84, 3, v0
    v_xor_b32 v85, v84, v0
    v_and_b32 v85, 7, v85
    v_lshrrev_b32 v86, 2, v84
    v_and_b32 v87, 3, v84
    v_lshlrev_b32 v86, 12, v86
    v_lshl_add_u32 v86, v87, 8, v86
    v_lshl_add_u32 v82, v85, 4, v86
    s_lshr_b32 s60, s57, 3
    s_lshl_b32 s60, s60, 17
    s_and_b32 s30, s57, 7
    s_lshr_b32 s31, s30, 1
    s_lshl_b32 s31, s31, 10
    s_and_b32 s30, s30, 1
    s_lshl_b32 s30, s30, 7
    s_add_u32 s60, s60, s31
    s_add_u32 s60, s60, s30
    s_mov_b32 s61, 0x3a800000
    s_waitcnt vmcnt(10)
    v_lshlrev_b32 v96, 16, v64
    v_and_b32 v97, 0xffff0000, v64
    v_lshlrev_b32 v98, 16, v65
    v_and_b32 v99, 0xffff0000, v65
    v_lshlrev_b32 v100, 16, v66
    v_and_b32 v101, 0xffff0000, v66
    v_lshlrev_b32 v102, 16, v67
    v_and_b32 v103, 0xffff0000, v67
    s_waitcnt vmcnt(9)
    v_lshlrev_b32 v104, 16, v68
    v_and_b32 v105, 0xffff0000, v68
    v_lshlrev_b32 v106, 16, v69
    v_and_b32 v107, 0xffff0000, v69
    v_lshlrev_b32 v108, 16, v70
    v_and_b32 v109, 0xffff0000, v70
    v_lshlrev_b32 v110, 16, v71
    v_and_b32 v111, 0xffff0000, v71
    s_waitcnt vmcnt(8)
    v_lshlrev_b32 v112, 16, v72
    v_and_b32 v113, 0xffff0000, v72
    v_lshlrev_b32 v114, 16, v73
    v_and_b32 v115, 0xffff0000, v73
    v_lshlrev_b32 v116, 16, v74
    v_and_b32 v117, 0xffff0000, v74
    v_lshlrev_b32 v118, 16, v75
    v_and_b32 v119, 0xffff0000, v75
    s_waitcnt vmcnt(7)
    s_cmp_lg_u32 s32, 0
    s_cbranch_scc1 L_nopub_q
    s_lshl_b32 s30, s28, 5
    v_mov_b32 v84, 1
    s_mov_b64 exec, 1
    buffer_store_dword v84, v31, s[44:47], s30 offen sc1
    s_mov_b64 exec, -1
L_nopub_q:
    v_lshlrev_b32 v120, 16, v76
    v_and_b32 v121, 0xffff0000, v76
    v_lshlrev_b32 v122, 16, v77
    v_and_b32 v123, 0xffff0000, v77
    v_lshlrev_b32 v124, 16, v78
    v_and_b32 v125, 0xffff0000, v78
    v_lshlrev_b32 v126, 16, v79
    v_and_b32 v127, 0xffff0000, v79
    v_pk_add_f32 v[84:85], v[96:97], v[98:99]
    v_pk_add_f32 v[86:87], v[100:101], v[102:103]
    v_pk_add_f32 v[84:85], v[84:85], v[104:105]
    v_pk_add_f32 v[86:87], v[86:87], v[106:107]
    v_pk_add_f32 v[84:85], v[84:85], v[108:109]
    v_pk_add_f32 v[86:87], v[86:87], v[110:111]
    v_pk_add_f32 v[84:85], v[84:85], v[112:113]
    v_pk_add_f32 v[86:87], v[86:87], v[114:115]
    v_pk_add_f32 v[84:85], v[84:85], v[116:117]
    v_pk_add_f32 v[86:87], v[86:87], v[118:119]
    v_pk_add_f32 v[84:85], v[84:85], v[120:121]
    v_pk_add_f32 v[86:87], v[86:87], v[122:123]
    v_pk_add_f32 v[84:85], v[84:85], v[124:125]
    v_pk_add_f32 v[86:87], v[86:87], v[126:127]
    v_pk_add_f32 v[84:85], v[84:85], v[86:87]
    v_add_f32 v84, v84, v85
    s_nop 1
    v_add_f32_dpp v84, v84, v84 quad_perm:[1,0,3,2] row_mask:0xf bank_mask:0xf
    s_nop 1
    v_add_f32_dpp v84, v84, v84 quad_perm:[2,3,0,1] row_mask:0xf bank_mask:0xf
    s_nop 1
    v_add_f32_dpp v84, v84, v84 row_half_mirror row_mask:0xf bank_mask:0xf
    s_nop 1
    v_add_f32_dpp v84, v84, v84 row_mirror row_mask:0xf bank_mask:0xf
    v_mov_b32 v85, v84
    s_nop 1
    v_permlane16_swap_b32 v84, v85
    v_add_f32 v84, v84, v85
    v_mul_f32 v84, s61, v84
    v_pk_add_f32 v[96:97], v[96:97], v[84:85] op_sel_hi:[1,0] neg_lo:[0,1] neg_hi:[0,1]
    v_pk_add_f32 v[98:99], v[98:99], v[84:85] op_sel_hi:[1,0] neg_lo:[0,1] neg_hi:[0,1]
    v_pk_add_f32 v[100:101], v[100:101], v[84:85] op_sel_hi:[1,0] neg_lo:[0,1] neg_hi:[0,1]
    v_pk_add_f32 v[102:103], v[102:103], v[84:85] op_sel_hi:[1,0] neg_lo:[0,1] neg_hi:[0,1]
    v_pk_add_f32 v[104:105], v[104:105], v[84:85] op_sel_hi:[1,0] neg_lo:[0,1] neg_hi:[0,1]
    v_pk_add_f32 v[106:107], v[106:107], v[84:85] op_sel_hi:[1,0] neg_lo:[0,1] neg_hi:[0,1]
    v_pk_add_f32 v[108:109], v[108:109], v[84:85] op_sel_hi:[1,0] neg_lo:[0,1] neg_hi:[0,1]
    v_pk_add_f32 v[110:111], v[110:111], v[84:85] op_sel_hi:[1,0] neg_lo:[0,1] neg_hi:[0,1]
    v_pk_add_f32 v[112:113], v[112:113], v[84:85] op_sel_hi:[1,0] neg_lo:[0,1] neg_hi:[0,1]
    v_pk_add_f32 v[114:115], v[114:115], v[84:85] op_sel_hi:[1,0] neg_lo:[0,1] neg_hi:[0,1]
    v_pk_add_f32 v[116:117], v[116:117], v[84:85] op_sel_hi:[1,0] neg_lo:[0,1] neg_hi:[0,1]
    v_pk_add_f32 v[118:119], v[118:119], v[84:85] op_sel_hi:[1,0] neg_lo:[0,1] neg_hi:[0,1]
    v_pk_add_f32 v[120:121], v[120:121], v[84:85] op_sel_hi:[1,0] neg_lo:[0,1] neg_hi:[0,1]
    v_pk_add_f32 v[122:123], v[122:123], v[84:85] op_sel_hi:[1,0] neg_lo:[0,1] neg_hi:[0,1]
    v_pk_add_f32 v[124:125], v[124:125], v[84:85] op_sel_hi:[1,0] neg_lo:[0,1] neg_hi:[0,1]
    v_pk_add_f32 v[126:127], v[126:127], v[84:85] op_sel_hi:[1,0] neg_lo:[0,1] neg_hi:[0,1]
    v_pk_mul_f32 v[86:87], v[96:97], v[96:97]
    v_pk_mul_f32 v[88:89], v[98:99], v[98:99]
    v_pk_fma_f32 v[86:87], v[100:101], v[100:101], v[86:87]
    v_pk_fma_f32 v[88:89], v[102:103], v[102:103], v[88:89]
    v_pk_fma_f32 v[86:87], v[104:105], v[104:105], v[86:87]
    v_pk_fma_f32 v[88:89], v[106:107], v[106:107], v[88:89]
    v_pk_fma_f32 v[86:87], v[108:109], v[108:109], v[86:87]
    v_pk_fma_f32 v[88:89], v[110:111], v[110:111], v[88:89]
    v_pk_fma_f32 v[86:87], v[112:113], v[112:113], v[86:87]
    v_pk_fma_f32 v[88:89], v[114:115], v[114:115], v[88:89]
    v_pk_fma_f32 v[86:87], v[116:117], v[116:117], v[86:87]
    v_pk_fma_f32 v[88:89], v[118:119], v[118:119], v[88:89]
    v_pk_fma_f32 v[86:87], v[120:121], v[120:121], v[86:87]
    v_pk_fma_f32 v[88:89], v[122:123], v[122:123], v[88:89]
    v_pk_fma_f32 v[86:87], v[124:125], v[124:125], v[86:87]
    v_pk_fma_f32 v[88:89], v[126:127], v[126:127], v[88:89]
    v_pk_add_f32 v[86:87], v[86:87], v[88:89]
    v_add_f32 v86, v86, v87
    s_nop 1
    v_add_f32_dpp v86, v86, v86 quad_perm:[1,0,3,2] row_mask:0xf bank_mask:0xf
    s_nop 1
    v_add_f32_dpp v86, v86, v86 quad_perm:[2,3,0,1] row_mask:0xf bank_mask:0xf
    s_nop 1
    v_add_f32_dpp v86, v86, v86 row_half_mirror row_mask:0xf bank_mask:0xf
    s_nop 1
    v_add_f32_dpp v86, v86, v86 row_mirror row_mask:0xf bank_mask:0xf
    v_mov_b32 v87, v86
    s_nop 1
    v_permlane16_swap_b32 v86, v87
    v_add_f32 v86, v86, v87
    v_mul_f32 v86, s61, v86
    v_cvt_pk_bf16_f32 v86, v86, v86
    v_lshlrev_b32 v86, 16, v86
    v_add_f32 v86, 0x3727c5ac, v86
    v_cvt_pk_bf16_f32 v86, v86, v86
    v_lshlrev_b32 v86, 16, v86
    v_sqrt_f32 v86, v86
    s_nop 0
    v_cvt_pk_bf16_f32 v86, v86, v86
    v_lshlrev_b32 v86, 16, v86
    v_rcp_f32 v86, v86
    v_mov_b32 v87, v84
    v_cvt_pk_bf16_f32 v87, v87, v87
    v_lshlrev_b32 v87, 16, v87
    v_sub_f32 v87, v84, v87
    v_mul_f32 v87, v87, v86
    v_pk_fma_f32 v[96:97], v[96:97], v[86:87], v[86:87] op_sel:[0,0,1] op_sel_hi:[1,0,1]
    v_pk_fma_f32 v[98:99], v[98:99], v[86:87], v[86:87] op_sel:[0,0,1] op_sel_hi:[1,0,1]
    v_pk_fma_f32 v[100:101], v[100:101], v[86:87], v[86:87] op_sel:[0,0,1] op_sel_hi:[1,0,1]
    v_pk_fma_f32 v[102:103], v[102:103], v[86:87], v[86:87] op_sel:[0,0,1] op_sel_hi:[1,0,1]
    v_cvt_pk_bf16_f32 v64, v96, v97
    v_cvt_pk_bf16_f32 v65, v98, v99
    v_cvt_pk_bf16_f32 v66, v100, v101
    v_cvt_pk_bf16_f32 v67, v102, v103
    ds_write_b128 v80, v[64:67] offset:0
    v_pk_fma_f32 v[104:105], v[104:105], v[86:87], v[86:87] op_sel:[0,0,1] op_sel_hi:[1,0,1]
    v_pk_fma_f32 v[106:107], v[106:107], v[86:87], v[86:87] op_sel:[0,0,1] op_sel_hi:[1,0,1]
    v_pk_fma_f32 v[108:109], v[108:109], v[86:87], v[86:87] op_sel:[0,0,1] op_sel_hi:[1,0,1]
    v_pk_fma_f32 v[110:111], v[110:111], v[86:87], v[86:87] op_sel:[0,0,1] op_sel_hi:[1,0,1]
    v_cvt_pk_bf16_f32 v68, v104, v105
    v_cvt_pk_bf16_f32 v69, v106, v107
    v_cvt_pk_bf16_f32 v70, v108, v109
    v_cvt_pk_bf16_f32 v71, v110, v111
    ds_write_b128 v80, v[68:71] offset:4096
    v_pk_fma_f32 v[112:113], v[112:113], v[86:87], v[86:87] op_sel:[0,0,1] op_sel_hi:[1,0,1]
    v_pk_fma_f32 v[114:115], v[114:115], v[86:87], v[86:87] op_sel:[0,0,1] op_sel_hi:[1,0,1]
    v_pk_fma_f32 v[116:117], v[116:117], v[86:87], v[86:87] op_sel:[0,0,1] op_sel_hi:[1,0,1]
    v_pk_fma_f32 v[118:119], v[118:119], v[86:87], v[86:87] op_sel:[0,0,1] op_sel_hi:[1,0,1]
    v_cvt_pk_bf16_f32 v72, v112, v113
    v_cvt_pk_bf16_f32 v73, v114, v115
    v_cvt_pk_bf16_f32 v74, v116, v117
    v_cvt_pk_bf16_f32 v75, v118, v119
    ds_write_b128 v80, v[72:75] offset:8192
    v_pk_fma_f32 v[120:121], v[120:121], v[86:87], v[86:87] op_sel:[0,0,1] op_sel_hi:[1,0,1]
    v_pk_fma_f32 v[122:123], v[122:123], v[86:87], v[86:87] op_sel:[0,0,1] op_sel_hi:[1,0,1]
    v_pk_fma_f32 v[124:125], v[124:125], v[86:87], v[86:87] op_sel:[0,0,1] op_sel_hi:[1,0,1]
    v_pk_fma_f32 v[126:127], v[126:127], v[86:87], v[86:87] op_sel:[0,0,1] op_sel_hi:[1,0,1]
    v_cvt_pk_bf16_f32 v76, v120, v121
    v_cvt_pk_bf16_f32 v77, v122, v123
    v_cvt_pk_bf16_f32 v78, v124, v125
    v_cvt_pk_bf16_f32 v79, v126, v127
    ds_write_b128 v80, v[76:79] offset:12288
    s_waitcnt lgkmcnt(0)
    s_barrier
    ds_read_b128 v[96:99], v81 offset:0
    ds_read_b128 v[100:103], v81 offset:4096
    ds_read_b128 v[104:107], v81 offset:8192
    ds_read_b128 v[108:111], v81 offset:12288
    s_waitcnt lgkmcnt(3)
    buffer_store_dwordx4 v[96:99], v82, s[8:11], s60 offen sc1
    s_add_u32 s60, s60, 32768
    s_waitcnt lgkmcnt(2)
    buffer_store_dwordx4 v[100:103], v82, s[8:11], s60 offen sc1
    s_add_u32 s60, s60, 32768
    s_waitcnt lgkmcnt(1)
    buffer_store_dwordx4 v[104:107], v82, s[8:11], s60 offen sc1
    s_add_u32 s60, s60, 32768
    s_waitcnt lgkmcnt(0)
    buffer_store_dwordx4 v[108:111], v82, s[8:11], s60 offen sc1
    s_cmp_eq_u32 s27, 0
    s_cbranch_scc1 L_ln_w0_q
    s_waitcnt vmcnt(0)
    s_barrier
    s_add_u32 m0, s26, 73728
    s_nop 0
    global_load_lds_dwordx4 v2, s[12:13] offset:0
    v_add_u32 v2, 393216, v2
    global_load_lds_dwordx4 v3, s[12:13] offset:1024
    v_add_u32 v3, 393216, v3
    global_load_lds_dwordx4 v4, s[12:13] offset:2048
    v_add_u32 v4, 393216, v4
    global_load_lds_dwordx4 v5, s[12:13] offset:3072
    v_add_u32 v5, 393216, v5
    s_add_u32 m0, s26, 77824
    s_nop 0
    global_load_lds_dwordx4 v6, s[12:13] offset:0
    v_add_u32 v6, 393216, v6
    global_load_lds_dwordx4 v7, s[12:13] offset:1024
    v_add_u32 v7, 393216, v7
    s_add_u32 m0, s26, 98304
    s_nop 0
    global_load_lds_dwordx4 v2, s[12:13] offset:0
    v_add_u32 v2, 393216, v2
    global_load_lds_dwordx4 v3, s[12:13] offset:1024
    v_add_u32 v3, 393216, v3
    global_load_lds_dwordx4 v4, s[12:13] offset:2048
    v_add_u32 v4, 393216, v4
    global_load_lds_dwordx4 v5, s[12:13] offset:3072
    v_add_u32 v5, 393216, v5
    s_add_u32 m0, s26, 102400
    s_nop 0
    global_load_lds_dwordx4 v6, s[12:13] offset:0
    v_add_u32 v6, 393216, v6
    global_load_lds_dwordx4 v7, s[12:13] offset:1024
    v_add_u32 v7, 393216, v7
    s_add_u32 m0, s26, 0
    s_nop 0
    global_load_lds_dwordx4 v2, s[12:13] offset:0
    v_add_u32 v2, 393216, v2
    global_load_lds_dwordx4 v3, s[12:13] offset:1024
    v_add_u32 v3, 393216, v3
    global_load_lds_dwordx4 v4, s[12:13] offset:2048
    v_add_u32 v4, 393216, v4
    global_load_lds_dwordx4 v5, s[12:13] offset:3072
    v_add_u32 v5, 393216, v5
    s_add_u32 m0, s26, 4096
    s_nop 0
    global_load_lds_dwordx4 v6, s[12:13] offset:0
    v_add_u32 v6, 393216, v6
    global_load_lds_dwordx4 v7, s[12:13] offset:1024
    v_add_u32 v7, 393216, v7
    v_lshl_add_u32 v24, v11, 3, v12
    v_mul_u32_u24 v24, 384, v24
    v_lshl_add_u32 v24, v13, 3, v24
    v_and_b32 v25, 1, v11
    v_lshlrev_b32 v25, 1, v25
    v_lshrrev_b32 v26, 1, v12
    v_or_b32 v25, v25, v26
    v_xor_b32 v26, 0, v25
    v_lshl_add_u32 v14, v26, 5, v24
    v_add_u32 v18, 73728, v14
    v_xor_b32 v26, 1, v25
    v_lshl_add_u32 v15, v26, 5, v24
    v_add_u32 v19, 73728, v15
    v_xor_b32 v26, 2, v25
    v_lshl_add_u32 v16, v26, 5, v24
    v_add_u32 v20, 73728, v16
    v_xor_b32 v26, 3, v25
    v_lshl_add_u32 v17, v26, 5, v24
    v_add_u32 v21, 73728, v17
    v_lshl_add_u32 v24, v11, 2, v12
    v_lshlrev_b32 v22, 6, v24
    v_lshl_add_u32 v22, v13, 3, v22
    v_add_u32 v22, 122880, v22
    v_mul_u32_u24 v8, 144, v24
    v_lshl_add_u32 v8, v13, 4, v8
    v_and_b32 v24, 15, v10
    v_mul_u32_u24 v9, 144, v24
    v_lshl_add_u32 v9, v11, 4, v9
    s_mul_i32 s30, s27, 9216
    v_add_u32 v9, s30, v9
    v_add_u32 v23, 73728, v9
    s_branch L_ln_wait_q
L_ln_w0_q:
    v_and_b32 v85, 7, v10
    v_lshlrev_b32 v85, 5, v85
L_ln_lead_q:
    buffer_load_dword v84, v85, s[44:47], 0 offen sc1
    s_waitcnt vmcnt(0)
    v_cmp_gt_u32 vcc, 1, v84
    s_nop 0
    s_cbranch_vccnz L_ln_lead_q
    s_barrier
    s_and_b32 s30, s57, 31
    s_lshr_b32 s31, s30, 4
    s_lshl_b32 s31, s31, 7
    s_and_b32 s30, s30, 15
    s_lshl_b32 s30, s30, 2
    s_add_u32 s30, s30, s31
    s_lshl_b32 s60, s28, 9
    s_add_u32 s60, s60, 28323840
    s_add_u32 s30, s30, s60
    v_mov_b32 v84, 1
    v_lshlrev_b32 v85, 8, v10
    s_mov_b64 exec, 1
    buffer_store_dword v84, v85, s[8:11], s30 offen sc1
    s_mov_b64 exec, -1
    s_and_b32 s30, s2, 0
    s_lshl_b32 s30, s30, 8
    s_add_u32 s60, s60, s30
    v_bfe_u32 v85, v10, 3, 2
    v_and_b32 v86, 7, v10
    v_lshlrev_b32 v86, 2, v86
    v_lshl_add_u32 v85, v85, 7, v86
    s_add_u32 m0, s26, 73728
    s_nop 0
    global_load_lds_dwordx4 v2, s[12:13] offset:0
    v_add_u32 v2, 393216, v2
    global_load_lds_dwordx4 v3, s[12:13] offset:1024
    v_add_u32 v3, 393216, v3
    global_load_lds_dwordx4 v4, s[12:13] offset:2048
    v_add_u32 v4, 393216, v4
    global_load_lds_dwordx4 v5, s[12:13] offset:3072
    v_add_u32 v5, 393216, v5
    s_add_u32 m0, s26, 77824
    s_nop 0
    global_load_lds_dwordx4 v6, s[12:13] offset:0
    v_add_u32 v6, 393216, v6
    global_load_lds_dwordx4 v7, s[12:13] offset:1024
    v_add_u32 v7, 393216, v7
    s_add_u32 m0, s26, 98304
    s_nop 0
    global_load_lds_dwordx4 v2, s[12:13] offset:0
    v_add_u32 v2, 393216, v2
    global_load_lds_dwordx4 v3, s[12:13] offset:1024
    v_add_u32 v3, 393216, v3
    global_load_lds_dwordx4 v4, s[12:13] offset:2048
    v_add_u32 v4, 393216, v4
    global_load_lds_dwordx4 v5, s[12:13] offset:3072
    v_add_u32 v5, 393216, v5
    s_add_u32 m0, s26, 102400
    s_nop 0
    global_load_lds_dwordx4 v6, s[12:13] offset:0
    v_add_u32 v6, 393216, v6
    global_load_lds_dwordx4 v7, s[12:13] offset:1024
    v_add_u32 v7, 393216, v7
    s_add_u32 m0, s26, 0
    s_nop 0
    global_load_lds_dwordx4 v2, s[12:13] offset:0
    v_add_u32 v2, 393216, v2
    global_load_lds_dwordx4 v3, s[12:13] offset:1024
    v_add_u32 v3, 393216, v3
    global_load_lds_dwordx4 v4, s[12:13] offset:2048
    v_add_u32 v4, 393216, v4
    global_load_lds_dwordx4 v5, s[12:13] offset:3072
    v_add_u32 v5, 393216, v5
    s_add_u32 m0, s26, 4096
    s_nop 0
    global_load_lds_dwordx4 v6, s[12:13] offset:0
    v_add_u32 v6, 393216, v6
    global_load_lds_dwordx4 v7, s[12:13] offset:1024
    v_add_u32 v7, 393216, v7
    v_lshl_add_u32 v24, v11, 3, v12
    v_mul_u32_u24 v24, 384, v24
    v_lshl_add_u32 v24, v13, 3, v24
    v_and_b32 v25, 1, v11
    v_lshlrev_b32 v25, 1, v25
    v_lshrrev_b32 v26, 1, v12
    v_or_b32 v25, v25, v26
    v_xor_b32 v26, 0, v25
    v_lshl_add_u32 v14, v26, 5, v24
    v_add_u32 v18, 73728, v14
    v_xor_b32 v26, 1, v25
    v_lshl_add_u32 v15, v26, 5, v24
    v_add_u32 v19, 73728, v15
    v_xor_b32 v26, 2, v25
    v_lshl_add_u32 v16, v26, 5, v24
    v_add_u32 v20, 73728, v16
    v_xor_b32 v26, 3, v25
    v_lshl_add_u32 v17, v26, 5, v24
    v_add_u32 v21, 73728, v17
    v_lshl_add_u32 v24, v11, 2, v12
    v_lshlrev_b32 v22, 6, v24
    v_lshl_add_u32 v22, v13, 3, v22
    v_add_u32 v22, 122880, v22
    v_mul_u32_u24 v8, 144, v24
    v_lshl_add_u32 v8, v13, 4, v8
    v_and_b32 v24, 15, v10
    v_mul_u32_u24 v9, 144, v24
    v_lshl_add_u32 v9, v11, 4, v9
    s_mul_i32 s30, s27, 9216
    v_add_u32 v9, s30, v9
    v_add_u32 v23, 73728, v9
    s_add_u32 s61, s60, 128
    s_mov_b32 s100, 0
L_ln_poll_q:
    s_load_dwordx16 s[68:83], s[8:9], s60 glc
    s_load_dwordx16 s[84:99], s[8:9], s61 glc
    s_waitcnt lgkmcnt(0)
    s_and_b64 s[68:69], s[68:69], s[84:85]
    s_and_b64 s[70:71], s[70:71], s[86:87]
    s_and_b64 s[72:73], s[72:73], s[88:89]
    s_and_b64 s[74:75], s[74:75], s[90:91]
    s_and_b64 s[76:77], s[76:77], s[92:93]
    s_and_b64 s[78:79], s[78:79], s[94:95]
    s_and_b64 s[80:81], s[80:81], s[96:97]
    s_and_b64 s[82:83], s[82:83], s[98:99]
    s_and_b64 s[68:69], s[68:69], s[76:77]
    s_and_b64 s[70:71], s[70:71], s[78:79]
    s_and_b64 s[72:73], s[72:73], s[80:81]
    s_and_b64 s[74:75], s[74:75], s[82:83]
    s_and_b64 s[68:69], s[68:69], s[72:73]
    s_and_b64 s[70:71], s[70:71], s[74:75]
    s_and_b64 s[68:69], s[68:69], s[70:71]
    s_and_b32 s68, s68, s69
    s_cbranch_scc1 L_ln_out_q
    s_sleep 0
    s_branch L_ln_poll_q
L_ln_out_q:
L_ln_wait_q:
    s_barrier
    global_load_dwordx4 a[0:3], v63, s[8:9] offset:0 sc1
    global_load_dwordx4 a[4:7], v63, s[8:9] offset:1024 sc1
    global_load_dwordx4 a[8:11], v63, s[8:9] offset:2048 sc1
    global_load_dwordx4 a[12:15], v63, s[8:9] offset:3072 sc1
    v_add_u32 v63, 0x1000, v63
    global_load_dwordx4 a[16:19], v63, s[8:9] offset:0 sc1
    global_load_dwordx4 a[20:23], v63, s[8:9] offset:1024 sc1
    global_load_dwordx4 a[24:27], v63, s[8:9] offset:2048 sc1
    global_load_dwordx4 a[28:31], v63, s[8:9] offset:3072 sc1
    v_add_u32 v63, 0x1000, v63
    global_load_dwordx4 a[32:35], v63, s[8:9] offset:0 sc1
    global_load_dwordx4 a[36:39], v63, s[8:9] offset:1024 sc1
    global_load_dwordx4 a[40:43], v63, s[8:9] offset:2048 sc1
    global_load_dwordx4 a[44:47], v63, s[8:9] offset:3072 sc1
    v_add_u32 v63, 0x1000, v63
    global_load_dwordx4 a[48:51], v63, s[8:9] offset:0 sc1
    global_load_dwordx4 a[52:55], v63, s[8:9] offset:1024 sc1
    global_load_dwordx4 a[56:59], v63, s[8:9] offset:2048 sc1
    global_load_dwordx4 a[60:63], v63, s[8:9] offset:3072 sc1
    v_add_u32 v63, 0x1000, v63
    RT 160,22,0
    RT 162,22,1024
    RT 164,22,32
    RT 166,22,1056
    RT 168,22,2048
    RT 170,22,3072
    RT 172,22,2080
    RT 174,22,3104
    RT 128,14,49152
    RT 130,14,50688
    RT 132,15,49152
    RT 134,15,50688
    RT 136,16,49152
    RT 138,16,50688
    s_waitcnt vmcnt(12) lgkmcnt(4)
    v_mfma_f32_16x16x32_bf16 v[64:67], a[128:131], a[0:3], 0
    RT 140,17,49152
    v_mfma_f32_16x16x32_bf16 v[68:71], a[128:131], a[4:7], 0
    RT 142,17,50688
    v_mfma_f32_16x16x32_bf16 v[72:75], a[128:131], a[8:11], 0
    global_load_dwordx4 a[64:67], v63, s[8:9] offset:0 sc1
    v_mfma_f32_16x16x32_bf16 v[76:79], a[128:131], a[12:15], 0
    s_waitcnt lgkmcnt(4)
    v_mfma_f32_16x16x32_bf16 v[92:95], a[132:135], a[12:15], 0
    RT 128,14,49280
    v_mfma_f32_16x16x32_bf16 v[88:91], a[132:135], a[8:11], 0
    RT 130,14,50816
    v_mfma_f32_16x16x32_bf16 v[84:87], a[132:135], a[4:7], 0
    global_load_dwordx4 a[68:71], v63, s[8:9] offset:1024 sc1
    v_mfma_f32_16x16x32_bf16 v[80:83], a[132:135], a[0:3], 0
    s_mov_b64 exec, 0xffff
    buffer_load_dword v29, v28, s[12:15], s65 offen
    s_mov_b64 exec, -1
    s_add_u32 s65, s65, 786432
    s_waitcnt lgkmcnt(4)
    v_mfma_f32_16x16x32_bf16 v[96:99], a[136:139], a[0:3], 0
    RT 132,15,49280
    v_mfma_f32_16x16x32_bf16 v[100:103], a[136:139], a[4:7], 0
    RT 134,15,50816
    v_mfma_f32_16x16x32_bf16 v[104:107], a[136:139], a[8:11], 0
    global_load_dwordx4 a[72:75], v63, s[8:9] offset:2048 sc1
    v_mfma_f32_16x16x32_bf16 v[108:111], a[136:139], a[12:15], 0
    s_waitcnt lgkmcnt(4)
    v_mfma_f32_16x16x32_bf16 v[124:127], a[140:143], a[12:15], 0
    RT 136,16,49280
    v_mfma_f32_16x16x32_bf16 v[120:123], a[140:143], a[8:11], 0
    RT 138,16,50816
    v_mfma_f32_16x16x32_bf16 v[116:119], a[140:143], a[4:7], 0
    global_load_dwordx4 a[76:79], v63, s[8:9] offset:3072 sc1
    v_mfma_f32_16x16x32_bf16 v[112:115], a[140:143], a[0:3], 0
    v_add_u32 v63, 0x1000, v63
    s_waitcnt lgkmcnt(4)
    v_mfma_f32_16x16x32_bf16 v[128:131], a[128:131], a[0:3], 0
    RT 140,17,49280
    v_mfma_f32_16x16x32_bf16 v[132:135], a[128:131], a[4:7], 0
    RT 142,17,50816
    v_mfma_f32_16x16x32_bf16 v[136:139], a[128:131], a[8:11], 0
    global_load_dwordx4 a[80:83], v63, s[8:9] offset:0 sc1
    v_mfma_f32_16x16x32_bf16 v[140:143], a[128:131], a[12:15], 0
    s_mov_b64 exec, 0xffff
    buffer_load_dword v29, v28, s[12:15], s65 offen
    s_mov_b64 exec, -1
    s_add_u32 s65, s65, 786432
    s_waitcnt lgkmcnt(4)
    v_mfma_f32_16x16x32_bf16 v[156:159], a[132:135], a[12:15], 0
    RT 128,14,49408
    v_mfma_f32_16x16x32_bf16 v[152:155], a[132:135], a[8:11], 0
    RT 130,14,50944
    v_mfma_f32_16x16x32_bf16 v[148:151], a[132:135], a[4:7], 0
    global_load_dwordx4 a[84:87], v63, s[8:9] offset:1024 sc1
    v_mfma_f32_16x16x32_bf16 v[144:147], a[132:135], a[0:3], 0
    s_waitcnt lgkmcnt(4)
    v_mfma_f32_16x16x32_bf16 v[160:163], a[136:139], a[0:3], 0
    RT 132,15,49408
    v_mfma_f32_16x16x32_bf16 v[164:167], a[136:139], a[4:7], 0
    RT 134,15,50944
    v_mfma_f32_16x16x32_bf16 v[168:171], a[136:139], a[8:11], 0
    global_load_dwordx4 a[88:91], v63, s[8:9] offset:2048 sc1
    v_mfma_f32_16x16x32_bf16 v[172:175], a[136:139], a[12:15], 0
    s_waitcnt lgkmcnt(4)
    v_mfma_f32_16x16x32_bf16 v[188:191], a[140:143], a[12:15], 0
    RT 136,16,49408
    v_mfma_f32_16x16x32_bf16 v[184:187], a[140:143], a[8:11], 0
    RT 138,16,50944
    v_mfma_f32_16x16x32_bf16 v[180:183], a[140:143], a[4:7], 0
    global_load_dwordx4 a[92:95], v63, s[8:9] offset:3072 sc1
    v_mfma_f32_16x16x32_bf16 v[176:179], a[140:143], a[0:3], 0
    v_add_u32 v63, 0x1000, v63
    s_mov_b64 exec, 0xffff
    buffer_load_dword v29, v28, s[12:15], s65 offen
    s_mov_b64 exec, -1
    s_add_u32 s65, s65, 786432
    s_waitcnt lgkmcnt(4)
    v_mfma_f32_16x16x32_bf16 v[192:195], a[128:131], a[0:3], 0
    RT 140,17,49408
    v_mfma_f32_16x16x32_bf16 v[196:199], a[128:131], a[4:7], 0
    RT 142,17,50944
    s_add_u32 m0, s26, 24576
    v_mfma_f32_16x16x32_bf16 v[200:203], a[128:131], a[8:11], 0
    global_load_lds_dwordx4 v2, s[12:13] offset:0
    v_mfma_f32_16x16x32_bf16 v[204:207], a[128:131], a[12:15], 0
    v_add_u32 v2, 393216, v2
    s_waitcnt lgkmcnt(4)
    v_mfma_f32_16x16x32_bf16 v[220:223], a[132:135], a[12:15], 0
    RT 128,14,61440
    v_mfma_f32_16x16x32_bf16 v[216:219], a[132:135], a[8:11], 0
    RT 130,14,62976
    v_mfma_f32_16x16x32_bf16 v[212:215], a[132:135], a[4:7], 0
    v_mfma_f32_16x16x32_bf16 v[208:211], a[132:135], a[0:3], 0
    s_waitcnt lgkmcnt(4)
    v_mfma_f32_16x16x32_bf16 v[224:227], a[136:139], a[0:3], 0
    RT 132,15,61440
    v_mfma_f32_16x16x32_bf16 v[228:231], a[136:139], a[4:7], 0
    RT 134,15,62976
    v_mfma_f32_16x16x32_bf16 v[232:235], a[136:139], a[8:11], 0
    global_load_lds_dwordx4 v3, s[12:13] offset:1024
    v_mfma_f32_16x16x32_bf16 v[236:239], a[136:139], a[12:15], 0
    v_add_u32 v3, 393216, v3
    s_waitcnt lgkmcnt(4)
    v_mfma_f32_16x16x32_bf16 v[252:255], a[140:143], a[12:15], 0
    RT 136,16,61440
    v_mfma_f32_16x16x32_bf16 v[248:251], a[140:143], a[8:11], 0
    RT 138,16,62976
    v_mfma_f32_16x16x32_bf16 v[244:247], a[140:143], a[4:7], 0
    global_load_lds_dwordx4 v4, s[12:13] offset:2048
    v_mfma_f32_16x16x32_bf16 v[240:243], a[140:143], a[0:3], 0
    v_add_u32 v4, 393216, v4
    s_waitcnt vmcnt(22) lgkmcnt(4)
    s_barrier
    MV 64,128,16
    RT 140,17,61440
    MV 68,128,20
    RT 142,17,62976
    MV 72,128,24
    global_load_lds_dwordx4 v5, s[12:13] offset:3072
    MV 76,128,28
    v_add_u32 v5, 393216, v5
    s_waitcnt lgkmcnt(4)
    MV 92,132,28
    RT 128,14,61568
    MV 88,132,24
    RT 130,14,63104
    MV 84,132,20
    MV 80,132,16
    s_waitcnt lgkmcnt(4)
    MV 96,136,16
    RT 132,15,61568
    MV 100,136,20
    RT 134,15,63104
    s_add_u32 m0, s26, 28672
    MV 104,136,24
    global_load_lds_dwordx4 v6, s[12:13] offset:0
    MV 108,136,28
    v_add_u32 v6, 393216, v6
    s_waitcnt lgkmcnt(4)
    MV 124,140,28
    RT 136,16,61568
    MV 120,140,24
    RT 138,16,63104
    MV 116,140,20
    MV 112,140,16
    s_waitcnt lgkmcnt(4)
    MV 128,128,16
    RT 140,17,61568
    MV 132,128,20
    RT 142,17,63104
    MV 136,128,24
    global_load_lds_dwordx4 v7, s[12:13] offset:1024
    MV 140,128,28
    v_add_u32 v7, 393216, v7
    s_waitcnt lgkmcnt(4)
    MV 156,132,28
    RT 128,14,61696
    MV 152,132,24
    RT 130,14,63232
    MV 148,132,20
    global_load_dwordx4 a[96:99], v63, s[8:9] offset:0 sc1
    MV 144,132,16
    s_waitcnt lgkmcnt(4)
    MV 160,136,16
    RT 132,15,61696
    MV 164,136,20
    RT 134,15,63232
    MV 168,136,24
    MV 172,136,28
    s_waitcnt lgkmcnt(4)
    MV 188,140,28
    RT 136,16,61696
    MV 184,140,24
    RT 138,16,63232
    MV 180,140,20
    global_load_dwordx4 a[100:103], v63, s[8:9] offset:1024 sc1
    MV 176,140,16
    s_waitcnt lgkmcnt(4)
    MV 192,128,16
    RT 140,17,61696
    MV 196,128,20
    RT 142,17,63232
    MV 200,128,24
    global_load_dwordx4 a[104:107], v63, s[8:9] offset:2048 sc1
    MV 204,128,28
    s_waitcnt lgkmcnt(4)
    MV 220,132,28
    RT 128,18,0
    MV 216,132,24
    RT 130,18,1536
    MV 212,132,20
    MV 208,132,16
    s_waitcnt lgkmcnt(4)
    MV 224,136,16
    RT 132,19,0
    MV 228,136,20
    RT 134,19,1536
    MV 232,136,24
    global_load_dwordx4 a[108:111], v63, s[8:9] offset:3072 sc1
    MV 236,136,28
    v_add_u32 v63, 0x1000, v63
    s_waitcnt lgkmcnt(4)
    s_barrier
    MV 252,140,28
    RT 136,20,0
    MV 248,140,24
    RT 138,20,1536
    MV 244,140,20
    MV 240,140,16
    s_waitcnt vmcnt(25) lgkmcnt(4)
    MV 64,128,32
    RT 140,21,0
    MV 68,128,36
    RT 142,21,1536
    MV 72,128,40
    global_load_dwordx4 a[112:115], v63, s[8:9] offset:0 sc1
    MV 76,128,44
    s_waitcnt lgkmcnt(4)
    MV 92,132,44
    RT 128,18,128
    MV 88,132,40
    RT 130,18,1664
    MV 84,132,36
    global_load_dwordx4 a[116:119], v63, s[8:9] offset:1024 sc1
    MV 80,132,32
    s_waitcnt lgkmcnt(4)
    MV 96,136,32
    RT 132,19,128
    MV 100,136,36
    RT 134,19,1664
    MV 104,136,40
    global_load_dwordx4 a[120:123], v63, s[8:9] offset:2048 sc1
    MV 108,136,44
    s_waitcnt lgkmcnt(4)
    MV 124,140,44
    RT 136,20,128
    MV 120,140,40
    RT 138,20,1664
    MV 116,140,36
    global_load_dwordx4 a[124:127], v63, s[8:9] offset:3072 sc1
    MV 112,140,32
    v_add_u32 v63, 0x1000, v63
    s_waitcnt lgkmcnt(4)
    MV 128,128,32
    RT 140,21,128
    MV 132,128,36
    RT 142,21,1664
    s_add_u32 m0, s26, 49152
    MV 136,128,40
    global_load_lds_dwordx4 v2, s[12:13] offset:0
    MV 140,128,44
    v_add_u32 v2, 393216, v2
    s_waitcnt lgkmcnt(4)
    MV 156,132,44
    RT 128,18,256
    MV 152,132,40
    RT 130,18,1792
    MV 148,132,36
    MV 144,132,32
    s_waitcnt lgkmcnt(4)
    MV 160,136,32
    RT 132,19,256
    MV 164,136,36
    RT 134,19,1792
    MV 168,136,40
    global_load_lds_dwordx4 v3, s[12:13] offset:1024
    MV 172,136,44
    v_add_u32 v3, 393216, v3
    s_waitcnt lgkmcnt(4)
    MV 188,140,44
    RT 136,20,256
    MV 184,140,40
    RT 138,20,1792
    MV 180,140,36
    global_load_lds_dwordx4 v4, s[12:13] offset:2048
    MV 176,140,32
    v_add_u32 v4, 393216, v4
    s_waitcnt lgkmcnt(4)
    MV 192,128,32
    RT 140,21,256
    MV 196,128,36
    RT 142,21,1792
    MV 200,128,40
    MV 204,128,44
    s_waitcnt lgkmcnt(4)
    MV 220,132,44
    RT 128,18,12288
    MV 216,132,40
    RT 130,18,13824
    MV 212,132,36
    global_load_lds_dwordx4 v5, s[12:13] offset:3072
    MV 208,132,32
    v_add_u32 v5, 393216, v5
    s_waitcnt lgkmcnt(4)
    MV 224,136,32
    RT 132,19,12288
    MV 228,136,36
    RT 134,19,13824
    MV 232,136,40
    MV 236,136,44
    s_waitcnt lgkmcnt(4)
    MV 252,140,44
    RT 136,20,12288
    MV 248,140,40
    RT 138,20,13824
    s_add_u32 m0, s26, 53248
    MV 244,140,36
    global_load_lds_dwordx4 v6, s[12:13] offset:0
    MV 240,140,32
    v_add_u32 v6, 393216, v6
    s_waitcnt vmcnt(30) lgkmcnt(4)
    MV 64,128,48
    RT 140,21,12288
    MV 68,128,52
    RT 142,21,13824
    MV 72,128,56
    global_load_lds_dwordx4 v7, s[12:13] offset:1024
    MV 76,128,60
    v_add_u32 v7, 393216, v7
    s_waitcnt lgkmcnt(4)
    MV 92,132,60
    RT 128,18,12416
    MV 88,132,56
    RT 130,18,13952
    MV 84,132,52
    MV 80,132,48
    s_waitcnt lgkmcnt(4)
    MV 96,136,48
    RT 132,19,12416
    MV 100,136,52
    RT 134,19,13952
    MV 104,136,56
    global_load_dwordx4 a[0:3], v63, s[8:9] offset:0 sc1
    MV 108,136,60
    s_waitcnt lgkmcnt(4)
    MV 124,140,60
    RT 136,20,12416
    MV 120,140,56
    RT 138,20,13952
    MV 116,140,52
    global_load_dwordx4 a[4:7], v63, s[8:9] offset:1024 sc1
    MV 112,140,48
    s_waitcnt lgkmcnt(4)
    MV 128,128,48
    RT 140,21,12416
    MV 132,128,52
    RT 142,21,13952
    MV 136,128,56
    MV 140,128,60
    s_waitcnt lgkmcnt(4)
    MV 156,132,60
    RT 128,18,12544
    MV 152,132,56
    RT 130,18,14080
    MV 148,132,52
    global_load_dwordx4 a[8:11], v63, s[8:9] offset:2048 sc1
    MV 144,132,48
    s_waitcnt lgkmcnt(4)
    MV 160,136,48
    RT 132,19,12544
    MV 164,136,52
    RT 134,19,14080
    MV 168,136,56
    MV 172,136,60
    s_waitcnt lgkmcnt(4)
    MV 188,140,60
    RT 136,20,12544
    MV 184,140,56
    RT 138,20,14080
    MV 180,140,52
    global_load_dwordx4 a[12:15], v63, s[8:9] offset:3072 sc1
    MV 176,140,48
    v_add_u32 v63, 0x1000, v63
    s_waitcnt lgkmcnt(4)
    MV 192,128,48
    RT 140,21,12544
    MV 196,128,52
    RT 142,21,14080
    MV 200,128,56
    global_load_dwordx4 a[16:19], v63, s[8:9] offset:0 sc1
    MV 204,128,60
    s_waitcnt lgkmcnt(4)
    MV 220,132,60
    RT 128,18,24576
    MV 216,132,56
    RT 130,18,26112
    MV 212,132,52
    MV 208,132,48
    s_waitcnt lgkmcnt(4)
    MV 224,136,48
    RT 132,19,24576
    MV 228,136,52
    RT 134,19,26112
    MV 232,136,56
    global_load_dwordx4 a[20:23], v63, s[8:9] offset:1024 sc1
    MV 236,136,60
    s_waitcnt lgkmcnt(4)
    s_barrier
    MV 252,140,60
    RT 136,20,24576
    MV 248,140,56
    RT 138,20,26112
    MV 244,140,52
    global_load_dwordx4 a[24:27], v63, s[8:9] offset:2048 sc1
    MV 240,140,48
    s_waitcnt vmcnt(33) lgkmcnt(4)
    MV 64,128,64
    RT 140,21,24576
    MV 68,128,68
    RT 142,21,26112
    MV 72,128,72
    global_load_dwordx4 a[28:31], v63, s[8:9] offset:3072 sc1
    MV 76,128,76
    v_add_u32 v63, 0x1000, v63
    s_mov_b64 exec, 0xffff
    buffer_load_dword v29, v28, s[12:15], s65 offen
    s_mov_b64 exec, -1
    s_add_u32 s65, s65, 786432
    s_waitcnt lgkmcnt(4)
    MV 92,132,76
    RT 128,18,24704
    MV 88,132,72
    RT 130,18,26240
    MV 84,132,68
    MV 80,132,64
    s_waitcnt lgkmcnt(4)
    MV 96,136,64
    RT 132,19,24704
    MV 100,136,68
    RT 134,19,26240
    s_add_u32 m0, s26, 73728
    MV 104,136,72
    global_load_lds_dwordx4 v2, s[12:13] offset:0
    MV 108,136,76
    v_add_u32 v2, 393216, v2
    s_waitcnt lgkmcnt(4)
    MV 124,140,76
    RT 136,20,24704
    MV 120,140,72
    RT 138,20,26240
    MV 116,140,68
    MV 112,140,64
    s_waitcnt lgkmcnt(4)
    MV 128,128,64
    RT 140,21,24704
    MV 132,128,68
    RT 142,21,26240
    MV 136,128,72
    global_load_lds_dwordx4 v3, s[12:13] offset:1024
    MV 140,128,76
    v_add_u32 v3, 393216, v3
    s_waitcnt lgkmcnt(4)
    MV 156,132,76
    RT 128,18,24832
    MV 152,132,72
    RT 130,18,26368
    MV 148,132,68
    global_load_lds_dwordx4 v4, s[12:13] offset:2048
    MV 144,132,64
    v_add_u32 v4, 393216, v4
    s_waitcnt lgkmcnt(4)
    MV 160,136,64
    RT 132,19,24832
    MV 164,136,68
    RT 134,19,26368
    MV 168,136,72
    MV 172,136,76
    s_waitcnt lgkmcnt(4)
    MV 188,140,76
    RT 136,20,24832
    MV 184,140,72
    RT 138,20,26368
    MV 180,140,68
    global_load_lds_dwordx4 v5, s[12:13] offset:3072
    MV 176,140,64
    v_add_u32 v5, 393216, v5
    s_waitcnt lgkmcnt(4)
    MV 192,128,64
    RT 140,21,24832
    MV 196,128,68
    RT 142,21,26368
    s_add_u32 m0, s26, 77824
    MV 200,128,72
    global_load_lds_dwordx4 v6, s[12:13] offset:0
    MV 204,128,76
    v_add_u32 v6, 393216, v6
    s_waitcnt lgkmcnt(4)
    MV 220,132,76
    RT 128,18,36864
    MV 216,132,72
    RT 130,18,38400
    MV 212,132,68
    MV 208,132,64
    s_waitcnt lgkmcnt(4)
    MV 224,136,64
    RT 132,19,36864
    MV 228,136,68
    RT 134,19,38400
    MV 232,136,72
    global_load_lds_dwordx4 v7, s[12:13] offset:1024
    MV 236,136,76
    v_add_u32 v7, 393216, v7
    s_waitcnt lgkmcnt(4)
    MV 252,140,76
    RT 136,20,36864
    MV 248,140,72
    RT 138,20,38400
    MV 244,140,68
    MV 240,140,64
    s_waitcnt vmcnt(36) lgkmcnt(4)
    MV 64,128,80
    RT 140,21,36864
    MV 68,128,84
    RT 142,21,38400
    MV 72,128,88
    global_load_dwordx4 a[32:35], v63, s[8:9] offset:0 sc1
    MV 76,128,92
    s_waitcnt lgkmcnt(4)
    MV 92,132,92
    RT 128,18,36992
    MV 88,132,88
    RT 130,18,38528
    MV 84,132,84
    global_load_dwordx4 a[36:39], v63, s[8:9] offset:1024 sc1
    MV 80,132,80
    s_waitcnt lgkmcnt(4)
    MV 96,136,80
    RT 132,19,36992
    MV 100,136,84
    RT 134,19,38528
    MV 104,136,88
    MV 108,136,92
    s_waitcnt lgkmcnt(4)
    MV 124,140,92
    RT 136,20,36992
    MV 120,140,88
    RT 138,20,38528
    MV 116,140,84
    global_load_dwordx4 a[40:43], v63, s[8:9] offset:2048 sc1
    MV 112,140,80
    s_waitcnt lgkmcnt(4)
    MV 128,128,80
    RT 140,21,36992
    MV 132,128,84
    RT 142,21,38528
    MV 136,128,88
    global_load_dwordx4 a[44:47], v63, s[8:9] offset:3072 sc1
    MV 140,128,92
    v_add_u32 v63, 0x1000, v63
    s_waitcnt lgkmcnt(4)
    MV 156,132,92
    RT 128,18,37120
    MV 152,132,88
    RT 130,18,38656
    MV 148,132,84
    MV 144,132,80
    s_waitcnt lgkmcnt(4)
    MV 160,136,80
    RT 132,19,37120
    MV 164,136,84
    RT 134,19,38656
    MV 168,136,88
    global_load_dwordx4 a[48:51], v63, s[8:9] offset:0 sc1
    MV 172,136,92
    s_waitcnt lgkmcnt(4)
    MV 188,140,92
    RT 136,20,37120
    MV 184,140,88
    RT 138,20,38656
    MV 180,140,84
    MV 176,140,80
    s_waitcnt lgkmcnt(4)
    MV 192,128,80
    RT 140,21,37120
    MV 196,128,84
    RT 142,21,38656
    MV 200,128,88
    global_load_dwordx4 a[52:55], v63, s[8:9] offset:1024 sc1
    MV 204,128,92
    s_waitcnt lgkmcnt(4)
    MV 220,132,92
    RT 128,14,0
    MV 216,132,88
    RT 130,14,1536
    MV 212,132,84
    global_load_dwordx4 a[56:59], v63, s[8:9] offset:2048 sc1
    MV 208,132,80
    s_waitcnt lgkmcnt(4)
    MV 224,136,80
    RT 132,15,0
    MV 228,136,84
    RT 134,15,1536
    MV 232,136,88
    MV 236,136,92
    s_waitcnt vmcnt(36) lgkmcnt(4)
    s_barrier
    MV 252,140,92
    RT 136,16,0
    MV 248,140,88
    RT 138,16,1536
    MV 244,140,84
    global_load_dwordx4 a[60:63], v63, s[8:9] offset:3072 sc1
    MV 240,140,80
    v_add_u32 v63, 0x1000, v63
    s_waitcnt vmcnt(33) lgkmcnt(4)
    MV 64,128,96
    RT 140,17,0
    MV 68,128,100
    RT 142,17,1536
    s_add_u32 m0, s26, 98304
    MV 72,128,104
    global_load_lds_dwordx4 v2, s[12:13] offset:0
    MV 76,128,108
    v_add_u32 v2, 393216, v2
    s_waitcnt lgkmcnt(4)
    MV 92,132,108
    RT 128,14,128
    MV 88,132,104
    RT 130,14,1664
    MV 84,132,100
    MV 80,132,96
    s_waitcnt lgkmcnt(4)
    MV 96,136,96
    RT 132,15,128
    MV 100,136,100
    RT 134,15,1664
    MV 104,136,104
    global_load_lds_dwordx4 v3, s[12:13] offset:1024
    MV 108,136,108
    v_add_u32 v3, 393216, v3
    s_waitcnt lgkmcnt(4)
    MV 124,140,108
    RT 136,16,128
    MV 120,140,104
    RT 138,16,1664
    MV 116,140,100
    MV 112,140,96
    s_waitcnt lgkmcnt(4)
    MV 128,128,96
    RT 140,17,128
    MV 132,128,100
    RT 142,17,1664
    MV 136,128,104
    global_load_lds_dwordx4 v4, s[12:13] offset:2048
    MV 140,128,108
    v_add_u32 v4, 393216, v4
    s_waitcnt lgkmcnt(4)
    MV 156,132,108
    RT 128,14,256
    MV 152,132,104
    RT 130,14,1792
    MV 148,132,100
    global_load_lds_dwordx4 v5, s[12:13] offset:3072
    MV 144,132,96
    v_add_u32 v5, 393216, v5
    s_waitcnt lgkmcnt(4)
    MV 160,136,96
    RT 132,15,256
    MV 164,136,100
    RT 134,15,1792
    MV 168,136,104
    MV 172,136,108
    s_waitcnt lgkmcnt(4)
    MV 188,140,108
    RT 136,16,256
    MV 184,140,104
    RT 138,16,1792
    s_add_u32 m0, s26, 102400
    MV 180,140,100
    global_load_lds_dwordx4 v6, s[12:13] offset:0
    MV 176,140,96
    v_add_u32 v6, 393216, v6
    s_waitcnt lgkmcnt(4)
    MV 192,128,96
    RT 140,17,256
    MV 196,128,100
    RT 142,17,1792
    MV 200,128,104
    global_load_lds_dwordx4 v7, s[12:13] offset:1024
    MV 204,128,108
    v_add_u32 v7, 393216, v7
    s_waitcnt lgkmcnt(4)
    MV 220,132,108
    RT 128,14,12288
    MV 216,132,104
    RT 130,14,13824
    MV 212,132,100
    MV 208,132,96
    s_waitcnt lgkmcnt(4)
    MV 224,136,96
    RT 132,15,12288
    MV 228,136,100
    RT 134,15,13824
    MV 232,136,104
    global_load_dwordx4 a[64:67], v63, s[8:9] offset:0 sc1
    MV 236,136,108
    s_waitcnt lgkmcnt(4)
    MV 252,140,108
    RT 136,16,12288
    MV 248,140,104
    RT 138,16,13824
    MV 244,140,100
    MV 240,140,96
    s_waitcnt vmcnt(36) lgkmcnt(4)
    MV 64,128,112
    RT 140,17,12288
    MV 68,128,116
    RT 142,17,13824
    MV 72,128,120
    global_load_dwordx4 a[68:71], v63, s[8:9] offset:1024 sc1
    MV 76,128,124
    s_waitcnt lgkmcnt(4)
    MV 92,132,124
    RT 128,14,12416
    MV 88,132,120
    RT 130,14,13952
    MV 84,132,116
    global_load_dwordx4 a[72:75], v63, s[8:9] offset:2048 sc1
    MV 80,132,112
    s_waitcnt lgkmcnt(4)
    MV 96,136,112
    RT 132,15,12416
    MV 100,136,116
    RT 134,15,13952
    MV 104,136,120
    MV 108,136,124
    s_waitcnt lgkmcnt(4)
    MV 124,140,124
    RT 136,16,12416
    MV 120,140,120
    RT 138,16,13952
    MV 116,140,116
    global_load_dwordx4 a[76:79], v63, s[8:9] offset:3072 sc1
    MV 112,140,112
    v_add_u32 v63, 0x1000, v63
    s_waitcnt lgkmcnt(4)
    MV 128,128,112
    RT 140,17,12416
    MV 132,128,116
    RT 142,17,13952
    MV 136,128,120
    global_load_dwordx4 a[80:83], v63, s[8:9] offset:0 sc1
    MV 140,128,124
    s_waitcnt lgkmcnt(4)
    MV 156,132,124
    RT 128,14,12544
    MV 152,132,120
    RT 130,14,14080
    MV 148,132,116
    MV 144,132,112
    s_waitcnt lgkmcnt(4)
    MV 160,136,112
    RT 132,15,12544
    MV 164,136,116
    RT 134,15,14080
    MV 168,136,120
    global_load_dwordx4 a[84:87], v63, s[8:9] offset:1024 sc1
    MV 172,136,124
    s_waitcnt lgkmcnt(4)
    MV 188,140,124
    RT 136,16,12544
    MV 184,140,120
    RT 138,16,14080
    MV 180,140,116
    MV 176,140,112
    s_waitcnt lgkmcnt(4)
    MV 192,128,112
    RT 140,17,12544
    MV 196,128,116
    RT 142,17,14080
    MV 200,128,120
    global_load_dwordx4 a[88:91], v63, s[8:9] offset:2048 sc1
    MV 204,128,124
    s_waitcnt lgkmcnt(4)
    MV 220,132,124
    RT 128,14,24576
    MV 216,132,120
    RT 130,14,26112
    MV 212,132,116
    global_load_dwordx4 a[92:95], v63, s[8:9] offset:3072 sc1
    MV 208,132,112
    v_add_u32 v63, 0x1000, v63
    s_waitcnt lgkmcnt(4)
    MV 224,136,112
    RT 132,15,24576
    MV 228,136,116
    RT 134,15,26112
    MV 232,136,120
    MV 236,136,124
    s_waitcnt vmcnt(37) lgkmcnt(4)
    s_barrier
    MV 252,140,124
    RT 136,16,24576
    MV 248,140,120
    RT 138,16,26112
    s_add_u32 m0, s26, 0
    MV 244,140,116
    global_load_lds_dwordx4 v2, s[12:13] offset:0
    MV 240,140,112
    v_add_u32 v2, 393216, v2
    s_waitcnt vmcnt(34) lgkmcnt(4)
    MV 64,128,0
    RT 140,17,24576
    MV 68,128,4
    RT 142,17,26112
    MV 72,128,8
    global_load_lds_dwordx4 v3, s[12:13] offset:1024
    MV 76,128,12
    v_add_u32 v3, 393216, v3
    s_mov_b64 exec, 0xffff
    buffer_load_dword v29, v28, s[12:15], s65 offen
    s_mov_b64 exec, -1
    s_add_u32 s65, s65, 786432
    s_waitcnt lgkmcnt(4)
    MV 92,132,12
    RT 128,14,24704
    MV 88,132,8
    RT 130,14,26240
    MV 84,132,4
    MV 80,132,0
    s_waitcnt lgkmcnt(4)
    MV 96,136,0
    RT 132,15,24704
    MV 100,136,4
    RT 134,15,26240
    MV 104,136,8
    global_load_lds_dwordx4 v4, s[12:13] offset:2048
    MV 108,136,12
    v_add_u32 v4, 393216, v4
    s_waitcnt lgkmcnt(4)
    MV 124,140,12
    RT 136,16,24704
    MV 120,140,8
    RT 138,16,26240
    MV 116,140,4
    MV 112,140,0
    s_waitcnt lgkmcnt(4)
    MV 128,128,0
    RT 140,17,24704
    MV 132,128,4
    RT 142,17,26240
    MV 136,128,8
    global_load_lds_dwordx4 v5, s[12:13] offset:3072
    MV 140,128,12
    v_add_u32 v5, 393216, v5
    s_waitcnt lgkmcnt(4)
    MV 156,132,12
    RT 128,14,24832
    MV 152,132,8
    RT 130,14,26368
    s_add_u32 m0, s26, 4096
    MV 148,132,4
    global_load_lds_dwordx4 v6, s[12:13] offset:0
    MV 144,132,0
    v_add_u32 v6, 393216, v6
    s_waitcnt lgkmcnt(4)
    MV 160,136,0
    RT 132,15,24832
    MV 164,136,4
    RT 134,15,26368
    MV 168,136,8
    MV 172,136,12
    s_waitcnt lgkmcnt(4)
    MV 188,140,12
    RT 136,16,24832
    MV 184,140,8
    RT 138,16,26368
    MV 180,140,4
    global_load_lds_dwordx4 v7, s[12:13] offset:1024
    MV 176,140,0
    v_add_u32 v7, 393216, v7
    s_waitcnt lgkmcnt(4)
    MV 192,128,0
    RT 140,17,24832
    MV 196,128,4
    RT 142,17,26368
    MV 200,128,8
    global_load_dwordx4 a[96:99], v63, s[8:9] offset:0 sc1
    MV 204,128,12
    s_waitcnt lgkmcnt(4)
    MV 220,132,12
    RT 128,14,36864
    MV 216,132,8
    RT 130,14,38400
    MV 212,132,4
    MV 208,132,0
    s_waitcnt lgkmcnt(4)
    MV 224,136,0
    RT 132,15,36864
    MV 228,136,4
    RT 134,15,38400
    MV 232,136,8
    global_load_dwordx4 a[100:103], v63, s[8:9] offset:1024 sc1
    MV 236,136,12
    s_waitcnt lgkmcnt(4)
    MV 252,140,12
    RT 136,16,36864
    MV 248,140,8
    RT 138,16,38400
    MV 244,140,4
    MV 240,140,0
    s_waitcnt vmcnt(38) lgkmcnt(4)
    MV 64,128,16
    RT 140,17,36864
    MV 68,128,20
    RT 142,17,38400
    MV 72,128,24
    global_load_dwordx4 a[104:107], v63, s[8:9] offset:2048 sc1
    MV 76,128,28
    s_waitcnt lgkmcnt(4)
    MV 92,132,28
    RT 128,14,36992
    MV 88,132,24
    RT 130,14,38528
    MV 84,132,20
    global_load_dwordx4 a[108:111], v63, s[8:9] offset:3072 sc1
    MV 80,132,16
    v_add_u32 v63, 0x1000, v63
    s_waitcnt lgkmcnt(4)
    MV 96,136,16
    RT 132,15,36992
    MV 100,136,20
    RT 134,15,38528
    MV 104,136,24
    MV 108,136,28
    s_waitcnt lgkmcnt(4)
    MV 124,140,28
    RT 136,16,36992
    MV 120,140,24
    RT 138,16,38528
    MV 116,140,20
    global_load_dwordx4 a[112:115], v63, s[8:9] offset:0 sc1
    MV 112,140,16
    s_waitcnt lgkmcnt(4)
    MV 128,128,16
    RT 140,17,36992
    MV 132,128,20
    RT 142,17,38528
    MV 136,128,24
    global_load_dwordx4 a[116:119], v63, s[8:9] offset:1024 sc1
    MV 140,128,28
    s_waitcnt lgkmcnt(4)
    MV 156,132,28
    RT 128,14,37120
    MV 152,132,24
    RT 130,14,38656
    MV 148,132,20
    MV 144,132,16
    s_waitcnt lgkmcnt(4)
    MV 160,136,16
    RT 132,15,37120
    MV 164,136,20
    RT 134,15,38656
    MV 168,136,24
    global_load_dwordx4 a[120:123], v63, s[8:9] offset:2048 sc1
    MV 172,136,28
    s_waitcnt lgkmcnt(4)
    MV 188,140,28
    RT 136,16,37120
    MV 184,140,24
    RT 138,16,38656
    MV 180,140,20
    MV 176,140,16
    s_waitcnt lgkmcnt(4)
    MV 192,128,16
    RT 140,17,37120
    MV 196,128,20
    RT 142,17,38656
    MV 200,128,24
    global_load_dwordx4 a[124:127], v63, s[8:9] offset:3072 sc1
    MV 204,128,28
    v_add_u32 v63, 0x1000, v63
    s_waitcnt lgkmcnt(4)
    MV 220,132,28
    RT 128,14,49152
    MV 216,132,24
    RT 130,14,50688
    MV 212,132,20
    global_load_dwordx4 a[0:3], v63, s[8:9] offset:0 sc1
    MV 208,132,16
    s_waitcnt lgkmcnt(4)
    MV 224,136,16
    RT 132,15,49152
    MV 228,136,20
    RT 134,15,50688
    MV 232,136,24
    MV 236,136,28
    s_waitcnt vmcnt(38) lgkmcnt(4)
    s_barrier
    MV 252,140,28
    RT 136,16,49152
    MV 248,140,24
    RT 138,16,50688
    s_add_u32 m0, s26, 24576
    MV 244,140,20
    global_load_lds_dwordx4 v2, s[12:13] offset:0
    MV 240,140,16
    v_add_u32 v2, 393216, v2
    s_waitcnt vmcnt(35) lgkmcnt(4)
    MV 64,128,32
    RT 140,17,49152
    MV 68,128,36
    RT 142,17,50688
    MV 72,128,40
    global_load_lds_dwordx4 v3, s[12:13] offset:1024
    MV 76,128,44
    v_add_u32 v3, 393216, v3
    s_waitcnt lgkmcnt(4)
    MV 92,132,44
    RT 128,14,49280
    MV 88,132,40
    RT 130,14,50816
    MV 84,132,36
    MV 80,132,32
    s_waitcnt lgkmcnt(4)
    MV 96,136,32
    RT 132,15,49280
    MV 100,136,36
    RT 134,15,50816
    MV 104,136,40
    global_load_lds_dwordx4 v4, s[12:13] offset:2048
    MV 108,136,44
    v_add_u32 v4, 393216, v4
    s_waitcnt lgkmcnt(4)
    MV 124,140,44
    RT 136,16,49280
    MV 120,140,40
    RT 138,16,50816
    MV 116,140,36
    MV 112,140,32
    s_waitcnt lgkmcnt(4)
    MV 128,128,32
    RT 140,17,49280
    MV 132,128,36
    RT 142,17,50816
    MV 136,128,40
    global_load_lds_dwordx4 v5, s[12:13] offset:3072
    MV 140,128,44
    v_add_u32 v5, 393216, v5
    s_waitcnt lgkmcnt(4)
    MV 156,132,44
    RT 128,14,49408
    MV 152,132,40
    RT 130,14,50944
    s_add_u32 m0, s26, 28672
    MV 148,132,36
    global_load_lds_dwordx4 v6, s[12:13] offset:0
    MV 144,132,32
    v_add_u32 v6, 393216, v6
    s_waitcnt lgkmcnt(4)
    MV 160,136,32
    RT 132,15,49408
    MV 164,136,36
    RT 134,15,50944
    MV 168,136,40
    MV 172,136,44
    s_waitcnt lgkmcnt(4)
    MV 188,140,44
    RT 136,16,49408
    MV 184,140,40
    RT 138,16,50944
    MV 180,140,36
    global_load_lds_dwordx4 v7, s[12:13] offset:1024
    MV 176,140,32
    v_add_u32 v7, 393216, v7
    s_waitcnt lgkmcnt(4)
    MV 192,128,32
    RT 140,17,49408
    MV 196,128,36
    RT 142,17,50944
    MV 200,128,40
    global_load_dwordx4 a[4:7], v63, s[8:9] offset:1024 sc1
    MV 204,128,44
    s_waitcnt lgkmcnt(4)
    MV 220,132,44
    RT 128,14,61440
    MV 216,132,40
    RT 130,14,62976
    MV 212,132,36
    MV 208,132,32
    s_waitcnt lgkmcnt(4)
    MV 224,136,32
    RT 132,15,61440
    MV 228,136,36
    RT 134,15,62976
    MV 232,136,40
    global_load_dwordx4 a[8:11], v63, s[8:9] offset:2048 sc1
    MV 236,136,44
    s_waitcnt lgkmcnt(4)
    MV 252,140,44
    RT 136,16,61440
    MV 248,140,40
    RT 138,16,62976
    MV 244,140,36
    MV 240,140,32
    s_waitcnt vmcnt(38) lgkmcnt(4)
    MV 64,128,48
    RT 140,17,61440
    MV 68,128,52
    RT 142,17,62976
    MV 72,128,56
    global_load_dwordx4 a[12:15], v63, s[8:9] offset:3072 sc1
    MV 76,128,60
    v_add_u32 v63, 0x1000, v63
    s_waitcnt lgkmcnt(4)
    MV 92,132,60
    RT 128,14,61568
    MV 88,132,56
    RT 130,14,63104
    MV 84,132,52
    global_load_dwordx4 a[16:19], v63, s[8:9] offset:0 sc1
    MV 80,132,48
    s_waitcnt lgkmcnt(4)
    MV 96,136,48
    RT 132,15,61568
    MV 100,136,52
    RT 134,15,63104
    MV 104,136,56
    MV 108,136,60
    s_waitcnt lgkmcnt(4)
    MV 124,140,60
    RT 136,16,61568
    MV 120,140,56
    RT 138,16,63104
    MV 116,140,52
    global_load_dwordx4 a[20:23], v63, s[8:9] offset:1024 sc1
    MV 112,140,48
    s_waitcnt lgkmcnt(4)
    MV 128,128,48
    RT 140,17,61568
    MV 132,128,52
    RT 142,17,63104
    MV 136,128,56
    global_load_dwordx4 a[24:27], v63, s[8:9] offset:2048 sc1
    MV 140,128,60
    s_waitcnt lgkmcnt(4)
    MV 156,132,60
    RT 128,14,61696
    MV 152,132,56
    RT 130,14,63232
    MV 148,132,52
    MV 144,132,48
    s_waitcnt lgkmcnt(4)
    MV 160,136,48
    RT 132,15,61696
    MV 164,136,52
    RT 134,15,63232
    MV 168,136,56
    global_load_dwordx4 a[28:31], v63, s[8:9] offset:3072 sc1
    MV 172,136,60
    v_add_u32 v63, 0x1000, v63
    s_waitcnt lgkmcnt(4)
    MV 188,140,60
    RT 136,16,61696
    MV 184,140,56
    RT 138,16,63232
    MV 180,140,52
    MV 176,140,48
    s_waitcnt lgkmcnt(4)
    MV 192,128,48
    RT 140,17,61696
    MV 196,128,52
    RT 142,17,63232
    MV 200,128,56
    global_load_dwordx4 a[32:35], v63, s[8:9] offset:0 sc1
    MV 204,128,60
    s_waitcnt lgkmcnt(4)
    MV 220,132,60
    RT 128,18,0
    MV 216,132,56
    RT 130,18,1536
    MV 212,132,52
    global_load_dwordx4 a[36:39], v63, s[8:9] offset:1024 sc1
    MV 208,132,48
    s_waitcnt lgkmcnt(4)
    MV 224,136,48
    RT 132,19,0
    MV 228,136,52
    RT 134,19,1536
    MV 232,136,56
    MV 236,136,60
    s_waitcnt vmcnt(39) lgkmcnt(4)
    s_barrier
    MV 252,140,60
    RT 136,20,0
    MV 248,140,56
    RT 138,20,1536
    s_add_u32 m0, s26, 49152
    MV 244,140,52
    global_load_lds_dwordx4 v2, s[12:13] offset:0
    MV 240,140,48
    v_add_u32 v2, 393216, v2
    s_waitcnt vmcnt(36) lgkmcnt(4)
    MV 64,128,64
    RT 140,21,0
    MV 68,128,68
    RT 142,21,1536
    MV 72,128,72
    global_load_lds_dwordx4 v3, s[12:13] offset:1024
    MV 76,128,76
    v_add_u32 v3, 393216, v3
    s_mov_b64 exec, 0xffff
    buffer_load_dword v29, v28, s[12:15], s65 offen
    s_mov_b64 exec, -1
    s_add_u32 s65, s65, 786432
    s_waitcnt lgkmcnt(4)
    MV 92,132,76
    RT 128,18,128
    MV 88,132,72
    RT 130,18,1664
    MV 84,132,68
    MV 80,132,64
    s_waitcnt lgkmcnt(4)
    MV 96,136,64
    RT 132,19,128
    MV 100,136,68
    RT 134,19,1664
    MV 104,136,72
    global_load_lds_dwordx4 v4, s[12:13] offset:2048
    MV 108,136,76
    v_add_u32 v4, 393216, v4
    s_waitcnt lgkmcnt(4)
    MV 124,140,76
    RT 136,20,128
    MV 120,140,72
    RT 138,20,1664
    MV 116,140,68
    MV 112,140,64
    s_waitcnt lgkmcnt(4)
    MV 128,128,64
    RT 140,21,128
    MV 132,128,68
    RT 142,21,1664
    MV 136,128,72
    global_load_lds_dwordx4 v5, s[12:13] offset:3072
    MV 140,128,76
    v_add_u32 v5, 393216, v5
    s_waitcnt lgkmcnt(4)
    MV 156,132,76
    RT 128,18,256
    MV 152,132,72
    RT 130,18,1792
    s_add_u32 m0, s26, 53248
    MV 148,132,68
    global_load_lds_dwordx4 v6, s[12:13] offset:0
    MV 144,132,64
    v_add_u32 v6, 393216, v6
    s_waitcnt lgkmcnt(4)
    MV 160,136,64
    RT 132,19,256
    MV 164,136,68
    RT 134,19,1792
    MV 168,136,72
    MV 172,136,76
    s_waitcnt lgkmcnt(4)
    MV 188,140,76
    RT 136,20,256
    MV 184,140,72
    RT 138,20,1792
    MV 180,140,68
    global_load_lds_dwordx4 v7, s[12:13] offset:1024
    MV 176,140,64
    v_add_u32 v7, 393216, v7
    s_waitcnt lgkmcnt(4)
    MV 192,128,64
    RT 140,21,256
    MV 196,128,68
    RT 142,21,1792
    MV 200,128,72
    global_load_dwordx4 a[40:43], v63, s[8:9] offset:2048 sc1
    MV 204,128,76
    s_waitcnt lgkmcnt(4)
    MV 220,132,76
    RT 128,18,12288
    MV 216,132,72
    RT 130,18,13824
    MV 212,132,68
    MV 208,132,64
    s_waitcnt lgkmcnt(4)
    MV 224,136,64
    RT 132,19,12288
    MV 228,136,68
    RT 134,19,13824
    MV 232,136,72
    global_load_dwordx4 a[44:47], v63, s[8:9] offset:3072 sc1
    MV 236,136,76
    v_add_u32 v63, 0x1000, v63
    s_waitcnt lgkmcnt(4)
    MV 252,140,76
    RT 136,20,12288
    MV 248,140,72
    RT 138,20,13824
    MV 244,140,68
    MV 240,140,64
    s_waitcnt vmcnt(40) lgkmcnt(4)
    MV 64,128,80
    RT 140,21,12288
    MV 68,128,84
    RT 142,21,13824
    MV 72,128,88
    global_load_dwordx4 a[48:51], v63, s[8:9] offset:0 sc1
    MV 76,128,92
    s_waitcnt lgkmcnt(4)
    MV 92,132,92
    RT 128,18,12416
    MV 88,132,88
    RT 130,18,13952
    MV 84,132,84
    global_load_dwordx4 a[52:55], v63, s[8:9] offset:1024 sc1
    MV 80,132,80
    s_waitcnt lgkmcnt(4)
    MV 96,136,80
    RT 132,19,12416
    MV 100,136,84
    RT 134,19,13952
    MV 104,136,88
    MV 108,136,92
    s_waitcnt lgkmcnt(4)
    MV 124,140,92
    RT 136,20,12416
    MV 120,140,88
    RT 138,20,13952
    MV 116,140,84
    global_load_dwordx4 a[56:59], v63, s[8:9] offset:2048 sc1
    MV 112,140,80
    s_waitcnt lgkmcnt(4)
    MV 128,128,80
    RT 140,21,12416
    MV 132,128,84
    RT 142,21,13952
    MV 136,128,88
    global_load_dwordx4 a[60:63], v63, s[8:9] offset:3072 sc1
    MV 140,128,92
    v_add_u32 v63, 0x1000, v63
    s_waitcnt lgkmcnt(4)
    MV 156,132,92
    RT 128,18,12544
    MV 152,132,88
    RT 130,18,14080
    MV 148,132,84
    MV 144,132,80
    s_waitcnt lgkmcnt(4)
    MV 160,136,80
    RT 132,19,12544
    MV 164,136,84
    RT 134,19,14080
    MV 168,136,88
    global_load_dwordx4 a[64:67], v63, s[8:9] offset:0 sc1
    MV 172,136,92
    s_waitcnt lgkmcnt(4)
    MV 188,140,92
    RT 136,20,12544
    MV 184,140,88
    RT 138,20,14080
    MV 180,140,84
    MV 176,140,80
    s_waitcnt lgkmcnt(4)
    MV 192,128,80
    RT 140,21,12544
    MV 196,128,84
    RT 142,21,14080
    MV 200,128,88
    global_load_dwordx4 a[68:71], v63, s[8:9] offset:1024 sc1
    MV 204,128,92
    s_waitcnt lgkmcnt(4)
    MV 220,132,92
    RT 128,18,24576
    MV 216,132,88
    RT 130,18,26112
    MV 212,132,84
    global_load_dwordx4 a[72:75], v63, s[8:9] offset:2048 sc1
    MV 208,132,80
    s_waitcnt lgkmcnt(4)
    MV 224,136,80
    RT 132,19,24576
    MV 228,136,84
    RT 134,19,26112
    MV 232,136,88
    MV 236,136,92
    s_waitcnt vmcnt(40) lgkmcnt(4)
    s_barrier
    MV 252,140,92
    RT 136,20,24576
    MV 248,140,88
    RT 138,20,26112
    s_add_u32 m0, s26, 73728
    MV 244,140,84
    global_load_lds_dwordx4 v2, s[12:13] offset:0
    MV 240,140,80
    v_add_u32 v2, 393216, v2
    s_waitcnt vmcnt(37) lgkmcnt(4)
    MV 64,128,96
    RT 140,21,24576
    MV 68,128,100
    RT 142,21,26112
    MV 72,128,104
    global_load_lds_dwordx4 v3, s[12:13] offset:1024
    MV 76,128,108
    v_add_u32 v3, 393216, v3
    s_waitcnt lgkmcnt(4)
    MV 92,132,108
    RT 128,18,24704
    MV 88,132,104
    RT 130,18,26240
    MV 84,132,100
    MV 80,132,96
    s_waitcnt lgkmcnt(4)
    MV 96,136,96
    RT 132,19,24704
    MV 100,136,100
    RT 134,19,26240
    MV 104,136,104
    global_load_lds_dwordx4 v4, s[12:13] offset:2048
    MV 108,136,108
    v_add_u32 v4, 393216, v4
    s_waitcnt lgkmcnt(4)
    MV 124,140,108
    RT 136,20,24704
    MV 120,140,104
    RT 138,20,26240
    MV 116,140,100
    MV 112,140,96
    s_waitcnt lgkmcnt(4)
    MV 128,128,96
    RT 140,21,24704
    MV 132,128,100
    RT 142,21,26240
    MV 136,128,104
    global_load_lds_dwordx4 v5, s[12:13] offset:3072
    MV 140,128,108
    v_add_u32 v5, 393216, v5
    s_waitcnt lgkmcnt(4)
    MV 156,132,108
    RT 128,18,24832
    MV 152,132,104
    RT 130,18,26368
    s_add_u32 m0, s26, 77824
    MV 148,132,100
    global_load_lds_dwordx4 v6, s[12:13] offset:0
    MV 144,132,96
    v_add_u32 v6, 393216, v6
    s_waitcnt lgkmcnt(4)
    MV 160,136,96
    RT 132,19,24832
    MV 164,136,100
    RT 134,19,26368
    MV 168,136,104
    MV 172,136,108
    s_waitcnt lgkmcnt(4)
    MV 188,140,108
    RT 136,20,24832
    MV 184,140,104
    RT 138,20,26368
    MV 180,140,100
    global_load_lds_dwordx4 v7, s[12:13] offset:1024
    MV 176,140,96
    v_add_u32 v7, 393216, v7
    s_waitcnt lgkmcnt(4)
    MV 192,128,96
    RT 140,21,24832
    MV 196,128,100
    RT 142,21,26368
    MV 200,128,104
    global_load_dwordx4 a[76:79], v63, s[8:9] offset:3072 sc1
    MV 204,128,108
    v_add_u32 v63, 0x1000, v63
    s_waitcnt lgkmcnt(4)
    MV 220,132,108
    RT 128,18,36864
    MV 216,132,104
    RT 130,18,38400
    MV 212,132,100
    MV 208,132,96
    s_waitcnt lgkmcnt(4)
    MV 224,136,96
    RT 132,19,36864
    MV 228,136,100
    RT 134,19,38400
    MV 232,136,104
    global_load_dwordx4 a[80:83], v63, s[8:9] offset:0 sc1
    MV 236,136,108
    s_waitcnt lgkmcnt(4)
    MV 252,140,108
    RT 136,20,36864
    MV 248,140,104
    RT 138,20,38400
    MV 244,140,100
    MV 240,140,96
    s_waitcnt vmcnt(40) lgkmcnt(4)
    MV 64,128,112
    RT 140,21,36864
    MV 68,128,116
    RT 142,21,38400
    MV 72,128,120
    global_load_dwordx4 a[84:87], v63, s[8:9] offset:1024 sc1
    MV 76,128,124
    s_waitcnt lgkmcnt(4)
    MV 92,132,124
    RT 128,18,36992
    MV 88,132,120
    RT 130,18,38528
    MV 84,132,116
    global_load_dwordx4 a[88:91], v63, s[8:9] offset:2048 sc1
    MV 80,132,112
    s_waitcnt lgkmcnt(4)
    MV 96,136,112
    RT 132,19,36992
    MV 100,136,116
    RT 134,19,38528
    MV 104,136,120
    MV 108,136,124
    s_waitcnt lgkmcnt(4)
    MV 124,140,124
    RT 136,20,36992
    MV 120,140,120
    RT 138,20,38528
    MV 116,140,116
    global_load_dwordx4 a[92:95], v63, s[8:9] offset:3072 sc1
    MV 112,140,112
    v_add_u32 v63, 0x1000, v63
    s_waitcnt lgkmcnt(4)
    MV 128,128,112
    RT 140,21,36992
    MV 132,128,116
    RT 142,21,38528
    MV 136,128,120
    global_load_dwordx4 a[96:99], v63, s[8:9] offset:0 sc1
    MV 140,128,124
    s_waitcnt lgkmcnt(4)
    MV 156,132,124
    RT 128,18,37120
    MV 152,132,120
    RT 130,18,38656
    MV 148,132,116
    MV 144,132,112
    s_waitcnt lgkmcnt(4)
    MV 160,136,112
    RT 132,19,37120
    MV 164,136,116
    RT 134,19,38656
    MV 168,136,120
    global_load_dwordx4 a[100:103], v63, s[8:9] offset:1024 sc1
    MV 172,136,124
    s_waitcnt lgkmcnt(4)
    MV 188,140,124
    RT 136,20,37120
    MV 184,140,120
    RT 138,20,38656
    MV 180,140,116
    MV 176,140,112
    s_waitcnt lgkmcnt(4)
    MV 192,128,112
    RT 140,21,37120
    MV 196,128,116
    RT 142,21,38656
    MV 200,128,120
    global_load_dwordx4 a[104:107], v63, s[8:9] offset:2048 sc1
    MV 204,128,124
    s_waitcnt lgkmcnt(4)
    MV 220,132,124
    RT 128,14,0
    MV 216,132,120
    RT 130,14,1536
    MV 212,132,116
    global_load_dwordx4 a[108:111], v63, s[8:9] offset:3072 sc1
    MV 208,132,112
    v_add_u32 v63, 0x1000, v63
    s_waitcnt lgkmcnt(4)
    MV 224,136,112
    RT 132,15,0
    MV 228,136,116
    RT 134,15,1536
    MV 232,136,120
    MV 236,136,124
    s_waitcnt vmcnt(40) lgkmcnt(4)
    s_barrier
    MV 252,140,124
    RT 136,16,0
    MV 248,140,120
    RT 138,16,1536
    s_add_u32 m0, s26, 98304
    MV 244,140,116
    global_load_lds_dwordx4 v2, s[12:13] offset:0
    MV 240,140,112
    v_add_u32 v2, 393216, v2
    s_waitcnt vmcnt(38) lgkmcnt(4)
    MV 64,128,0
    RT 140,17,0
    MV 68,128,4
    RT 142,17,1536
    MV 72,128,8
    global_load_lds_dwordx4 v3, s[12:13] offset:1024
    MV 76,128,12
    v_add_u32 v3, 393216, v3
    s_mov_b64 exec, 0xffff
    buffer_load_dword v29, v28, s[12:15], s65 offen
    s_mov_b64 exec, -1
    s_add_u32 s65, s65, 786432
    s_waitcnt lgkmcnt(4)
    MV 92,132,12
    RT 128,14,128
    MV 88,132,8
    RT 130,14,1664
    MV 84,132,4
    MV 80,132,0
    s_waitcnt lgkmcnt(4)
    MV 96,136,0
    RT 132,15,128
    MV 100,136,4
    RT 134,15,1664
    MV 104,136,8
    global_load_lds_dwordx4 v4, s[12:13] offset:2048
    MV 108,136,12
    v_add_u32 v4, 393216, v4
    s_waitcnt lgkmcnt(4)
    MV 124,140,12
    RT 136,16,128
    MV 120,140,8
    RT 138,16,1664
    MV 116,140,4
    MV 112,140,0
    s_waitcnt lgkmcnt(4)
    MV 128,128,0
    RT 140,17,128
    MV 132,128,4
    RT 142,17,1664
    MV 136,128,8
    global_load_lds_dwordx4 v5, s[12:13] offset:3072
    MV 140,128,12
    v_add_u32 v5, 393216, v5
    s_waitcnt lgkmcnt(4)
    MV 156,132,12
    RT 128,14,256
    MV 152,132,8
    RT 130,14,1792
    s_add_u32 m0, s26, 102400
    MV 148,132,4
    global_load_lds_dwordx4 v6, s[12:13] offset:0
    MV 144,132,0
    v_add_u32 v6, 393216, v6
    s_waitcnt lgkmcnt(4)
    MV 160,136,0
    RT 132,15,256
    MV 164,136,4
    RT 134,15,1792
    MV 168,136,8
    MV 172,136,12
    s_waitcnt lgkmcnt(4)
    MV 188,140,12
    RT 136,16,256
    MV 184,140,8
    RT 138,16,1792
    MV 180,140,4
    global_load_lds_dwordx4 v7, s[12:13] offset:1024
    MV 176,140,0
    v_add_u32 v7, 393216, v7
    s_waitcnt lgkmcnt(4)
    MV 192,128,0
    RT 140,17,256
    MV 196,128,4
    RT 142,17,1792
    MV 200,128,8
    global_load_dwordx4 a[112:115], v63, s[8:9] offset:0 sc1
    MV 204,128,12
    s_waitcnt lgkmcnt(4)
    MV 220,132,12
    RT 128,14,12288
    MV 216,132,8
    RT 130,14,13824
    MV 212,132,4
    MV 208,132,0
    s_waitcnt lgkmcnt(4)
    MV 224,136,0
    RT 132,15,12288
    MV 228,136,4
    RT 134,15,13824
    MV 232,136,8
    global_load_dwordx4 a[116:119], v63, s[8:9] offset:1024 sc1
    MV 236,136,12
    s_waitcnt lgkmcnt(4)
    MV 252,140,12
    RT 136,16,12288
    MV 248,140,8
    RT 138,16,13824
    MV 244,140,4
    MV 240,140,0
    s_waitcnt vmcnt(42) lgkmcnt(4)
    MV 64,128,16
    RT 140,17,12288
    MV 68,128,20
    RT 142,17,13824
    MV 72,128,24
    global_load_dwordx4 a[120:123], v63, s[8:9] offset:2048 sc1
    MV 76,128,28
    s_waitcnt lgkmcnt(4)
    MV 92,132,28
    RT 128,14,12416
    MV 88,132,24
    RT 130,14,13952
    MV 84,132,20
    global_load_dwordx4 a[124:127], v63, s[8:9] offset:3072 sc1
    MV 80,132,16
    v_add_u32 v63, 0x1000, v63
    s_waitcnt lgkmcnt(4)
    MV 96,136,16
    RT 132,15,12416
    MV 100,136,20
    RT 134,15,13952
    MV 104,136,24
    MV 108,136,28
    s_waitcnt lgkmcnt(4)
    MV 124,140,28
    RT 136,16,12416
    MV 120,140,24
    RT 138,16,13952
    MV 116,140,20
    global_load_dwordx4 a[0:3], v63, s[8:9] offset:0 sc1
    MV 112,140,16
    s_waitcnt lgkmcnt(4)
    MV 128,128,16
    RT 140,17,12416
    MV 132,128,20
    RT 142,17,13952
    MV 136,128,24
    global_load_dwordx4 a[4:7], v63, s[8:9] offset:1024 sc1
    MV 140,128,28
    s_waitcnt lgkmcnt(4)
    MV 156,132,28
    RT 128,14,12544
    MV 152,132,24
    RT 130,14,14080
    MV 148,132,20
    MV 144,132,16
    s_waitcnt lgkmcnt(4)
    MV 160,136,16
    RT 132,15,12544
    MV 164,136,20
    RT 134,15,14080
    MV 168,136,24
    global_load_dwordx4 a[8:11], v63, s[8:9] offset:2048 sc1
    MV 172,136,28
    s_waitcnt lgkmcnt(4)
    MV 188,140,28
    RT 136,16,12544
    MV 184,140,24
    RT 138,16,14080
    MV 180,140,20
    MV 176,140,16
    s_waitcnt lgkmcnt(4)
    MV 192,128,16
    RT 140,17,12544
    MV 196,128,20
    RT 142,17,14080
    MV 200,128,24
    global_load_dwordx4 a[12:15], v63, s[8:9] offset:3072 sc1
    MV 204,128,28
    v_add_u32 v63, 0x1000, v63
    s_waitcnt lgkmcnt(4)
    MV 220,132,28
    RT 128,14,24576
    MV 216,132,24
    RT 130,14,26112
    MV 212,132,20
    MV 208,132,16
    s_waitcnt lgkmcnt(4)
    MV 224,136,16
    RT 132,15,24576
    MV 228,136,20
    RT 134,15,26112
    MV 232,136,24
    MV 236,136,28
    s_waitcnt vmcnt(39) lgkmcnt(4)
    s_barrier
    MV 252,140,28
    RT 136,16,24576
    MV 248,140,24
    RT 138,16,26112
    s_add_u32 m0, s26, 0
    MV 244,140,20
    global_load_lds_dwordx4 v2, s[12:13] offset:0
    MV 240,140,16
    v_add_u32 v2, 393216, v2
    s_waitcnt vmcnt(38) lgkmcnt(4)
    MV 64,128,32
    RT 140,17,24576
    MV 68,128,36
    RT 142,17,26112
    MV 72,128,40
    global_load_lds_dwordx4 v3, s[12:13] offset:1024
    MV 76,128,44
    v_add_u32 v3, 393216, v3
    s_waitcnt lgkmcnt(4)
    MV 92,132,44
    RT 128,14,24704
    MV 88,132,40
    RT 130,14,26240
    MV 84,132,36
    MV 80,132,32
    s_waitcnt lgkmcnt(4)
    MV 96,136,32
    RT 132,15,24704
    MV 100,136,36
    RT 134,15,26240
    MV 104,136,40
    global_load_lds_dwordx4 v4, s[12:13] offset:2048
    MV 108,136,44
    v_add_u32 v4, 393216, v4
    s_waitcnt lgkmcnt(4)
    MV 124,140,44
    RT 136,16,24704
    MV 120,140,40
    RT 138,16,26240
    MV 116,140,36
    global_load_lds_dwordx4 v5, s[12:13] offset:3072
    MV 112,140,32
    v_add_u32 v5, 393216, v5
    s_waitcnt lgkmcnt(4)
    MV 128,128,32
    RT 140,17,24704
    MV 132,128,36
    RT 142,17,26240
    MV 136,128,40
    MV 140,128,44
    s_waitcnt lgkmcnt(4)
    MV 156,132,44
    RT 128,14,24832
    MV 152,132,40
    RT 130,14,26368
    s_add_u32 m0, s26, 4096
    MV 148,132,36
    global_load_lds_dwordx4 v6, s[12:13] offset:0
    MV 144,132,32
    v_add_u32 v6, 393216, v6
    s_waitcnt lgkmcnt(4)
    MV 160,136,32
    RT 132,15,24832
    MV 164,136,36
    RT 134,15,26368
    MV 168,136,40
    MV 172,136,44
    s_waitcnt lgkmcnt(4)
    MV 188,140,44
    RT 136,16,24832
    MV 184,140,40
    RT 138,16,26368
    MV 180,140,36
    global_load_lds_dwordx4 v7, s[12:13] offset:1024
    MV 176,140,32
    v_add_u32 v7, 393216, v7
    s_waitcnt lgkmcnt(4)
    MV 192,128,32
    RT 140,17,24832
    MV 196,128,36
    RT 142,17,26368
    MV 200,128,40
    global_load_dwordx4 a[16:19], v63, s[8:9] offset:0 sc1
    MV 204,128,44
    s_waitcnt lgkmcnt(4)
    MV 220,132,44
    RT 128,14,36864
    MV 216,132,40
    RT 130,14,38400
    MV 212,132,36
    MV 208,132,32
    s_waitcnt lgkmcnt(4)
    MV 224,136,32
    RT 132,15,36864
    MV 228,136,36
    RT 134,15,38400
    MV 232,136,40
    global_load_dwordx4 a[20:23], v63, s[8:9] offset:1024 sc1
    MV 236,136,44
    s_waitcnt lgkmcnt(4)
    MV 252,140,44
    RT 136,16,36864
    MV 248,140,40
    RT 138,16,38400
    MV 244,140,36
    global_load_dwordx4 a[24:27], v63, s[8:9] offset:2048 sc1
    MV 240,140,32
    s_waitcnt vmcnt(42) lgkmcnt(4)
    MV 64,128,48
    RT 140,17,36864
    MV 68,128,52
    RT 142,17,38400
    MV 72,128,56
    MV 76,128,60
    s_waitcnt lgkmcnt(4)
    MV 92,132,60
    RT 128,14,36992
    MV 88,132,56
    RT 130,14,38528
    MV 84,132,52
    global_load_dwordx4 a[28:31], v63, s[8:9] offset:3072 sc1
    MV 80,132,48
    v_add_u32 v63, 0x1000, v63
    s_waitcnt lgkmcnt(4)
    MV 96,136,48
    RT 132,15,36992
    MV 100,136,52
    RT 134,15,38528
    MV 104,136,56
    MV 108,136,60
    s_waitcnt lgkmcnt(4)
    MV 124,140,60
    RT 136,16,36992
    MV 120,140,56
    RT 138,16,38528
    MV 116,140,52
    global_load_dwordx4 a[32:35], v63, s[8:9] offset:0 sc1
    MV 112,140,48
    s_waitcnt lgkmcnt(4)
    MV 128,128,48
    RT 140,17,36992
    MV 132,128,52
    RT 142,17,38528
    MV 136,128,56
    global_load_dwordx4 a[36:39], v63, s[8:9] offset:1024 sc1
    MV 140,128,60
    s_waitcnt lgkmcnt(4)
    MV 156,132,60
    RT 128,14,37120
    MV 152,132,56
    RT 130,14,38656
    MV 148,132,52
    MV 144,132,48
    s_waitcnt lgkmcnt(4)
    MV 160,136,48
    RT 132,15,37120
    MV 164,136,52
    RT 134,15,38656
    MV 168,136,56
    global_load_dwordx4 a[40:43], v63, s[8:9] offset:2048 sc1
    MV 172,136,60
    s_waitcnt lgkmcnt(4)
    MV 188,140,60
    RT 136,16,37120
    MV 184,140,56
    RT 138,16,38656
    MV 180,140,52
    global_load_dwordx4 a[44:47], v63, s[8:9] offset:3072 sc1
    MV 176,140,48
    v_add_u32 v63, 0x1000, v63
    s_waitcnt lgkmcnt(4)
    MV 192,128,48
    RT 140,17,37120
    MV 196,128,52
    RT 142,17,38656
    MV 200,128,56
    MV 204,128,60
    s_waitcnt lgkmcnt(4)
    MV 220,132,60
    RT 128,14,49152
    MV 216,132,56
    RT 130,14,50688
    MV 212,132,52
    MV 208,132,48
    s_waitcnt lgkmcnt(4)
    MV 224,136,48
    RT 132,15,49152
    MV 228,136,52
    RT 134,15,50688
    MV 232,136,56
    MV 236,136,60
    s_waitcnt vmcnt(38) lgkmcnt(4)
    s_barrier
    MV 252,140,60
    RT 136,16,49152
    MV 248,140,56
    RT 138,16,50688
    s_add_u32 m0, s26, 24576
    MV 244,140,52
    global_load_lds_dwordx4 v2, s[12:13] offset:0
    MV 240,140,48
    v_add_u32 v2, 393216, v2
    s_waitcnt vmcnt(38) lgkmcnt(4)
    MV 64,128,64
    RT 140,17,49152
    MV 68,128,68
    RT 142,17,50688
    MV 72,128,72
    global_load_lds_dwordx4 v3, s[12:13] offset:1024
    MV 76,128,76
    v_add_u32 v3, 393216, v3
    s_waitcnt lgkmcnt(4)
    MV 92,132,76
    RT 128,14,49280
    MV 88,132,72
    RT 130,14,50816
    MV 84,132,68
    MV 80,132,64
    s_waitcnt lgkmcnt(4)
    MV 96,136,64
    RT 132,15,49280
    MV 100,136,68
    RT 134,15,50816
    MV 104,136,72
    global_load_lds_dwordx4 v4, s[12:13] offset:2048
    MV 108,136,76
    v_add_u32 v4, 393216, v4
    s_waitcnt lgkmcnt(4)
    MV 124,140,76
    RT 136,16,49280
    MV 120,140,72
    RT 138,16,50816
    MV 116,140,68
    global_load_lds_dwordx4 v5, s[12:13] offset:3072
    MV 112,140,64
    v_add_u32 v5, 393216, v5
    s_waitcnt lgkmcnt(4)
    MV 128,128,64
    RT 140,17,49280
    MV 132,128,68
    RT 142,17,50816
    MV 136,128,72
    MV 140,128,76
    s_waitcnt lgkmcnt(4)
    MV 156,132,76
    RT 128,14,49408
    MV 152,132,72
    RT 130,14,50944
    s_add_u32 m0, s26, 28672
    MV 148,132,68
    global_load_lds_dwordx4 v6, s[12:13] offset:0
    MV 144,132,64
    v_add_u32 v6, 393216, v6
    s_waitcnt lgkmcnt(4)
    MV 160,136,64
    RT 132,15,49408
    MV 164,136,68
    RT 134,15,50944
    MV 168,136,72
    MV 172,136,76
    s_waitcnt lgkmcnt(4)
    MV 188,140,76
    RT 136,16,49408
    MV 184,140,72
    RT 138,16,50944
    MV 180,140,68
    global_load_lds_dwordx4 v7, s[12:13] offset:1024
    MV 176,140,64
    v_add_u32 v7, 393216, v7
    s_waitcnt lgkmcnt(4)
    MV 192,128,64
    RT 140,17,49408
    MV 196,128,68
    RT 142,17,50944
    MV 200,128,72
    global_load_dwordx4 a[48:51], v63, s[8:9] offset:0 sc1
    MV 204,128,76
    s_waitcnt lgkmcnt(4)
    MV 220,132,76
    RT 128,14,61440
    MV 216,132,72
    RT 130,14,62976
    MV 212,132,68
    MV 208,132,64
    s_waitcnt lgkmcnt(4)
    MV 224,136,64
    RT 132,15,61440
    MV 228,136,68
    RT 134,15,62976
    MV 232,136,72
    global_load_dwordx4 a[52:55], v63, s[8:9] offset:1024 sc1
    MV 236,136,76
    s_waitcnt lgkmcnt(4)
    MV 252,140,76
    RT 136,16,61440
    MV 248,140,72
    RT 138,16,62976
    MV 244,140,68
    global_load_dwordx4 a[56:59], v63, s[8:9] offset:2048 sc1
    MV 240,140,64
    s_waitcnt vmcnt(42) lgkmcnt(4)
    MV 64,128,80
    RT 140,17,61440
    MV 68,128,84
    RT 142,17,62976
    MV 72,128,88
    MV 76,128,92
    s_waitcnt lgkmcnt(4)
    MV 92,132,92
    RT 128,14,61568
    MV 88,132,88
    RT 130,14,63104
    MV 84,132,84
    global_load_dwordx4 a[60:63], v63, s[8:9] offset:3072 sc1
    MV 80,132,80
    v_add_u32 v63, 0x1000, v63
    s_waitcnt lgkmcnt(4)
    MV 96,136,80
    RT 132,15,61568
    MV 100,136,84
    RT 134,15,63104
    MV 104,136,88
    MV 108,136,92
    s_waitcnt lgkmcnt(4)
    MV 124,140,92
    RT 136,16,61568
    MV 120,140,88
    RT 138,16,63104
    MV 116,140,84
    global_load_dwordx4 a[64:67], v63, s[8:9] offset:0 sc1
    MV 112,140,80
    s_waitcnt lgkmcnt(4)
    MV 128,128,80
    RT 140,17,61568
    MV 132,128,84
    RT 142,17,63104
    MV 136,128,88
    global_load_dwordx4 a[68:71], v63, s[8:9] offset:1024 sc1
    MV 140,128,92
    s_waitcnt lgkmcnt(4)
    MV 156,132,92
    RT 128,14,61696
    MV 152,132,88
    RT 130,14,63232
    MV 148,132,84
    MV 144,132,80
    s_waitcnt lgkmcnt(4)
    MV 160,136,80
    RT 132,15,61696
    MV 164,136,84
    RT 134,15,63232
    MV 168,136,88
    global_load_dwordx4 a[72:75], v63, s[8:9] offset:2048 sc1
    MV 172,136,92
    s_waitcnt lgkmcnt(4)
    MV 188,140,92
    RT 136,16,61696
    MV 184,140,88
    RT 138,16,63232
    MV 180,140,84
    global_load_dwordx4 a[76:79], v63, s[8:9] offset:3072 sc1
    MV 176,140,80
    v_add_u32 v63, 0x1000, v63
    s_waitcnt lgkmcnt(4)
    MV 192,128,80
    RT 140,17,61696
    MV 196,128,84
    RT 142,17,63232
    MV 200,128,88
    MV 204,128,92
    s_waitcnt lgkmcnt(4)
    MV 220,132,92
    RT 128,18,0
    MV 216,132,88
    RT 130,18,1536
    MV 212,132,84
    MV 208,132,80
    s_waitcnt lgkmcnt(4)
    MV 224,136,80
    RT 132,19,0
    MV 228,136,84
    RT 134,19,1536
    MV 232,136,88
    MV 236,136,92
    s_waitcnt vmcnt(36) lgkmcnt(4)
    s_barrier
    MV 252,140,92
    RT 136,20,0
    MV 248,140,88
    RT 138,20,1536
    s_add_u32 m0, s26, 49152
    MV 244,140,84
    global_load_lds_dwordx4 v2, s[12:13] offset:0
    MV 240,140,80
    v_add_u32 v2, 393216, v2
    s_waitcnt lgkmcnt(4)
    MV 64,128,96
    RT 140,21,0
    MV 68,128,100
    RT 142,21,1536
    MV 72,128,104
    global_load_lds_dwordx4 v3, s[12:13] offset:1024
    MV 76,128,108
    v_add_u32 v3, 393216, v3
    s_waitcnt lgkmcnt(4)
    MV 92,132,108
    RT 128,18,128
    MV 88,132,104
    RT 130,18,1664
    MV 84,132,100
    MV 80,132,96
    s_waitcnt lgkmcnt(4)
    MV 96,136,96
    RT 132,19,128
    MV 100,136,100
    RT 134,19,1664
    MV 104,136,104
    global_load_lds_dwordx4 v4, s[12:13] offset:2048
    MV 108,136,108
    v_add_u32 v4, 393216, v4
    s_waitcnt lgkmcnt(4)
    MV 124,140,108
    RT 136,20,128
    MV 120,140,104
    RT 138,20,1664
    MV 116,140,100
    global_load_lds_dwordx4 v5, s[12:13] offset:3072
    MV 112,140,96
    v_add_u32 v5, 393216, v5
    s_waitcnt lgkmcnt(4)
    MV 128,128,96
    RT 140,21,128
    MV 132,128,100
    RT 142,21,1664
    MV 136,128,104
    MV 140,128,108
    s_waitcnt lgkmcnt(4)
    MV 156,132,108
    RT 128,18,256
    MV 152,132,104
    RT 130,18,1792
    s_add_u32 m0, s26, 53248
    MV 148,132,100
    global_load_lds_dwordx4 v6, s[12:13] offset:0
    MV 144,132,96
    v_add_u32 v6, 393216, v6
    s_waitcnt lgkmcnt(4)
    MV 160,136,96
    RT 132,19,256
    MV 164,136,100
    RT 134,19,1792
    MV 168,136,104
    MV 172,136,108
    s_waitcnt lgkmcnt(4)
    MV 188,140,108
    RT 136,20,256
    MV 184,140,104
    RT 138,20,1792
    MV 180,140,100
    global_load_lds_dwordx4 v7, s[12:13] offset:1024
    MV 176,140,96
    v_add_u32 v7, 393216, v7
    s_waitcnt lgkmcnt(4)
    MV 192,128,96
    RT 140,21,256
    MV 196,128,100
    RT 142,21,1792
    MV 200,128,104
    global_load_dwordx4 a[80:83], v63, s[8:9] offset:0 sc1
    MV 204,128,108
    s_waitcnt lgkmcnt(4)
    MV 220,132,108
    RT 128,18,12288
    MV 216,132,104
    RT 130,18,13824
    MV 212,132,100
    MV 208,132,96
    s_waitcnt lgkmcnt(4)
    MV 224,136,96
    RT 132,19,12288
    MV 228,136,100
    RT 134,19,13824
    MV 232,136,104
    global_load_dwordx4 a[84:87], v63, s[8:9] offset:1024 sc1
    MV 236,136,108
    s_waitcnt lgkmcnt(4)
    MV 252,140,108
    RT 136,20,12288
    MV 248,140,104
    RT 138,20,13824
    MV 244,140,100
    global_load_dwordx4 a[88:91], v63, s[8:9] offset:2048 sc1
    MV 240,140,96
    s_waitcnt vmcnt(41) lgkmcnt(4)
    MV 64,128,112
    RT 140,21,12288
    MV 68,128,116
    RT 142,21,13824
    MV 72,128,120
    MV 76,128,124
    s_waitcnt lgkmcnt(4)
    MV 92,132,124
    RT 128,18,12416
    MV 88,132,120
    RT 130,18,13952
    MV 84,132,116
    global_load_dwordx4 a[92:95], v63, s[8:9] offset:3072 sc1
    MV 80,132,112
    v_add_u32 v63, 0x1000, v63
    s_waitcnt lgkmcnt(4)
    MV 96,136,112
    RT 132,19,12416
    MV 100,136,116
    RT 134,19,13952
    MV 104,136,120
    MV 108,136,124
    s_waitcnt lgkmcnt(4)
    MV 124,140,124
    RT 136,20,12416
    MV 120,140,120
    RT 138,20,13952
    MV 116,140,116
    global_load_dwordx4 a[96:99], v63, s[8:9] offset:0 sc1
    MV 112,140,112
    s_waitcnt lgkmcnt(4)
    MV 128,128,112
    RT 140,21,12416
    MV 132,128,116
    RT 142,21,13952
    MV 136,128,120
    global_load_dwordx4 a[100:103], v63, s[8:9] offset:1024 sc1
    MV 140,128,124
    s_waitcnt lgkmcnt(4)
    MV 156,132,124
    RT 128,18,12544
    MV 152,132,120
    RT 130,18,14080
    MV 148,132,116
    MV 144,132,112
    s_waitcnt lgkmcnt(4)
    MV 160,136,112
    RT 132,19,12544
    MV 164,136,116
    RT 134,19,14080
    MV 168,136,120
    global_load_dwordx4 a[104:107], v63, s[8:9] offset:2048 sc1
    MV 172,136,124
    s_waitcnt lgkmcnt(4)
    MV 188,140,124
    RT 136,20,12544
    MV 184,140,120
    RT 138,20,14080
    MV 180,140,116
    global_load_dwordx4 a[108:111], v63, s[8:9] offset:3072 sc1
    MV 176,140,112
    v_add_u32 v63, 0x1000, v63
    s_waitcnt lgkmcnt(4)
    MV 192,128,112
    RT 140,21,12544
    MV 196,128,116
    RT 142,21,14080
    MV 200,128,120
    MV 204,128,124
    s_waitcnt lgkmcnt(4)
    MV 220,132,124
    RT 128,18,24576
    MV 216,132,120
    RT 130,18,26112
    MV 212,132,116
    MV 208,132,112
    s_waitcnt lgkmcnt(4)
    MV 224,136,112
    RT 132,19,24576
    MV 228,136,116
    RT 134,19,26112
    MV 232,136,120
    MV 236,136,124
    s_waitcnt vmcnt(36) lgkmcnt(4)
    s_barrier
    MV 252,140,124
    RT 136,20,24576
    MV 248,140,120
    RT 138,20,26112
    MV 244,140,116
    MV 240,140,112
    s_waitcnt lgkmcnt(4)
    MV 64,128,0
    RT 140,21,24576
    MV 68,128,4
    RT 142,21,26112
    MV 72,128,8
    global_load_dwordx4 a[112:115], v63, s[8:9] offset:0 sc1
    MV 76,128,12
    s_waitcnt lgkmcnt(4)
    MV 92,132,12
    RT 128,18,24704
    MV 88,132,8
    RT 130,18,26240
    MV 84,132,4
    global_load_dwordx4 a[116:119], v63, s[8:9] offset:1024 sc1
    MV 80,132,0
    s_waitcnt lgkmcnt(4)
    MV 96,136,0
    RT 132,19,24704
    MV 100,136,4
    RT 134,19,26240
    MV 104,136,8
    MV 108,136,12
    s_waitcnt lgkmcnt(4)
    MV 124,140,12
    RT 136,20,24704
    MV 120,140,8
    RT 138,20,26240
    MV 116,140,4
    global_load_dwordx4 a[120:123], v63, s[8:9] offset:2048 sc1
    MV 112,140,0
    s_waitcnt lgkmcnt(4)
    MV 128,128,0
    RT 140,21,24704
    MV 132,128,4
    RT 142,21,26240
    MV 136,128,8
    global_load_dwordx4 a[124:127], v63, s[8:9] offset:3072 sc1
    MV 140,128,12
    v_add_u32 v63, 0x1000, v63
    s_waitcnt lgkmcnt(4)
    MV 156,132,12
    RT 128,18,24832
    MV 152,132,8
    RT 130,18,26368
    MV 148,132,4
    MV 144,132,0
    s_waitcnt lgkmcnt(4)
    MV 160,136,0
    RT 132,19,24832
    MV 164,136,4
    RT 134,19,26368
    MV 168,136,8
    MV 172,136,12
    s_waitcnt lgkmcnt(4)
    MV 188,140,12
    RT 136,20,24832
    MV 184,140,8
    RT 138,20,26368
    MV 180,140,4
    MV 176,140,0
    s_waitcnt lgkmcnt(4)
    MV 192,128,0
    RT 140,21,24832
    MV 196,128,4
    RT 142,21,26368
    MV 200,128,8
    MV 204,128,12
    s_waitcnt lgkmcnt(4)
    MV 220,132,12
    RT 128,18,36864
    MV 216,132,8
    RT 130,18,38400
    MV 212,132,4
    MV 208,132,0
    global_load_dword v0, v30, s[48:49]
    s_waitcnt lgkmcnt(4)
    MV 224,136,0
    RT 132,19,36864
    MV 228,136,4
    RT 134,19,38400
    MV 232,136,8
    MV 236,136,12
    s_waitcnt lgkmcnt(4)
    MV 252,140,12
    RT 136,20,36864
    MV 248,140,8
    RT 138,20,38400
    MV 244,140,4
    MV 240,140,0
    s_lshr_b32 s30, s2, 1
    s_lshl_b32 s30, s30, 2
    s_add_u32 s30, s30, s27
    s_mul_i32 s31, s30, 7168
    s_mul_i32 s32, s33, 3670016
    s_add_u32 s31, s31, s32
    v_min_u32 v28, 55, v10
    v_lshlrev_b32 v28, 7, v28
    s_mov_b32 s16, s34
    s_mov_b32 s17, s35
    s_mov_b32 s18, 7340032
    s_mov_b32 s19, 0x00020000
    buffer_load_dword v0, v28, s[16:19], s31 offen
    s_waitcnt vmcnt(38) lgkmcnt(4)
    MV 64,128,16
    RT 140,21,36864
    MV 68,128,20
    RT 142,21,38400
    MV 72,128,24
    MV 76,128,28
    s_waitcnt lgkmcnt(4)
    MV 92,132,28
    RT 128,18,36992
    MV 88,132,24
    RT 130,18,38528
    MV 84,132,20
    MV 80,132,16
    s_lshr_b32 s60, s2, 3
    s_lshl_b32 s60, s60, 2
    s_add_u32 s60, s60, s27
    s_lshl_b32 s30, s60, 4
    s_mul_i32 s31, s33, 1536
    s_add_u32 s30, s30, s31
    s_lshl_b32 s31, s30, 11
    s_add_u32 s31, s31, 384
    v_and_b32 v28, 31, v10
    v_lshlrev_b32 v28, 10, v28
    buffer_load_dword v0, v28, s[16:19], s31 offen
    s_waitcnt lgkmcnt(4)
    MV 96,136,16
    RT 132,19,36992
    MV 100,136,20
    RT 134,19,38528
    MV 104,136,24
    MV 108,136,28
    s_waitcnt lgkmcnt(4)
    MV 124,140,28
    RT 136,20,36992
    MV 120,140,24
    RT 138,20,38528
    MV 116,140,20
    MV 112,140,16
    s_lshl_b32 s30, s2, 2
    s_add_u32 s30, s30, s27
    s_lshl_b32 s31, s30, 11
    v_and_b32 v28, 15, v10
    v_lshlrev_b32 v28, 7, v28
    s_mov_b32 s16, s36
    s_mov_b32 s17, s37
    s_mov_b32 s18, 2097152
    buffer_load_dword v0, v28, s[16:19], s31 offen
    s_waitcnt lgkmcnt(4)
    MV 128,128,16
    RT 140,21,36992
    MV 132,128,20
    RT 142,21,38528
    MV 136,128,24
    MV 140,128,28
    s_waitcnt lgkmcnt(4)
    MV 156,132,28
    RT 128,18,37120
    MV 152,132,24
    RT 130,18,38656
    MV 148,132,20
    MV 144,132,16
    s_lshl_b32 s31, s55, 2
    s_add_u32 s31, s31, s27
    s_lshl_b32 s31, s31, 16
    s_lshl_b32 s30, s56, 8
    s_add_u32 s31, s31, s30
    s_lshl_b32 s30, s33, 7
    s_add_u32 s31, s31, s30
    v_and_b32 v28, 31, v10
    v_lshlrev_b32 v28, 11, v28
    buffer_load_dword v0, v28, s[20:23], s31 offen
    s_waitcnt lgkmcnt(4)
    MV 160,136,16
    RT 132,19,37120
    MV 164,136,20
    RT 134,19,38656
    MV 168,136,24
    MV 172,136,28
    s_waitcnt lgkmcnt(4)
    MV 188,140,28
    RT 136,20,37120
    MV 184,140,24
    RT 138,20,38656
    MV 180,140,20
    MV 176,140,16
    s_waitcnt lgkmcnt(4)
    MV 192,128,16
    RT 140,21,37120
    MV 196,128,20
    RT 142,21,38656
    MV 200,128,24
    MV 204,128,28
    s_waitcnt lgkmcnt(4)
    MV 220,132,28
    RT 128,14,128
    MV 216,132,24
    RT 130,14,1664
    MV 212,132,20
    MV 208,132,16
    s_waitcnt lgkmcnt(4)
    MV 224,136,16
    RT 132,14,12416
    MV 228,136,20
    RT 134,14,13952
    MV 232,136,24
    MV 236,136,28
    s_waitcnt vmcnt(17) lgkmcnt(4)
    s_barrier
    MV 252,140,28
    RT 136,14,24704
    MV 248,140,24
    RT 138,14,26240
    MV 244,140,20
    MV 240,140,16
    s_waitcnt lgkmcnt(4)
    MV 128,128,32
    RT 140,14,36992
    MV 132,128,36
    RT 142,14,38528
    MV 136,128,40
    MV 140,128,44
    s_waitcnt lgkmcnt(4)
    MV 140,132,60
    RT 128,14,49280
    MV 136,132,56
    RT 130,14,50816
    MV 132,132,52
    MV 128,132,48
    s_mov_b32 s12, s34
    s_waitcnt lgkmcnt(4)
    MV 128,136,64
    RT 132,14,61568
    MV 132,136,68
    RT 134,14,63104
    MV 136,136,72
    s_mov_b32 s13, s35
    MV 140,136,76
    s_mov_b32 s14, 7340032
    s_waitcnt vmcnt(13) lgkmcnt(4)
    MV 140,140,92
    RT 136,15,128
    MV 136,140,88
    RT 138,15,1664
    MV 132,140,84
    s_lshl_b32 s26, s27, 11
    MV 128,140,80
    s_lshl_b32 s25, s27, 14
    s_waitcnt vmcnt(9) lgkmcnt(4)
    MV 128,128,96
    RT 140,15,12416
    MV 132,128,100
    RT 142,15,13952
    MV 136,128,104
    MV 140,128,108
    s_lshl_b32 s30, s56, 8
    s_waitcnt vmcnt(5) lgkmcnt(4)
    MV 140,132,124
    RT 128,15,24704
    MV 136,132,120
    RT 130,15,26240
    MV 132,132,116
    s_add_u32 s25, s25, s30
    MV 128,132,112
    s_mul_i32 s31, s33, 6881280
    s_waitcnt lgkmcnt(4)
    MV 144,136,32
    RT 132,15,36992
    MV 148,136,36
    RT 134,15,38528
    MV 152,136,40
    s_add_u32 s25, s25, s31
    MV 156,136,44
    s_lshl_b32 s3, s33, 1
    s_waitcnt lgkmcnt(4)
    MV 156,140,60
    RT 136,15,49280
    MV 152,140,56
    RT 138,15,50816
    MV 148,140,52
    MV 144,140,48
    s_sub_u32 s3, 1, s3
    s_waitcnt lgkmcnt(4)
    MV 144,128,64
    RT 140,15,61568
    MV 148,128,68
    RT 142,15,63104
    MV 152,128,72
    s_mul_i32 s3, s3, 458752
    MV 156,128,76
    s_ashr_i32 s58, s3, 4
    s_waitcnt lgkmcnt(4)
    MV 156,132,92
    RT 128,16,128
    MV 152,132,88
    RT 130,16,1664
    MV 148,132,84
    s_lshl_b32 s30, s55, 1
    MV 144,132,80
    s_lshr_b32 s31, s27, 1
    s_waitcnt lgkmcnt(4)
    MV 144,136,96
    RT 132,16,12416
    MV 148,136,100
    RT 134,16,13952
    MV 152,136,104
    MV 156,136,108
    s_add_u32 s30, s30, s31
    s_waitcnt lgkmcnt(4)
    MV 156,140,124
    RT 136,16,24704
    MV 152,140,120
    RT 138,16,26240
    MV 148,140,116
    s_mul_i32 s24, s30, 589824
    MV 144,140,112
    s_and_b32 s31, s27, 1
    s_waitcnt lgkmcnt(4)
    MV 160,128,32
    RT 140,16,36992
    MV 164,128,36
    RT 142,16,38528
    MV 168,128,40
    s_lshl_b32 s31, s31, 11
    MV 172,128,44
    s_add_u32 s24, s24, s31
    s_waitcnt lgkmcnt(4)
    MV 172,132,60
    RT 128,16,49280
    MV 168,132,56
    RT 130,16,50816
    MV 164,132,52
    s_add_u32 s24, s24, 4194304
    MV 160,132,48
    s_add_u32 s42, s24, 458752
    s_waitcnt lgkmcnt(4)
    MV 160,136,64
    RT 132,16,61568
    MV 164,136,68
    RT 134,16,63104
    MV 168,136,72
    MV 172,136,76
    s_mul_i32 s31, s33, 430080
    s_waitcnt lgkmcnt(4)
    MV 172,140,92
    RT 136,17,128
    MV 168,140,88
    RT 138,17,1664
    MV 164,140,84
    s_add_u32 s24, s24, s31
    MV 160,140,80
    s_lshl_b32 s30, s30, 7
    s_waitcnt lgkmcnt(4)
    MV 160,128,96
    RT 140,17,12416
    MV 164,128,100
    RT 142,17,13952
    MV 168,128,104
    s_add_u32 s66, s30, 28311616
    MV 172,128,108
    s_add_u32 s67, s30, 28311552
    s_waitcnt lgkmcnt(4)
    MV 172,132,124
    RT 128,17,24704
    MV 168,132,120
    RT 130,17,26240
    MV 164,132,116
    MV 160,132,112
    s_lshl_b32 s30, s29, 5
    s_waitcnt lgkmcnt(4)
    MV 176,136,32
    RT 132,17,36992
    MV 180,136,36
    RT 134,17,38528
    MV 184,136,40
    s_add_u32 s30, s30, s27
    MV 188,136,44
    s_mul_i32 s60, s30, 4352
    s_waitcnt lgkmcnt(4)
    MV 188,140,60
    RT 136,17,49280
    MV 184,140,56
    RT 138,17,50816
    MV 180,140,52
    s_add_u32 s60, s60, 25165824
    MV 176,140,48
    s_mul_i32 s61, s28, 17408
    s_waitcnt lgkmcnt(4)
    MV 176,128,64
    RT 140,17,61568
    MV 180,128,68
    RT 142,17,63104
    MV 184,128,72
    MV 188,128,76
    s_add_u32 s61, s61, s60
    s_waitcnt lgkmcnt(4)
    MV 188,132,92
    RT 128,14,256
    MV 184,132,88
    RT 130,14,1792
    MV 180,132,84
    s_andn2_b32 s57, s63, 31
    MV 176,132,80
    s_lshl_b32 s30, s29, 2
    s_waitcnt lgkmcnt(4)
    MV 176,136,96
    RT 132,14,12544
    MV 180,136,100
    RT 134,14,14080
    MV 184,136,104
    s_mul_i32 s32, s30, 2304
    MV 188,136,108
    s_add_u32 s32, s32, 27525120
    s_waitcnt lgkmcnt(4)
    MV 188,140,124
    RT 136,14,24832
    MV 184,140,120
    RT 138,14,26368
    MV 180,140,116
    s_mul_i32 s65, s27, 2304
    MV 176,140,112
    s_add_u32 s65, s65, s32
    s_waitcnt lgkmcnt(4)
    MV 192,128,32
    RT 140,14,37120
    MV 196,128,36
    RT 142,14,38656
    MV 200,128,40
    MV 204,128,44
    s_waitcnt lgkmcnt(4)
    MV 204,132,60
    RT 128,14,49408
    s_mov_b32 s4, 1069066811
    MV 200,132,56
    RT 130,14,50944
    MV 196,132,52
    s_mov_b32 s5, 1069066811
    MV 192,132,48
    s_mov_b32 s6, 3216550459
    s_mov_b32 s7, 3216550459
    s_waitcnt lgkmcnt(4)
    MV 192,136,64
    RT 132,14,61696
    v_cvt_pk_bf16_f32 v24, v128, v129
    MV 196,136,68
    RT 134,14,63232
    v_cvt_pk_bf16_f32 v25, v130, v131
    MV 200,136,72
    v_cvt_pk_bf16_f32 v26, v144, v145
    MV 204,136,76
    v_cvt_pk_bf16_f32 v27, v146, v147
    v_cvt_pk_bf16_f32 v28, v160, v161
    s_waitcnt lgkmcnt(4)
    MV 204,140,92
    RT 136,15,256
    v_cvt_pk_bf16_f32 v29, v162, v163
    MV 200,140,88
    RT 138,15,1792
    v_mfma_f32_16x16x32_bf16 v[128:131], a[160:163], v[24:27], 0
    MV 196,140,84
    v_cvt_pk_bf16_f32 v30, v176, v177
    MV 192,140,80
    v_cvt_pk_bf16_f32 v31, v178, v179
    v_mfma_f32_16x16x32_bf16 v[144:147], a[164:167], v[24:27], 0
    s_waitcnt lgkmcnt(4)
    MV 192,128,96
    RT 140,15,12544
    v_cvt_pk_bf16_f32 v32, v132, v133
    MV 196,128,100
    RT 142,15,14080
    v_cvt_pk_bf16_f32 v33, v134, v135
    MV 200,128,104
    v_mfma_f32_16x16x32_bf16 v[160:163], a[168:171], v[28:31], 0
    MV 204,128,108
    v_cvt_pk_bf16_f32 v34, v148, v149
    v_cvt_pk_bf16_f32 v35, v150, v151
    s_waitcnt lgkmcnt(4)
    MV 204,132,124
    RT 128,15,24832
    v_mfma_f32_16x16x32_bf16 v[176:179], a[172:175], v[28:31], 0
    MV 200,132,120
    RT 130,15,26368
    v_cvt_pk_bf16_f32 v36, v164, v165
    MV 196,132,116
    v_cvt_pk_bf16_f32 v37, v166, v167
    MV 192,132,112
    v_mfma_f32_16x16x32_bf16 v[132:135], a[160:163], v[32:35], 0
    v_cvt_pk_bf16_f32 v38, v180, v181
    s_waitcnt lgkmcnt(4)
    MV 208,136,32
    RT 132,15,37120
    v_cvt_pk_bf16_f32 v39, v182, v183
    MV 212,136,36
    RT 134,15,38656
    v_mfma_f32_16x16x32_bf16 v[148:151], a[164:167], v[32:35], 0
    MV 216,136,40
    v_cvt_pk_bf16_f32 v40, v136, v137
    MV 220,136,44
    v_cvt_pk_bf16_f32 v41, v138, v139
    v_mfma_f32_16x16x32_bf16 v[164:167], a[168:171], v[36:39], 0
    s_waitcnt lgkmcnt(4)
    MV 220,140,60
    RT 136,15,49408
    v_cvt_pk_bf16_f32 v42, v152, v153
    MV 216,140,56
    RT 138,15,50944
    v_cvt_pk_bf16_f32 v43, v154, v155
    MV 212,140,52
    v_mfma_f32_16x16x32_bf16 v[180:183], a[172:175], v[36:39], 0
    MV 208,140,48
    v_cvt_pk_bf16_f32 v44, v168, v169
    v_cvt_pk_bf16_f32 v45, v170, v171
    s_waitcnt lgkmcnt(4)
    MV 208,128,64
    RT 140,15,61696
    v_mfma_f32_16x16x32_bf16 v[136:139], a[160:163], v[40:43], 0
    MV 212,128,68
    RT 142,15,63232
    MV 216,128,72
    v_cvt_pk_bf16_f32 v46, v184, v185
    MV 220,128,76
    v_cvt_pk_bf16_f32 v47, v186, v187
    v_mfma_f32_16x16x32_bf16 v[152:155], a[164:167], v[40:43], 0
    s_waitcnt lgkmcnt(4)
    MV 220,132,92
    RT 128,16,256
    v_cvt_pk_bf16_f32 v48, v140, v141
    MV 216,132,88
    RT 130,16,1792
    v_cvt_pk_bf16_f32 v49, v142, v143
    MV 212,132,84
    v_mfma_f32_16x16x32_bf16 v[168:171], a[168:171], v[44:47], 0
    MV 208,132,80
    v_cvt_pk_bf16_f32 v50, v156, v157
    v_cvt_pk_bf16_f32 v51, v158, v159
    s_waitcnt lgkmcnt(4)
    MV 208,136,96
    RT 132,16,12544
    v_mfma_f32_16x16x32_bf16 v[184:187], a[172:175], v[44:47], 0
    MV 212,136,100
    RT 134,16,14080
    v_cvt_pk_bf16_f32 v52, v172, v173
    MV 216,136,104
    v_cvt_pk_bf16_f32 v53, v174, v175
    MV 220,136,108
    v_mfma_f32_16x16x32_bf16 v[140:143], a[160:163], v[48:51], 0
    v_cvt_pk_bf16_f32 v54, v188, v189
    s_waitcnt lgkmcnt(4)
    MV 220,140,124
    RT 136,16,24832
    v_cvt_pk_bf16_f32 v55, v190, v191
    MV 216,140,120
    RT 138,16,26368
    v_mfma_f32_16x16x32_bf16 v[156:159], a[164:167], v[48:51], 0
    MV 212,140,116
    v_mfma_f32_16x16x32_bf16 v[172:175], a[168:171], v[52:55], 0
    MV 208,140,112
    v_mfma_f32_16x16x32_bf16 v[188:191], a[172:175], v[52:55], 0
    v_max3_f32 v2, v128, v129, v130
    s_waitcnt lgkmcnt(4)
    MV 224,128,32
    RT 140,16,37120
    v_max3_f32 v4, v160, v161, v162
    MV 228,128,36
    RT 142,16,38656
    v_max3_f32 v3, -v128, -v129, -v130
    MV 232,128,40
    v_max3_f32 v5, -v160, -v161, -v162
    MV 236,128,44
    v_max3_f32 v2, v2, v131, v144
    v_max3_f32 v4, v4, v163, v176
    s_waitcnt lgkmcnt(4)
    MV 236,132,60
    RT 128,16,49408
    v_max3_f32 v3, v3, -v131, -v144
    MV 232,132,56
    RT 130,16,50944
    v_max3_f32 v5, v5, -v163, -v176
    MV 228,132,52
    v_max3_f32 v2, v2, v145, v146
    MV 224,132,48
    v_max3_f32 v4, v4, v177, v178
    v_max3_f32 v3, v3, -v145, -v146
    s_waitcnt lgkmcnt(4)
    MV 224,136,64
    RT 132,16,61696
    v_max3_f32 v5, v5, -v177, -v178
    MV 228,136,68
    RT 134,16,63232
    v_max_f32 v2, v2, v147
    MV 232,136,72
    v_max_f32 v4, v4, v179
    MV 236,136,76
    v_max_f32_e64 v3, v3, -v147
    v_max_f32_e64 v5, v5, -v179
    s_waitcnt lgkmcnt(4)
    MV 236,140,92
    RT 136,17,256
    v_permlane32_swap_b32 v2, v3
    MV 232,140,88
    RT 138,17,1792
    v_permlane32_swap_b32 v4, v5
    MV 228,140,84
    v_max_f32 v2, v2, v3
    MV 224,140,80
    v_max_f32 v4, v4, v5
    v_mov_b32 v3, v2
    s_waitcnt lgkmcnt(4)
    MV 224,128,96
    RT 140,17,12544
    v_mov_b32 v5, v4
    MV 228,128,100
    RT 142,17,14080
    MV 232,128,104
    v_permlane16_swap_b32 v2, v3
    MV 236,128,108
    v_permlane16_swap_b32 v4, v5
    v_max_f32 v2, v2, v3
    s_waitcnt lgkmcnt(4)
    MV 236,132,124
    RT 128,17,24832
    v_max_f32 v4, v4, v5
    MV 232,132,120
    RT 130,17,26368
    v_mov_b32 v3, v2
    MV 228,132,116
    v_mov_b32 v5, v4
    MV 224,132,112
    v_permlane32_swap_b32 v2, v3
    v_permlane32_swap_b32 v4, v5
    s_waitcnt lgkmcnt(4)
    MV 240,136,32
    RT 132,17,37120
    v_max3_f32 v6, v132, v133, v134
    MV 244,136,36
    RT 134,17,38656
    v_max3_f32 v18, v164, v165, v166
    MV 248,136,40
    v_max3_f32 v7, -v132, -v133, -v134
    MV 252,136,44
    v_max3_f32 v19, -v164, -v165, -v166
    v_max3_f32 v6, v6, v135, v148
    s_waitcnt lgkmcnt(4)
    MV 252,140,60
    RT 136,17,49408
    v_max3_f32 v18, v18, v167, v180
    MV 248,140,56
    RT 138,17,50944
    v_max3_f32 v7, v7, -v135, -v148
    MV 244,140,52
    v_max3_f32 v19, v19, -v167, -v180
    MV 240,140,48
    v_max3_f32 v6, v6, v149, v150
    v_max3_f32 v18, v18, v181, v182
    s_waitcnt lgkmcnt(4)
    MV 240,128,64
    RT 140,17,61696
    v_max3_f32 v7, v7, -v149, -v150
    MV 244,128,68
    RT 142,17,63232
    v_max3_f32 v19, v19, -v181, -v182
    MV 248,128,72
    v_max_f32 v6, v6, v151
    MV 252,128,76
    v_max_f32 v18, v18, v183
    v_max_f32_e64 v7, v7, -v151
    s_waitcnt lgkmcnt(4)
    MV 252,132,92
    RT 128,14,0
    v_max_f32_e64 v19, v19, -v183
    MV 248,132,88
    RT 130,14,1536
    v_permlane32_swap_b32 v6, v7
    MV 244,132,84
    v_permlane32_swap_b32 v18, v19
    MV 240,132,80
    v_max_f32 v6, v6, v7
    v_max_f32 v18, v18, v19
    s_waitcnt lgkmcnt(4)
    MV 240,136,96
    RT 132,14,12288
    v_mov_b32 v7, v6
    MV 244,136,100
    RT 134,14,13824
    v_mov_b32 v19, v18
    MV 248,136,104
    v_permlane16_swap_b32 v6, v7
    MV 252,136,108
    v_permlane16_swap_b32 v18, v19
    v_max_f32 v6, v6, v7
    s_waitcnt lgkmcnt(4)
    MV 252,140,124
    RT 136,14,24576
    v_max_f32 v18, v18, v19
    MV 248,140,120
    RT 138,14,26112
    v_mov_b32 v7, v6
    MV 244,140,116
    v_mov_b32 v19, v18
    MV 240,140,112
    v_permlane32_swap_b32 v6, v7
    v_permlane32_swap_b32 v18, v19
    s_waitcnt lgkmcnt(4)
    MV 64,128,32
    RT 140,14,36864
    MV 68,128,36
    RT 142,14,38400
    MV 72,128,40
    MV 76,128,44
    s_waitcnt lgkmcnt(4)
    MV 76,132,60
    RT 128,14,49152
    v_cvt_pk_bf16_f32 v192, v192, v193
    MV 72,132,56
    RT 130,14,50688
    MV 68,132,52
    v_cvt_pk_bf16_f32 v193, v194, v195
    MV 64,132,48
    v_cvt_pk_bf16_f32 v194, v208, v209
    v_cvt_pk_bf16_f32 v195, v210, v211
    s_waitcnt lgkmcnt(4)
    MV 64,136,64
    RT 132,14,61440
    v_cvt_pk_bf16_f32 v224, v224, v225
    MV 68,136,68
    RT 134,14,62976
    MV 72,136,72
    v_cvt_pk_bf16_f32 v225, v226, v227
    MV 76,136,76
    v_cvt_pk_bf16_f32 v226, v240, v241
    v_cvt_pk_bf16_f32 v227, v242, v243
    s_waitcnt lgkmcnt(4)
    MV 76,140,92
    RT 136,15,0
    v_cvt_pk_bf16_f32 v196, v196, v197
    MV 72,140,88
    RT 138,15,1536
    MV 68,140,84
    v_cvt_pk_bf16_f32 v197, v198, v199
    MV 64,140,80
    v_cvt_pk_bf16_f32 v198, v212, v213
    v_cvt_pk_bf16_f32 v199, v214, v215
    s_waitcnt lgkmcnt(4)
    MV 64,128,96
    RT 140,15,12288
    v_cvt_pk_bf16_f32 v228, v228, v229
    MV 68,128,100
    RT 142,15,13824
    MV 72,128,104
    v_cvt_pk_bf16_f32 v229, v230, v231
    MV 76,128,108
    v_cvt_pk_bf16_f32 v230, v244, v245
    v_cvt_pk_bf16_f32 v231, v246, v247
    s_waitcnt lgkmcnt(4)
    MV 76,132,124
    RT 128,15,24576
    v_cvt_pk_bf16_f32 v200, v200, v201
    MV 72,132,120
    RT 130,15,26112
    MV 68,132,116
    v_cvt_pk_bf16_f32 v201, v202, v203
    MV 64,132,112
    v_cvt_pk_bf16_f32 v202, v216, v217
    v_cvt_pk_bf16_f32 v203, v218, v219
    s_waitcnt lgkmcnt(4)
    MV 80,136,32
    RT 132,15,36864
    v_cvt_pk_bf16_f32 v232, v232, v233
    MV 84,136,36
    RT 134,15,38400
    MV 88,136,40
    v_cvt_pk_bf16_f32 v233, v234, v235
    MV 92,136,44
    v_cvt_pk_bf16_f32 v234, v248, v249
    v_cvt_pk_bf16_f32 v235, v250, v251
    s_waitcnt lgkmcnt(4)
    MV 92,140,60
    RT 136,15,49152
    v_cvt_pk_bf16_f32 v204, v204, v205
    MV 88,140,56
    RT 138,15,50688
    MV 84,140,52
    v_cvt_pk_bf16_f32 v205, v206, v207
    MV 80,140,48
    v_cvt_pk_bf16_f32 v206, v220, v221
    v_cvt_pk_bf16_f32 v207, v222, v223
    s_waitcnt lgkmcnt(4)
    MV 80,128,64
    RT 140,15,61440
    v_cvt_pk_bf16_f32 v236, v236, v237
    MV 84,128,68
    RT 142,15,62976
    MV 88,128,72
    v_cvt_pk_bf16_f32 v237, v238, v239
    MV 92,128,76
    v_cvt_pk_bf16_f32 v238, v252, v253
    v_cvt_pk_bf16_f32 v239, v254, v255
    s_waitcnt lgkmcnt(4)
    MV 92,132,92
    RT 128,16,0
    v_max3_f32 v208, v136, v137, v138
    MV 88,132,88
    RT 130,16,1536
    MV 84,132,84
    v_max3_f32 v210, v168, v169, v170
    MV 80,132,80
    v_max3_f32 v209, -v136, -v137, -v138
    v_max3_f32 v211, -v168, -v169, -v170
    s_waitcnt lgkmcnt(4)
    MV 80,136,96
    RT 132,16,12288
    v_max3_f32 v208, v208, v139, v152
    MV 84,136,100
    RT 134,16,13824
    MV 88,136,104
    v_max3_f32 v210, v210, v171, v184
    MV 92,136,108
    v_max3_f32 v209, v209, -v139, -v152
    v_max3_f32 v211, v211, -v171, -v184
    s_waitcnt lgkmcnt(4)
    MV 92,140,124
    RT 136,16,24576
    v_max3_f32 v208, v208, v153, v154
    MV 88,140,120
    RT 138,16,26112
    MV 84,140,116
    v_max3_f32 v210, v210, v185, v186
    MV 80,140,112
    v_max3_f32 v209, v209, -v153, -v154
    v_max3_f32 v211, v211, -v185, -v186
    s_waitcnt lgkmcnt(4)
    MV 96,128,32
    RT 140,16,36864
    v_max_f32 v208, v208, v155
    MV 100,128,36
    RT 142,16,38400
    MV 104,128,40
    v_max_f32 v210, v210, v187
    MV 108,128,44
    v_max_f32_e64 v209, v209, -v155
    v_max_f32_e64 v211, v211, -v187
    s_waitcnt lgkmcnt(4)
    MV 108,132,60
    RT 128,16,49152
    v_permlane32_swap_b32 v208, v209
    MV 104,132,56
    RT 130,16,50688
    MV 100,132,52
    v_permlane32_swap_b32 v210, v211
    MV 96,132,48
    v_max_f32 v208, v208, v209
    v_max_f32 v210, v210, v211
    s_waitcnt lgkmcnt(4)
    MV 96,136,64
    RT 132,16,61440
    v_mov_b32 v209, v208
    MV 100,136,68
    RT 134,16,62976
    MV 104,136,72
    v_mov_b32 v211, v210
    MV 108,136,76
    v_permlane16_swap_b32 v208, v209
    v_permlane16_swap_b32 v210, v211
    s_waitcnt lgkmcnt(4)
    MV 108,140,92
    RT 136,17,0
    v_max_f32 v208, v208, v209
    MV 104,140,88
    RT 138,17,1536
    MV 100,140,84
    v_max_f32 v210, v210, v211
    MV 96,140,80
    v_mov_b32 v209, v208
    v_mov_b32 v211, v210
    s_waitcnt lgkmcnt(4)
    MV 96,128,96
    RT 140,17,12288
    v_permlane32_swap_b32 v208, v209
    MV 100,128,100
    RT 142,17,13824
    MV 104,128,104
    v_permlane32_swap_b32 v210, v211
    MV 108,128,108
    v_max3_f32 v212, v140, v141, v142
    v_max3_f32 v214, v172, v173, v174
    s_waitcnt lgkmcnt(4)
    MV 108,132,124
    RT 128,17,24576
    v_max3_f32 v213, -v140, -v141, -v142
    MV 104,132,120
    RT 130,17,26112
    MV 100,132,116
    v_max3_f32 v215, -v172, -v173, -v174
    MV 96,132,112
    v_max3_f32 v212, v212, v143, v156
    v_max3_f32 v214, v214, v175, v188
    s_waitcnt lgkmcnt(4)
    MV 112,136,32
    RT 132,17,36864
    v_max3_f32 v213, v213, -v143, -v156
    MV 116,136,36
    RT 134,17,38400
    MV 120,136,40
    v_max3_f32 v215, v215, -v175, -v188
    MV 124,136,44
    v_max3_f32 v212, v212, v157, v158
    v_max3_f32 v214, v214, v189, v190
    s_waitcnt lgkmcnt(4)
    MV 124,140,60
    RT 136,17,49152
    v_max3_f32 v213, v213, -v157, -v158
    MV 120,140,56
    RT 138,17,50688
    MV 116,140,52
    v_max3_f32 v215, v215, -v189, -v190
    MV 112,140,48
    v_max_f32 v212, v212, v159
    v_max_f32 v214, v214, v191
    s_waitcnt lgkmcnt(4)
    MV 112,128,64
    RT 140,17,61440
    v_max_f32_e64 v213, v213, -v159
    MV 116,128,68
    RT 142,17,62976
    MV 120,128,72
    v_max_f32_e64 v215, v215, -v191
    MV 124,128,76
    v_permlane32_swap_b32 v212, v213
    v_permlane32_swap_b32 v214, v215
    s_waitcnt lgkmcnt(4)
    MV 124,132,92
    v_max_f32 v212, v212, v213
    MV 120,132,88
    v_max_f32 v214, v214, v215
    MV 116,132,84
    v_mov_b32 v213, v212
    MV 112,132,80
    v_mov_b32 v215, v214
    s_waitcnt lgkmcnt(2)
    MV 112,136,96
    v_permlane16_swap_b32 v212, v213
    MV 116,136,100
    v_permlane16_swap_b32 v214, v215
    MV 120,136,104
    v_max_f32 v212, v212, v213
    MV 124,136,108
    v_max_f32 v214, v214, v215
    s_waitcnt lgkmcnt(0)
    MV 124,140,124
    v_mov_b32 v213, v212
    MV 120,140,120
    v_mov_b32 v215, v214
    MV 116,140,116
    v_permlane32_swap_b32 v212, v213
    MV 112,140,112
    v_permlane32_swap_b32 v214, v215
    v_pk_mul_f32 v[2:3], v[2:3], s[6:7]
    v_pk_mul_f32 v[4:5], v[4:5], s[6:7]
    v_pk_fma_f32 v[24:25], v[128:129], s[4:5], v[2:3] op_sel_hi:[1,1,0]
    v_pk_fma_f32 v[44:45], v[160:161], s[4:5], v[4:5] op_sel_hi:[1,1,0]
    v_pk_fma_f32 v[26:27], v[130:131], s[4:5], v[2:3] op_sel_hi:[1,1,0]
    v_pk_fma_f32 v[46:47], v[162:163], s[4:5], v[4:5] op_sel_hi:[1,1,0]
    v_pk_fma_f32 v[28:29], v[144:145], s[4:5], v[2:3] op_sel_hi:[1,1,0]
    v_pk_fma_f32 v[48:49], v[176:177], s[4:5], v[4:5] op_sel_hi:[1,1,0]
    v_pk_fma_f32 v[30:31], v[146:147], s[4:5], v[2:3] op_sel_hi:[1,1,0]
    v_pk_fma_f32 v[50:51], v[178:179], s[4:5], v[4:5] op_sel_hi:[1,1,0]
    v_pk_fma_f32 v[32:33], v[128:129], s[6:7], v[2:3] op_sel:[0,0,1] op_sel_hi:[1,1,1]
    v_pk_fma_f32 v[52:53], v[160:161], s[6:7], v[4:5] op_sel:[0,0,1] op_sel_hi:[1,1,1]
    v_pk_fma_f32 v[34:35], v[130:131], s[6:7], v[2:3] op_sel:[0,0,1] op_sel_hi:[1,1,1]
    v_pk_fma_f32 v[54:55], v[162:163], s[6:7], v[4:5] op_sel:[0,0,1] op_sel_hi:[1,1,1]
    v_pk_fma_f32 v[36:37], v[144:145], s[6:7], v[2:3] op_sel:[0,0,1] op_sel_hi:[1,1,1]
    v_pk_fma_f32 v[56:57], v[176:177], s[6:7], v[4:5] op_sel:[0,0,1] op_sel_hi:[1,1,1]
    v_pk_fma_f32 v[38:39], v[146:147], s[6:7], v[2:3] op_sel:[0,0,1] op_sel_hi:[1,1,1]
    v_pk_fma_f32 v[58:59], v[178:179], s[6:7], v[4:5] op_sel:[0,0,1] op_sel_hi:[1,1,1]
    v_exp_f32 v24, v24
    v_exp_f32 v44, v44
    v_exp_f32 v25, v25
    v_exp_f32 v45, v45
    v_exp_f32 v26, v26
    v_exp_f32 v46, v46
    v_exp_f32 v27, v27
    v_exp_f32 v47, v47
    v_exp_f32 v28, v28
    v_exp_f32 v48, v48
    v_exp_f32 v29, v29
    v_exp_f32 v49, v49
    v_exp_f32 v30, v30
    v_exp_f32 v50, v50
    v_exp_f32 v31, v31
    v_exp_f32 v51, v51
    v_exp_f32 v32, v32
    v_exp_f32 v52, v52
    v_exp_f32 v33, v33
    v_exp_f32 v53, v53
    v_exp_f32 v34, v34
    v_exp_f32 v54, v54
    v_exp_f32 v35, v35
    v_exp_f32 v55, v55
    v_exp_f32 v36, v36
    v_exp_f32 v56, v56
    v_exp_f32 v37, v37
    v_exp_f32 v57, v57
    v_exp_f32 v38, v38
    v_exp_f32 v58, v58
    v_exp_f32 v39, v39
    v_exp_f32 v59, v59
    v_pk_add_f32 v[2:3], v[24:25], v[26:27]
    v_pk_add_f32 v[4:5], v[44:45], v[46:47]
    v_pk_add_f32 v[42:43], v[32:33], v[34:35]
    v_pk_add_f32 v[62:63], v[52:53], v[54:55]
    v_pk_add_f32 v[2:3], v[2:3], v[28:29]
    v_pk_add_f32 v[4:5], v[4:5], v[48:49]
    v_pk_add_f32 v[42:43], v[42:43], v[36:37]
    v_pk_add_f32 v[62:63], v[62:63], v[56:57]
    v_pk_add_f32 v[2:3], v[2:3], v[30:31]
    v_pk_add_f32 v[4:5], v[4:5], v[50:51]
    v_pk_add_f32 v[42:43], v[42:43], v[38:39]
    v_pk_add_f32 v[62:63], v[62:63], v[58:59]
    v_add_f32 v2, v2, v3
    v_add_f32 v4, v4, v5
    v_add_f32 v3, v42, v43
    v_add_f32 v5, v62, v63
    s_nop 0
    v_permlane32_swap_b32 v2, v3
    v_permlane32_swap_b32 v4, v5
    v_add_f32 v2, v2, v3
    v_add_f32 v4, v4, v5
    v_mov_b32 v3, v2
    v_mov_b32 v5, v4
    s_nop 0
    v_permlane16_swap_b32 v2, v3
    v_permlane16_swap_b32 v4, v5
    v_add_f32 v2, v2, v3
    v_add_f32 v4, v4, v5
    v_mov_b32 v3, v2
    v_mov_b32 v5, v4
    s_nop 0
    v_permlane32_swap_b32 v2, v3
    v_permlane32_swap_b32 v4, v5
    v_rcp_f32 v2, v2
    v_rcp_f32 v4, v4
    v_rcp_f32 v3, v3
    v_rcp_f32 v5, v5
    v_pk_mul_f32 v[24:25], v[24:25], v[2:3] op_sel_hi:[1,0]
    v_pk_mul_f32 v[44:45], v[44:45], v[4:5] op_sel_hi:[1,0]
    v_pk_mul_f32 v[26:27], v[26:27], v[2:3] op_sel_hi:[1,0]
    v_pk_mul_f32 v[46:47], v[46:47], v[4:5] op_sel_hi:[1,0]
    v_pk_mul_f32 v[28:29], v[28:29], v[2:3] op_sel_hi:[1,0]
    v_pk_mul_f32 v[48:49], v[48:49], v[4:5] op_sel_hi:[1,0]
    v_pk_mul_f32 v[30:31], v[30:31], v[2:3] op_sel_hi:[1,0]
    v_pk_mul_f32 v[50:51], v[50:51], v[4:5] op_sel_hi:[1,0]
    v_pk_mul_f32 v[32:33], v[32:33], v[2:3] op_sel:[0,1] op_sel_hi:[1,1]
    v_pk_mul_f32 v[52:53], v[52:53], v[4:5] op_sel:[0,1] op_sel_hi:[1,1]
    v_pk_mul_f32 v[34:35], v[34:35], v[2:3] op_sel:[0,1] op_sel_hi:[1,1]
    v_pk_mul_f32 v[54:55], v[54:55], v[4:5] op_sel:[0,1] op_sel_hi:[1,1]
    v_pk_mul_f32 v[36:37], v[36:37], v[2:3] op_sel:[0,1] op_sel_hi:[1,1]
    v_pk_mul_f32 v[56:57], v[56:57], v[4:5] op_sel:[0,1] op_sel_hi:[1,1]
    v_pk_mul_f32 v[38:39], v[38:39], v[2:3] op_sel:[0,1] op_sel_hi:[1,1]
    v_pk_mul_f32 v[58:59], v[58:59], v[4:5] op_sel:[0,1] op_sel_hi:[1,1]
    v_cvt_pk_bf16_f32 v128, v24, v25
    v_cvt_pk_bf16_f32 v160, v44, v45
    v_cvt_pk_bf16_f32 v129, v26, v27
    v_cvt_pk_bf16_f32 v161, v46, v47
    v_cvt_pk_bf16_f32 v130, v28, v29
    v_cvt_pk_bf16_f32 v162, v48, v49
    v_cvt_pk_bf16_f32 v131, v30, v31
    v_cvt_pk_bf16_f32 v163, v50, v51
    v_cvt_pk_bf16_f32 v144, v32, v33
    v_cvt_pk_bf16_f32 v176, v52, v53
    v_cvt_pk_bf16_f32 v145, v34, v35
    v_cvt_pk_bf16_f32 v177, v54, v55
    v_cvt_pk_bf16_f32 v146, v36, v37
    v_cvt_pk_bf16_f32 v178, v56, v57
    v_cvt_pk_bf16_f32 v147, v38, v39
    v_cvt_pk_bf16_f32 v179, v58, v59
    ds_write_b128 v23, v[128:131] offset:0
    ds_write_b128 v23, v[160:163] offset:36864
    ds_write_b128 v23, v[144:147] offset:64
    ds_write_b128 v23, v[176:179] offset:36928
    s_barrier
    v_pk_mul_f32 v[6:7], v[6:7], s[6:7]
    ds_write_b128 v9, v[192:195] offset:0
    v_pk_mul_f32 v[18:19], v[18:19], s[6:7]
    v_pk_fma_f32 v[24:25], v[132:133], s[4:5], v[6:7] op_sel_hi:[1,1,0]
    v_pk_fma_f32 v[44:45], v[164:165], s[4:5], v[18:19] op_sel_hi:[1,1,0]
    v_pk_fma_f32 v[26:27], v[134:135], s[4:5], v[6:7] op_sel_hi:[1,1,0]
    v_pk_fma_f32 v[46:47], v[166:167], s[4:5], v[18:19] op_sel_hi:[1,1,0]
    v_pk_fma_f32 v[28:29], v[148:149], s[4:5], v[6:7] op_sel_hi:[1,1,0]
    v_pk_fma_f32 v[48:49], v[180:181], s[4:5], v[18:19] op_sel_hi:[1,1,0]
    v_pk_fma_f32 v[30:31], v[150:151], s[4:5], v[6:7] op_sel_hi:[1,1,0]
    v_pk_fma_f32 v[50:51], v[182:183], s[4:5], v[18:19] op_sel_hi:[1,1,0]
    v_pk_fma_f32 v[32:33], v[132:133], s[6:7], v[6:7] op_sel:[0,0,1] op_sel_hi:[1,1,1]
    v_pk_fma_f32 v[52:53], v[164:165], s[6:7], v[18:19] op_sel:[0,0,1] op_sel_hi:[1,1,1]
    v_pk_fma_f32 v[34:35], v[134:135], s[6:7], v[6:7] op_sel:[0,0,1] op_sel_hi:[1,1,1]
    v_pk_fma_f32 v[54:55], v[166:167], s[6:7], v[18:19] op_sel:[0,0,1] op_sel_hi:[1,1,1]
    v_pk_fma_f32 v[36:37], v[148:149], s[6:7], v[6:7] op_sel:[0,0,1] op_sel_hi:[1,1,1]
    v_pk_fma_f32 v[56:57], v[180:181], s[6:7], v[18:19] op_sel:[0,0,1] op_sel_hi:[1,1,1]
    v_pk_fma_f32 v[38:39], v[150:151], s[6:7], v[6:7] op_sel:[0,0,1] op_sel_hi:[1,1,1]
    v_pk_fma_f32 v[58:59], v[182:183], s[6:7], v[18:19] op_sel:[0,0,1] op_sel_hi:[1,1,1]
    v_exp_f32 v24, v24
    v_exp_f32 v44, v44
    v_exp_f32 v25, v25
    v_exp_f32 v45, v45
    v_exp_f32 v26, v26
    v_exp_f32 v46, v46
    v_exp_f32 v27, v27
    v_exp_f32 v47, v47
    v_exp_f32 v28, v28
    v_exp_f32 v48, v48
    v_exp_f32 v29, v29
    v_exp_f32 v49, v49
    v_exp_f32 v30, v30
    v_exp_f32 v50, v50
    v_exp_f32 v31, v31
    v_exp_f32 v51, v51
    v_exp_f32 v32, v32
    v_exp_f32 v52, v52
    v_exp_f32 v33, v33
    v_exp_f32 v53, v53
    v_exp_f32 v34, v34
    v_exp_f32 v54, v54
    v_exp_f32 v35, v35
    v_exp_f32 v55, v55
    v_exp_f32 v36, v36
    v_exp_f32 v56, v56
    v_exp_f32 v37, v37
    v_exp_f32 v57, v57
    ds_write_b128 v9, v[224:227] offset:64
    v_exp_f32 v38, v38
    v_exp_f32 v58, v58
    v_exp_f32 v39, v39
    v_exp_f32 v59, v59
    v_pk_add_f32 v[6:7], v[24:25], v[26:27]
    v_pk_add_f32 v[18:19], v[44:45], v[46:47]
    v_pk_add_f32 v[42:43], v[32:33], v[34:35]
    v_pk_add_f32 v[62:63], v[52:53], v[54:55]
    v_pk_add_f32 v[6:7], v[6:7], v[28:29]
    v_pk_add_f32 v[18:19], v[18:19], v[48:49]
    v_pk_add_f32 v[42:43], v[42:43], v[36:37]
    v_pk_add_f32 v[62:63], v[62:63], v[56:57]
    v_pk_add_f32 v[6:7], v[6:7], v[30:31]
    v_pk_add_f32 v[18:19], v[18:19], v[50:51]
    v_pk_add_f32 v[42:43], v[42:43], v[38:39]
    v_pk_add_f32 v[62:63], v[62:63], v[58:59]
    v_add_f32 v6, v6, v7
    v_add_f32 v18, v18, v19
    v_add_f32 v7, v42, v43
    v_add_f32 v19, v62, v63
    s_nop 0
    v_permlane32_swap_b32 v6, v7
    v_permlane32_swap_b32 v18, v19
    v_add_f32 v6, v6, v7
    v_add_f32 v18, v18, v19
    v_mov_b32 v7, v6
    v_mov_b32 v19, v18
    s_nop 0
    v_permlane16_swap_b32 v6, v7
    v_permlane16_swap_b32 v18, v19
    v_add_f32 v6, v6, v7
    v_add_f32 v18, v18, v19
    v_mov_b32 v7, v6
    v_mov_b32 v19, v18
    s_nop 0
    v_permlane32_swap_b32 v6, v7
    v_permlane32_swap_b32 v18, v19
    v_rcp_f32 v6, v6
    v_rcp_f32 v18, v18
    v_rcp_f32 v7, v7
    v_rcp_f32 v19, v19
    v_pk_mul_f32 v[24:25], v[24:25], v[6:7] op_sel_hi:[1,0]
    v_pk_mul_f32 v[44:45], v[44:45], v[18:19] op_sel_hi:[1,0]
    v_pk_mul_f32 v[26:27], v[26:27], v[6:7] op_sel_hi:[1,0]
    v_pk_mul_f32 v[46:47], v[46:47], v[18:19] op_sel_hi:[1,0]
    v_pk_mul_f32 v[28:29], v[28:29], v[6:7] op_sel_hi:[1,0]
    v_pk_mul_f32 v[48:49], v[48:49], v[18:19] op_sel_hi:[1,0]
    v_pk_mul_f32 v[30:31], v[30:31], v[6:7] op_sel_hi:[1,0]
    ds_write_b128 v9, v[196:199] offset:2304
    v_pk_mul_f32 v[50:51], v[50:51], v[18:19] op_sel_hi:[1,0]
    v_pk_mul_f32 v[32:33], v[32:33], v[6:7] op_sel:[0,1] op_sel_hi:[1,1]
    v_pk_mul_f32 v[52:53], v[52:53], v[18:19] op_sel:[0,1] op_sel_hi:[1,1]
    v_pk_mul_f32 v[34:35], v[34:35], v[6:7] op_sel:[0,1] op_sel_hi:[1,1]
    v_pk_mul_f32 v[54:55], v[54:55], v[18:19] op_sel:[0,1] op_sel_hi:[1,1]
    v_pk_mul_f32 v[36:37], v[36:37], v[6:7] op_sel:[0,1] op_sel_hi:[1,1]
    v_pk_mul_f32 v[56:57], v[56:57], v[18:19] op_sel:[0,1] op_sel_hi:[1,1]
    v_pk_mul_f32 v[38:39], v[38:39], v[6:7] op_sel:[0,1] op_sel_hi:[1,1]
    v_pk_mul_f32 v[58:59], v[58:59], v[18:19] op_sel:[0,1] op_sel_hi:[1,1]
    v_cvt_pk_bf16_f32 v132, v24, v25
    v_cvt_pk_bf16_f32 v164, v44, v45
    v_cvt_pk_bf16_f32 v133, v26, v27
    v_cvt_pk_bf16_f32 v165, v46, v47
    v_cvt_pk_bf16_f32 v134, v28, v29
    v_cvt_pk_bf16_f32 v166, v48, v49
    v_cvt_pk_bf16_f32 v135, v30, v31
    v_cvt_pk_bf16_f32 v167, v50, v51
    v_cvt_pk_bf16_f32 v148, v32, v33
    v_cvt_pk_bf16_f32 v180, v52, v53
    v_cvt_pk_bf16_f32 v149, v34, v35
    v_cvt_pk_bf16_f32 v181, v54, v55
    v_cvt_pk_bf16_f32 v150, v36, v37
    v_cvt_pk_bf16_f32 v182, v56, v57
    v_cvt_pk_bf16_f32 v151, v38, v39
    v_cvt_pk_bf16_f32 v183, v58, v59
    ds_write_b128 v23, v[132:135] offset:2304
    ds_write_b128 v23, v[164:167] offset:39168
    ds_write_b128 v23, v[148:151] offset:2368
    ds_write_b128 v23, v[180:183] offset:39232
    v_pk_mul_f32 v[208:209], v[208:209], s[6:7]
    v_pk_mul_f32 v[210:211], v[210:211], s[6:7]
    v_pk_fma_f32 v[24:25], v[136:137], s[4:5], v[208:209] op_sel_hi:[1,1,0]
    v_pk_fma_f32 v[44:45], v[168:169], s[4:5], v[210:211] op_sel_hi:[1,1,0]
    v_pk_fma_f32 v[26:27], v[138:139], s[4:5], v[208:209] op_sel_hi:[1,1,0]
    v_pk_fma_f32 v[46:47], v[170:171], s[4:5], v[210:211] op_sel_hi:[1,1,0]
    v_pk_fma_f32 v[28:29], v[152:153], s[4:5], v[208:209] op_sel_hi:[1,1,0]
    v_pk_fma_f32 v[48:49], v[184:185], s[4:5], v[210:211] op_sel_hi:[1,1,0]
    v_pk_fma_f32 v[30:31], v[154:155], s[4:5], v[208:209] op_sel_hi:[1,1,0]
    v_pk_fma_f32 v[50:51], v[186:187], s[4:5], v[210:211] op_sel_hi:[1,1,0]
    v_pk_fma_f32 v[32:33], v[136:137], s[6:7], v[208:209] op_sel:[0,0,1] op_sel_hi:[1,1,1]
    v_pk_fma_f32 v[52:53], v[168:169], s[6:7], v[210:211] op_sel:[0,0,1] op_sel_hi:[1,1,1]
    v_pk_fma_f32 v[34:35], v[138:139], s[6:7], v[208:209] op_sel:[0,0,1] op_sel_hi:[1,1,1]
    v_pk_fma_f32 v[54:55], v[170:171], s[6:7], v[210:211] op_sel:[0,0,1] op_sel_hi:[1,1,1]
    v_pk_fma_f32 v[36:37], v[152:153], s[6:7], v[208:209] op_sel:[0,0,1] op_sel_hi:[1,1,1]
    v_pk_fma_f32 v[56:57], v[184:185], s[6:7], v[210:211] op_sel:[0,0,1] op_sel_hi:[1,1,1]
    ds_write_b128 v9, v[228:231] offset:2368
    v_pk_fma_f32 v[38:39], v[154:155], s[6:7], v[208:209] op_sel:[0,0,1] op_sel_hi:[1,1,1]
    v_pk_fma_f32 v[58:59], v[186:187], s[6:7], v[210:211] op_sel:[0,0,1] op_sel_hi:[1,1,1]
    v_exp_f32 v24, v24
    v_exp_f32 v44, v44
    v_exp_f32 v25, v25
    v_exp_f32 v45, v45
    v_exp_f32 v26, v26
    v_exp_f32 v46, v46
    v_exp_f32 v27, v27
    v_exp_f32 v47, v47
    v_exp_f32 v28, v28
    v_exp_f32 v48, v48
    v_exp_f32 v29, v29
    v_exp_f32 v49, v49
    v_exp_f32 v30, v30
    v_exp_f32 v50, v50
    v_exp_f32 v31, v31
    v_exp_f32 v51, v51
    v_exp_f32 v32, v32
    v_exp_f32 v52, v52
    v_exp_f32 v33, v33
    v_exp_f32 v53, v53
    v_exp_f32 v34, v34
    v_exp_f32 v54, v54
    v_exp_f32 v35, v35
    v_exp_f32 v55, v55
    v_exp_f32 v36, v36
    v_exp_f32 v56, v56
    v_exp_f32 v37, v37
    v_exp_f32 v57, v57
    v_exp_f32 v38, v38
    v_exp_f32 v58, v58
    v_exp_f32 v39, v39
    v_exp_f32 v59, v59
    v_pk_add_f32 v[208:209], v[24:25], v[26:27]
    v_pk_add_f32 v[210:211], v[44:45], v[46:47]
    v_pk_add_f32 v[42:43], v[32:33], v[34:35]
    v_pk_add_f32 v[62:63], v[52:53], v[54:55]
    v_pk_add_f32 v[208:209], v[208:209], v[28:29]
    v_pk_add_f32 v[210:211], v[210:211], v[48:49]
    v_pk_add_f32 v[42:43], v[42:43], v[36:37]
    v_pk_add_f32 v[62:63], v[62:63], v[56:57]
    v_pk_add_f32 v[208:209], v[208:209], v[30:31]
    v_pk_add_f32 v[210:211], v[210:211], v[50:51]
    v_pk_add_f32 v[42:43], v[42:43], v[38:39]
    ds_write_b128 v9, v[200:203] offset:4608
    v_pk_add_f32 v[62:63], v[62:63], v[58:59]
    v_add_f32 v208, v208, v209
    v_add_f32 v210, v210, v211
    v_add_f32 v209, v42, v43
    v_add_f32 v211, v62, v63
    s_nop 0
    v_permlane32_swap_b32 v208, v209
    v_permlane32_swap_b32 v210, v211
    v_add_f32 v208, v208, v209
    v_add_f32 v210, v210, v211
    v_mov_b32 v209, v208
    v_mov_b32 v211, v210
    s_nop 0
    v_permlane16_swap_b32 v208, v209
    v_permlane16_swap_b32 v210, v211
    v_add_f32 v208, v208, v209
    v_add_f32 v210, v210, v211
    v_mov_b32 v209, v208
    v_mov_b32 v211, v210
    s_nop 0
    v_permlane32_swap_b32 v208, v209
    v_permlane32_swap_b32 v210, v211
    v_rcp_f32 v208, v208
    v_rcp_f32 v210, v210
    v_rcp_f32 v209, v209
    v_rcp_f32 v211, v211
    v_pk_mul_f32 v[24:25], v[24:25], v[208:209] op_sel_hi:[1,0]
    v_pk_mul_f32 v[44:45], v[44:45], v[210:211] op_sel_hi:[1,0]
    v_pk_mul_f32 v[26:27], v[26:27], v[208:209] op_sel_hi:[1,0]
    v_pk_mul_f32 v[46:47], v[46:47], v[210:211] op_sel_hi:[1,0]
    v_pk_mul_f32 v[28:29], v[28:29], v[208:209] op_sel_hi:[1,0]
    v_pk_mul_f32 v[48:49], v[48:49], v[210:211] op_sel_hi:[1,0]
    v_pk_mul_f32 v[30:31], v[30:31], v[208:209] op_sel_hi:[1,0]
    v_pk_mul_f32 v[50:51], v[50:51], v[210:211] op_sel_hi:[1,0]
    v_pk_mul_f32 v[32:33], v[32:33], v[208:209] op_sel:[0,1] op_sel_hi:[1,1]
    v_pk_mul_f32 v[52:53], v[52:53], v[210:211] op_sel:[0,1] op_sel_hi:[1,1]
    v_pk_mul_f32 v[34:35], v[34:35], v[208:209] op_sel:[0,1] op_sel_hi:[1,1]
    v_pk_mul_f32 v[54:55], v[54:55], v[210:211] op_sel:[0,1] op_sel_hi:[1,1]
    v_pk_mul_f32 v[36:37], v[36:37], v[208:209] op_sel:[0,1] op_sel_hi:[1,1]
    v_pk_mul_f32 v[56:57], v[56:57], v[210:211] op_sel:[0,1] op_sel_hi:[1,1]
    v_pk_mul_f32 v[38:39], v[38:39], v[208:209] op_sel:[0,1] op_sel_hi:[1,1]
    v_pk_mul_f32 v[58:59], v[58:59], v[210:211] op_sel:[0,1] op_sel_hi:[1,1]
    v_cvt_pk_bf16_f32 v136, v24, v25
    v_cvt_pk_bf16_f32 v168, v44, v45
    v_cvt_pk_bf16_f32 v137, v26, v27
    v_cvt_pk_bf16_f32 v169, v46, v47
    v_cvt_pk_bf16_f32 v138, v28, v29
    v_cvt_pk_bf16_f32 v170, v48, v49
    ds_write_b128 v9, v[232:235] offset:4672
    v_cvt_pk_bf16_f32 v139, v30, v31
    v_cvt_pk_bf16_f32 v171, v50, v51
    v_cvt_pk_bf16_f32 v152, v32, v33
    v_cvt_pk_bf16_f32 v184, v52, v53
    v_cvt_pk_bf16_f32 v153, v34, v35
    v_cvt_pk_bf16_f32 v185, v54, v55
    v_cvt_pk_bf16_f32 v154, v36, v37
    v_cvt_pk_bf16_f32 v186, v56, v57
    v_cvt_pk_bf16_f32 v155, v38, v39
    v_cvt_pk_bf16_f32 v187, v58, v59
    ds_write_b128 v23, v[136:139] offset:4608
    ds_write_b128 v23, v[168:171] offset:41472
    ds_write_b128 v23, v[152:155] offset:4672
    ds_write_b128 v23, v[184:187] offset:41536
    v_pk_mul_f32 v[212:213], v[212:213], s[6:7]
    v_pk_mul_f32 v[214:215], v[214:215], s[6:7]
    v_pk_fma_f32 v[24:25], v[140:141], s[4:5], v[212:213] op_sel_hi:[1,1,0]
    v_pk_fma_f32 v[44:45], v[172:173], s[4:5], v[214:215] op_sel_hi:[1,1,0]
    v_pk_fma_f32 v[26:27], v[142:143], s[4:5], v[212:213] op_sel_hi:[1,1,0]
    v_pk_fma_f32 v[46:47], v[174:175], s[4:5], v[214:215] op_sel_hi:[1,1,0]
    v_pk_fma_f32 v[28:29], v[156:157], s[4:5], v[212:213] op_sel_hi:[1,1,0]
    v_pk_fma_f32 v[48:49], v[188:189], s[4:5], v[214:215] op_sel_hi:[1,1,0]
    v_pk_fma_f32 v[30:31], v[158:159], s[4:5], v[212:213] op_sel_hi:[1,1,0]
    v_pk_fma_f32 v[50:51], v[190:191], s[4:5], v[214:215] op_sel_hi:[1,1,0]
    v_pk_fma_f32 v[32:33], v[140:141], s[6:7], v[212:213] op_sel:[0,0,1] op_sel_hi:[1,1,1]
    v_pk_fma_f32 v[52:53], v[172:173], s[6:7], v[214:215] op_sel:[0,0,1] op_sel_hi:[1,1,1]
    v_pk_fma_f32 v[34:35], v[142:143], s[6:7], v[212:213] op_sel:[0,0,1] op_sel_hi:[1,1,1]
    v_pk_fma_f32 v[54:55], v[174:175], s[6:7], v[214:215] op_sel:[0,0,1] op_sel_hi:[1,1,1]
    v_pk_fma_f32 v[36:37], v[156:157], s[6:7], v[212:213] op_sel:[0,0,1] op_sel_hi:[1,1,1]
    v_pk_fma_f32 v[56:57], v[188:189], s[6:7], v[214:215] op_sel:[0,0,1] op_sel_hi:[1,1,1]
    v_pk_fma_f32 v[38:39], v[158:159], s[6:7], v[212:213] op_sel:[0,0,1] op_sel_hi:[1,1,1]
    v_pk_fma_f32 v[58:59], v[190:191], s[6:7], v[214:215] op_sel:[0,0,1] op_sel_hi:[1,1,1]
    v_exp_f32 v24, v24
    v_exp_f32 v44, v44
    v_exp_f32 v25, v25
    v_exp_f32 v45, v45
    v_exp_f32 v26, v26
    v_exp_f32 v46, v46
    v_exp_f32 v27, v27
    v_exp_f32 v47, v47
    v_exp_f32 v28, v28
    v_exp_f32 v48, v48
    v_exp_f32 v29, v29
    v_exp_f32 v49, v49
    v_exp_f32 v30, v30
    ds_write_b128 v9, v[204:207] offset:6912
    v_exp_f32 v50, v50
    v_exp_f32 v31, v31
    v_exp_f32 v51, v51
    v_exp_f32 v32, v32
    v_exp_f32 v52, v52
    v_exp_f32 v33, v33
    v_exp_f32 v53, v53
    v_exp_f32 v34, v34
    v_exp_f32 v54, v54
    v_exp_f32 v35, v35
    v_exp_f32 v55, v55
    v_exp_f32 v36, v36
    v_exp_f32 v56, v56
    v_exp_f32 v37, v37
    v_exp_f32 v57, v57
    v_exp_f32 v38, v38
    v_exp_f32 v58, v58
    v_exp_f32 v39, v39
    v_exp_f32 v59, v59
    v_pk_add_f32 v[212:213], v[24:25], v[26:27]
    v_pk_add_f32 v[214:215], v[44:45], v[46:47]
    v_pk_add_f32 v[42:43], v[32:33], v[34:35]
    v_pk_add_f32 v[62:63], v[52:53], v[54:55]
    v_pk_add_f32 v[212:213], v[212:213], v[28:29]
    v_pk_add_f32 v[214:215], v[214:215], v[48:49]
    v_pk_add_f32 v[42:43], v[42:43], v[36:37]
    v_pk_add_f32 v[62:63], v[62:63], v[56:57]
    v_pk_add_f32 v[212:213], v[212:213], v[30:31]
    v_pk_add_f32 v[214:215], v[214:215], v[50:51]
    v_pk_add_f32 v[42:43], v[42:43], v[38:39]
    v_pk_add_f32 v[62:63], v[62:63], v[58:59]
    v_add_f32 v212, v212, v213
    v_add_f32 v214, v214, v215
    v_add_f32 v213, v42, v43
    v_add_f32 v215, v62, v63
    s_nop 0
    v_permlane32_swap_b32 v212, v213
    v_permlane32_swap_b32 v214, v215
    v_add_f32 v212, v212, v213
    v_add_f32 v214, v214, v215
    v_mov_b32 v213, v212
    v_mov_b32 v215, v214
    s_nop 0
    v_permlane16_swap_b32 v212, v213
    v_permlane16_swap_b32 v214, v215
    v_add_f32 v212, v212, v213
    v_add_f32 v214, v214, v215
    ds_write_b128 v9, v[236:239] offset:6976
    v_mov_b32 v213, v212
    v_mov_b32 v215, v214
    s_nop 0
    v_permlane32_swap_b32 v212, v213
    v_permlane32_swap_b32 v214, v215
    v_rcp_f32 v212, v212
    v_rcp_f32 v214, v214
    v_rcp_f32 v213, v213
    v_rcp_f32 v215, v215
    v_pk_mul_f32 v[24:25], v[24:25], v[212:213] op_sel_hi:[1,0]
    v_pk_mul_f32 v[44:45], v[44:45], v[214:215] op_sel_hi:[1,0]
    v_pk_mul_f32 v[26:27], v[26:27], v[212:213] op_sel_hi:[1,0]
    v_pk_mul_f32 v[46:47], v[46:47], v[214:215] op_sel_hi:[1,0]
    v_pk_mul_f32 v[28:29], v[28:29], v[212:213] op_sel_hi:[1,0]
    v_pk_mul_f32 v[48:49], v[48:49], v[214:215] op_sel_hi:[1,0]
    v_pk_mul_f32 v[30:31], v[30:31], v[212:213] op_sel_hi:[1,0]
    v_pk_mul_f32 v[50:51], v[50:51], v[214:215] op_sel_hi:[1,0]
    v_pk_mul_f32 v[32:33], v[32:33], v[212:213] op_sel:[0,1] op_sel_hi:[1,1]
    v_pk_mul_f32 v[52:53], v[52:53], v[214:215] op_sel:[0,1] op_sel_hi:[1,1]
    v_pk_mul_f32 v[34:35], v[34:35], v[212:213] op_sel:[0,1] op_sel_hi:[1,1]
    v_pk_mul_f32 v[54:55], v[54:55], v[214:215] op_sel:[0,1] op_sel_hi:[1,1]
    v_pk_mul_f32 v[36:37], v[36:37], v[212:213] op_sel:[0,1] op_sel_hi:[1,1]
    v_pk_mul_f32 v[56:57], v[56:57], v[214:215] op_sel:[0,1] op_sel_hi:[1,1]
    v_pk_mul_f32 v[38:39], v[38:39], v[212:213] op_sel:[0,1] op_sel_hi:[1,1]
    v_pk_mul_f32 v[58:59], v[58:59], v[214:215] op_sel:[0,1] op_sel_hi:[1,1]
    v_cvt_pk_bf16_f32 v140, v24, v25
    v_cvt_pk_bf16_f32 v172, v44, v45
    v_cvt_pk_bf16_f32 v141, v26, v27
    v_cvt_pk_bf16_f32 v173, v46, v47
    v_cvt_pk_bf16_f32 v142, v28, v29
    v_cvt_pk_bf16_f32 v174, v48, v49
    v_cvt_pk_bf16_f32 v143, v30, v31
    v_cvt_pk_bf16_f32 v175, v50, v51
    v_cvt_pk_bf16_f32 v156, v32, v33
    v_cvt_pk_bf16_f32 v188, v52, v53
    v_cvt_pk_bf16_f32 v157, v34, v35
    v_cvt_pk_bf16_f32 v189, v54, v55
    v_cvt_pk_bf16_f32 v158, v36, v37
    v_cvt_pk_bf16_f32 v190, v56, v57
    v_cvt_pk_bf16_f32 v159, v38, v39
    v_cvt_pk_bf16_f32 v191, v58, v59
    ds_write_b128 v23, v[140:143] offset:6912
    ds_write_b128 v23, v[172:175] offset:43776
    ds_write_b128 v23, v[156:159] offset:6976
    ds_write_b128 v23, v[188:191] offset:43840
    s_lshr_b32 s30, s27, 1
    s_lshl_b32 s31, s30, 6
    v_add_u32 v15, s31, v8
    s_mul_i32 s30, s30, 36864
    s_and_b32 s31, s27, 1
    s_lshl_b32 s31, s31, 6
    s_add_u32 s30, s30, s31
    s_add_u32 s30, s30, 73728
    v_add_u32 v14, s30, v8
    v_mov_b32 v240, 0x3f803f80
    v_mov_b32 v241, 0x3f803f80
    v_mov_b32 v242, 0x3f803f80
    v_mov_b32 v243, 0x3f803f80
    v_cvt_pk_bf16_f32 v24, v64, v65
    v_cvt_pk_bf16_f32 v25, v66, v67
    v_cvt_pk_bf16_f32 v26, v80, v81
    v_cvt_pk_bf16_f32 v27, v82, v83
    v_cvt_pk_bf16_f32 v28, v96, v97
    v_cvt_pk_bf16_f32 v29, v98, v99
    v_mfma_f32_16x16x32_bf16 v[64:67], a[160:163], v[24:27], 0
    v_cvt_pk_bf16_f32 v30, v112, v113
    v_cvt_pk_bf16_f32 v31, v114, v115
    v_mfma_f32_16x16x32_bf16 v[80:83], a[164:167], v[24:27], 0
    v_cvt_pk_bf16_f32 v32, v68, v69
    v_cvt_pk_bf16_f32 v33, v70, v71
    v_mfma_f32_16x16x32_bf16 v[96:99], a[168:171], v[28:31], 0
    v_cvt_pk_bf16_f32 v34, v84, v85
    v_cvt_pk_bf16_f32 v35, v86, v87
    v_mfma_f32_16x16x32_bf16 v[112:115], a[172:175], v[28:31], 0
    v_cvt_pk_bf16_f32 v36, v100, v101
    v_cvt_pk_bf16_f32 v37, v102, v103
    v_mfma_f32_16x16x32_bf16 v[68:71], a[160:163], v[32:35], 0
    v_cvt_pk_bf16_f32 v38, v116, v117
    v_cvt_pk_bf16_f32 v39, v118, v119
    v_mfma_f32_16x16x32_bf16 v[84:87], a[164:167], v[32:35], 0
    v_cvt_pk_bf16_f32 v40, v72, v73
    v_cvt_pk_bf16_f32 v41, v74, v75
    v_mfma_f32_16x16x32_bf16 v[100:103], a[168:171], v[36:39], 0
    v_cvt_pk_bf16_f32 v42, v88, v89
    v_cvt_pk_bf16_f32 v43, v90, v91
    v_mfma_f32_16x16x32_bf16 v[116:119], a[172:175], v[36:39], 0
    v_cvt_pk_bf16_f32 v44, v104, v105
    v_cvt_pk_bf16_f32 v45, v106, v107
    v_mfma_f32_16x16x32_bf16 v[72:75], a[160:163], v[40:43], 0
    v_cvt_pk_bf16_f32 v46, v120, v121
    v_cvt_pk_bf16_f32 v47, v122, v123
    v_mfma_f32_16x16x32_bf16 v[88:91], a[164:167], v[40:43], 0
    v_cvt_pk_bf16_f32 v48, v76, v77
    v_cvt_pk_bf16_f32 v49, v78, v79
    v_mfma_f32_16x16x32_bf16 v[104:107], a[168:171], v[44:47], 0
    v_cvt_pk_bf16_f32 v50, v92, v93
    v_cvt_pk_bf16_f32 v51, v94, v95
    v_mfma_f32_16x16x32_bf16 v[120:123], a[172:175], v[44:47], 0
    v_cvt_pk_bf16_f32 v52, v108, v109
    v_cvt_pk_bf16_f32 v53, v110, v111
    v_mfma_f32_16x16x32_bf16 v[76:79], a[160:163], v[48:51], 0
    v_cvt_pk_bf16_f32 v54, v124, v125
    v_cvt_pk_bf16_f32 v55, v126, v127
    v_mfma_f32_16x16x32_bf16 v[92:95], a[164:167], v[48:51], 0
    s_nop 0
    v_mfma_f32_16x16x32_bf16 v[108:111], a[168:171], v[52:55], 0
    v_mfma_f32_16x16x32_bf16 v[124:127], a[172:175], v[52:55], 0
    s_waitcnt lgkmcnt(0)
    s_barrier
    RT 0,14,0
    RT 2,14,2304
    RT 4,14,8
    RT 6,14,2312
    RT 8,15,0
    RT 10,15,2304
    RT 12,15,8
    RT 14,15,2312
    RT 16,14,4608
    RT 18,14,6912
    RT 20,14,4616
    RT 22,14,6920
    RT 24,15,4608
    RT 26,15,6912
    RT 28,15,4616
    RT 30,15,6920
    s_waitcnt lgkmcnt(8)
    v_mfma_f32_16x16x32_bf16 v[192:195], a[0:3], a[8:11], 0
    v_mov_b32 v31, 0
    v_lshlrev_b32 v19, 4, v10
    s_xor_b32 s30, s33, 1
    v_mfma_f32_16x16x32_bf16 v[200:203], a[0:3], a[12:15], 0
    s_lshl_b32 s30, s30, 3
    v_and_b32 v17, 15, v10
    v_min_u32 v4, 7, v17
    v_mfma_f32_16x16x32_bf16 v[208:211], a[0:3], v[240:243], 0
    v_mfma_f32_16x16x32_bf16 v[196:199], a[4:7], a[8:11], 0
    v_xor_b32 v17, s30, v17
    v_add_u32 v16, 0, v11
    v_lshlrev_b32 v18, 1, v16
    v_mfma_f32_16x16x32_bf16 v[204:207], a[4:7], a[12:15], 0
    v_xor_b32 v18, v18, v17
    v_lshlrev_b32 v18, 4, v18
    v_lshl_add_u32 v2, v16, 11, v18
    v_mfma_f32_16x16x32_bf16 v[212:215], a[4:7], v[240:243], 0
    RT 32,14,9216
    RT 34,14,11520
    RT 36,14,9224
    RT 38,14,11528
    RT 40,15,9216
    RT 42,15,11520
    RT 44,15,9224
    RT 46,15,11528
    s_waitcnt lgkmcnt(8)
    MV 192,16,24
    v_add_u32 v16, 4, v11
    v_lshlrev_b32 v18, 1, v16
    v_xor_b32 v18, v18, v17
    MV 200,16,28
    v_lshlrev_b32 v18, 4, v18
    v_lshl_add_u32 v3, v16, 11, v18
    v_subrev_u32 v3, 1024, v3
    v_mfma_f32_16x16x32_bf16 v[208:211], a[16:19], v[240:243], v[208:211]
    MV 196,20,24
    s_mul_i32 s31, s33, 15
    v_xor_b32 v4, s31, v4
    v_lshlrev_b32 v4, 2, v4
    MV 204,20,28
    v_add_u32 v2, s25, v2
    v_add_u32 v3, s25, v3
    v_add_u32 v28, s24, v1
    v_mfma_f32_16x16x32_bf16 v[212:215], a[20:23], v[240:243], v[212:215]
    RT 48,14,13824
    RT 50,14,16128
    RT 52,14,13832
    RT 54,14,16136
    RT 56,15,13824
    RT 58,15,16128
    RT 60,15,13832
    RT 62,15,16136
    s_waitcnt lgkmcnt(8)
    MV 192,32,40
    v_lshl_add_u32 v16, v11, 2, v12
    v_and_b32 v17, 7, v16
    v_lshlrev_b32 v16, 8, v16
    MV 200,32,44
    v_lshl_add_u32 v16, v13, 3, v16
    v_xor_b32 v18, 0, v17
    v_lshl_add_u32 v32, v18, 5, v16
    v_mfma_f32_16x16x32_bf16 v[208:211], a[32:35], v[240:243], v[208:211]
    MV 196,36,40
    v_add_u32 v40, 65536, v32
    v_xor_b32 v18, 1, v17
    v_lshl_add_u32 v33, v18, 5, v16
    MV 204,36,44
    v_add_u32 v41, 65536, v33
    v_xor_b32 v18, 2, v17
    v_lshl_add_u32 v34, v18, 5, v16
    v_mfma_f32_16x16x32_bf16 v[212:215], a[36:39], v[240:243], v[212:215]
    RT 64,14,18432
    RT 66,14,20736
    RT 68,14,18440
    RT 70,14,20744
    RT 72,15,18432
    RT 74,15,20736
    RT 76,15,18440
    RT 78,15,20744
    s_waitcnt lgkmcnt(8)
    MV 192,48,56
    v_add_u32 v42, 65536, v34
    v_xor_b32 v18, 3, v17
    v_lshl_add_u32 v35, v18, 5, v16
    MV 200,48,60
    v_add_u32 v43, 65536, v35
    v_xor_b32 v18, 4, v17
    v_lshl_add_u32 v36, v18, 5, v16
    v_mfma_f32_16x16x32_bf16 v[208:211], a[48:51], v[240:243], v[208:211]
    MV 196,52,56
    v_add_u32 v44, 65536, v36
    v_xor_b32 v18, 5, v17
    v_lshl_add_u32 v37, v18, 5, v16
    MV 204,52,60
    v_add_u32 v45, 65536, v37
    v_xor_b32 v18, 6, v17
    v_lshl_add_u32 v38, v18, 5, v16
    v_mfma_f32_16x16x32_bf16 v[212:215], a[52:55], v[240:243], v[212:215]
    RT 80,14,23040
    RT 82,14,25344
    RT 84,14,23048
    RT 86,14,25352
    RT 88,15,23040
    RT 90,15,25344
    RT 92,15,23048
    RT 94,15,25352
    s_waitcnt lgkmcnt(8)
    MV 192,64,72
    v_add_u32 v46, 65536, v38
    v_xor_b32 v18, 7, v17
    v_lshl_add_u32 v39, v18, 5, v16
    MV 200,64,76
    v_add_u32 v47, 65536, v39
    v_and_b32 v56, 1, v10
    v_lshlrev_b32 v56, 4, v56
    v_mfma_f32_16x16x32_bf16 v[208:211], a[64:67], v[240:243], v[208:211]
    MV 196,68,72
    v_lshl_add_u32 v56, v11, 5, v56
    v_add_u32 v56, 4096, v56
    v_and_b32 v57, 7, v10
    MV 204,68,76
    s_mov_b32 s30, 17408
    v_mul_lo_u32 v57, v57, s30
    v_bfe_u32 v58, v10, 3, 2
    v_mfma_f32_16x16x32_bf16 v[212:215], a[68:71], v[240:243], v[212:215]
    RT 96,14,27648
    RT 98,14,29952
    RT 100,14,27656
    RT 102,14,29960
    RT 104,15,27648
    RT 106,15,29952
    RT 108,15,27656
    RT 110,15,29960
    s_waitcnt lgkmcnt(8)
    MV 192,80,88
    v_lshl_add_u32 v57, v58, 5, v57
    s_lshl_b32 s30, s28, 2
    s_add_u32 s30, s30, 4096
    MV 200,80,92
    v_add_u32 v57, s30, v57
    v_and_b32 v63, 7, v10
    v_lshlrev_b32 v63, 4, v63
    v_mfma_f32_16x16x32_bf16 v[208:211], a[80:83], v[240:243], v[208:211]
    MV 196,84,88
    s_lshl_b32 s30, s28, 7
    v_add_u32 v63, s30, v63
    v_lshl_add_u32 v59, v58, 10, v63
    MV 204,84,92
    v_lshrrev_b32 v61, 5, v10
    s_mov_b32 s30, 17408
    v_mad_u32_u24 v59, v61, s30, v59
    v_mfma_f32_16x16x32_bf16 v[212:215], a[84:87], v[240:243], v[212:215]
    RT 112,14,32256
    RT 114,14,34560
    RT 116,14,32264
    RT 118,14,34568
    RT 120,15,32256
    RT 122,15,34560
    RT 124,15,32264
    RT 126,15,34568
    s_waitcnt lgkmcnt(8)
    MV 192,96,104
    v_lshrrev_b32 v61, 1, v58
    v_lshl_add_u32 v63, v61, 10, v63
    v_and_b32 v61, 1, v58
    MV 200,96,108
    v_lshl_add_u32 v61, v61, 3, v63
    v_and_b32 v60, 7, v10
    v_lshlrev_b32 v60, 2, v60
    v_mfma_f32_16x16x32_bf16 v[208:211], a[96:99], v[240:243], v[208:211]
    MV 196,100,104
    s_lshl_b32 s30, s28, 1
    s_add_u32 s30, s30, 2048
    v_lshl_add_u32 v62, v58, 4, s30
    MV 204,100,108
    v_mfma_f32_16x16x32_bf16 v[212:215], a[100:103], v[240:243], v[212:215]
    s_waitcnt lgkmcnt(0)
    MV 192,112,120
    MV 200,112,124
    v_mfma_f32_16x16x32_bf16 v[208:211], a[112:115], v[240:243], v[208:211]
    MV 196,116,120
    MV 204,116,124
    v_mfma_f32_16x16x32_bf16 v[212:215], a[116:119], v[240:243], v[212:215]
    s_barrier
    s_nop 1
    buffer_store_dwordx4 v[192:195], v19, s[8:11], s61 offen offset:0 sc1
    s_nop 1
    buffer_store_dwordx4 v[196:199], v19, s[8:11], s61 offen offset:1024 sc1
    buffer_store_dwordx4 v[200:203], v19, s[8:11], s61 offen offset:2048 sc1
    buffer_store_dwordx4 v[204:207], v19, s[8:11], s61 offen offset:3072 sc1
    s_mov_b32 exec_lo, 0x00020002
    s_mov_b32 exec_hi, 0x00020002
    v_mov_b32 v208, v212
    v_mov_b32 v209, v213
    v_mov_b32 v210, v214
    v_mov_b32 v211, v215
    s_mov_b32 exec_lo, 0x00030003
    s_mov_b32 exec_hi, 0x00030003
    buffer_store_dwordx4 v[208:211], v56, s[8:11], s61 offen sc1
    s_mov_b64 exec, -1
    v_max3_f32 v144, v64, v65, v66
    s_add_u32 m0, s26, 32768
    s_nop 0
    global_load_lds_dwordx4 v2, s[12:13] offset:0
    v_add_u32 v2, 65536, v2
    v_max3_f32 v164, v96, v97, v98
    v_max3_f32 v145, -v64, -v65, -v66
    v_max3_f32 v165, -v96, -v97, -v98
    v_max3_f32 v144, v144, v67, v80
    v_max3_f32 v164, v164, v99, v112
    v_max3_f32 v145, v145, -v67, -v80
    v_max3_f32 v165, v165, -v99, -v112
    v_max3_f32 v144, v144, v81, v82
    v_max3_f32 v164, v164, v113, v114
    v_max3_f32 v145, v145, -v81, -v82
    v_max3_f32 v165, v165, -v113, -v114
    v_max_f32 v144, v144, v83
    global_load_lds_dwordx4 v3, s[12:13] offset:1024
    v_add_u32 v3, 65536, v3
    v_max_f32 v164, v164, v115
    v_max_f32_e64 v145, v145, -v83
    v_max_f32_e64 v165, v165, -v115
    s_nop 0
    v_permlane32_swap_b32 v144, v145
    v_permlane32_swap_b32 v164, v165
    v_max_f32 v144, v144, v145
    v_max_f32 v164, v164, v165
    v_mov_b32 v145, v144
    v_mov_b32 v165, v164
    s_nop 0
    v_permlane16_swap_b32 v144, v145
    v_permlane16_swap_b32 v164, v165
    v_max_f32 v144, v144, v145
    s_add_u32 m0, s26, 40960
    s_nop 0
    global_load_lds_dwordx4 v2, s[12:13] offset:0
    v_add_u32 v2, 65536, v2
    v_max_f32 v164, v164, v165
    v_mov_b32 v145, v144
    v_mov_b32 v165, v164
    s_nop 0
    v_permlane32_swap_b32 v144, v145
    v_permlane32_swap_b32 v164, v165
    v_pk_mul_f32 v[144:145], v[144:145], s[6:7]
    v_pk_mul_f32 v[164:165], v[164:165], s[6:7]
    v_pk_fma_f32 v[128:129], v[64:65], s[4:5], v[144:145] op_sel_hi:[1,1,0]
    v_pk_fma_f32 v[148:149], v[96:97], s[4:5], v[164:165] op_sel_hi:[1,1,0]
    v_pk_fma_f32 v[130:131], v[66:67], s[4:5], v[144:145] op_sel_hi:[1,1,0]
    v_pk_fma_f32 v[150:151], v[98:99], s[4:5], v[164:165] op_sel_hi:[1,1,0]
    v_pk_fma_f32 v[132:133], v[80:81], s[4:5], v[144:145] op_sel_hi:[1,1,0]
    global_load_lds_dwordx4 v3, s[12:13] offset:1024
    v_add_u32 v3, 65536, v3
    v_pk_fma_f32 v[152:153], v[112:113], s[4:5], v[164:165] op_sel_hi:[1,1,0]
    v_pk_fma_f32 v[134:135], v[82:83], s[4:5], v[144:145] op_sel_hi:[1,1,0]
    v_pk_fma_f32 v[154:155], v[114:115], s[4:5], v[164:165] op_sel_hi:[1,1,0]
    v_pk_fma_f32 v[136:137], v[64:65], s[6:7], v[144:145] op_sel:[0,0,1] op_sel_hi:[1,1,1]
    v_pk_fma_f32 v[156:157], v[96:97], s[6:7], v[164:165] op_sel:[0,0,1] op_sel_hi:[1,1,1]
    v_pk_fma_f32 v[138:139], v[66:67], s[6:7], v[144:145] op_sel:[0,0,1] op_sel_hi:[1,1,1]
    v_pk_fma_f32 v[158:159], v[98:99], s[6:7], v[164:165] op_sel:[0,0,1] op_sel_hi:[1,1,1]
    v_pk_fma_f32 v[140:141], v[80:81], s[6:7], v[144:145] op_sel:[0,0,1] op_sel_hi:[1,1,1]
    v_pk_fma_f32 v[160:161], v[112:113], s[6:7], v[164:165] op_sel:[0,0,1] op_sel_hi:[1,1,1]
    v_pk_fma_f32 v[142:143], v[82:83], s[6:7], v[144:145] op_sel:[0,0,1] op_sel_hi:[1,1,1]
    v_pk_fma_f32 v[162:163], v[114:115], s[6:7], v[164:165] op_sel:[0,0,1] op_sel_hi:[1,1,1]
    v_exp_f32 v128, v128
    s_add_u32 m0, s26, 49152
    s_nop 0
    global_load_lds_dwordx4 v2, s[12:13] offset:0
    s_add_u32 s59, s3, 4294836224
    v_add_u32 v2, s59, v2
    v_exp_f32 v148, v148
    v_exp_f32 v129, v129
    v_exp_f32 v149, v149
    v_exp_f32 v130, v130
    v_exp_f32 v150, v150
    v_exp_f32 v131, v131
    v_exp_f32 v151, v151
    v_exp_f32 v132, v132
    v_exp_f32 v152, v152
    v_exp_f32 v133, v133
    v_exp_f32 v153, v153
    v_exp_f32 v134, v134
    global_load_lds_dwordx4 v3, s[12:13] offset:1024
    s_add_u32 s59, s3, 4294836224
    v_add_u32 v3, s59, v3
    v_exp_f32 v154, v154
    v_exp_f32 v135, v135
    v_exp_f32 v155, v155
    v_exp_f32 v136, v136
    v_exp_f32 v156, v156
    v_exp_f32 v137, v137
    v_exp_f32 v157, v157
    v_exp_f32 v138, v138
    v_exp_f32 v158, v158
    v_exp_f32 v139, v139
    v_exp_f32 v159, v159
    v_exp_f32 v140, v140
    s_add_u32 m0, s26, 57344
    s_nop 0
    global_load_lds_dwordx4 v2, s[12:13] offset:0
    v_add_u32 v2, 65536, v2
    v_exp_f32 v160, v160
    v_exp_f32 v141, v141
    v_exp_f32 v161, v161
    v_exp_f32 v142, v142
    v_exp_f32 v162, v162
    v_exp_f32 v143, v143
    v_exp_f32 v163, v163
    v_cvt_pk_bf16_f32 v64, v128, v129
    v_cvt_pk_bf16_f32 v96, v148, v149
    v_cvt_pk_bf16_f32 v65, v130, v131
    v_cvt_pk_bf16_f32 v97, v150, v151
    v_cvt_pk_bf16_f32 v66, v132, v133
    global_load_lds_dwordx4 v3, s[12:13] offset:1024
    v_add_u32 v3, 65536, v3
    v_cvt_pk_bf16_f32 v98, v152, v153
    v_cvt_pk_bf16_f32 v67, v134, v135
    v_cvt_pk_bf16_f32 v99, v154, v155
    v_cvt_pk_bf16_f32 v80, v136, v137
    v_cvt_pk_bf16_f32 v112, v156, v157
    v_cvt_pk_bf16_f32 v81, v138, v139
    v_cvt_pk_bf16_f32 v113, v158, v159
    v_cvt_pk_bf16_f32 v82, v140, v141
    v_cvt_pk_bf16_f32 v114, v160, v161
    v_cvt_pk_bf16_f32 v83, v142, v143
    v_cvt_pk_bf16_f32 v115, v162, v163
    v_max3_f32 v144, v68, v69, v70
    s_add_u32 m0, s26, 65536
    s_nop 0
    global_load_lds_dwordx4 v2, s[12:13] offset:0
    v_add_u32 v2, 65536, v2
    v_max3_f32 v164, v100, v101, v102
    v_max3_f32 v145, -v68, -v69, -v70
    v_max3_f32 v165, -v100, -v101, -v102
    v_max3_f32 v144, v144, v71, v84
    v_max3_f32 v164, v164, v103, v116
    v_max3_f32 v145, v145, -v71, -v84
    v_max3_f32 v165, v165, -v103, -v116
    v_max3_f32 v144, v144, v85, v86
    v_max3_f32 v164, v164, v117, v118
    v_max3_f32 v145, v145, -v85, -v86
    v_max3_f32 v165, v165, -v117, -v118
    v_max_f32 v144, v144, v87
    global_load_lds_dwordx4 v3, s[12:13] offset:1024
    v_add_u32 v3, 65536, v3
    v_max_f32 v164, v164, v119
    v_max_f32_e64 v145, v145, -v87
    v_max_f32_e64 v165, v165, -v119
    s_nop 0
    v_permlane32_swap_b32 v144, v145
    v_permlane32_swap_b32 v164, v165
    v_max_f32 v144, v144, v145
    v_max_f32 v164, v164, v165
    v_mov_b32 v145, v144
    v_mov_b32 v165, v164
    s_nop 0
    v_permlane16_swap_b32 v144, v145
    v_permlane16_swap_b32 v164, v165
    v_max_f32 v144, v144, v145
    s_add_u32 m0, s26, 73728
    s_nop 0
    global_load_lds_dwordx4 v2, s[12:13] offset:0
    s_add_u32 s59, s3, 4294836224
    v_add_u32 v2, s59, v2
    v_max_f32 v164, v164, v165
    v_mov_b32 v145, v144
    v_mov_b32 v165, v164
    s_nop 0
    v_permlane32_swap_b32 v144, v145
    v_permlane32_swap_b32 v164, v165
    v_pk_mul_f32 v[144:145], v[144:145], s[6:7]
    v_pk_mul_f32 v[164:165], v[164:165], s[6:7]
    v_pk_fma_f32 v[128:129], v[68:69], s[4:5], v[144:145] op_sel_hi:[1,1,0]
    v_pk_fma_f32 v[148:149], v[100:101], s[4:5], v[164:165] op_sel_hi:[1,1,0]
    v_pk_fma_f32 v[130:131], v[70:71], s[4:5], v[144:145] op_sel_hi:[1,1,0]
    v_pk_fma_f32 v[150:151], v[102:103], s[4:5], v[164:165] op_sel_hi:[1,1,0]
    v_pk_fma_f32 v[132:133], v[84:85], s[4:5], v[144:145] op_sel_hi:[1,1,0]
    global_load_lds_dwordx4 v3, s[12:13] offset:1024
    s_add_u32 s59, s3, 4294836224
    v_add_u32 v3, s59, v3
    v_pk_fma_f32 v[152:153], v[116:117], s[4:5], v[164:165] op_sel_hi:[1,1,0]
    v_pk_fma_f32 v[134:135], v[86:87], s[4:5], v[144:145] op_sel_hi:[1,1,0]
    v_pk_fma_f32 v[154:155], v[118:119], s[4:5], v[164:165] op_sel_hi:[1,1,0]
    v_pk_fma_f32 v[136:137], v[68:69], s[6:7], v[144:145] op_sel:[0,0,1] op_sel_hi:[1,1,1]
    v_pk_fma_f32 v[156:157], v[100:101], s[6:7], v[164:165] op_sel:[0,0,1] op_sel_hi:[1,1,1]
    v_pk_fma_f32 v[138:139], v[70:71], s[6:7], v[144:145] op_sel:[0,0,1] op_sel_hi:[1,1,1]
    v_pk_fma_f32 v[158:159], v[102:103], s[6:7], v[164:165] op_sel:[0,0,1] op_sel_hi:[1,1,1]
    v_pk_fma_f32 v[140:141], v[84:85], s[6:7], v[144:145] op_sel:[0,0,1] op_sel_hi:[1,1,1]
    v_pk_fma_f32 v[160:161], v[116:117], s[6:7], v[164:165] op_sel:[0,0,1] op_sel_hi:[1,1,1]
    v_pk_fma_f32 v[142:143], v[86:87], s[6:7], v[144:145] op_sel:[0,0,1] op_sel_hi:[1,1,1]
    v_pk_fma_f32 v[162:163], v[118:119], s[6:7], v[164:165] op_sel:[0,0,1] op_sel_hi:[1,1,1]
    v_exp_f32 v128, v128
    s_add_u32 m0, s26, 81920
    s_nop 0
    global_load_lds_dwordx4 v2, s[12:13] offset:0
    v_add_u32 v2, 65536, v2
    v_exp_f32 v148, v148
    v_exp_f32 v129, v129
    v_exp_f32 v149, v149
    v_exp_f32 v130, v130
    v_exp_f32 v150, v150
    v_exp_f32 v131, v131
    v_exp_f32 v151, v151
    v_exp_f32 v132, v132
    v_exp_f32 v152, v152
    v_exp_f32 v133, v133
    v_exp_f32 v153, v153
    v_exp_f32 v134, v134
    global_load_lds_dwordx4 v3, s[12:13] offset:1024
    v_add_u32 v3, 65536, v3
    v_exp_f32 v154, v154
    v_exp_f32 v135, v135
    v_exp_f32 v155, v155
    v_exp_f32 v136, v136
    v_exp_f32 v156, v156
    v_exp_f32 v137, v137
    v_exp_f32 v157, v157
    v_exp_f32 v138, v138
    v_exp_f32 v158, v158
    v_exp_f32 v139, v139
    v_exp_f32 v159, v159
    v_exp_f32 v140, v140
    s_add_u32 m0, s26, 90112
    s_nop 0
    global_load_lds_dwordx4 v2, s[12:13] offset:0
    v_add_u32 v2, 65536, v2
    v_exp_f32 v160, v160
    v_exp_f32 v141, v141
    v_exp_f32 v161, v161
    v_exp_f32 v142, v142
    v_exp_f32 v162, v162
    v_exp_f32 v143, v143
    v_exp_f32 v163, v163
    v_cvt_pk_bf16_f32 v68, v128, v129
    v_cvt_pk_bf16_f32 v100, v148, v149
    v_cvt_pk_bf16_f32 v69, v130, v131
    v_cvt_pk_bf16_f32 v101, v150, v151
    v_cvt_pk_bf16_f32 v70, v132, v133
    global_load_lds_dwordx4 v3, s[12:13] offset:1024
    v_add_u32 v3, 65536, v3
    v_cvt_pk_bf16_f32 v102, v152, v153
    v_cvt_pk_bf16_f32 v71, v134, v135
    v_cvt_pk_bf16_f32 v103, v154, v155
    v_cvt_pk_bf16_f32 v84, v136, v137
    v_cvt_pk_bf16_f32 v116, v156, v157
    v_cvt_pk_bf16_f32 v85, v138, v139
    v_cvt_pk_bf16_f32 v117, v158, v159
    v_cvt_pk_bf16_f32 v86, v140, v141
    v_cvt_pk_bf16_f32 v118, v160, v161
    v_cvt_pk_bf16_f32 v87, v142, v143
    v_cvt_pk_bf16_f32 v119, v162, v163
    s_waitcnt vmcnt(16)
    v_mov_b32 v24, 1
    s_mov_b64 exec, 1
    buffer_store_dword v24, v31, s[8:11], s63 offen sc1
    s_mov_b64 exec, -1
    v_max3_f32 v144, v72, v73, v74
    s_add_u32 m0, s26, 98304
    s_nop 0
    global_load_lds_dwordx4 v2, s[12:13] offset:0
    s_add_u32 s59, s3, 4294836224
    v_add_u32 v2, s59, v2
    v_max3_f32 v164, v104, v105, v106
    v_max3_f32 v145, -v72, -v73, -v74
    v_max3_f32 v165, -v104, -v105, -v106
    v_max3_f32 v144, v144, v75, v88
    v_max3_f32 v164, v164, v107, v120
    v_max3_f32 v145, v145, -v75, -v88
    v_max3_f32 v165, v165, -v107, -v120
    v_max3_f32 v144, v144, v89, v90
    v_max3_f32 v164, v164, v121, v122
    v_max3_f32 v145, v145, -v89, -v90
    v_max3_f32 v165, v165, -v121, -v122
    v_max_f32 v144, v144, v91
    global_load_lds_dwordx4 v3, s[12:13] offset:1024
    s_add_u32 s59, s3, 4294836224
    v_add_u32 v3, s59, v3
    v_max_f32 v164, v164, v123
    v_max_f32_e64 v145, v145, -v91
    v_max_f32_e64 v165, v165, -v123
    s_nop 0
    v_permlane32_swap_b32 v144, v145
    v_permlane32_swap_b32 v164, v165
    v_max_f32 v144, v144, v145
    v_max_f32 v164, v164, v165
    v_mov_b32 v145, v144
    v_mov_b32 v165, v164
    s_nop 0
    v_permlane16_swap_b32 v144, v145
    v_permlane16_swap_b32 v164, v165
    v_max_f32 v144, v144, v145
    s_add_u32 m0, s26, 106496
    s_nop 0
    global_load_lds_dwordx4 v2, s[12:13] offset:0
    v_add_u32 v2, 65536, v2
    v_max_f32 v164, v164, v165
    v_mov_b32 v145, v144
    v_mov_b32 v165, v164
    s_nop 0
    v_permlane32_swap_b32 v144, v145
    v_permlane32_swap_b32 v164, v165
    v_pk_mul_f32 v[144:145], v[144:145], s[6:7]
    v_pk_mul_f32 v[164:165], v[164:165], s[6:7]
    v_pk_fma_f32 v[128:129], v[72:73], s[4:5], v[144:145] op_sel_hi:[1,1,0]
    v_pk_fma_f32 v[148:149], v[104:105], s[4:5], v[164:165] op_sel_hi:[1,1,0]
    v_pk_fma_f32 v[130:131], v[74:75], s[4:5], v[144:145] op_sel_hi:[1,1,0]
    v_pk_fma_f32 v[150:151], v[106:107], s[4:5], v[164:165] op_sel_hi:[1,1,0]
    v_pk_fma_f32 v[132:133], v[88:89], s[4:5], v[144:145] op_sel_hi:[1,1,0]
    global_load_lds_dwordx4 v3, s[12:13] offset:1024
    v_add_u32 v3, 65536, v3
    v_pk_fma_f32 v[152:153], v[120:121], s[4:5], v[164:165] op_sel_hi:[1,1,0]
    v_pk_fma_f32 v[134:135], v[90:91], s[4:5], v[144:145] op_sel_hi:[1,1,0]
    v_pk_fma_f32 v[154:155], v[122:123], s[4:5], v[164:165] op_sel_hi:[1,1,0]
    v_pk_fma_f32 v[136:137], v[72:73], s[6:7], v[144:145] op_sel:[0,0,1] op_sel_hi:[1,1,1]
    v_pk_fma_f32 v[156:157], v[104:105], s[6:7], v[164:165] op_sel:[0,0,1] op_sel_hi:[1,1,1]
    v_pk_fma_f32 v[138:139], v[74:75], s[6:7], v[144:145] op_sel:[0,0,1] op_sel_hi:[1,1,1]
    v_pk_fma_f32 v[158:159], v[106:107], s[6:7], v[164:165] op_sel:[0,0,1] op_sel_hi:[1,1,1]
    v_pk_fma_f32 v[140:141], v[88:89], s[6:7], v[144:145] op_sel:[0,0,1] op_sel_hi:[1,1,1]
    v_pk_fma_f32 v[160:161], v[120:121], s[6:7], v[164:165] op_sel:[0,0,1] op_sel_hi:[1,1,1]
    v_pk_fma_f32 v[142:143], v[90:91], s[6:7], v[144:145] op_sel:[0,0,1] op_sel_hi:[1,1,1]
    v_pk_fma_f32 v[162:163], v[122:123], s[6:7], v[164:165] op_sel:[0,0,1] op_sel_hi:[1,1,1]
    v_exp_f32 v128, v128
    s_add_u32 m0, s26, 114688
    s_nop 0
    global_load_lds_dwordx4 v2, s[12:13] offset:0
    v_add_u32 v2, 65536, v2
    v_exp_f32 v148, v148
    v_exp_f32 v129, v129
    v_exp_f32 v149, v149
    v_exp_f32 v130, v130
    v_exp_f32 v150, v150
    v_exp_f32 v131, v131
    v_exp_f32 v151, v151
    v_exp_f32 v132, v132
    v_exp_f32 v152, v152
    v_exp_f32 v133, v133
    v_exp_f32 v153, v153
    v_exp_f32 v134, v134
    global_load_lds_dwordx4 v3, s[12:13] offset:1024
    v_add_u32 v3, 65536, v3
    v_exp_f32 v154, v154
    v_exp_f32 v135, v135
    v_exp_f32 v155, v155
    v_exp_f32 v136, v136
    v_exp_f32 v156, v156
    v_exp_f32 v137, v137
    v_exp_f32 v157, v157
    v_exp_f32 v138, v138
    v_exp_f32 v158, v158
    v_exp_f32 v139, v139
    v_exp_f32 v159, v159
    v_exp_f32 v140, v140
    s_add_u32 m0, s26, 122880
    s_nop 0
    global_load_lds_dwordx4 v2, s[12:13] offset:0
    s_add_u32 s59, s3, 4294836224
    v_add_u32 v2, s59, v2
    v_exp_f32 v160, v160
    v_exp_f32 v141, v141
    v_exp_f32 v161, v161
    v_exp_f32 v142, v142
    v_exp_f32 v162, v162
    v_exp_f32 v143, v143
    v_exp_f32 v163, v163
    v_cvt_pk_bf16_f32 v72, v128, v129
    v_cvt_pk_bf16_f32 v104, v148, v149
    v_cvt_pk_bf16_f32 v73, v130, v131
    v_cvt_pk_bf16_f32 v105, v150, v151
    v_cvt_pk_bf16_f32 v74, v132, v133
    global_load_lds_dwordx4 v3, s[12:13] offset:1024
    s_add_u32 s59, s3, 4294836224
    v_add_u32 v3, s59, v3
    v_cvt_pk_bf16_f32 v106, v152, v153
    v_cvt_pk_bf16_f32 v75, v134, v135
    v_cvt_pk_bf16_f32 v107, v154, v155
    v_cvt_pk_bf16_f32 v88, v136, v137
    v_cvt_pk_bf16_f32 v120, v156, v157
    v_cvt_pk_bf16_f32 v89, v138, v139
    v_cvt_pk_bf16_f32 v121, v158, v159
    v_cvt_pk_bf16_f32 v90, v140, v141
    v_cvt_pk_bf16_f32 v122, v160, v161
    v_cvt_pk_bf16_f32 v91, v142, v143
    v_cvt_pk_bf16_f32 v123, v162, v163
    v_max3_f32 v144, v76, v77, v78
    s_add_u32 m0, s26, 0
    s_nop 0
    global_load_lds_dwordx4 v2, s[12:13] offset:0
    v_add_u32 v2, 65536, v2
    v_max3_f32 v164, v108, v109, v110
    v_max3_f32 v145, -v76, -v77, -v78
    v_max3_f32 v165, -v108, -v109, -v110
    v_max3_f32 v144, v144, v79, v92
    v_max3_f32 v164, v164, v111, v124
    v_max3_f32 v145, v145, -v79, -v92
    v_max3_f32 v165, v165, -v111, -v124
    v_max3_f32 v144, v144, v93, v94
    v_max3_f32 v164, v164, v125, v126
    v_max3_f32 v145, v145, -v93, -v94
    v_max3_f32 v165, v165, -v125, -v126
    v_max_f32 v144, v144, v95
    global_load_lds_dwordx4 v3, s[12:13] offset:1024
    v_add_u32 v3, 65536, v3
    v_max_f32 v164, v164, v127
    v_max_f32_e64 v145, v145, -v95
    v_max_f32_e64 v165, v165, -v127
    s_nop 0
    v_permlane32_swap_b32 v144, v145
    v_permlane32_swap_b32 v164, v165
    v_max_f32 v144, v144, v145
    v_max_f32 v164, v164, v165
    v_mov_b32 v145, v144
    v_mov_b32 v165, v164
    s_nop 0
    v_permlane16_swap_b32 v144, v145
    v_permlane16_swap_b32 v164, v165
    v_max_f32 v144, v144, v145
    s_add_u32 m0, s26, 8192
    s_nop 0
    global_load_lds_dwordx4 v2, s[12:13] offset:0
    v_add_u32 v2, 65536, v2
    v_max_f32 v164, v164, v165
    v_mov_b32 v145, v144
    v_mov_b32 v165, v164
    s_nop 0
    v_permlane32_swap_b32 v144, v145
    v_permlane32_swap_b32 v164, v165
    v_pk_mul_f32 v[144:145], v[144:145], s[6:7]
    v_pk_mul_f32 v[164:165], v[164:165], s[6:7]
    v_pk_fma_f32 v[128:129], v[76:77], s[4:5], v[144:145] op_sel_hi:[1,1,0]
    v_pk_fma_f32 v[148:149], v[108:109], s[4:5], v[164:165] op_sel_hi:[1,1,0]
    v_pk_fma_f32 v[130:131], v[78:79], s[4:5], v[144:145] op_sel_hi:[1,1,0]
    v_pk_fma_f32 v[150:151], v[110:111], s[4:5], v[164:165] op_sel_hi:[1,1,0]
    v_pk_fma_f32 v[132:133], v[92:93], s[4:5], v[144:145] op_sel_hi:[1,1,0]
    global_load_lds_dwordx4 v3, s[12:13] offset:1024
    v_add_u32 v3, 65536, v3
    v_pk_fma_f32 v[152:153], v[124:125], s[4:5], v[164:165] op_sel_hi:[1,1,0]
    v_pk_fma_f32 v[134:135], v[94:95], s[4:5], v[144:145] op_sel_hi:[1,1,0]
    v_pk_fma_f32 v[154:155], v[126:127], s[4:5], v[164:165] op_sel_hi:[1,1,0]
    v_pk_fma_f32 v[136:137], v[76:77], s[6:7], v[144:145] op_sel:[0,0,1] op_sel_hi:[1,1,1]
    v_pk_fma_f32 v[156:157], v[108:109], s[6:7], v[164:165] op_sel:[0,0,1] op_sel_hi:[1,1,1]
    v_pk_fma_f32 v[138:139], v[78:79], s[6:7], v[144:145] op_sel:[0,0,1] op_sel_hi:[1,1,1]
    v_pk_fma_f32 v[158:159], v[110:111], s[6:7], v[164:165] op_sel:[0,0,1] op_sel_hi:[1,1,1]
    v_pk_fma_f32 v[140:141], v[92:93], s[6:7], v[144:145] op_sel:[0,0,1] op_sel_hi:[1,1,1]
    v_pk_fma_f32 v[160:161], v[124:125], s[6:7], v[164:165] op_sel:[0,0,1] op_sel_hi:[1,1,1]
    v_pk_fma_f32 v[142:143], v[94:95], s[6:7], v[144:145] op_sel:[0,0,1] op_sel_hi:[1,1,1]
    v_pk_fma_f32 v[162:163], v[126:127], s[6:7], v[164:165] op_sel:[0,0,1] op_sel_hi:[1,1,1]
    v_exp_f32 v128, v128
    s_add_u32 m0, s26, 16384
    s_nop 0
    global_load_lds_dwordx4 v2, s[12:13] offset:0
    s_add_u32 s59, s3, 4294836224
    v_add_u32 v2, s59, v2
    v_exp_f32 v148, v148
    v_exp_f32 v129, v129
    v_exp_f32 v149, v149
    v_exp_f32 v130, v130
    v_exp_f32 v150, v150
    v_exp_f32 v131, v131
    v_exp_f32 v151, v151
    v_exp_f32 v132, v132
    v_exp_f32 v152, v152
    v_exp_f32 v133, v133
    v_exp_f32 v153, v153
    v_exp_f32 v134, v134
    global_load_lds_dwordx4 v3, s[12:13] offset:1024
    s_add_u32 s59, s3, 4294836224
    v_add_u32 v3, s59, v3
    v_exp_f32 v154, v154
    v_exp_f32 v135, v135
    v_exp_f32 v155, v155
    v_exp_f32 v136, v136
    v_exp_f32 v156, v156
    v_exp_f32 v137, v137
    v_exp_f32 v157, v157
    v_exp_f32 v138, v138
    v_exp_f32 v158, v158
    v_exp_f32 v139, v139
    v_exp_f32 v159, v159
    v_exp_f32 v140, v140
    s_add_u32 m0, s26, 24576
    s_nop 0
    global_load_lds_dwordx4 v2, s[12:13] offset:0
    v_add_u32 v2, 65536, v2
    v_exp_f32 v160, v160
    v_exp_f32 v141, v141
    v_exp_f32 v161, v161
    buffer_load_dword v5, v4, s[8:11], s67 offen sc1
    v_exp_f32 v142, v142
    v_exp_f32 v162, v162
    v_exp_f32 v143, v143
    v_exp_f32 v163, v163
    v_cvt_pk_bf16_f32 v76, v128, v129
    v_cvt_pk_bf16_f32 v108, v148, v149
    v_cvt_pk_bf16_f32 v77, v130, v131
    v_cvt_pk_bf16_f32 v109, v150, v151
    global_load_lds_dwordx4 v3, s[12:13] offset:1024
    v_add_u32 v3, 65536, v3
    v_cvt_pk_bf16_f32 v78, v132, v133
    v_cvt_pk_bf16_f32 v110, v152, v153
    v_cvt_pk_bf16_f32 v79, v134, v135
    v_cvt_pk_bf16_f32 v111, v154, v155
    v_cvt_pk_bf16_f32 v92, v136, v137
    v_cvt_pk_bf16_f32 v124, v156, v157
    v_cvt_pk_bf16_f32 v93, v138, v139
    v_cvt_pk_bf16_f32 v125, v158, v159
    v_cvt_pk_bf16_f32 v94, v140, v141
    v_cvt_pk_bf16_f32 v126, v160, v161
    v_cvt_pk_bf16_f32 v95, v142, v143
    v_cvt_pk_bf16_f32 v127, v162, v163
    s_waitcnt vmcnt(1)
    v_cmp_gt_u32 vcc, 1, v5
    s_nop 0
    s_cbranch_vccnz L_slow_q_1
L_back_q_1:
    global_load_dwordx4 a[0:3], v28, s[8:9] offset:0 sc1
    global_load_dwordx4 a[4:7], v28, s[8:9] offset:1024 sc1
    v_add_u32 v28, 4096, v28
    global_load_dwordx4 a[8:11], v28, s[8:9] offset:0 sc1
    global_load_dwordx4 a[12:15], v28, s[8:9] offset:1024 sc1
    v_add_u32 v28, 4096, v28
    global_load_dwordx4 a[16:19], v28, s[8:9] offset:0 sc1
    global_load_dwordx4 a[20:23], v28, s[8:9] offset:1024 sc1
    s_add_u32 s59, s58, 4294959104
    v_add_u32 v28, s59, v28
    global_load_dwordx4 a[24:27], v28, s[8:9] offset:0 sc1
    global_load_dwordx4 a[28:31], v28, s[8:9] offset:1024 sc1
    v_add_u32 v28, 4096, v28
    global_load_dwordx4 a[32:35], v28, s[8:9] offset:0 sc1
    global_load_dwordx4 a[36:39], v28, s[8:9] offset:1024 sc1
    v_add_u32 v28, 4096, v28
    global_load_dwordx4 a[40:43], v28, s[8:9] offset:0 sc1
    global_load_dwordx4 a[44:47], v28, s[8:9] offset:1024 sc1
    s_add_u32 s59, s58, 4294959104
    v_add_u32 v28, s59, v28
    s_waitcnt vmcnt(63)
    s_barrier
    RT 128,32,32768
    RT 130,32,36864
    RT 132,33,32768
    RT 134,33,36864
    RT 136,34,32768
    RT 138,34,36864
    RT 140,35,32768
    RT 142,35,36864
    RT 144,36,32768
    RT 146,36,36864
    RT 148,37,32768
    RT 150,37,36864
    s_waitcnt vmcnt(10) lgkmcnt(8)
    v_mfma_f32_16x16x32_bf16 v[208:211], a[128:131], a[0:3], 0
    RT 152,38,32768
    RT 154,38,36864
    v_mfma_f32_16x16x32_bf16 v[212:215], a[128:131], a[4:7], 0
    global_load_dwordx4 a[48:51], v28, s[8:9] offset:0 sc1
    v_mfma_f32_16x16x32_bf16 v[220:223], a[132:135], a[4:7], 0
    RT 128,39,32768
    RT 130,39,36864
    v_mfma_f32_16x16x32_bf16 v[216:219], a[132:135], a[0:3], 0
    global_load_dwordx4 a[52:55], v28, s[8:9] offset:1024 sc1
    s_waitcnt lgkmcnt(8)
    v_mfma_f32_16x16x32_bf16 v[240:243], a[136:139], a[0:3], 0
    RT 132,32,40960
    v_add_u32 v28, 4096, v28
    v_mfma_f32_16x16x32_bf16 v[244:247], a[136:139], a[4:7], 0
    RT 134,32,45056
    v_mfma_f32_16x16x32_bf16 v[252:255], a[140:143], a[4:7], 0
    RT 136,33,40960
    RT 138,33,45056
    v_mfma_f32_16x16x32_bf16 v[248:251], a[140:143], a[0:3], 0
    global_load_dwordx4 a[56:59], v28, s[8:9] offset:0 sc1
    s_waitcnt lgkmcnt(8)
    v_mfma_f32_16x16x32_bf16 v[176:179], a[144:147], a[0:3], 0
    RT 140,34,40960
    v_mfma_f32_16x16x32_bf16 v[180:183], a[144:147], a[4:7], 0
    RT 142,34,45056
    v_mfma_f32_16x16x32_bf16 v[188:191], a[148:151], a[4:7], 0
    RT 144,35,40960
    RT 146,35,45056
    v_mfma_f32_16x16x32_bf16 v[184:187], a[148:151], a[0:3], 0
    global_load_dwordx4 a[60:63], v28, s[8:9] offset:1024 sc1
    s_waitcnt lgkmcnt(8)
    v_mfma_f32_16x16x32_bf16 v[192:195], a[152:155], a[0:3], 0
    RT 148,36,40960
    v_add_u32 v28, 4096, v28
    v_mfma_f32_16x16x32_bf16 v[196:199], a[152:155], a[4:7], 0
    RT 150,36,45056
    v_mfma_f32_16x16x32_bf16 v[204:207], a[128:131], a[4:7], 0
    RT 152,37,40960
    RT 154,37,45056
    v_mfma_f32_16x16x32_bf16 v[200:203], a[128:131], a[0:3], 0
    global_load_dwordx4 a[64:67], v28, s[8:9] offset:0 sc1
    s_waitcnt vmcnt(13) lgkmcnt(8)
    s_barrier
    MV 208,132,8
    RT 128,38,40960
    MV 212,132,12
    RT 130,38,45056
    MV 220,136,12
    RT 132,39,40960
    RT 134,39,45056
    MV 216,136,8
    global_load_dwordx4 a[68:71], v28, s[8:9] offset:1024 sc1
    s_waitcnt lgkmcnt(8)
    MV 240,140,8
    RT 136,32,49152
    s_add_u32 s59, s58, 4294959104
    MV 244,140,12
    RT 138,32,53248
    v_add_u32 v28, s59, v28
    MV 252,144,12
    RT 140,33,49152
    RT 142,33,53248
    MV 248,144,8
    global_load_dwordx4 a[72:75], v28, s[8:9] offset:0 sc1
    s_waitcnt lgkmcnt(8)
    MV 176,148,8
    RT 144,34,49152
    MV 180,148,12
    RT 146,34,53248
    buffer_load_dword v22, v60, s[8:11], s57 offen sc1
    MV 188,152,12
    RT 148,35,49152
    RT 150,35,53248
    MV 184,152,8
    global_load_dwordx4 a[76:79], v28, s[8:9] offset:1024 sc1
    s_waitcnt lgkmcnt(8)
    MV 192,128,8
    RT 152,36,49152
    v_add_u32 v28, 4096, v28
    MV 196,128,12
    RT 154,36,53248
    s_waitcnt lgkmcnt(10)
    s_barrier
    MV 204,132,12
    RT 128,37,49152
    RT 130,37,53248
    MV 200,132,8
    global_load_dwordx4 a[80:83], v28, s[8:9] offset:0 sc1
    s_waitcnt vmcnt(16) lgkmcnt(8)
    MV 208,136,16
    RT 132,38,49152
    RT 134,38,53248
    MV 212,136,20
    global_load_dwordx4 a[84:87], v28, s[8:9] offset:1024 sc1
    MV 220,140,20
    RT 136,39,49152
    v_add_u32 v28, 4096, v28
    MV 216,140,16
    RT 138,39,53248
    s_waitcnt lgkmcnt(8)
    MV 240,144,16
    RT 140,32,57344
    MV 244,144,20
    RT 142,32,61440
    MV 252,148,20
    RT 144,33,57344
    RT 146,33,61440
    MV 248,148,16
    global_load_dwordx4 a[88:91], v28, s[8:9] offset:0 sc1
    s_waitcnt lgkmcnt(8)
    MV 176,152,16
    RT 148,34,57344
    MV 180,152,20
    RT 150,34,61440
    MV 188,128,20
    RT 152,35,57344
    RT 154,35,61440
    MV 184,128,16
    global_load_dwordx4 a[92:95], v28, s[8:9] offset:1024 sc1
    s_waitcnt lgkmcnt(8)
    MV 192,132,16
    RT 128,36,57344
    s_add_u32 s59, s58, 4294959104
    MV 196,132,20
    RT 130,36,61440
    v_add_u32 v28, s59, v28
    MV 204,136,20
    RT 132,37,57344
    RT 134,37,61440
    MV 200,136,16
    global_load_dwordx4 a[96:99], v28, s[8:9] offset:0 sc1
    s_waitcnt vmcnt(18) lgkmcnt(8)
    MV 208,140,24
    RT 136,38,57344
    MV 212,140,28
    RT 138,38,61440
    MV 220,144,28
    RT 140,39,57344
    RT 142,39,61440
    MV 216,144,24
    global_load_dwordx4 a[100:103], v28, s[8:9] offset:1024 sc1
    s_waitcnt lgkmcnt(8)
    MV 240,148,24
    RT 144,40,0
    v_add_u32 v28, 4096, v28
    MV 244,148,28
    RT 146,40,4096
    MV 252,152,28
    RT 148,41,0
    RT 150,41,4096
    MV 248,152,24
    global_load_dwordx4 a[104:107], v28, s[8:9] offset:0 sc1
    s_waitcnt lgkmcnt(8)
    MV 176,128,24
    RT 152,42,0
    MV 180,128,28
    RT 154,42,4096
    MV 188,132,28
    RT 128,43,0
    RT 130,43,4096
    MV 184,132,24
    global_load_dwordx4 a[108:111], v28, s[8:9] offset:1024 sc1
    s_waitcnt lgkmcnt(8)
    MV 192,136,24
    RT 132,44,0
    v_add_u32 v28, 4096, v28
    MV 196,136,28
    RT 134,44,4096
    s_waitcnt vmcnt(9)
    v_cmp_gt_u32 vcc, 1, v22
    s_nop 0
    s_cbranch_vccnz L_slow_q_2
L_back_q_2:
    buffer_load_dword v128, v57, s[8:11], s60 offen sc1
    buffer_load_dwordx4 v[132:135], v59, s[8:11], s60 offen sc1
    s_add_u32 s60, s60, 34816
    buffer_load_dwordx4 v[136:139], v59, s[8:11], s60 offen sc1
    s_add_u32 s60, s60, 34816
    buffer_load_dwordx4 v[140:143], v59, s[8:11], s60 offen sc1
    s_add_u32 s60, s60, 34816
    buffer_load_dwordx4 v[144:147], v59, s[8:11], s60 offen sc1
    s_waitcnt lgkmcnt(10)
    s_barrier
    s_add_u32 m0, s26, 32768
    MV 204,140,28
    RT 136,45,0
    RT 138,45,4096
    MV 200,140,24
    global_load_lds_dwordx4 v2, s[12:13] offset:0
    s_waitcnt lgkmcnt(8)
    MV 208,144,32
    RT 140,46,0
    RT 142,46,4096
    MV 212,144,36
    v_add_u32 v2, 65536, v2
    global_load_lds_dwordx4 v3, s[12:13] offset:1024
    MV 220,148,36
    RT 144,47,0
    v_add_u32 v3, 65536, v3
    MV 216,148,32
    RT 146,47,4096
    s_waitcnt lgkmcnt(8)
    MV 240,152,32
    RT 148,40,8192
    MV 244,152,36
    RT 150,40,12288
    s_add_u32 m0, s26, 40960
    MV 252,128,36
    RT 152,41,8192
    RT 154,41,12288
    MV 248,128,32
    global_load_lds_dwordx4 v2, s[12:13] offset:0
    s_waitcnt lgkmcnt(8)
    MV 176,132,32
    RT 128,42,8192
    s_add_u32 s59, s3, 4294836224
    MV 180,132,36
    RT 130,42,12288
    v_add_u32 v2, s59, v2
    MV 188,136,36
    RT 132,43,8192
    RT 134,43,12288
    MV 184,136,32
    global_load_lds_dwordx4 v3, s[12:13] offset:1024
    s_waitcnt lgkmcnt(8)
    MV 192,140,32
    RT 136,44,8192
    s_add_u32 s59, s3, 4294836224
    MV 196,140,36
    RT 138,44,12288
    v_add_u32 v3, s59, v3
    MV 204,144,36
    RT 140,45,8192
    RT 142,45,12288
    MV 200,144,32
    global_load_dwordx4 a[112:115], v28, s[8:9] offset:0 sc1
    s_waitcnt lgkmcnt(8)
    MV 208,148,40
    RT 144,46,8192
    MV 212,148,44
    RT 146,46,12288
    MV 220,152,44
    RT 148,47,8192
    RT 150,47,12288
    MV 216,152,40
    global_load_dwordx4 a[116:119], v28, s[8:9] offset:1024 sc1
    s_waitcnt lgkmcnt(8)
    MV 240,128,40
    RT 152,40,16384
    s_add_u32 s59, s58, 4294959104
    MV 244,128,44
    RT 154,40,20480
    v_add_u32 v28, s59, v28
    MV 252,132,44
    RT 128,41,16384
    RT 130,41,20480
    MV 248,132,40
    global_load_dwordx4 a[120:123], v28, s[8:9] offset:0 sc1
    s_waitcnt lgkmcnt(8)
    MV 176,136,40
    RT 132,42,16384
    MV 180,136,44
    RT 134,42,20480
    MV 188,140,44
    RT 136,43,16384
    RT 138,43,20480
    MV 184,140,40
    global_load_dwordx4 a[124:127], v28, s[8:9] offset:1024 sc1
    s_waitcnt lgkmcnt(8)
    MV 192,144,40
    RT 140,44,16384
    v_add_u32 v28, 4096, v28
    MV 196,144,44
    RT 142,44,20480
    s_waitcnt lgkmcnt(10)
    s_barrier
    s_add_u32 m0, s26, 49152
    MV 204,148,44
    RT 144,45,16384
    RT 146,45,20480
    MV 200,148,40
    global_load_lds_dwordx4 v2, s[12:13] offset:0
    s_waitcnt lgkmcnt(8)
    MV 208,152,48
    RT 148,46,16384
    RT 150,46,20480
    MV 212,152,52
    v_add_u32 v2, 65536, v2
    global_load_lds_dwordx4 v3, s[12:13] offset:1024
    s_waitcnt vmcnt(10)
    v_add_f32 v132, v132, v136
    v_add_f32 v133, v133, v137
    MV 220,128,52
    RT 152,47,16384
    v_add_u32 v3, 65536, v3
    MV 216,128,48
    RT 154,47,20480
    v_add_f32 v134, v134, v138
    v_add_f32 v135, v135, v139
    v_add_f32_dpp v128, v128, v128 quad_perm:[1,0,3,2] row_mask:0xf bank_mask:0xf
    s_waitcnt lgkmcnt(8)
    MV 240,132,48
    RT 128,40,24576
    MV 244,132,52
    RT 130,40,28672
    v_add_f32 v132, v132, v140
    v_add_f32 v133, v133, v141
    v_add_f32 v134, v134, v142
    s_add_u32 m0, s26, 57344
    MV 252,136,52
    RT 132,41,24576
    RT 134,41,28672
    MV 248,136,48
    global_load_lds_dwordx4 v2, s[12:13] offset:0
    v_add_f32 v135, v135, v143
    v_add_f32_dpp v128, v128, v128 quad_perm:[2,3,0,1] row_mask:0xf bank_mask:0xf
    v_add_f32 v132, v132, v144
    s_waitcnt lgkmcnt(8)
    MV 176,140,48
    RT 136,42,24576
    v_add_u32 v2, 65536, v2
    MV 180,140,52
    RT 138,42,28672
    v_add_f32 v133, v133, v145
    v_add_f32 v134, v134, v146
    v_add_f32 v135, v135, v147
    MV 188,144,52
    RT 140,43,24576
    RT 142,43,28672
    MV 184,144,48
    global_load_lds_dwordx4 v3, s[12:13] offset:1024
    v_add_f32_dpp v128, v128, v128 row_half_mirror row_mask:0xf bank_mask:0xf
    v_permlane32_swap_b32 v132, v134
    v_permlane32_swap_b32 v133, v135
    s_waitcnt lgkmcnt(8)
    MV 192,148,48
    RT 144,44,24576
    v_add_u32 v3, 65536, v3
    MV 196,148,52
    RT 146,44,28672
    v_add_f32 v132, v132, v134
    v_add_f32 v133, v133, v135
    v_cvt_pk_bf16_f32 v132, v132, v133
    MV 204,152,52
    RT 148,45,24576
    RT 150,45,28672
    MV 200,152,48
    global_load_dwordx4 a[0:3], v28, s[8:9] offset:0 sc1
    v_cvt_pk_bf16_f32 v128, v128, v128
    v_mov_b32 v133, v132
    s_nop 1
    v_permlane32_swap_b32 v132, v133
    s_waitcnt lgkmcnt(8)
    MV 208,128,56
    RT 152,46,24576
    MV 212,128,60
    RT 154,46,28672
    s_mov_b32 exec_hi, 0
    buffer_store_dwordx2 v[132:133], v61, s[8:11], s65 offen sc1
    s_mov_b64 exec, -1
    s_mov_b32 exec_lo, 0x01010101
    s_mov_b32 exec_hi, 0
    buffer_store_short v128, v62, s[8:11], s65 offen sc1
    s_mov_b64 exec, -1
    MV 220,132,60
    RT 128,47,24576
    RT 130,47,28672
    MV 216,132,56
    global_load_dwordx4 a[4:7], v28, s[8:9] offset:1024 sc1
    s_waitcnt lgkmcnt(8)
    MV 240,136,56
    RT 132,40,32768
    v_add_u32 v28, 4096, v28
    MV 244,136,60
    RT 134,40,36864
    MV 252,140,60
    RT 136,41,32768
    RT 138,41,36864
    MV 248,140,56
    global_load_dwordx4 a[8:11], v28, s[8:9] offset:0 sc1
    s_waitcnt lgkmcnt(8)
    MV 176,144,56
    RT 140,42,32768
    MV 180,144,60
    RT 142,42,36864
    MV 188,148,60
    RT 144,43,32768
    RT 146,43,36864
    MV 184,148,56
    global_load_dwordx4 a[12:15], v28, s[8:9] offset:1024 sc1
    s_waitcnt lgkmcnt(8)
    MV 192,152,56
    RT 148,44,32768
    s_add_u32 s59, s58, 4294959104
    MV 196,152,60
    RT 150,44,36864
    v_add_u32 v28, s59, v28
    s_waitcnt lgkmcnt(10)
    s_barrier
    s_add_u32 m0, s26, 65536
    MV 204,128,60
    RT 152,45,32768
    RT 154,45,36864
    MV 200,128,56
    global_load_lds_dwordx4 v2, s[12:13] offset:0
    s_waitcnt lgkmcnt(8)
    MV 208,132,64
    RT 128,46,32768
    RT 130,46,36864
    MV 212,132,68
    s_mul_i32 s59, s3, -6
    s_add_u32 s59, s59, 65536
    v_add_u32 v2, s59, v2
    global_load_lds_dwordx4 v3, s[12:13] offset:1024
    MV 220,136,68
    RT 132,47,32768
    s_mul_i32 s59, s3, -6
    s_add_u32 s59, s59, 65536
    MV 216,136,64
    RT 134,47,36864
    v_add_u32 v3, s59, v3
    s_waitcnt lgkmcnt(8)
    MV 240,140,64
    RT 136,40,40960
    MV 244,140,68
    RT 138,40,45056
    s_add_u32 m0, s26, 73728
    MV 252,144,68
    RT 140,41,40960
    RT 142,41,45056
    MV 248,144,64
    global_load_lds_dwordx4 v2, s[12:13] offset:0
    s_waitcnt lgkmcnt(8)
    MV 176,148,64
    RT 144,42,40960
    v_add_u32 v2, 65536, v2
    MV 180,148,68
    RT 146,42,45056
    MV 188,152,68
    RT 148,43,40960
    RT 150,43,45056
    MV 184,152,64
    global_load_lds_dwordx4 v3, s[12:13] offset:1024
    s_waitcnt lgkmcnt(8)
    MV 192,128,64
    RT 152,44,40960
    v_add_u32 v3, 65536, v3
    MV 196,128,68
    RT 154,44,45056
    s_mov_b32 s16, s36
    MV 204,132,68
    RT 128,45,40960
    RT 130,45,45056
    MV 200,132,64
    global_load_dwordx4 a[16:19], v28, s[8:9] offset:0 sc1
    s_mov_b32 s17, s37
    s_waitcnt lgkmcnt(8)
    MV 208,136,72
    RT 132,46,40960
    s_mov_b32 s18, 2097152
    MV 212,136,76
    RT 134,46,45056
    MV 220,140,76
    RT 136,47,40960
    RT 138,47,45056
    MV 216,140,72
    global_load_dwordx4 a[20:23], v28, s[8:9] offset:1024 sc1
    s_mov_b32 s19, 0x00020000
    s_waitcnt lgkmcnt(8)
    MV 240,144,72
    RT 140,40,49152
    v_add_u32 v28, 4096, v28
    MV 244,144,76
    RT 142,40,53248
    s_lshl_b32 s30, s56, 8
    MV 252,148,76
    RT 144,41,49152
    RT 146,41,53248
    s_lshl_b32 s31, s33, 7
    MV 248,148,72
    global_load_dwordx4 a[24:27], v28, s[8:9] offset:0 sc1
    s_waitcnt vmcnt(10)
    v_mov_b32 v24, 1
    s_mov_b64 exec, 1
    buffer_store_dword v24, v31, s[8:11], s64 offen sc1
    s_mov_b64 exec, -1
    s_andn2_b32 s57, s64, 127
    v_and_b32 v60, 31, v10
    v_lshlrev_b32 v60, 2, v60
    v_lshlrev_b32 v62, 4, v11
    v_add_u32 v62, 2048, v62
    s_waitcnt lgkmcnt(8)
    MV 176,152,72
    RT 148,42,49152
    s_add_u32 s30, s30, s31
    MV 180,152,76
    RT 150,42,53248
    MV 188,128,76
    RT 152,43,49152
    RT 154,43,53248
    MV 184,128,72
    global_load_dwordx4 a[28:31], v28, s[8:9] offset:1024 sc1
    s_lshl_b32 s43, s27, 16
    s_waitcnt lgkmcnt(8)
    MV 192,132,72
    RT 128,44,49152
    v_add_u32 v28, 4096, v28
    MV 196,132,76
    RT 130,44,53248
    s_add_u32 s43, s43, s30
    s_waitcnt lgkmcnt(10)
    s_barrier
    s_add_u32 m0, s26, 81920
    MV 204,136,76
    RT 132,45,49152
    RT 134,45,53248
    MV 200,136,72
    global_load_lds_dwordx4 v2, s[12:13] offset:0
    s_lshl_b32 s40, s55, 2
    s_waitcnt lgkmcnt(8)
    MV 208,140,80
    RT 136,46,49152
    RT 138,46,53248
    MV 212,140,84
    v_add_u32 v2, 65536, v2
    global_load_lds_dwordx4 v3, s[12:13] offset:1024
    s_add_u32 s40, s40, s27
    MV 220,144,84
    RT 140,47,49152
    v_add_u32 v3, 65536, v3
    MV 216,144,80
    RT 142,47,53248
    s_lshl_b32 s40, s40, 16
    s_waitcnt lgkmcnt(8)
    MV 240,148,80
    RT 144,40,57344
    s_add_u32 s40, s40, s30
    MV 244,148,84
    RT 146,40,61440
    s_add_u32 m0, s26, 90112
    MV 252,152,84
    RT 148,41,57344
    RT 150,41,61440
    MV 248,152,80
    global_load_lds_dwordx4 v2, s[12:13] offset:0
    v_lshrrev_b32 v25, 3, v10
    s_waitcnt lgkmcnt(8)
    MV 176,128,80
    RT 152,42,57344
    v_add_u32 v2, 65536, v2
    MV 180,128,84
    RT 154,42,61440
    v_and_b32 v26, 7, v10
    MV 188,132,84
    RT 128,43,57344
    RT 130,43,61440
    MV 184,132,80
    global_load_lds_dwordx4 v3, s[12:13] offset:1024
    v_and_b32 v27, 6, v25
    s_waitcnt lgkmcnt(8)
    MV 192,136,80
    RT 132,44,57344
    v_add_u32 v3, 65536, v3
    MV 196,136,84
    RT 134,44,61440
    v_xor_b32 v27, v26, v27
    MV 204,140,84
    RT 136,45,57344
    RT 138,45,61440
    MV 200,140,80
    global_load_dwordx4 a[32:35], v28, s[8:9] offset:0 sc1
    v_lshlrev_b32 v27, 4, v27
    s_waitcnt lgkmcnt(8)
    MV 208,144,88
    RT 140,46,57344
    v_lshl_add_u32 v6, v25, 11, v27
    MV 212,144,92
    RT 142,46,61440
    v_add_u32 v7, 15360, v6
    MV 220,148,92
    RT 144,47,57344
    RT 146,47,61440
    MV 216,148,88
    global_load_dwordx4 a[36:39], v28, s[8:9] offset:1024 sc1
    v_add_u32 v8, 30720, v6
    s_waitcnt lgkmcnt(8)
    MV 240,152,88
    RT 148,32,0
    s_mul_i32 s59, s58, -6
    s_add_u32 s59, s59, 4096
    MV 244,152,92
    RT 150,32,4096
    v_add_u32 v28, s59, v28
    v_add_u32 v9, 46080, v6
    s_add_u32 m0, s26, 98304
    MV 252,128,92
    RT 152,33,0
    RT 154,33,4096
    MV 248,128,88
    global_load_lds_dwordx4 v2, s[12:13] offset:0
    v_xor_b32 v26, v25, v26
    s_waitcnt lgkmcnt(8)
    MV 176,132,88
    RT 128,34,0
    s_add_u32 s59, s3, 4294770688
    MV 180,132,92
    RT 130,34,4096
    v_add_u32 v2, s59, v2
    v_lshlrev_b32 v26, 4, v26
    MV 188,136,92
    RT 132,35,0
    RT 134,35,4096
    MV 184,136,88
    global_load_lds_dwordx4 v3, s[12:13] offset:1024
    v_lshl_add_u32 v18, v25, 11, v26
    s_waitcnt lgkmcnt(8)
    MV 192,140,88
    RT 136,36,0
    s_add_u32 s59, s3, 4294770688
    MV 196,140,92
    RT 138,36,4096
    v_add_u32 v3, s59, v3
    v_lshl_add_u32 v25, v11, 2, v12
    s_waitcnt lgkmcnt(10)
    s_barrier
    s_add_u32 m0, s26, 106496
    MV 204,144,92
    RT 140,37,0
    RT 142,37,4096
    MV 200,144,88
    global_load_lds_dwordx4 v2, s[12:13] offset:0
    v_bfe_u32 v26, v25, 1, 2
    s_waitcnt lgkmcnt(8)
    MV 208,148,96
    RT 144,38,0
    v_add_u32 v2, 65536, v2
    MV 212,148,100
    RT 146,38,4096
    v_lshlrev_b32 v25, 7, v25
    MV 220,152,100
    RT 148,39,0
    RT 150,39,4096
    MV 216,152,96
    global_load_lds_dwordx4 v3, s[12:13] offset:1024
    v_lshl_add_u32 v25, v13, 3, v25
    s_waitcnt lgkmcnt(8)
    MV 240,128,96
    RT 152,32,8192
    v_add_u32 v3, 65536, v3
    MV 244,128,100
    RT 154,32,12288
    v_xor_b32 v27, 0, v26
    s_add_u32 m0, s26, 114688
    MV 252,132,100
    RT 128,33,8192
    RT 130,33,12288
    MV 248,132,96
    global_load_lds_dwordx4 v2, s[12:13] offset:0
    v_lshl_add_u32 v48, v27, 5, v25
    s_waitcnt lgkmcnt(8)
    MV 176,136,96
    RT 132,34,8192
    v_add_u32 v2, 65536, v2
    MV 180,136,100
    RT 134,34,12288
    buffer_load_dword v5, v4, s[8:11], s67 offen sc1
    v_add_u32 v52, 65536, v48
    MV 188,140,100
    RT 136,35,8192
    RT 138,35,12288
    MV 184,140,96
    global_load_lds_dwordx4 v3, s[12:13] offset:1024
    v_xor_b32 v27, 1, v26
    s_waitcnt lgkmcnt(8)
    MV 192,144,96
    RT 140,36,8192
    v_add_u32 v3, 65536, v3
    MV 196,144,100
    RT 142,36,12288
    v_lshl_add_u32 v49, v27, 5, v25
    s_add_u32 m0, s26, 122880
    MV 204,148,100
    RT 144,37,8192
    RT 146,37,12288
    MV 200,148,96
    global_load_lds_dwordx4 v2, s[12:13] offset:0
    v_add_u32 v53, 65536, v49
    s_waitcnt lgkmcnt(8)
    MV 208,152,104
    RT 148,38,8192
    v_add_u32 v2, 65536, v2
    MV 212,152,108
    RT 150,38,12288
    v_xor_b32 v27, 2, v26
    MV 220,128,108
    RT 152,39,8192
    RT 154,39,12288
    MV 216,128,104
    global_load_lds_dwordx4 v3, s[12:13] offset:1024
    v_lshl_add_u32 v50, v27, 5, v25
    s_waitcnt lgkmcnt(8)
    MV 240,132,104
    RT 128,32,16384
    v_add_u32 v3, 65536, v3
    MV 244,132,108
    RT 130,32,20480
    v_add_u32 v54, 65536, v50
    MV 252,136,108
    RT 132,33,16384
    v_xor_b32 v27, 3, v26
    MV 248,136,104
    RT 134,33,20480
    buffer_load_dword v22, v60, s[8:11], s57 offen sc1
    v_lshl_add_u32 v51, v27, 5, v25
    s_waitcnt lgkmcnt(8)
    MV 176,140,104
    RT 136,34,16384
    v_add_u32 v55, 65536, v51
    MV 180,140,108
    RT 138,34,20480
    MV 188,144,108
    RT 140,35,16384
    v_and_b32 v20, 15, v10
    MV 184,144,104
    RT 142,35,20480
    s_waitcnt lgkmcnt(8)
    MV 192,148,104
    RT 144,36,16384
    v_lshlrev_b32 v20, 2, v20
    MV 196,148,108
    RT 146,36,20480
    s_waitcnt lgkmcnt(10)
    s_barrier
    s_add_u32 m0, s26, 0
    MV 204,152,108
    RT 148,37,16384
    RT 150,37,20480
    MV 200,152,104
    global_load_lds_dwordx4 v2, s[12:13] offset:0
    s_lshl_b32 s48, s2, 2
    s_waitcnt lgkmcnt(8)
    MV 208,128,112
    RT 152,38,16384
    s_add_u32 s59, s3, 4294770688
    MV 212,128,116
    RT 154,38,20480
    v_add_u32 v2, s59, v2
    s_add_u32 s48, s48, s27
    MV 220,132,116
    RT 128,39,16384
    RT 130,39,20480
    MV 216,132,112
    global_load_lds_dwordx4 v3, s[12:13] offset:1024
    s_lshl_b32 s49, s48, 13
    s_waitcnt lgkmcnt(8)
    MV 240,136,112
    RT 132,32,24576
    s_add_u32 s59, s3, 4294770688
    MV 244,136,116
    RT 134,32,28672
    v_add_u32 v3, s59, v3
    s_add_u32 s49, s49, 33554432
    s_add_u32 m0, s26, 8192
    MV 252,140,116
    RT 136,33,24576
    RT 138,33,28672
    MV 248,140,112
    global_load_lds_dwordx4 v2, s[12:13] offset:0
    s_xor_b32 s50, s49, 4227072
    s_waitcnt lgkmcnt(8)
    MV 176,144,112
    RT 140,34,24576
    v_add_u32 v2, 65536, v2
    MV 180,144,116
    RT 142,34,28672
    s_add_u32 s52, s49, 4096
    MV 188,148,116
    RT 144,35,24576
    RT 146,35,28672
    MV 184,148,112
    global_load_lds_dwordx4 v3, s[12:13] offset:1024
    s_add_u32 s53, s50, 4096
    s_waitcnt lgkmcnt(8)
    MV 192,152,112
    RT 148,36,24576
    v_add_u32 v3, 65536, v3
    MV 196,152,116
    RT 150,36,28672
    s_xor_b32 s54, s51, 2064
    MV 204,128,116
    RT 152,37,24576
    s_lshl_b32 s48, s27, 12
    MV 200,128,112
    RT 154,37,28672
    s_waitcnt lgkmcnt(8)
    MV 208,132,120
    RT 128,38,24576
    RT 130,38,28672
    v_add_u32 v6, s43, v6
    MV 212,132,124
    s_waitcnt vmcnt(8)
    v_cmp_gt_u32 vcc, 2, v5
    s_nop 0
    s_cbranch_vccnz L_slow_q_3
L_back_q_3:
    global_load_dwordx4 a[40:43], v28, s[8:9] offset:0 sc1
    MV 220,136,124
    RT 132,39,24576
    RT 134,39,28672
    MV 216,136,120
    global_load_dwordx4 a[44:47], v28, s[8:9] offset:1024 sc1
    v_add_u32 v7, s43, v7
    s_waitcnt lgkmcnt(8)
    MV 240,140,120
    RT 136,32,32768
    v_add_u32 v28, 4096, v28
    MV 244,140,124
    RT 138,32,36864
    v_add_u32 v8, s43, v8
    MV 252,144,124
    RT 140,33,32768
    RT 142,33,36864
    MV 248,144,120
    global_load_dwordx4 a[48:51], v28, s[8:9] offset:0 sc1
    v_add_u32 v9, s43, v9
    s_waitcnt lgkmcnt(8)
    MV 176,148,120
    RT 144,34,32768
    s_mov_b32 s44, s38
    MV 180,148,124
    RT 146,34,36864
    MV 188,152,124
    RT 148,35,32768
    RT 150,35,36864
    s_mov_b32 s45, s39
    s_mov_b32 s46, 4194304
    MV 184,152,120
    global_load_dwordx4 a[52:55], v28, s[8:9] offset:1024 sc1
    s_waitcnt vmcnt(8)
    v_cmp_gt_u32 vcc, 1, v22
    s_nop 0
    s_cbranch_vccnz L_slow_q_4
L_back_q_4:
    buffer_load_dwordx4 v[224:227], v62, s[8:11], s32 offen sc1
    buffer_load_dwordx4 a[160:163], v19, s[8:11], s32 offen offset:0 sc1
    buffer_load_dwordx4 a[164:167], v19, s[8:11], s32 offen offset:1024 sc1
    s_add_u32 s32, s32, 2304
    buffer_load_dwordx4 v[228:231], v62, s[8:11], s32 offen sc1
    buffer_load_dwordx4 a[168:171], v19, s[8:11], s32 offen offset:0 sc1
    buffer_load_dwordx4 a[172:175], v19, s[8:11], s32 offen offset:1024 sc1
    s_add_u32 s32, s32, 2304
    buffer_load_dwordx4 v[232:235], v62, s[8:11], s32 offen sc1
    buffer_load_dwordx4 a[176:179], v19, s[8:11], s32 offen offset:0 sc1
    buffer_load_dwordx4 a[180:183], v19, s[8:11], s32 offen offset:1024 sc1
    s_add_u32 s32, s32, 2304
    buffer_load_dwordx4 v[236:239], v62, s[8:11], s32 offen sc1
    buffer_load_dwordx4 a[184:187], v19, s[8:11], s32 offen offset:0 sc1
    buffer_load_dwordx4 a[188:191], v19, s[8:11], s32 offen offset:1024 sc1
    s_waitcnt lgkmcnt(8)
    MV 192,128,120
    RT 152,36,32768
    v_add_u32 v28, 4096, v28
    MV 196,128,124
    RT 154,36,36864
    s_waitcnt lgkmcnt(10)
    s_barrier
    MV 204,132,124
    RT 128,37,32768
    RT 130,37,36864
    MV 200,132,120
    global_load_dwordx4 a[56:59], v28, s[8:9] offset:0 sc1
    s_waitcnt lgkmcnt(8)
    MV 208,136,0
    RT 132,38,32768
    RT 134,38,36864
    MV 212,136,4
    global_load_dwordx4 a[60:63], v28, s[8:9] offset:1024 sc1
    MV 220,140,4
    RT 136,39,32768
    v_add_u32 v28, 4096, v28
    MV 216,140,0
    RT 138,39,36864
    s_waitcnt lgkmcnt(8)
    MV 240,144,0
    RT 140,32,40960
    RT 142,32,45056
    MV 244,144,4
    global_load_dwordx4 a[64:67], v28, s[8:9] offset:0 sc1
    MV 252,148,4
    RT 144,33,40960
    RT 146,33,45056
    MV 248,148,0
    global_load_dwordx4 a[68:71], v28, s[8:9] offset:1024 sc1
    s_waitcnt lgkmcnt(8)
    MV 176,152,0
    RT 148,34,40960
    s_add_u32 s59, s58, 4294955008
    MV 180,152,4
    RT 150,34,45056
    v_add_u32 v28, s59, v28
    MV 188,128,4
    RT 152,35,40960
    RT 154,35,45056
    MV 184,128,0
    global_load_dwordx4 a[72:75], v28, s[8:9] offset:0 sc1
    s_waitcnt lgkmcnt(8)
    MV 192,132,0
    RT 128,36,40960
    MV 196,132,4
    RT 130,36,45056
    MV 204,136,4
    RT 132,37,40960
    RT 134,37,45056
    MV 200,136,0
    global_load_dwordx4 a[76:79], v28, s[8:9] offset:1024 sc1
    s_waitcnt lgkmcnt(8)
    MV 208,140,8
    RT 136,38,40960
    v_add_u32 v28, 4096, v28
    MV 212,140,12
    RT 138,38,45056
    MV 220,144,12
    RT 140,39,40960
    RT 142,39,45056
    MV 216,144,8
    global_load_dwordx4 a[80:83], v28, s[8:9] offset:0 sc1
    s_waitcnt lgkmcnt(8)
    MV 240,148,8
    RT 144,32,49152
    MV 244,148,12
    RT 146,32,53248
    MV 252,152,12
    RT 148,33,49152
    RT 150,33,53248
    MV 248,152,8
    global_load_dwordx4 a[84:87], v28, s[8:9] offset:1024 sc1
    s_waitcnt lgkmcnt(8)
    MV 176,128,8
    RT 152,34,49152
    v_add_u32 v28, 4096, v28
    MV 180,128,12
    RT 154,34,53248
    MV 188,132,12
    RT 128,35,49152
    RT 130,35,53248
    MV 184,132,8
    global_load_dwordx4 a[88:91], v28, s[8:9] offset:0 sc1
    s_waitcnt lgkmcnt(8)
    MV 192,136,8
    RT 132,36,49152
    MV 196,136,12
    RT 134,36,53248
    s_waitcnt lgkmcnt(10)
    s_barrier
    MV 204,140,12
    RT 136,37,49152
    RT 138,37,53248
    MV 200,140,8
    global_load_dwordx4 a[92:95], v28, s[8:9] offset:1024 sc1
    s_waitcnt vmcnt(10)
    v_and_b32 v24, 3, v10
    v_cmp_ne_u32 s[68:69], 0, v24
    v_mov_b32 v24, 0x3f803f80
    s_lshl_b32 s60, s28, 2
    s_waitcnt lgkmcnt(8)
    s_add_u32 m0, s26, 16384
    MV 208,144,16
    RT 140,38,49152
    RT 142,38,53248
    MV 212,144,20
    v_add_u32 v28, 4096, v28
    global_load_lds_dwordx4 v2, s[12:13] offset:0
    s_add_u32 s60, s60, s27
    s_mul_i32 s60, s60, 589824
    s_lshl_b32 s30, s29, 13
    s_add_u32 s60, s60, s30
    s_add_u32 s60, s60, 4653056
    MV 220,148,20
    RT 144,39,49152
    v_add_u32 v2, 65536, v2
    MV 216,148,16
    RT 146,39,53248
    s_add_u32 s61, s60, 4096
    s_mov_b32 s4, 0x358637bd
    v_cndmask_b32 v224, v224, v24, s[68:69]
    v_cndmask_b32 v225, v225, v24, s[68:69]
    v_cndmask_b32 v226, v226, v24, s[68:69]
    s_waitcnt lgkmcnt(8)
    MV 240,152,16
    RT 148,32,57344
    RT 150,32,61440
    MV 244,152,20
    global_load_lds_dwordx4 v3, s[12:13] offset:1024
    v_cndmask_b32 v227, v227, v24, s[68:69]
    v_cndmask_b32 v228, v228, v24, s[68:69]
    v_cndmask_b32 v229, v229, v24, s[68:69]
    v_cndmask_b32 v230, v230, v24, s[68:69]
    v_cndmask_b32 v231, v231, v24, s[68:69]
    s_add_u32 m0, s26, 24576
    MV 252,128,20
    RT 152,33,57344
    RT 154,33,61440
    MV 248,128,16
    v_add_u32 v3, 65536, v3
    global_load_lds_dwordx4 v2, s[12:13] offset:0
    v_cndmask_b32 v232, v232, v24, s[68:69]
    v_cndmask_b32 v233, v233, v24, s[68:69]
    v_cndmask_b32 v234, v234, v24, s[68:69]
    v_cndmask_b32 v235, v235, v24, s[68:69]
    v_cndmask_b32 v236, v236, v24, s[68:69]
    s_waitcnt lgkmcnt(8)
    MV 176,132,16
    RT 128,34,57344
    v_add_u32 v2, 65536, v2
    MV 180,132,20
    RT 130,34,61440
    v_cndmask_b32 v237, v237, v24, s[68:69]
    v_cndmask_b32 v238, v238, v24, s[68:69]
    v_cndmask_b32 v239, v239, v24, s[68:69]
    v_mfma_f32_16x16x32_bf16 v[144:147], v[224:227], v[64:67], 0
    v_mfma_f32_16x16x32_bf16 v[148:151], v[228:231], v[80:83], 0
    MV 188,136,20
    RT 132,35,57344
    RT 134,35,61440
    MV 184,136,16
    global_load_lds_dwordx4 v3, s[12:13] offset:1024
    v_mfma_f32_16x16x32_bf16 v[128:131], a[160:163], v[64:67], 0
    v_mfma_f32_16x16x32_bf16 v[132:135], a[164:167], v[64:67], 0
    v_mfma_f32_16x16x32_bf16 v[136:139], a[168:171], v[80:83], 0
    v_mfma_f32_16x16x32_bf16 v[140:143], a[172:175], v[80:83], 0
    v_mfma_f32_16x16x32_bf16 v[168:171], v[224:227], v[68:71], 0
    s_waitcnt lgkmcnt(8)
    MV 192,140,16
    RT 136,36,57344
    v_add_u32 v3, 65536, v3
    MV 196,140,20
    RT 138,36,61440
    v_mfma_f32_16x16x32_bf16 v[172:175], v[228:231], v[84:87], 0
    v_mfma_f32_16x16x32_bf16 v[152:155], a[160:163], v[68:71], 0
    v_mfma_f32_16x16x32_bf16 v[156:159], a[164:167], v[68:71], 0
    v_mfma_f32_16x16x32_bf16 v[160:163], a[168:171], v[84:87], 0
    v_mfma_f32_16x16x32_bf16 v[164:167], a[172:175], v[84:87], 0
    MV 204,144,20
    RT 140,37,57344
    RT 142,37,61440
    MV 200,144,16
    global_load_dwordx4 a[96:99], v28, s[8:9] offset:0 sc1
    v_mul_f32 v146, v144, v149
    v_mul_f32 v147, v145, v149
    v_fmac_f32 v146, v148, v145
    v_fmac_f32 v146, s4, v147
    v_rcp_f32 v146, v146
    s_waitcnt lgkmcnt(8)
    MV 208,148,24
    RT 144,38,57344
    MV 212,148,28
    RT 146,38,61440
    s_nop 0
    v_mul_f32 v150, v149, v146
    v_mul_f32 v151, v145, v146
    v_mul_f32 v128, v128, v150
    v_mul_f32 v129, v129, v150
    MV 220,152,28
    RT 148,39,57344
    RT 150,39,61440
    MV 216,152,24
    global_load_dwordx4 a[100:103], v28, s[8:9] offset:1024 sc1
    v_mul_f32 v130, v130, v150
    v_mul_f32 v131, v131, v150
    v_mul_f32 v132, v132, v150
    v_mul_f32 v133, v133, v150
    v_mul_f32 v134, v134, v150
    s_waitcnt lgkmcnt(8)
    MV 240,128,24
    RT 152,40,0
    s_add_u32 s59, s58, 4294955008
    MV 244,128,28
    RT 154,40,4096
    v_add_u32 v28, s59, v28
    v_mul_f32 v135, v135, v150
    v_fmac_f32 v128, v136, v151
    v_fmac_f32 v129, v137, v151
    v_fmac_f32 v130, v138, v151
    v_fmac_f32 v131, v139, v151
    MV 252,132,28
    RT 128,41,0
    RT 130,41,4096
    MV 248,132,24
    global_load_dwordx4 a[104:107], v28, s[8:9] offset:0 sc1
    v_fmac_f32 v132, v140, v151
    v_fmac_f32 v133, v141, v151
    v_fmac_f32 v134, v142, v151
    v_fmac_f32 v135, v143, v151
    v_cvt_pk_bf16_f32 v128, v128, v129
    s_waitcnt lgkmcnt(8)
    MV 176,136,24
    RT 132,42,0
    MV 180,136,28
    RT 134,42,4096
    v_cvt_pk_bf16_f32 v129, v130, v131
    v_cvt_pk_bf16_f32 v130, v132, v133
    v_cvt_pk_bf16_f32 v131, v134, v135
    buffer_store_dwordx4 v[128:131], v1, s[8:11], s60 offen offset:0 sc1
    v_mfma_f32_16x16x32_bf16 v[144:147], v[224:227], v[72:75], 0
    MV 188,140,28
    RT 136,43,0
    RT 138,43,4096
    MV 184,140,24
    global_load_dwordx4 a[108:111], v28, s[8:9] offset:1024 sc1
    v_mfma_f32_16x16x32_bf16 v[148:151], v[228:231], v[88:91], 0
    v_mfma_f32_16x16x32_bf16 v[128:131], a[160:163], v[72:75], 0
    v_mfma_f32_16x16x32_bf16 v[132:135], a[164:167], v[72:75], 0
    v_mfma_f32_16x16x32_bf16 v[136:139], a[168:171], v[88:91], 0
    v_mfma_f32_16x16x32_bf16 v[140:143], a[172:175], v[88:91], 0
    s_waitcnt lgkmcnt(8)
    MV 192,144,24
    RT 140,44,0
    v_add_u32 v28, 4096, v28
    MV 196,144,28
    RT 142,44,4096
    v_mul_f32 v170, v168, v173
    v_mul_f32 v171, v169, v173
    v_fmac_f32 v170, v172, v169
    v_fmac_f32 v170, s4, v171
    v_rcp_f32 v170, v170
    s_waitcnt lgkmcnt(10)
    s_barrier
    s_add_u32 m0, s26, 32768
    MV 204,148,28
    RT 144,45,0
    RT 146,45,4096
    MV 200,148,24
    global_load_lds_dwordx4 v2, s[12:13] offset:0
    s_nop 0
    v_mul_f32 v174, v173, v170
    v_mul_f32 v175, v169, v170
    v_mul_f32 v152, v152, v174
    v_mul_f32 v153, v153, v174
    s_waitcnt lgkmcnt(8)
    MV 208,152,32
    RT 148,46,0
    RT 150,46,4096
    MV 212,152,36
    s_add_u32 s59, s3, 4294770688
    v_add_u32 v2, s59, v2
    global_load_lds_dwordx4 v3, s[12:13] offset:1024
    v_mul_f32 v154, v154, v174
    v_mul_f32 v155, v155, v174
    v_mul_f32 v156, v156, v174
    v_mul_f32 v157, v157, v174
    v_mul_f32 v158, v158, v174
    MV 220,128,36
    RT 152,47,0
    s_add_u32 s59, s3, 4294770688
    MV 216,128,32
    RT 154,47,4096
    v_add_u32 v3, s59, v3
    v_mul_f32 v159, v159, v174
    v_fmac_f32 v152, v160, v175
    v_fmac_f32 v153, v161, v175
    v_fmac_f32 v154, v162, v175
    v_fmac_f32 v155, v163, v175
    s_waitcnt lgkmcnt(8)
    MV 240,132,32
    RT 128,40,8192
    MV 244,132,36
    RT 130,40,12288
    v_fmac_f32 v156, v164, v175
    v_fmac_f32 v157, v165, v175
    v_fmac_f32 v158, v166, v175
    v_fmac_f32 v159, v167, v175
    v_cvt_pk_bf16_f32 v152, v152, v153
    s_add_u32 m0, s26, 40960
    MV 252,136,36
    RT 132,41,8192
    RT 134,41,12288
    MV 248,136,32
    global_load_lds_dwordx4 v2, s[12:13] offset:0
    v_cvt_pk_bf16_f32 v153, v154, v155
    v_cvt_pk_bf16_f32 v154, v156, v157
    v_cvt_pk_bf16_f32 v155, v158, v159
    buffer_store_dwordx4 v[152:155], v1, s[8:11], s60 offen offset:1024 sc1
    v_mfma_f32_16x16x32_bf16 v[168:171], v[224:227], v[76:79], 0
    s_waitcnt lgkmcnt(8)
    MV 176,140,32
    RT 136,42,8192
    v_add_u32 v2, 65536, v2
    MV 180,140,36
    RT 138,42,12288
    v_mfma_f32_16x16x32_bf16 v[172:175], v[228:231], v[92:95], 0
    v_mfma_f32_16x16x32_bf16 v[152:155], a[160:163], v[76:79], 0
    v_mfma_f32_16x16x32_bf16 v[156:159], a[164:167], v[76:79], 0
    v_mfma_f32_16x16x32_bf16 v[160:163], a[168:171], v[92:95], 0
    v_mfma_f32_16x16x32_bf16 v[164:167], a[172:175], v[92:95], 0
    MV 188,144,36
    RT 140,43,8192
    RT 142,43,12288
    MV 184,144,32
    global_load_lds_dwordx4 v3, s[12:13] offset:1024
    v_mul_f32 v146, v144, v149
    v_mul_f32 v147, v145, v149
    v_fmac_f32 v146, v148, v145
    v_fmac_f32 v146, s4, v147
    v_rcp_f32 v146, v146
    s_waitcnt lgkmcnt(8)
    MV 192,148,32
    RT 144,44,8192
    v_add_u32 v3, 65536, v3
    MV 196,148,36
    RT 146,44,12288
    s_nop 0
    v_mul_f32 v150, v149, v146
    v_mul_f32 v151, v145, v146
    v_mul_f32 v128, v128, v150
    v_mul_f32 v129, v129, v150
    MV 204,152,36
    RT 148,45,8192
    RT 150,45,12288
    MV 200,152,32
    global_load_dwordx4 a[112:115], v28, s[8:9] offset:0 sc1
    v_mul_f32 v130, v130, v150
    v_mul_f32 v131, v131, v150
    v_mul_f32 v132, v132, v150
    v_mul_f32 v133, v133, v150
    v_mul_f32 v134, v134, v150
    s_waitcnt lgkmcnt(8)
    MV 208,128,40
    RT 152,46,8192
    MV 212,128,44
    RT 154,46,12288
    v_mul_f32 v135, v135, v150
    v_fmac_f32 v128, v136, v151
    v_fmac_f32 v129, v137, v151
    v_fmac_f32 v130, v138, v151
    v_fmac_f32 v131, v139, v151
    MV 220,132,44
    RT 128,47,8192
    RT 130,47,12288
    MV 216,132,40
    global_load_dwordx4 a[116:119], v28, s[8:9] offset:1024 sc1
    v_fmac_f32 v132, v140, v151
    v_fmac_f32 v133, v141, v151
    v_fmac_f32 v134, v142, v151
    v_fmac_f32 v135, v143, v151
    v_cvt_pk_bf16_f32 v128, v128, v129
    s_waitcnt lgkmcnt(8)
    MV 240,136,40
    RT 132,40,16384
    v_add_u32 v28, 4096, v28
    MV 244,136,44
    RT 134,40,20480
    v_cvt_pk_bf16_f32 v129, v130, v131
    v_cvt_pk_bf16_f32 v130, v132, v133
    v_cvt_pk_bf16_f32 v131, v134, v135
    buffer_store_dwordx4 v[128:131], v1, s[8:11], s60 offen offset:2048 sc1
    v_mfma_f32_16x16x32_bf16 v[144:147], v[232:235], v[96:99], 0
    MV 252,140,44
    RT 136,41,16384
    RT 138,41,20480
    MV 248,140,40
    global_load_dwordx4 a[120:123], v28, s[8:9] offset:0 sc1
    v_mfma_f32_16x16x32_bf16 v[148:151], v[236:239], v[112:115], 0
    v_mfma_f32_16x16x32_bf16 v[128:131], a[176:179], v[96:99], 0
    v_mfma_f32_16x16x32_bf16 v[132:135], a[180:183], v[96:99], 0
    v_mfma_f32_16x16x32_bf16 v[136:139], a[184:187], v[112:115], 0
    v_mfma_f32_16x16x32_bf16 v[140:143], a[188:191], v[112:115], 0
    s_waitcnt lgkmcnt(8)
    MV 176,144,40
    RT 140,42,16384
    MV 180,144,44
    RT 142,42,20480
    v_mul_f32 v170, v168, v173
    v_mul_f32 v171, v169, v173
    v_fmac_f32 v170, v172, v169
    v_fmac_f32 v170, s4, v171
    v_rcp_f32 v170, v170
    MV 188,148,44
    RT 144,43,16384
    RT 146,43,20480
    MV 184,148,40
    global_load_dwordx4 a[124:127], v28, s[8:9] offset:1024 sc1
    s_nop 0
    v_mul_f32 v174, v173, v170
    v_mul_f32 v175, v169, v170
    v_mul_f32 v152, v152, v174
    v_mul_f32 v153, v153, v174
    s_waitcnt lgkmcnt(8)
    MV 192,152,40
    RT 148,44,16384
    v_add_u32 v28, 4096, v28
    MV 196,152,44
    RT 150,44,20480
    v_mul_f32 v154, v154, v174
    v_mul_f32 v155, v155, v174
    v_mul_f32 v156, v156, v174
    v_mul_f32 v157, v157, v174
    v_mul_f32 v158, v158, v174
    s_waitcnt lgkmcnt(10)
    s_barrier
    s_add_u32 m0, s26, 49152
    MV 204,128,44
    RT 152,45,16384
    RT 154,45,20480
    MV 200,128,40
    global_load_lds_dwordx4 v2, s[12:13] offset:0
    v_mul_f32 v159, v159, v174
    v_fmac_f32 v152, v160, v175
    v_fmac_f32 v153, v161, v175
    v_fmac_f32 v154, v162, v175
    v_fmac_f32 v155, v163, v175
    s_waitcnt lgkmcnt(8)
    MV 208,132,48
    RT 128,46,16384
    RT 130,46,20480
    MV 212,132,52
    v_add_u32 v2, 65536, v2
    global_load_lds_dwordx4 v3, s[12:13] offset:1024
    v_fmac_f32 v156, v164, v175
    v_fmac_f32 v157, v165, v175
    v_fmac_f32 v158, v166, v175
    v_fmac_f32 v159, v167, v175
    v_cvt_pk_bf16_f32 v152, v152, v153
    MV 220,136,52
    RT 132,47,16384
    v_add_u32 v3, 65536, v3
    MV 216,136,48
    RT 134,47,20480
    v_cvt_pk_bf16_f32 v153, v154, v155
    v_cvt_pk_bf16_f32 v154, v156, v157
    v_cvt_pk_bf16_f32 v155, v158, v159
    buffer_store_dwordx4 v[152:155], v1, s[8:11], s60 offen offset:3072 sc1
    v_mfma_f32_16x16x32_bf16 v[168:171], v[232:235], v[100:103], 0
    s_waitcnt lgkmcnt(8)
    MV 240,140,48
    RT 136,40,24576
    MV 244,140,52
    RT 138,40,28672
    v_mfma_f32_16x16x32_bf16 v[172:175], v[236:239], v[116:119], 0
    v_mfma_f32_16x16x32_bf16 v[152:155], a[176:179], v[100:103], 0
    v_mfma_f32_16x16x32_bf16 v[156:159], a[180:183], v[100:103], 0
    v_mfma_f32_16x16x32_bf16 v[160:163], a[184:187], v[116:119], 0
    v_mfma_f32_16x16x32_bf16 v[164:167], a[188:191], v[116:119], 0
    s_add_u32 m0, s26, 57344
    MV 252,144,52
    RT 140,41,24576
    RT 142,41,28672
    MV 248,144,48
    global_load_lds_dwordx4 v2, s[12:13] offset:0
    v_mul_f32 v146, v144, v149
    v_mul_f32 v147, v145, v149
    v_fmac_f32 v146, v148, v145
    v_fmac_f32 v146, s4, v147
    v_rcp_f32 v146, v146
    s_waitcnt lgkmcnt(8)
    MV 176,148,48
    RT 144,42,24576
    v_add_u32 v2, 65536, v2
    MV 180,148,52
    RT 146,42,28672
    s_nop 0
    v_mul_f32 v150, v149, v146
    v_mul_f32 v151, v145, v146
    v_mul_f32 v128, v128, v150
    v_mul_f32 v129, v129, v150
    MV 188,152,52
    RT 148,43,24576
    RT 150,43,28672
    MV 184,152,48
    global_load_lds_dwordx4 v3, s[12:13] offset:1024
    v_mul_f32 v130, v130, v150
    v_mul_f32 v131, v131, v150
    v_mul_f32 v132, v132, v150
    v_mul_f32 v133, v133, v150
    v_mul_f32 v134, v134, v150
    s_waitcnt lgkmcnt(8)
    MV 192,128,48
    RT 152,44,24576
    v_add_u32 v3, 65536, v3
    MV 196,128,52
    RT 154,44,28672
    v_mul_f32 v135, v135, v150
    v_fmac_f32 v128, v136, v151
    v_fmac_f32 v129, v137, v151
    v_fmac_f32 v130, v138, v151
    v_fmac_f32 v131, v139, v151
    MV 204,132,52
    RT 128,45,24576
    RT 130,45,28672
    MV 200,132,48
    global_load_dwordx4 a[0:3], v28, s[8:9] offset:0 sc1
    v_fmac_f32 v132, v140, v151
    v_fmac_f32 v133, v141, v151
    v_fmac_f32 v134, v142, v151
    v_fmac_f32 v135, v143, v151
    v_cvt_pk_bf16_f32 v128, v128, v129
    s_waitcnt vmcnt(33) lgkmcnt(8)
    MV 208,136,56
    RT 132,46,24576
    MV 212,136,60
    RT 134,46,28672
    v_cvt_pk_bf16_f32 v129, v130, v131
    v_cvt_pk_bf16_f32 v130, v132, v133
    v_cvt_pk_bf16_f32 v131, v134, v135
    buffer_store_dwordx4 v[128:131], v1, s[8:11], s61 offen offset:0 sc1
    v_mfma_f32_16x16x32_bf16 v[144:147], v[232:235], v[104:107], 0
    MV 220,140,60
    RT 136,47,24576
    RT 138,47,28672
    MV 216,140,56
    global_load_dwordx4 a[4:7], v28, s[8:9] offset:1024 sc1
    v_mfma_f32_16x16x32_bf16 v[148:151], v[236:239], v[120:123], 0
    v_mfma_f32_16x16x32_bf16 v[128:131], a[176:179], v[104:107], 0
    v_mfma_f32_16x16x32_bf16 v[132:135], a[180:183], v[104:107], 0
    v_mfma_f32_16x16x32_bf16 v[136:139], a[184:187], v[120:123], 0
    v_mfma_f32_16x16x32_bf16 v[140:143], a[188:191], v[120:123], 0
    s_waitcnt lgkmcnt(8)
    MV 240,144,56
    RT 140,40,32768
    s_add_u32 s59, s58, 4294955008
    MV 244,144,60
    RT 142,40,36864
    v_add_u32 v28, s59, v28
    v_mul_f32 v170, v168, v173
    v_mul_f32 v171, v169, v173
    v_fmac_f32 v170, v172, v169
    v_fmac_f32 v170, s4, v171
    v_rcp_f32 v170, v170
    MV 252,148,60
    RT 144,41,32768
    RT 146,41,36864
    MV 248,148,56
    global_load_dwordx4 a[8:11], v28, s[8:9] offset:0 sc1
    s_nop 0
    v_mul_f32 v174, v173, v170
    v_mul_f32 v175, v169, v170
    v_mul_f32 v152, v152, v174
    v_mul_f32 v153, v153, v174
    s_waitcnt lgkmcnt(8)
    MV 176,152,56
    RT 148,42,32768
    MV 180,152,60
    RT 150,42,36864
    v_mul_f32 v154, v154, v174
    v_mul_f32 v155, v155, v174
    v_mul_f32 v156, v156, v174
    v_mul_f32 v157, v157, v174
    v_mul_f32 v158, v158, v174
    MV 188,128,60
    RT 152,43,32768
    RT 154,43,36864
    MV 184,128,56
    global_load_dwordx4 a[12:15], v28, s[8:9] offset:1024 sc1
    v_mul_f32 v159, v159, v174
    v_fmac_f32 v152, v160, v175
    v_fmac_f32 v153, v161, v175
    v_fmac_f32 v154, v162, v175
    v_fmac_f32 v155, v163, v175
    s_waitcnt lgkmcnt(8)
    MV 192,132,56
    RT 128,44,32768
    v_add_u32 v28, 4096, v28
    MV 196,132,60
    RT 130,44,36864
    v_fmac_f32 v156, v164, v175
    v_fmac_f32 v157, v165, v175
    v_fmac_f32 v158, v166, v175
    v_fmac_f32 v159, v167, v175
    v_cvt_pk_bf16_f32 v152, v152, v153
    s_waitcnt lgkmcnt(10)
    s_barrier
    s_add_u32 m0, s26, 65536
    MV 204,136,60
    RT 132,45,32768
    RT 134,45,36864
    MV 200,136,56
    global_load_lds_dwordx4 v2, s[12:13] offset:0
    v_cvt_pk_bf16_f32 v153, v154, v155
    v_cvt_pk_bf16_f32 v154, v156, v157
    v_cvt_pk_bf16_f32 v155, v158, v159
    buffer_store_dwordx4 v[152:155], v1, s[8:11], s61 offen offset:1024 sc1
    v_mfma_f32_16x16x32_bf16 v[168:171], v[232:235], v[108:111], 0
    s_waitcnt vmcnt(37) lgkmcnt(8)
    MV 208,140,64
    RT 136,46,32768
    RT 138,46,36864
    MV 212,140,68
    s_add_u32 s59, s3, 4294770688
    v_add_u32 v2, s59, v2
    global_load_lds_dwordx4 v3, s[12:13] offset:1024
    v_mfma_f32_16x16x32_bf16 v[172:175], v[236:239], v[124:127], 0
    v_mfma_f32_16x16x32_bf16 v[152:155], a[176:179], v[108:111], 0
    v_mfma_f32_16x16x32_bf16 v[156:159], a[180:183], v[108:111], 0
    v_mfma_f32_16x16x32_bf16 v[160:163], a[184:187], v[124:127], 0
    v_mfma_f32_16x16x32_bf16 v[164:167], a[188:191], v[124:127], 0
    MV 220,144,68
    RT 140,47,32768
    s_add_u32 s59, s3, 4294770688
    MV 216,144,64
    RT 142,47,36864
    v_add_u32 v3, s59, v3
    v_mul_f32 v146, v144, v149
    v_mul_f32 v147, v145, v149
    v_fmac_f32 v146, v148, v145
    v_fmac_f32 v146, s4, v147
    v_rcp_f32 v146, v146
    s_waitcnt lgkmcnt(8)
    MV 240,148,64
    RT 144,40,40960
    MV 244,148,68
    RT 146,40,45056
    s_nop 0
    v_mul_f32 v150, v149, v146
    v_mul_f32 v151, v145, v146
    v_mul_f32 v128, v128, v150
    v_mul_f32 v129, v129, v150
    s_add_u32 m0, s26, 73728
    MV 252,152,68
    RT 148,41,40960
    RT 150,41,45056
    MV 248,152,64
    global_load_lds_dwordx4 v2, s[12:13] offset:0
    v_mul_f32 v130, v130, v150
    v_mul_f32 v131, v131, v150
    v_mul_f32 v132, v132, v150
    v_mul_f32 v133, v133, v150
    v_mul_f32 v134, v134, v150
    s_waitcnt lgkmcnt(8)
    MV 176,128,64
    RT 152,42,40960
    v_add_u32 v2, 65536, v2
    MV 180,128,68
    RT 154,42,45056
    v_mul_f32 v135, v135, v150
    v_fmac_f32 v128, v136, v151
    v_fmac_f32 v129, v137, v151
    v_fmac_f32 v130, v138, v151
    v_fmac_f32 v131, v139, v151
    MV 188,132,68
    RT 128,43,40960
    RT 130,43,45056
    MV 184,132,64
    global_load_lds_dwordx4 v3, s[12:13] offset:1024
    v_fmac_f32 v132, v140, v151
    v_fmac_f32 v133, v141, v151
    v_fmac_f32 v134, v142, v151
    v_fmac_f32 v135, v143, v151
    v_cvt_pk_bf16_f32 v128, v128, v129
    s_waitcnt lgkmcnt(8)
    MV 192,136,64
    RT 132,44,40960
    v_add_u32 v3, 65536, v3
    MV 196,136,68
    RT 134,44,45056
    v_cvt_pk_bf16_f32 v129, v130, v131
    v_cvt_pk_bf16_f32 v130, v132, v133
    v_cvt_pk_bf16_f32 v131, v134, v135
    buffer_store_dwordx4 v[128:131], v1, s[8:11], s61 offen offset:2048 sc1
    v_mul_f32 v170, v168, v173
    MV 204,140,68
    RT 136,45,40960
    RT 138,45,45056
    MV 200,140,64
    global_load_dwordx4 a[16:19], v28, s[8:9] offset:0 sc1
    v_mul_f32 v171, v169, v173
    v_fmac_f32 v170, v172, v169
    v_fmac_f32 v170, s4, v171
    v_rcp_f32 v170, v170
    s_nop 0
    s_waitcnt vmcnt(40) lgkmcnt(8)
    MV 208,144,72
    RT 140,46,40960
    MV 212,144,76
    RT 142,46,45056
    v_mul_f32 v174, v173, v170
    v_mul_f32 v175, v169, v170
    v_mul_f32 v152, v152, v174
    v_mul_f32 v153, v153, v174
    v_mul_f32 v154, v154, v174
    MV 220,148,76
    RT 144,47,40960
    RT 146,47,45056
    MV 216,148,72
    global_load_dwordx4 a[20:23], v28, s[8:9] offset:1024 sc1
    v_mul_f32 v155, v155, v174
    v_mul_f32 v156, v156, v174
    v_mul_f32 v157, v157, v174
    v_mul_f32 v158, v158, v174
    v_mul_f32 v159, v159, v174
    s_waitcnt lgkmcnt(8)
    MV 240,152,72
    RT 148,40,49152
    v_add_u32 v28, 4096, v28
    MV 244,152,76
    RT 150,40,53248
    v_fmac_f32 v152, v160, v175
    v_fmac_f32 v153, v161, v175
    v_fmac_f32 v154, v162, v175
    v_fmac_f32 v155, v163, v175
    v_fmac_f32 v156, v164, v175
    MV 252,128,76
    RT 152,41,49152
    RT 154,41,53248
    MV 248,128,72
    global_load_dwordx4 a[24:27], v28, s[8:9] offset:0 sc1
    v_fmac_f32 v157, v165, v175
    v_fmac_f32 v158, v166, v175
    v_fmac_f32 v159, v167, v175
    v_cvt_pk_bf16_f32 v152, v152, v153
    v_cvt_pk_bf16_f32 v153, v154, v155
    s_waitcnt lgkmcnt(8)
    MV 176,132,72
    RT 128,42,49152
    MV 180,132,76
    RT 130,42,53248
    v_cvt_pk_bf16_f32 v154, v156, v157
    v_cvt_pk_bf16_f32 v155, v158, v159
    buffer_store_dwordx4 v[152:155], v1, s[8:11], s61 offen offset:3072 sc1
    MV 188,136,76
    RT 132,43,49152
    RT 134,43,53248
    MV 184,136,72
    global_load_dwordx4 a[28:31], v28, s[8:9] offset:1024 sc1
    s_waitcnt lgkmcnt(8)
    MV 192,140,72
    RT 136,44,49152
    v_add_u32 v28, 4096, v28
    MV 196,140,76
    RT 138,44,53248
    s_waitcnt lgkmcnt(10)
    s_barrier
    MV 204,144,76
    RT 140,45,49152
    MV 200,144,72
    RT 142,45,53248
    s_waitcnt vmcnt(42) lgkmcnt(8)
    s_add_u32 m0, s26, 81920
    MV 208,148,80
    RT 144,46,49152
    RT 146,46,53248
    MV 212,148,84
    global_load_lds_dwordx4 v2, s[12:13] offset:0
    MV 220,152,84
    RT 148,47,49152
    RT 150,47,53248
    MV 216,152,80
    v_add_u32 v2, 65536, v2
    global_load_lds_dwordx4 v3, s[12:13] offset:1024
    s_waitcnt lgkmcnt(8)
    MV 240,128,80
    RT 152,40,57344
    v_add_u32 v3, 65536, v3
    MV 244,128,84
    RT 154,40,61440
    MV 252,132,84
    RT 128,41,57344
    MV 248,132,80
    RT 130,41,61440
    s_waitcnt lgkmcnt(8)
    MV 176,136,80
    RT 132,42,57344
    MV 180,136,84
    RT 134,42,61440
    MV 188,140,84
    RT 136,43,57344
    MV 184,140,80
    RT 138,43,61440
    s_waitcnt lgkmcnt(8)
    MV 192,144,80
    RT 140,44,57344
    MV 196,144,84
    RT 142,44,61440
    MV 204,148,84
    RT 144,45,57344
    MV 200,148,80
    RT 146,45,61440
    s_waitcnt vmcnt(42) lgkmcnt(8)
    s_add_u32 m0, s26, 90112
    MV 208,152,88
    RT 148,46,57344
    RT 150,46,61440
    MV 212,152,92
    global_load_lds_dwordx4 v2, s[12:13] offset:0
    MV 220,128,92
    RT 152,47,57344
    RT 154,47,61440
    MV 216,128,88
    v_add_u32 v2, 65536, v2
    global_load_lds_dwordx4 v3, s[12:13] offset:1024
    s_waitcnt lgkmcnt(8)
    MV 240,132,88
    RT 128,32,0
    v_add_u32 v3, 65536, v3
    MV 244,132,92
    RT 130,32,4096
    MV 252,136,92
    RT 132,33,0
    MV 248,136,88
    RT 134,33,4096
    s_waitcnt lgkmcnt(8)
    MV 176,140,88
    RT 136,34,0
    MV 180,140,92
    RT 138,34,4096
    MV 188,144,92
    RT 140,35,0
    MV 184,144,88
    RT 142,35,4096
    s_waitcnt lgkmcnt(8)
    MV 192,148,88
    RT 144,36,0
    MV 196,148,92
    RT 146,36,4096
    s_waitcnt vmcnt(40) lgkmcnt(10)
    s_barrier
    MV 204,152,92
    RT 148,37,0
    RT 150,37,4096
    MV 200,152,88
    global_load_dwordx4 a[32:35], v28, s[8:9] offset:0 sc1
    s_waitcnt vmcnt(6)
    v_mov_b32 v24, 1
    s_mov_b64 exec, 1
    buffer_store_dword v24, v31, s[8:11], s62 offen sc1
    s_mov_b64 exec, -1
    s_waitcnt lgkmcnt(8)
    MV 208,128,96
    RT 152,38,0
    RT 154,38,4096
    MV 212,128,100
    global_load_dwordx4 a[36:39], v28, s[8:9] offset:1024 sc1
    MV 220,132,100
    RT 128,39,0
    s_add_u32 s59, s58, 4294955008
    MV 216,132,96
    RT 130,39,4096
    v_add_u32 v28, s59, v28
    s_waitcnt lgkmcnt(8)
    MV 240,136,96
    RT 132,32,8192
    RT 134,32,12288
    MV 244,136,100
    global_load_dwordx4 a[40:43], v28, s[8:9] offset:0 sc1
    MV 252,140,100
    RT 136,33,8192
    RT 138,33,12288
    MV 248,140,96
    global_load_dwordx4 a[44:47], v28, s[8:9] offset:1024 sc1
    s_waitcnt lgkmcnt(8)
    MV 176,144,96
    RT 140,34,8192
    v_add_u32 v28, 4096, v28
    MV 180,144,100
    RT 142,34,12288
    s_add_u32 m0, s26, 98304
    MV 188,148,100
    RT 144,35,8192
    RT 146,35,12288
    MV 184,148,96
    global_load_lds_dwordx4 v2, s[12:13] offset:0
    s_waitcnt lgkmcnt(8)
    MV 192,152,96
    RT 148,36,8192
    RT 150,36,12288
    MV 196,152,100
    s_add_u32 s59, s3, 4294770688
    v_add_u32 v2, s59, v2
    global_load_lds_dwordx4 v3, s[12:13] offset:1024
    MV 204,128,100
    RT 152,37,8192
    s_add_u32 s59, s3, 4294770688
    MV 200,128,96
    RT 154,37,12288
    v_add_u32 v3, s59, v3
    s_waitcnt lgkmcnt(8)
    s_add_u32 m0, s26, 106496
    MV 208,132,104
    RT 128,38,8192
    RT 130,38,12288
    MV 212,132,108
    global_load_lds_dwordx4 v2, s[12:13] offset:0
    MV 220,136,108
    RT 132,39,8192
    RT 134,39,12288
    MV 216,136,104
    v_add_u32 v2, 65536, v2
    global_load_lds_dwordx4 v3, s[12:13] offset:1024
    s_waitcnt lgkmcnt(8)
    MV 240,140,104
    RT 136,32,16384
    v_add_u32 v3, 65536, v3
    MV 244,140,108
    RT 138,32,20480
    MV 252,144,108
    RT 140,33,16384
    RT 142,33,20480
    MV 248,144,104
    global_load_dwordx4 a[48:51], v28, s[8:9] offset:0 sc1
    s_waitcnt lgkmcnt(8)
    MV 176,148,104
    RT 144,34,16384
    MV 180,148,108
    RT 146,34,20480
    MV 188,152,108
    RT 148,35,16384
    RT 150,35,20480
    MV 184,152,104
    global_load_dwordx4 a[52:55], v28, s[8:9] offset:1024 sc1
    s_waitcnt lgkmcnt(8)
    MV 192,128,104
    RT 152,36,16384
    v_add_u32 v28, 4096, v28
    MV 196,128,108
    RT 154,36,20480
    s_waitcnt lgkmcnt(10)
    s_barrier
    MV 204,132,108
    RT 128,37,16384
    RT 130,37,20480
    MV 200,132,104
    global_load_dwordx4 a[56:59], v28, s[8:9] offset:0 sc1
    s_waitcnt lgkmcnt(8)
    MV 208,136,112
    RT 132,38,16384
    RT 134,38,20480
    MV 212,136,116
    global_load_dwordx4 a[60:63], v28, s[8:9] offset:1024 sc1
    MV 220,140,116
    RT 136,39,16384
    v_add_u32 v28, 4096, v28
    MV 216,140,112
    RT 138,39,20480
    s_waitcnt lgkmcnt(8)
    s_add_u32 m0, s26, 114688
    MV 240,144,112
    RT 140,32,24576
    RT 142,32,28672
    MV 244,144,116
    global_load_lds_dwordx4 v2, s[12:13] offset:0
    MV 252,148,116
    RT 144,33,24576
    RT 146,33,28672
    MV 248,148,112
    v_add_u32 v2, 65536, v2
    global_load_lds_dwordx4 v3, s[12:13] offset:1024
    s_waitcnt lgkmcnt(8)
    MV 176,152,112
    RT 148,34,24576
    v_add_u32 v3, 65536, v3
    MV 180,152,116
    RT 150,34,28672
    s_add_u32 m0, s26, 122880
    MV 188,128,116
    RT 152,35,24576
    RT 154,35,28672
    MV 184,128,112
    global_load_lds_dwordx4 v2, s[12:13] offset:0
    s_waitcnt lgkmcnt(8)
    MV 192,132,112
    RT 128,36,24576
    v_add_u32 v2, 65536, v2
    MV 196,132,116
    RT 130,36,28672
    MV 204,136,116
    RT 132,37,24576
    RT 134,37,28672
    MV 200,136,112
    global_load_lds_dwordx4 v3, s[12:13] offset:1024
    s_waitcnt lgkmcnt(8)
    MV 208,140,120
    RT 136,38,24576
    v_add_u32 v3, 65536, v3
    MV 212,140,124
    RT 138,38,28672
    MV 220,144,124
    RT 140,39,24576
    RT 142,39,28672
    MV 216,144,120
    global_load_dwordx4 a[64:67], v28, s[8:9] offset:0 sc1
    s_waitcnt lgkmcnt(8)
    MV 240,148,120
    RT 144,32,32768
    MV 244,148,124
    RT 146,32,36864
    MV 252,152,124
    RT 148,33,32768
    RT 150,33,36864
    MV 248,152,120
    global_load_dwordx4 a[68:71], v28, s[8:9] offset:1024 sc1
    s_waitcnt lgkmcnt(8)
    MV 176,128,120
    RT 152,34,32768
    s_add_u32 s59, s58, 4294955008
    MV 180,128,124
    RT 154,34,36864
    v_add_u32 v28, s59, v28
    MV 188,132,124
    RT 128,35,32768
    RT 130,35,36864
    MV 184,132,120
    global_load_dwordx4 a[72:75], v28, s[8:9] offset:0 sc1
    s_waitcnt lgkmcnt(8)
    MV 192,136,120
    RT 132,36,32768
    MV 196,136,124
    RT 134,36,36864
    s_waitcnt lgkmcnt(10)
    s_barrier
    MV 204,140,124
    RT 136,37,32768
    RT 138,37,36864
    MV 200,140,120
    global_load_dwordx4 a[76:79], v28, s[8:9] offset:1024 sc1
    s_waitcnt lgkmcnt(8)
    s_add_u32 m0, s26, 0
    MV 208,144,0
    RT 140,38,32768
    RT 142,38,36864
    MV 212,144,4
    v_add_u32 v28, 4096, v28
    global_load_lds_dwordx4 v2, s[12:13] offset:0
    MV 220,148,4
    RT 144,39,32768
    s_add_u32 s59, s3, 4294770688
    MV 216,148,0
    RT 146,39,36864
    v_add_u32 v2, s59, v2
    s_waitcnt lgkmcnt(8)
    MV 240,152,0
    RT 148,32,40960
    RT 150,32,45056
    MV 244,152,4
    global_load_lds_dwordx4 v3, s[12:13] offset:1024
    s_add_u32 m0, s26, 8192
    MV 252,128,4
    RT 152,33,40960
    RT 154,33,45056
    MV 248,128,0
    s_add_u32 s59, s3, 4294770688
    v_add_u32 v3, s59, v3
    global_load_lds_dwordx4 v2, s[12:13] offset:0
    s_waitcnt lgkmcnt(8)
    MV 176,132,0
    RT 128,34,40960
    v_add_u32 v2, 65536, v2
    MV 180,132,4
    RT 130,34,45056
    MV 188,136,4
    RT 132,35,40960
    RT 134,35,45056
    MV 184,136,0
    global_load_lds_dwordx4 v3, s[12:13] offset:1024
    s_waitcnt lgkmcnt(8)
    MV 192,140,0
    RT 136,36,40960
    v_add_u32 v3, 65536, v3
    MV 196,140,4
    RT 138,36,45056
    MV 204,144,4
    RT 140,37,40960
    RT 142,37,45056
    MV 200,144,0
    global_load_dwordx4 a[80:83], v28, s[8:9] offset:0 sc1
    s_waitcnt lgkmcnt(8)
    MV 208,148,8
    RT 144,38,40960
    MV 212,148,12
    RT 146,38,45056
    MV 220,152,12
    RT 148,39,40960
    RT 150,39,45056
    MV 216,152,8
    global_load_dwordx4 a[84:87], v28, s[8:9] offset:1024 sc1
    s_waitcnt lgkmcnt(8)
    MV 240,128,8
    RT 152,32,49152
    v_add_u32 v28, 4096, v28
    MV 244,128,12
    RT 154,32,53248
    MV 252,132,12
    RT 128,33,49152
    RT 130,33,53248
    MV 248,132,8
    global_load_dwordx4 a[88:91], v28, s[8:9] offset:0 sc1
    s_waitcnt lgkmcnt(8)
    MV 176,136,8
    RT 132,34,49152
    MV 180,136,12
    RT 134,34,53248
    MV 188,140,12
    RT 136,35,49152
    RT 138,35,53248
    MV 184,140,8
    global_load_dwordx4 a[92:95], v28, s[8:9] offset:1024 sc1
    s_waitcnt lgkmcnt(8)
    MV 192,144,8
    RT 140,36,49152
    v_add_u32 v28, 4096, v28
    MV 196,144,12
    RT 142,36,53248
    s_waitcnt lgkmcnt(10)
    s_barrier
    s_add_u32 m0, s26, 16384
    MV 204,148,12
    RT 144,37,49152
    RT 146,37,53248
    MV 200,148,8
    global_load_lds_dwordx4 v2, s[12:13] offset:0
    s_waitcnt lgkmcnt(8)
    MV 208,152,16
    RT 148,38,49152
    RT 150,38,53248
    MV 212,152,20
    v_add_u32 v2, 65536, v2
    global_load_lds_dwordx4 v3, s[12:13] offset:1024
    MV 220,128,20
    RT 152,39,49152
    v_add_u32 v3, 65536, v3
    MV 216,128,16
    RT 154,39,53248
    s_waitcnt lgkmcnt(8)
    MV 240,132,16
    RT 128,32,57344
    MV 244,132,20
    RT 130,32,61440
    s_add_u32 m0, s26, 24576
    MV 252,136,20
    RT 132,33,57344
    RT 134,33,61440
    MV 248,136,16
    global_load_lds_dwordx4 v2, s[12:13] offset:0
    s_waitcnt lgkmcnt(8)
    MV 176,140,16
    RT 136,34,57344
    v_add_u32 v2, 65536, v2
    MV 180,140,20
    RT 138,34,61440
    MV 188,144,20
    RT 140,35,57344
    RT 142,35,61440
    MV 184,144,16
    global_load_lds_dwordx4 v3, s[12:13] offset:1024
    s_waitcnt lgkmcnt(8)
    MV 192,148,16
    RT 144,36,57344
    v_add_u32 v3, 65536, v3
    MV 196,148,20
    RT 146,36,61440
    MV 204,152,20
    RT 148,37,57344
    RT 150,37,61440
    MV 200,152,16
    global_load_dwordx4 a[96:99], v28, s[8:9] offset:0 sc1
    s_waitcnt vmcnt(38) lgkmcnt(8)
    MV 208,128,24
    RT 152,38,57344
    MV 212,128,28
    RT 154,38,61440
    MV 220,132,28
    RT 128,39,57344
    RT 130,39,61440
    MV 216,132,24
    global_load_dwordx4 a[100:103], v28, s[8:9] offset:1024 sc1
    buffer_load_dword v22, v20, s[8:11], s66 offen sc1
    s_waitcnt lgkmcnt(8)
    MV 240,136,24
    RT 132,40,0
    s_add_u32 s59, s58, 4294955008
    MV 244,136,28
    RT 134,40,4096
    v_add_u32 v28, s59, v28
    MV 252,140,28
    RT 136,41,0
    RT 138,41,4096
    MV 248,140,24
    global_load_dwordx4 a[104:107], v28, s[8:9] offset:0 sc1
    s_waitcnt lgkmcnt(8)
    MV 176,144,24
    RT 140,42,0
    MV 180,144,28
    RT 142,42,4096
    MV 188,148,28
    RT 144,43,0
    RT 146,43,4096
    MV 184,148,24
    global_load_dwordx4 a[108:111], v28, s[8:9] offset:1024 sc1
    s_waitcnt lgkmcnt(8)
    MV 192,152,24
    RT 148,44,0
    v_add_u32 v28, 4096, v28
    MV 196,152,28
    RT 150,44,4096
    s_waitcnt vmcnt(38) lgkmcnt(10)
    s_barrier
    s_add_u32 m0, s26, 32768
    MV 204,128,28
    RT 152,45,0
    RT 154,45,4096
    MV 200,128,24
    global_load_lds_dwordx4 v2, s[12:13] offset:0
    s_waitcnt vmcnt(36) lgkmcnt(8)
    MV 208,132,32
    RT 128,46,0
    RT 130,46,4096
    MV 212,132,36
    v_add_u32 v2, s3, v2
    global_load_lds_dwordx4 v3, s[12:13] offset:1024
    MV 220,136,36
    RT 132,47,0
    v_add_u32 v3, s3, v3
    MV 216,136,32
    RT 134,47,4096
    s_waitcnt lgkmcnt(8)
    MV 240,140,32
    RT 136,40,8192
    MV 244,140,36
    RT 138,40,12288
    s_add_u32 m0, s26, 40960
    MV 252,144,36
    RT 140,41,8192
    RT 142,41,12288
    MV 248,144,32
    global_load_lds_dwordx4 v2, s[12:13] offset:0
    s_waitcnt lgkmcnt(8)
    MV 176,148,32
    RT 144,42,8192
    MV 180,148,36
    RT 146,42,12288
    MV 188,152,36
    RT 148,43,8192
    RT 150,43,12288
    MV 184,152,32
    global_load_lds_dwordx4 v3, s[12:13] offset:1024
    s_waitcnt lgkmcnt(8)
    MV 192,128,32
    RT 152,44,8192
    MV 196,128,36
    RT 154,44,12288
    MV 204,132,36
    RT 128,45,8192
    RT 130,45,12288
    MV 200,132,32
    global_load_dwordx4 a[112:115], v28, s[8:9] offset:0 sc1
    s_waitcnt vmcnt(38) lgkmcnt(8)
    MV 208,136,40
    RT 132,46,8192
    MV 212,136,44
    RT 134,46,12288
    MV 220,140,44
    RT 136,47,8192
    RT 138,47,12288
    MV 216,140,40
    global_load_dwordx4 a[116:119], v28, s[8:9] offset:1024 sc1
    s_waitcnt lgkmcnt(8)
    MV 240,144,40
    RT 140,40,16384
    v_add_u32 v28, 4096, v28
    MV 244,144,44
    RT 142,40,20480
    MV 252,148,44
    RT 144,41,16384
    RT 146,41,20480
    MV 248,148,40
    global_load_dwordx4 a[120:123], v28, s[8:9] offset:0 sc1
    s_waitcnt lgkmcnt(8)
    MV 176,152,40
    RT 148,42,16384
    MV 180,152,44
    RT 150,42,20480
    MV 188,128,44
    RT 152,43,16384
    RT 154,43,20480
    MV 184,128,40
    global_load_dwordx4 a[124:127], v28, s[8:9] offset:1024 sc1
    s_waitcnt lgkmcnt(8)
    MV 192,132,40
    RT 128,44,16384
    v_add_u32 v28, 4096, v28
    MV 196,132,44
    RT 130,44,20480
    s_waitcnt vmcnt(37) lgkmcnt(10)
    s_barrier
    s_add_u32 m0, s48, 49152
    MV 204,136,44
    RT 132,45,16384
    RT 134,45,20480
    MV 200,136,40
    s_add_u32 s41, s48, 49152
    global_load_lds_dwordx4 v6, s[16:17] offset:0
    s_waitcnt vmcnt(36) lgkmcnt(8)
    MV 208,140,48
    RT 136,46,16384
    RT 138,46,20480
    MV 212,140,52
    v_add_u32 v6, 262144, v6
    global_load_lds_dwordx4 v7, s[16:17] offset:1024
    MV 220,144,52
    RT 140,47,16384
    RT 142,47,20480
    MV 216,144,48
    v_add_u32 v7, 262144, v7
    global_load_lds_dwordx4 v8, s[16:17] offset:2048
    s_waitcnt lgkmcnt(8)
    MV 240,148,48
    RT 144,40,24576
    RT 146,40,28672
    MV 244,148,52
    v_add_u32 v8, 262144, v8
    global_load_lds_dwordx4 v9, s[16:17] offset:3072
    MV 252,152,52
    RT 148,41,24576
    RT 150,41,28672
    MV 248,152,48
    v_add_u32 v9, 262144, v9
    global_load_dwordx4 a[0:3], v28, s[8:9] offset:0 sc1
    s_waitcnt lgkmcnt(8)
    MV 176,128,48
    RT 152,42,24576
    RT 154,42,28672
    MV 180,128,52
    global_load_dwordx4 a[4:7], v28, s[8:9] offset:1024 sc1
    s_add_u32 m0, s48, 65536
    MV 188,132,52
    RT 128,43,24576
    RT 130,43,28672
    MV 184,132,48
    v_add_u32 v28, s58, v28
    s_add_u32 s41, s48, 65536
    global_load_lds_dwordx4 v6, s[16:17] offset:0
    s_waitcnt lgkmcnt(8)
    MV 192,136,48
    RT 132,44,24576
    RT 134,44,28672
    MV 196,136,52
    v_add_u32 v6, 262144, v6
    global_load_lds_dwordx4 v7, s[16:17] offset:1024
    MV 204,140,52
    RT 136,45,24576
    RT 138,45,28672
    MV 200,140,48
    v_add_u32 v7, 262144, v7
    global_load_lds_dwordx4 v8, s[16:17] offset:2048
    s_waitcnt vmcnt(42) lgkmcnt(8)
    MV 208,144,56
    RT 140,46,24576
    RT 142,46,28672
    MV 212,144,60
    v_add_u32 v8, 262144, v8
    global_load_dwordx4 a[8:11], v28, s[8:9] offset:0 sc1
    MV 220,148,60
    RT 144,47,24576
    RT 146,47,28672
    MV 216,148,56
    global_load_dwordx4 a[12:15], v28, s[8:9] offset:1024 sc1
    s_waitcnt lgkmcnt(8)
    MV 240,152,56
    RT 148,40,32768
    RT 150,40,36864
    MV 244,152,60
    v_add_u32 v28, s42, v1
    global_load_lds_dwordx4 v9, s[16:17] offset:3072
    MV 252,128,60
    RT 152,41,32768
    RT 154,41,36864
    MV 248,128,56
    v_add_u32 v9, 262144, v9
    s_waitcnt vmcnt(22)
    v_cmp_gt_u32 vcc, 1, v22
    s_nop 0
    s_cbranch_vccnz L_slow_q_5
L_back_q_5:
    global_load_dwordx4 a[16:19], v28, s[8:9] offset:0 sc1
    s_waitcnt lgkmcnt(8)
    MV 176,132,56
    RT 128,42,32768
    RT 130,42,36864
    MV 180,132,60
    global_load_dwordx4 a[20:23], v28, s[8:9] offset:1024 sc1
    MV 188,136,60
    RT 132,43,32768
    RT 134,43,36864
    MV 184,136,56
    v_add_u32 v28, 0x1000, v28
    global_load_dwordx4 a[24:27], v28, s[8:9] offset:0 sc1
    s_waitcnt lgkmcnt(8)
    MV 192,140,56
    RT 136,44,32768
    RT 138,44,36864
    MV 196,140,60
    global_load_dwordx4 a[28:31], v28, s[8:9] offset:1024 sc1
    s_waitcnt lgkmcnt(10)
    s_barrier
    MV 204,144,60
    RT 140,45,32768
    RT 142,45,36864
    MV 200,144,56
    v_add_u32 v28, 0x1000, v28
    global_load_dwordx4 a[32:35], v28, s[8:9] offset:0 sc1
    s_waitcnt lgkmcnt(8)
    MV 208,148,64
    RT 144,46,32768
    RT 146,46,36864
    MV 212,148,68
    global_load_dwordx4 a[36:39], v28, s[8:9] offset:1024 sc1
    MV 220,152,68
    RT 148,47,32768
    RT 150,47,36864
    MV 216,152,64
    v_add_u32 v28, 0x1000, v28
    global_load_dwordx4 a[40:43], v28, s[8:9] offset:0 sc1
    s_waitcnt lgkmcnt(8)
    MV 240,128,64
    RT 152,40,40960
    RT 154,40,45056
    MV 244,128,68
    global_load_dwordx4 a[44:47], v28, s[8:9] offset:1024 sc1
    s_add_u32 m0, s48, 81920
    MV 252,132,68
    RT 128,41,40960
    RT 130,41,45056
    MV 248,132,64
    v_add_u32 v28, 0x1000, v28
    s_add_u32 s41, s48, 81920
    global_load_lds_dwordx4 v6, s[16:17] offset:0
    s_waitcnt lgkmcnt(8)
    MV 176,136,64
    RT 132,42,40960
    RT 134,42,45056
    MV 180,136,68
    v_add_u32 v6, 262144, v6
    global_load_lds_dwordx4 v7, s[16:17] offset:1024
    MV 188,140,68
    RT 136,43,40960
    RT 138,43,45056
    MV 184,140,64
    v_add_u32 v7, 262144, v7
    global_load_lds_dwordx4 v8, s[16:17] offset:2048
    s_waitcnt lgkmcnt(8)
    MV 192,144,64
    RT 140,44,40960
    RT 142,44,45056
    MV 196,144,68
    v_add_u32 v8, 262144, v8
    global_load_lds_dwordx4 v9, s[16:17] offset:3072
    MV 204,148,68
    RT 144,45,40960
    RT 146,45,45056
    MV 200,148,64
    v_add_u32 v9, 262144, v9
    global_load_dwordx4 a[48:51], v28, s[8:9] offset:0 sc1
    s_waitcnt lgkmcnt(8)
    MV 208,152,72
    RT 148,46,40960
    RT 150,46,45056
    MV 212,152,76
    global_load_dwordx4 a[52:55], v28, s[8:9] offset:1024 sc1
    MV 220,128,76
    RT 152,47,40960
    RT 154,47,45056
    MV 216,128,72
    v_add_u32 v28, 0x1000, v28
    global_load_dwordx4 a[56:59], v28, s[8:9] offset:0 sc1
    s_waitcnt lgkmcnt(8)
    MV 240,132,72
    RT 128,40,49152
    RT 130,40,53248
    MV 244,132,76
    global_load_dwordx4 a[60:63], v28, s[8:9] offset:1024 sc1
    MV 252,136,76
    RT 132,41,49152
    RT 134,41,53248
    MV 248,136,72
    v_add_u32 v28, 0x1000, v28
    global_load_dwordx4 a[64:67], v28, s[8:9] offset:0 sc1
    s_waitcnt lgkmcnt(8)
    MV 176,140,72
    RT 136,42,49152
    RT 138,42,53248
    MV 180,140,76
    global_load_dwordx4 a[68:71], v28, s[8:9] offset:1024 sc1
    MV 188,144,76
    RT 140,43,49152
    v_add_u32 v28, 0x1000, v28
    MV 184,144,72
    RT 142,43,53248
    s_waitcnt lgkmcnt(8)
    MV 192,148,72
    RT 144,44,49152
    MV 196,148,76
    RT 146,44,53248
    s_waitcnt lgkmcnt(10)
    s_barrier
    s_add_u32 m0, s48, 98304
    MV 204,152,76
    RT 148,45,49152
    RT 150,45,53248
    MV 200,152,72
    s_add_u32 s41, s48, 98304
    global_load_lds_dwordx4 v6, s[16:17] offset:0
    s_waitcnt lgkmcnt(8)
    MV 208,128,80
    RT 152,46,49152
    RT 154,46,53248
    MV 212,128,84
    v_add_u32 v6, 262144, v6
    global_load_dwordx4 a[72:75], v28, s[8:9] offset:0 sc1
    MV 220,132,84
    RT 128,47,49152
    RT 130,47,53248
    MV 216,132,80
    global_load_dwordx4 a[76:79], v28, s[8:9] offset:1024 sc1
    s_waitcnt lgkmcnt(8)
    MV 240,136,80
    RT 132,40,57344
    RT 134,40,61440
    MV 244,136,84
    v_add_u32 v28, 0x1000, v28
    global_load_lds_dwordx4 v7, s[16:17] offset:1024
    MV 252,140,84
    RT 136,41,57344
    RT 138,41,61440
    MV 248,140,80
    v_add_u32 v7, 262144, v7
    global_load_lds_dwordx4 v8, s[16:17] offset:2048
    s_waitcnt lgkmcnt(8)
    MV 176,144,80
    RT 140,42,57344
    RT 142,42,61440
    MV 180,144,84
    v_add_u32 v8, 262144, v8
    global_load_lds_dwordx4 v9, s[16:17] offset:3072
    MV 188,148,84
    RT 144,43,57344
    v_add_u32 v9, 262144, v9
    MV 184,148,80
    RT 146,43,61440
    s_waitcnt lgkmcnt(8)
    MV 192,152,80
    RT 148,44,57344
    MV 196,152,84
    RT 150,44,61440
    MV 204,128,84
    RT 152,45,57344
    MV 200,128,80
    RT 154,45,61440
    s_waitcnt lgkmcnt(8)
    MV 208,132,88
    RT 128,46,57344
    RT 130,46,61440
    MV 212,132,92
    global_load_dwordx4 a[80:83], v28, s[8:9] offset:0 sc1
    MV 220,136,92
    RT 132,47,57344
    RT 134,47,61440
    MV 216,136,88
    global_load_dwordx4 a[84:87], v28, s[8:9] offset:1024 sc1
    s_waitcnt lgkmcnt(8)
    MV 240,140,88
    RT 136,32,0
    v_add_u32 v28, 0x1000, v28
    MV 244,140,92
    RT 138,32,4096
    MV 252,144,92
    RT 140,33,0
    MV 248,144,88
    RT 142,33,4096
    s_waitcnt lgkmcnt(8)
    MV 176,148,88
    RT 144,34,0
    MV 180,148,92
    RT 146,34,4096
    MV 188,152,92
    RT 148,35,0
    MV 184,152,88
    RT 150,35,4096
    s_waitcnt lgkmcnt(8)
    MV 192,128,88
    RT 152,36,0
    MV 196,128,92
    RT 154,36,4096
    s_waitcnt lgkmcnt(10)
    s_barrier
    s_add_u32 m0, s48, 114688
    MV 204,132,92
    RT 128,37,0
    RT 130,37,4096
    MV 200,132,88
    s_add_u32 s41, s48, 114688
    global_load_lds_dwordx4 v6, s[16:17] offset:0
    s_waitcnt lgkmcnt(8)
    MV 208,136,96
    RT 132,38,0
    RT 134,38,4096
    MV 212,136,100
    v_add_u32 v6, 262144, v6
    global_load_dwordx4 a[88:91], v28, s[8:9] offset:0 sc1
    MV 220,140,100
    RT 136,39,0
    RT 138,39,4096
    MV 216,140,96
    global_load_dwordx4 a[92:95], v28, s[8:9] offset:1024 sc1
    s_waitcnt lgkmcnt(8)
    MV 240,144,96
    RT 140,32,8192
    RT 142,32,12288
    MV 244,144,100
    v_add_u32 v28, 0x1000, v28
    global_load_lds_dwordx4 v7, s[16:17] offset:1024
    MV 252,148,100
    RT 144,33,8192
    RT 146,33,12288
    MV 248,148,96
    v_add_u32 v7, 262144, v7
    global_load_lds_dwordx4 v8, s[16:17] offset:2048
    s_waitcnt lgkmcnt(8)
    MV 176,152,96
    RT 148,34,8192
    v_add_u32 v8, 262144, v8
    MV 180,152,100
    RT 150,34,12288
    MV 188,128,100
    RT 152,35,8192
    MV 184,128,96
    RT 154,35,12288
    s_waitcnt lgkmcnt(8)
    MV 192,132,96
    RT 128,36,8192
    MV 196,132,100
    RT 130,36,12288
    MV 204,136,100
    RT 132,37,8192
    MV 200,136,96
    RT 134,37,12288
    s_waitcnt vmcnt(51) lgkmcnt(8)
    MV 208,140,104
    RT 136,38,8192
    RT 138,38,12288
    MV 212,140,108
    global_load_dwordx4 a[96:99], v28, s[8:9] offset:0 sc1
    MV 220,144,108
    RT 140,39,8192
    RT 142,39,12288
    MV 216,144,104
    global_load_dwordx4 a[100:103], v28, s[8:9] offset:1024 sc1
    s_waitcnt lgkmcnt(8)
    MV 240,148,104
    RT 144,32,16384
    v_add_u32 v28, 0x1000, v28
    MV 244,148,108
    RT 146,32,20480
    MV 252,152,108
    RT 148,33,16384
    MV 248,152,104
    RT 150,33,20480
    s_waitcnt lgkmcnt(8)
    MV 176,128,104
    RT 152,34,16384
    MV 180,128,108
    RT 154,34,20480
    MV 188,132,108
    RT 128,35,16384
    MV 184,132,104
    RT 130,35,20480
    s_waitcnt lgkmcnt(8)
    MV 192,136,104
    RT 132,36,16384
    MV 196,136,108
    RT 134,36,20480
    s_waitcnt vmcnt(49) lgkmcnt(10)
    s_barrier
    MV 204,140,108
    RT 136,37,16384
    RT 138,37,20480
    MV 200,140,104
    global_load_lds_dwordx4 v9, s[16:17] offset:3072
    s_waitcnt vmcnt(48) lgkmcnt(8)
    MV 208,144,112
    RT 140,38,16384
    RT 142,38,20480
    MV 212,144,116
    v_add_u32 v9, 262144, v9
    global_load_dwordx4 a[104:107], v28, s[8:9] offset:0 sc1
    MV 220,148,116
    RT 144,39,16384
    RT 146,39,20480
    MV 216,148,112
    global_load_dwordx4 a[108:111], v28, s[8:9] offset:1024 sc1
    s_waitcnt lgkmcnt(8)
    s_add_u32 m0, s48, 0
    MV 240,152,112
    RT 148,32,24576
    RT 150,32,28672
    MV 244,152,116
    v_add_u32 v28, 0x1000, v28
    s_add_u32 s41, s48, 0
    global_load_lds_dwordx4 v6, s[16:17] offset:0
    MV 252,128,116
    RT 152,33,24576
    RT 154,33,28672
    MV 248,128,112
    v_add_u32 v6, 262144, v6
    global_load_lds_dwordx4 v7, s[16:17] offset:1024
    s_waitcnt lgkmcnt(8)
    MV 176,132,112
    RT 128,34,24576
    RT 130,34,28672
    MV 180,132,116
    v_add_u32 v7, 262144, v7
    global_load_lds_dwordx4 v8, s[16:17] offset:2048
    MV 188,136,116
    RT 132,35,24576
    v_add_u32 v8, 262144, v8
    MV 184,136,112
    RT 134,35,28672
    s_waitcnt lgkmcnt(8)
    MV 192,140,112
    RT 136,36,24576
    MV 196,140,116
    RT 138,36,28672
    MV 204,144,116
    RT 140,37,24576
    MV 200,144,112
    RT 142,37,28672
    s_waitcnt vmcnt(51) lgkmcnt(8)
    MV 208,148,120
    RT 144,38,24576
    RT 146,38,28672
    MV 212,148,124
    global_load_dwordx4 a[112:115], v28, s[8:9] offset:0 sc1
    MV 220,152,124
    RT 148,39,24576
    RT 150,39,28672
    MV 216,152,120
    global_load_dwordx4 a[116:119], v28, s[8:9] offset:1024 sc1
    s_waitcnt lgkmcnt(8)
    MV 240,128,120
    RT 152,32,32768
    v_add_u32 v28, 0x1000, v28
    MV 244,128,124
    RT 154,32,36864
    MV 252,132,124
    RT 128,33,32768
    MV 248,132,120
    RT 130,33,36864
    s_waitcnt lgkmcnt(8)
    MV 176,136,120
    RT 132,34,32768
    MV 180,136,124
    RT 134,34,36864
    MV 188,140,124
    RT 136,35,32768
    MV 184,140,120
    RT 138,35,36864
    s_waitcnt lgkmcnt(8)
    MV 192,144,120
    RT 140,36,32768
    MV 196,144,124
    RT 142,36,36864
    s_waitcnt vmcnt(49) lgkmcnt(10)
    s_barrier
    MV 204,148,124
    RT 144,37,32768
    RT 146,37,36864
    MV 200,148,120
    global_load_lds_dwordx4 v9, s[16:17] offset:3072
    s_waitcnt vmcnt(48) lgkmcnt(8)
    MV 208,152,0
    RT 148,38,32768
    RT 150,38,36864
    MV 212,152,4
    v_add_u32 v9, 262144, v9
    global_load_dwordx4 a[120:123], v28, s[8:9] offset:0 sc1
    MV 220,128,4
    RT 152,39,32768
    RT 154,39,36864
    MV 216,128,0
    global_load_dwordx4 a[124:127], v28, s[8:9] offset:1024 sc1
    s_waitcnt lgkmcnt(8)
    s_add_u32 m0, s48, 16384
    MV 240,132,0
    RT 128,32,40960
    RT 130,32,45056
    MV 244,132,4
    v_add_u32 v28, 0x1000, v28
    s_add_u32 s41, s48, 16384
    global_load_lds_dwordx4 v6, s[16:17] offset:0
    MV 252,136,4
    RT 132,33,40960
    RT 134,33,45056
    MV 248,136,0
    v_add_u32 v6, 262144, v6
    global_load_lds_dwordx4 v7, s[16:17] offset:1024
    s_waitcnt lgkmcnt(8)
    MV 176,140,0
    RT 136,34,40960
    RT 138,34,45056
    MV 180,140,4
    v_add_u32 v7, 262144, v7
    global_load_lds_dwordx4 v8, s[16:17] offset:2048
    MV 188,144,4
    RT 140,35,40960
    v_add_u32 v8, 262144, v8
    MV 184,144,0
    RT 142,35,45056
    s_waitcnt lgkmcnt(8)
    MV 192,148,0
    RT 144,36,40960
    MV 196,148,4
    RT 146,36,45056
    MV 204,152,4
    RT 148,37,40960
    MV 200,152,0
    RT 150,37,45056
    s_waitcnt vmcnt(48) lgkmcnt(8)
    MV 208,128,8
    RT 152,38,40960
    RT 154,38,45056
    MV 212,128,12
    global_load_dwordx4 a[0:3], v28, s[8:9] offset:0 sc1
    MV 220,132,12
    RT 128,39,40960
    RT 130,39,45056
    MV 216,132,8
    global_load_dwordx4 a[4:7], v28, s[8:9] offset:1024 sc1
    s_waitcnt lgkmcnt(8)
    MV 240,136,8
    RT 132,48,49152
    RT 134,48,51200
    MV 244,136,12
    v_add_u32 v28, 0x1000, v28
    global_load_lds_dwordx4 v9, s[16:17] offset:3072
    MV 252,140,12
    RT 136,49,49152
    v_add_u32 v9, 262144, v9
    MV 248,140,8
    RT 138,49,51200
    s_waitcnt lgkmcnt(8)
    MV 176,144,8
    RT 140,50,49152
    MV 180,144,12
    RT 142,50,51200
    MV 188,148,12
    RT 144,51,49152
    MV 184,148,8
    RT 146,51,51200
    s_waitcnt lgkmcnt(8)
    MV 192,152,8
    RT 148,48,53248
    MV 196,152,12
    RT 150,48,55296
    s_waitcnt vmcnt(50) lgkmcnt(10)
    s_barrier
    s_add_u32 m0, s48, 32768
    MV 204,128,12
    RT 152,49,53248
    RT 154,49,55296
    MV 200,128,8
    s_add_u32 s41, s48, 32768
    global_load_lds_dwordx4 v6, s[16:17] offset:0
    s_waitcnt vmcnt(49) lgkmcnt(8)
    v_mfma_f32_16x16x32_bf16 v[128:131], a[132:135], a[16:19], 0
    RT 128,50,53248
    RT 130,50,55296
    v_mfma_f32_16x16x32_bf16 v[132:135], a[132:135], a[20:23], 0
    v_add_u32 v6, 262144, v6
    global_load_dwordx4 a[8:11], v28, s[8:9] offset:0 sc1
    v_mfma_f32_16x16x32_bf16 v[140:143], a[136:139], a[20:23], 0
    RT 132,51,53248
    v_mfma_f32_16x16x32_bf16 v[136:139], a[136:139], a[16:19], 0
    RT 134,51,55296
    s_waitcnt lgkmcnt(8)
    v_mfma_f32_16x16x32_bf16 v[144:147], a[140:143], a[16:19], 0
    RT 136,48,57344
    RT 138,48,59392
    v_mfma_f32_16x16x32_bf16 v[148:151], a[140:143], a[20:23], 0
    global_load_dwordx4 a[12:15], v28, s[8:9] offset:1024 sc1
    v_cvt_pk_bf16_f32 v208, v208, v209
    v_cvt_pk_bf16_f32 v209, v210, v211
    v_cvt_pk_bf16_f32 v210, v212, v213
    v_cvt_pk_bf16_f32 v211, v214, v215
    v_mfma_f32_16x16x32_bf16 v[156:159], a[144:147], a[20:23], 0
    RT 140,49,57344
    RT 142,49,59392
    v_mfma_f32_16x16x32_bf16 v[152:155], a[144:147], a[16:19], 0
    v_add_u32 v28, 0x1000, v28
    global_load_lds_dwordx4 v7, s[16:17] offset:1024
    buffer_store_dwordx4 v[208:211], v1, s[8:11], s49 offen offset:0 sc1
    s_waitcnt vmcnt(51) lgkmcnt(8)
    MV 128,148,24
    RT 144,50,57344
    v_add_u32 v7, 262144, v7
    MV 132,148,28
    RT 146,50,59392
    v_cvt_pk_bf16_f32 v216, v216, v217
    v_cvt_pk_bf16_f32 v217, v218, v219
    v_cvt_pk_bf16_f32 v218, v220, v221
    v_cvt_pk_bf16_f32 v219, v222, v223
    MV 140,152,28
    RT 148,51,57344
    RT 150,51,59392
    MV 136,152,24
    global_load_dwordx4 a[16:19], v28, s[8:9] offset:0 sc1
    buffer_store_dwordx4 v[216:219], v1, s[8:11], s49 offen offset:1024 sc1
    s_waitcnt lgkmcnt(8)
    MV 144,128,24
    RT 152,48,61440
    MV 148,128,28
    RT 154,48,63488
    v_cvt_pk_bf16_f32 v240, v240, v241
    v_cvt_pk_bf16_f32 v241, v242, v243
    v_cvt_pk_bf16_f32 v242, v244, v245
    v_cvt_pk_bf16_f32 v243, v246, v247
    MV 156,132,28
    RT 128,49,61440
    MV 152,132,24
    RT 130,49,63488
    buffer_store_dwordx4 v[240:243], v1, s[8:11], s49 offen offset:2048 sc1
    s_waitcnt vmcnt(52) lgkmcnt(8)
    MV 128,136,32
    RT 132,50,61440
    RT 134,50,63488
    MV 132,136,36
    global_load_dwordx4 a[20:23], v28, s[8:9] offset:1024 sc1
    v_cvt_pk_bf16_f32 v248, v248, v249
    v_cvt_pk_bf16_f32 v249, v250, v251
    v_cvt_pk_bf16_f32 v250, v252, v253
    v_cvt_pk_bf16_f32 v251, v254, v255
    MV 140,140,36
    RT 136,51,61440
    v_add_u32 v28, 0x1000, v28
    MV 136,140,32
    RT 138,51,63488
    buffer_store_dwordx4 v[248:251], v1, s[8:11], s49 offen offset:3072 sc1
    s_waitcnt lgkmcnt(8)
    MV 144,144,32
    RT 140,52,0
    MV 148,144,36
    RT 142,52,2048
    MV 156,148,36
    RT 144,53,0
    MV 152,148,32
    RT 146,53,2048
    s_waitcnt vmcnt(52) lgkmcnt(8)
    MV 128,152,40
    RT 148,54,0
    RT 150,54,2048
    MV 132,152,44
    global_load_dwordx4 a[24:27], v28, s[8:9] offset:0 sc1
    MV 140,128,44
    RT 152,55,0
    MV 136,128,40
    RT 154,55,2048
    s_waitcnt lgkmcnt(8)
    MV 144,132,40
    RT 128,52,4096
    MV 148,132,44
    RT 130,52,6144
    s_waitcnt vmcnt(49) lgkmcnt(10)
    s_barrier
    MV 156,136,44
    RT 132,53,4096
    RT 134,53,6144
    MV 152,136,40
    global_load_dwordx4 a[28:31], v28, s[8:9] offset:1024 sc1
    s_waitcnt vmcnt(48) lgkmcnt(8)
    MV 128,140,48
    RT 136,54,4096
    RT 138,54,6144
    MV 132,140,52
    v_add_u32 v28, 0x1000, v28
    global_load_dwordx4 a[32:35], v28, s[8:9] offset:0 sc1
    MV 140,144,52
    RT 140,55,4096
    MV 136,144,48
    RT 142,55,6144
    s_waitcnt lgkmcnt(8)
    MV 144,148,48
    RT 144,52,8192
    RT 146,52,10240
    MV 148,148,52
    global_load_dwordx4 a[36:39], v28, s[8:9] offset:1024 sc1
    MV 156,152,52
    RT 148,53,8192
    RT 150,53,10240
    MV 152,152,48
    v_add_u32 v28, 0x1000, v28
    global_load_dwordx4 a[40:43], v28, s[8:9] offset:0 sc1
    s_waitcnt vmcnt(49) lgkmcnt(8)
    MV 128,128,56
    RT 152,54,8192
    MV 132,128,60
    RT 154,54,10240
    MV 140,132,60
    RT 128,55,8192
    RT 130,55,10240
    MV 136,132,56
    global_load_dwordx4 a[44:47], v28, s[8:9] offset:1024 sc1
    s_waitcnt lgkmcnt(8)
    MV 144,136,56
    RT 132,52,12288
    RT 134,52,14336
    MV 148,136,60
    v_add_u32 v28, 0x1000, v28
    global_load_dwordx4 a[48:51], v28, s[8:9] offset:0 sc1
    MV 156,140,60
    RT 136,53,12288
    MV 152,140,56
    RT 138,53,14336
    s_waitcnt vmcnt(49) lgkmcnt(8)
    MV 128,144,64
    RT 140,54,12288
    RT 142,54,14336
    MV 132,144,68
    global_load_dwordx4 a[52:55], v28, s[8:9] offset:1024 sc1
    MV 140,148,68
    RT 144,55,12288
    RT 146,55,14336
    MV 136,148,64
    v_add_u32 v28, 0x1000, v28
    global_load_dwordx4 a[56:59], v28, s[8:9] offset:0 sc1
    s_waitcnt lgkmcnt(8)
    MV 144,152,64
    RT 148,52,16384
    MV 148,152,68
    RT 150,52,18432
    MV 156,128,68
    RT 152,53,16384
    RT 154,53,18432
    MV 152,128,64
    global_load_dwordx4 a[60:63], v28, s[8:9] offset:1024 sc1
    s_waitcnt vmcnt(49) lgkmcnt(8)
    MV 128,132,72
    RT 128,54,16384
    RT 130,54,18432
    MV 132,132,76
    v_add_u32 v28, 0x1000, v28
    global_load_dwordx4 a[64:67], v28, s[8:9] offset:0 sc1
    MV 140,136,76
    RT 132,55,16384
    MV 136,136,72
    RT 134,55,18432
    s_waitcnt lgkmcnt(8)
    MV 144,140,72
    RT 136,52,20480
    RT 138,52,22528
    MV 148,140,76
    global_load_dwordx4 a[68:71], v28, s[8:9] offset:1024 sc1
    s_waitcnt vmcnt(48) lgkmcnt(10)
    s_barrier
    MV 156,144,76
    RT 140,53,20480
    RT 142,53,22528
    MV 152,144,72
    v_add_u32 v28, 0x1000, v28
    global_load_lds_dwordx4 v8, s[16:17] offset:2048
    s_waitcnt vmcnt(47) lgkmcnt(8)
    s_waitcnt vmcnt(13)
    v_mov_b32 v24, 1
    s_mov_b64 exec, 1
    buffer_store_dword v24, v31, s[8:11], s51 offen sc1
    s_mov_b64 exec, -1
    MV 128,148,80
    RT 144,54,20480
    v_add_u32 v8, 262144, v8
    MV 132,148,84
    RT 146,54,22528
    MV 140,152,84
    RT 148,55,20480
    RT 150,55,22528
    MV 136,152,80
    global_load_dwordx4 a[72:75], v28, s[8:9] offset:0 sc1
    s_waitcnt lgkmcnt(8)
    MV 144,128,80
    RT 152,52,24576
    RT 154,52,26624
    MV 148,128,84
    global_load_dwordx4 a[76:79], v28, s[8:9] offset:1024 sc1
    MV 156,132,84
    RT 128,53,24576
    v_add_u32 v28, 0x1000, v28
    MV 152,132,80
    RT 130,53,26624
    s_waitcnt lgkmcnt(8)
    MV 128,136,88
    RT 132,54,24576
    RT 134,54,26624
    MV 132,136,92
    global_load_lds_dwordx4 v9, s[16:17] offset:3072
    MV 140,140,92
    RT 136,55,24576
    RT 138,55,26624
    MV 136,140,88
    v_add_u32 v9, 262144, v9
    global_load_dwordx4 a[80:83], v28, s[8:9] offset:0 sc1
    s_waitcnt lgkmcnt(8)
    MV 144,144,88
    RT 140,52,28672
    MV 148,144,92
    RT 142,52,30720
    MV 156,148,92
    RT 144,53,28672
    RT 146,53,30720
    MV 152,148,88
    global_load_dwordx4 a[84:87], v28, s[8:9] offset:1024 sc1
    s_waitcnt lgkmcnt(8)
    MV 128,152,96
    RT 148,54,28672
    RT 150,54,30720
    MV 132,152,100
    v_add_u32 v28, 0x1000, v28
    global_load_dwordx4 a[88:91], v28, s[8:9] offset:0 sc1
    MV 140,128,100
    RT 152,55,28672
    MV 136,128,96
    RT 154,55,30720
    s_waitcnt lgkmcnt(8)
    MV 144,132,96
    RT 128,52,32768
    RT 130,52,34816
    MV 148,132,100
    global_load_dwordx4 a[92:95], v28, s[8:9] offset:1024 sc1
    MV 156,136,100
    RT 132,53,32768
    v_add_u32 v28, 0x1000, v28
    MV 152,136,96
    RT 134,53,34816
    s_waitcnt lgkmcnt(8)
    MV 128,140,104
    RT 136,54,32768
    RT 138,54,34816
    MV 132,140,108
    global_load_dwordx4 a[96:99], v28, s[8:9] offset:0 sc1
    MV 140,144,108
    RT 140,55,32768
    RT 142,55,34816
    MV 136,144,104
    global_load_dwordx4 a[100:103], v28, s[8:9] offset:1024 sc1
    s_waitcnt lgkmcnt(8)
    MV 144,148,104
    RT 144,52,36864
    v_add_u32 v28, 0x1000, v28
    MV 148,148,108
    RT 146,52,38912
    s_waitcnt lgkmcnt(10)
    s_barrier
    MV 156,152,108
    RT 148,53,36864
    MV 152,152,104
    RT 150,53,38912
    s_waitcnt lgkmcnt(8)
    MV 128,128,112
    RT 152,54,36864
    RT 154,54,38912
    MV 132,128,116
    global_load_dwordx4 a[104:107], v28, s[8:9] offset:0 sc1
    MV 140,132,116
    RT 128,55,36864
    RT 130,55,38912
    MV 136,132,112
    global_load_dwordx4 a[108:111], v28, s[8:9] offset:1024 sc1
    s_waitcnt lgkmcnt(8)
    MV 144,136,112
    RT 132,52,40960
    v_add_u32 v28, 0x1000, v28
    MV 148,136,116
    RT 134,52,43008
    MV 156,140,116
    RT 136,53,40960
    MV 152,140,112
    RT 138,53,43008
    s_waitcnt lgkmcnt(8)
    MV 128,144,120
    RT 140,54,40960
    RT 142,54,43008
    MV 132,144,124
    global_load_dwordx4 a[112:115], v28, s[8:9] offset:0 sc1
    MV 140,148,124
    RT 144,55,40960
    RT 146,55,43008
    MV 136,148,120
    global_load_dwordx4 a[116:119], v28, s[8:9] offset:1024 sc1
    s_waitcnt lgkmcnt(8)
    MV 144,152,120
    RT 148,52,45056
    v_add_u32 v28, 0x1000, v28
    MV 148,152,124
    RT 150,52,47104
    MV 156,128,124
    RT 152,53,45056
    MV 152,128,120
    RT 154,53,47104
    s_waitcnt lgkmcnt(8)
    MV 128,132,0
    RT 128,54,45056
    RT 130,54,47104
    MV 132,132,4
    global_load_dwordx4 a[120:123], v28, s[8:9] offset:0 sc1
    s_add_u32 m0, s48, 131072
    s_add_u32 s59, s40, 0
    buffer_load_dwordx4 v18, s[20:23], s59 offen lds
    s_mov_b32 m0, s41
    MV 140,136,4
    RT 132,55,45056
    RT 134,55,47104
    MV 136,136,0
    global_load_dwordx4 a[124:127], v28, s[8:9] offset:1024 sc1
    s_waitcnt lgkmcnt(8)
    MV 144,140,0
    RT 136,52,49152
    v_add_u32 v28, 0x1000, v28
    MV 148,140,4
    RT 138,52,51200
    MV 156,144,4
    RT 140,53,49152
    MV 152,144,0
    RT 142,53,51200
    s_waitcnt lgkmcnt(8)
    MV 128,148,8
    RT 144,54,49152
    RT 146,54,51200
    MV 132,148,12
    global_load_dwordx4 a[0:3], v28, s[8:9] offset:0 sc1
    s_add_u32 m0, s48, 132096
    s_add_u32 s59, s40, 16384
    buffer_load_dwordx4 v18, s[20:23], s59 offen lds
    s_mov_b32 m0, s41
    MV 140,152,12
    RT 148,55,49152
    RT 150,55,51200
    MV 136,152,8
    global_load_dwordx4 a[4:7], v28, s[8:9] offset:1024 sc1
    s_waitcnt lgkmcnt(8)
    MV 144,128,8
    RT 152,52,53248
    v_add_u32 v28, 0x1000, v28
    MV 148,128,12
    RT 154,52,55296
    s_waitcnt lgkmcnt(10)
    s_barrier
    MV 156,132,12
    RT 128,53,53248
    MV 152,132,8
    RT 130,53,55296
    s_waitcnt lgkmcnt(8)
    MV 128,136,16
    RT 132,54,53248
    RT 134,54,55296
    MV 132,136,20
    global_load_dwordx4 a[8:11], v28, s[8:9] offset:0 sc1
    s_add_u32 m0, s48, 133120
    s_add_u32 s59, s40, 32768
    buffer_load_dwordx4 v18, s[20:23], s59 offen lds
    s_mov_b32 m0, s41
    MV 140,140,20
    RT 136,55,53248
    RT 138,55,55296
    MV 136,140,16
    global_load_dwordx4 a[12:15], v28, s[8:9] offset:1024 sc1
    s_waitcnt lgkmcnt(8)
    MV 144,144,16
    RT 140,52,57344
    v_add_u32 v28, 0x1000, v28
    MV 148,144,20
    RT 142,52,59392
    MV 156,148,20
    RT 144,53,57344
    MV 152,148,16
    RT 146,53,59392
    s_waitcnt vmcnt(34) lgkmcnt(8)
    MV 128,152,24
    RT 148,54,57344
    MV 132,152,28
    RT 150,54,59392
    s_add_u32 m0, s48, 134144
    s_add_u32 s59, s40, 49152
    buffer_load_dwordx4 v18, s[20:23], s59 offen lds
    s_mov_b32 m0, s41
    MV 140,128,28
    RT 152,55,57344
    MV 136,128,24
    RT 154,55,59392
    s_waitcnt lgkmcnt(8)
    MV 144,132,24
    RT 128,52,61440
    MV 148,132,28
    RT 130,52,63488
    MV 156,136,28
    RT 132,53,61440
    MV 152,136,24
    RT 134,53,63488
    s_waitcnt vmcnt(33) lgkmcnt(8)
    MV 128,140,32
    RT 136,54,61440
    s_mov_b32 s30, 3216550459
    MV 132,140,36
    RT 138,54,63488
    MV 140,144,36
    RT 140,55,61440
    s_mov_b32 s31, 3216550459
    MV 136,144,32
    RT 142,55,63488
    s_waitcnt lgkmcnt(8)
    MV 144,148,32
    RT 144,48,0
    v_and_b32 v26, 15, v10
    MV 148,148,36
    RT 146,48,2048
    MV 156,152,36
    RT 148,49,0
    v_lshrrev_b32 v25, 1, v11
    MV 152,152,32
    RT 150,49,2048
    s_waitcnt vmcnt(31) lgkmcnt(8)
    MV 128,128,40
    RT 152,50,0
    v_xor_b32 v25, v25, v26
    MV 132,128,44
    RT 154,50,2048
    MV 140,132,44
    RT 128,51,0
    v_and_b32 v25, 7, v25
    MV 136,132,40
    RT 130,51,2048
    s_waitcnt lgkmcnt(8)
    MV 144,136,40
    RT 132,48,4096
    v_lshlrev_b32 v25, 4, v25
    MV 148,136,44
    RT 134,48,6144
    s_waitcnt lgkmcnt(10)
    s_barrier
    MV 156,140,44
    RT 136,49,4096
    v_lshl_add_u32 v25, v26, 7, v25
    MV 152,140,40
    RT 138,49,6144
    s_waitcnt vmcnt(29) lgkmcnt(8)
    MV 128,144,48
    RT 140,50,4096
    v_and_b32 v26, 1, v11
    MV 132,144,52
    RT 142,50,6144
    MV 140,148,52
    RT 144,51,4096
    v_lshl_add_u32 v25, v26, 3, v25
    MV 136,148,48
    RT 146,51,6144
    s_waitcnt lgkmcnt(8)
    MV 144,152,48
    RT 148,48,8192
    s_add_u32 s59, s48, 131072
    MV 148,152,52
    RT 150,48,10240
    MV 156,128,52
    RT 152,49,8192
    v_add_u32 v2, s59, v25
    MV 152,128,48
    RT 154,49,10240
    s_waitcnt vmcnt(27) lgkmcnt(8)
    buffer_load_dword v23, v31, s[8:11], s54 offen sc1
    MV 128,132,56
    RT 128,50,8192
    v_xor_b32 v3, 32, v2
    MV 132,132,60
    RT 130,50,10240
    MV 140,136,60
    RT 132,51,8192
    v_xor_b32 v4, 64, v2
    MV 136,136,56
    RT 134,51,10240
    s_waitcnt lgkmcnt(8)
    MV 144,140,56
    RT 136,48,12288
    v_xor_b32 v5, 96, v2
    MV 148,140,60
    RT 138,48,14336
    MV 156,144,60
    RT 140,49,12288
    v_lshl_add_u32 v6, v10, 4, s59
    MV 152,144,56
    RT 142,49,14336
    s_waitcnt vmcnt(26) lgkmcnt(8)
    MV 128,148,64
    RT 144,50,12288
    MV 132,148,68
    RT 146,50,14336
    MV 140,152,68
    RT 148,51,12288
    MV 136,152,64
    RT 150,51,14336
    s_waitcnt lgkmcnt(8)
    MV 144,128,64
    RT 152,48,16384
    MV 148,128,68
    RT 154,48,18432
    s_waitcnt vmcnt(1)
    MV 156,132,68
    RT 128,49,16384
    ds_read_b64 v[160:161], v2 offset:0
    MV 152,132,64
    RT 130,49,18432
    s_waitcnt lgkmcnt(8)
    MV 128,136,72
    RT 132,50,16384
    ds_read_b64 v[168:169], v2 offset:2048
    MV 132,136,76
    RT 134,50,18432
    MV 140,140,76
    RT 136,51,16384
    ds_read_b64 v[162:163], v3 offset:0
    MV 136,140,72
    RT 138,51,18432
    s_waitcnt lgkmcnt(8)
    MV 144,144,72
    RT 140,48,20480
    ds_read_b64 v[170:171], v3 offset:2048
    MV 148,144,76
    RT 142,48,22528
    s_waitcnt lgkmcnt(10)
    s_barrier
    MV 156,148,76
    RT 144,49,20480
    ds_read_b64 v[164:165], v4 offset:0
    MV 152,148,72
    RT 146,49,22528
    s_waitcnt lgkmcnt(8)
    s_waitcnt vmcnt(0)
    v_cmp_gt_u32 vcc, 1, v23
    s_nop 0
    s_cbranch_vccnz L_slow_q_6
L_back_q_6:
    buffer_load_dwordx4 v[208:211], v1, s[8:11], s50 offen offset:0 sc1
    buffer_load_dwordx4 v[212:215], v1, s[8:11], s50 offen offset:1024 sc1
    buffer_load_dwordx4 v[216:219], v1, s[8:11], s50 offen offset:2048 sc1
    buffer_load_dwordx4 v[220:223], v1, s[8:11], s50 offen offset:3072 sc1
    MV 128,152,80
    RT 148,50,20480
    ds_read_b64 v[172:173], v4 offset:2048
    MV 132,152,84
    RT 150,50,22528
    MV 140,128,84
    RT 152,51,20480
    ds_read_b64 v[166:167], v5 offset:0
    MV 136,128,80
    RT 154,51,22528
    s_waitcnt lgkmcnt(8)
    MV 144,132,80
    RT 128,48,24576
    ds_read_b64 v[174:175], v5 offset:2048
    MV 148,132,84
    RT 130,48,26624
    MV 156,136,84
    RT 132,49,24576
    MV 152,136,80
    RT 134,49,26624
    s_waitcnt lgkmcnt(8)
    MV 128,140,88
    RT 136,50,24576
    MV 132,140,92
    RT 138,50,26624
    MV 140,144,92
    RT 140,51,24576
    MV 136,144,88
    RT 142,51,26624
    s_waitcnt lgkmcnt(8)
    MV 144,148,88
    RT 144,48,28672
    MV 148,148,92
    RT 146,48,30720
    MV 156,152,92
    RT 148,49,28672
    MV 152,152,88
    RT 150,49,30720
    s_waitcnt lgkmcnt(8)
    MV 128,128,96
    RT 152,50,28672
    MV 132,128,100
    RT 154,50,30720
    MV 140,132,100
    RT 128,51,28672
    MV 136,132,96
    RT 130,51,30720
    s_waitcnt lgkmcnt(8)
    MV 144,136,96
    RT 132,48,32768
    MV 148,136,100
    RT 134,48,34816
    MV 156,140,100
    RT 136,49,32768
    MV 152,140,96
    RT 138,49,34816
    s_waitcnt lgkmcnt(8)
    MV 128,144,104
    RT 140,50,32768
    v_lshlrev_b32 v224, 16, v160
    MV 132,144,108
    RT 142,50,34816
    MV 140,148,108
    RT 144,51,32768
    v_and_b32 v225, 0xffff0000, v160
    MV 136,148,104
    RT 146,51,34816
    v_lshlrev_b32 v226, 16, v161
    s_waitcnt lgkmcnt(8)
    MV 144,152,104
    RT 148,48,36864
    v_and_b32 v227, 0xffff0000, v161
    MV 148,152,108
    RT 150,48,38912
    v_lshlrev_b32 v228, 16, v168
    s_barrier
    MV 156,128,108
    RT 152,49,36864
    v_and_b32 v229, 0xffff0000, v168
    MV 152,128,104
    RT 154,49,38912
    v_lshlrev_b32 v230, 16, v169
    s_waitcnt lgkmcnt(8)
    MV 128,132,112
    RT 128,50,36864
    v_and_b32 v231, 0xffff0000, v169
    MV 132,132,116
    RT 130,50,38912
    MV 140,136,116
    RT 132,51,36864
    v_lshlrev_b32 v232, 16, v162
    MV 136,136,112
    RT 134,51,38912
    v_and_b32 v233, 0xffff0000, v162
    s_waitcnt lgkmcnt(8)
    MV 144,140,112
    RT 136,48,40960
    v_lshlrev_b32 v234, 16, v163
    MV 148,140,116
    RT 138,48,43008
    v_and_b32 v235, 0xffff0000, v163
    MV 156,144,116
    RT 140,49,40960
    v_lshlrev_b32 v236, 16, v170
    MV 152,144,112
    RT 142,49,43008
    v_and_b32 v237, 0xffff0000, v170
    s_waitcnt lgkmcnt(8)
    MV 128,148,120
    RT 144,50,40960
    v_lshlrev_b32 v238, 16, v171
    MV 132,148,124
    RT 146,50,43008
    v_and_b32 v239, 0xffff0000, v171
    MV 140,152,124
    RT 148,51,40960
    v_lshlrev_b32 v240, 16, v164
    MV 136,152,120
    RT 150,51,43008
    s_waitcnt lgkmcnt(8)
    MV 144,128,120
    RT 152,48,45056
    v_and_b32 v241, 0xffff0000, v164
    MV 148,128,124
    RT 154,48,47104
    v_lshlrev_b32 v242, 16, v165
    MV 156,132,124
    RT 128,49,45056
    v_and_b32 v243, 0xffff0000, v165
    MV 152,132,120
    RT 130,49,47104
    v_lshlrev_b32 v244, 16, v172
    s_waitcnt lgkmcnt(8)
    MV 128,136,0
    RT 132,50,45056
    v_and_b32 v245, 0xffff0000, v172
    MV 132,136,4
    RT 134,50,47104
    v_lshlrev_b32 v246, 16, v173
    MV 140,140,4
    RT 136,51,45056
    v_and_b32 v247, 0xffff0000, v173
    MV 136,140,0
    RT 138,51,47104
    s_waitcnt lgkmcnt(8)
    MV 144,144,0
    v_lshlrev_b32 v248, 16, v166
    MV 148,144,4
    v_and_b32 v249, 0xffff0000, v166
    MV 156,148,4
    v_lshlrev_b32 v250, 16, v167
    MV 152,148,0
    v_and_b32 v251, 0xffff0000, v167
    s_waitcnt lgkmcnt(4)
    MV 128,152,8
    v_lshlrev_b32 v252, 16, v174
    MV 132,152,12
    v_and_b32 v253, 0xffff0000, v174
    MV 140,128,12
    v_lshlrev_b32 v254, 16, v175
    MV 136,128,8
    v_and_b32 v255, 0xffff0000, v175
    s_waitcnt lgkmcnt(0)
    MV 144,132,8
    MV 148,132,12
    MV 156,136,12
    MV 152,136,8
    s_waitcnt vmcnt(0)
    v_lshlrev_b32 v64, 16, v208
    v_lshlrev_b32 v72, 16, v212
    v_lshlrev_b32 v80, 16, v216
    v_lshlrev_b32 v88, 16, v220
    v_and_b32 v65, 0xffff0000, v208
    v_and_b32 v73, 0xffff0000, v212
    v_and_b32 v81, 0xffff0000, v216
    v_and_b32 v89, 0xffff0000, v220
    v_lshlrev_b32 v66, 16, v209
    v_lshlrev_b32 v74, 16, v213
    v_lshlrev_b32 v82, 16, v217
    v_lshlrev_b32 v90, 16, v221
    v_and_b32 v67, 0xffff0000, v209
    v_and_b32 v75, 0xffff0000, v213
    v_and_b32 v83, 0xffff0000, v217
    v_and_b32 v91, 0xffff0000, v221
    v_pk_add_f32 v[176:177], v[176:177], v[64:65]
    v_pk_add_f32 v[184:185], v[184:185], v[72:73]
    v_pk_add_f32 v[192:193], v[192:193], v[80:81]
    v_pk_add_f32 v[200:201], v[200:201], v[88:89]
    v_pk_add_f32 v[178:179], v[178:179], v[66:67]
    v_pk_add_f32 v[186:187], v[186:187], v[74:75]
    v_pk_add_f32 v[194:195], v[194:195], v[82:83]
    v_pk_add_f32 v[202:203], v[202:203], v[90:91]
    v_pk_mul_f32 v[96:97], v[176:177], s[30:31]
    v_pk_mul_f32 v[104:105], v[184:185], s[30:31]
    v_pk_mul_f32 v[112:113], v[192:193], s[30:31]
    v_pk_mul_f32 v[120:121], v[200:201], s[30:31]
    v_pk_mul_f32 v[98:99], v[178:179], s[30:31]
    v_pk_mul_f32 v[106:107], v[186:187], s[30:31]
    v_pk_mul_f32 v[114:115], v[194:195], s[30:31]
    v_pk_mul_f32 v[122:123], v[202:203], s[30:31]
    v_exp_f32 v96, v96
    v_exp_f32 v104, v104
    v_exp_f32 v112, v112
    v_exp_f32 v120, v120
    v_exp_f32 v97, v97
    v_exp_f32 v105, v105
    v_exp_f32 v113, v113
    v_exp_f32 v121, v121
    v_exp_f32 v98, v98
    v_exp_f32 v106, v106
    v_exp_f32 v114, v114
    v_exp_f32 v122, v122
    v_exp_f32 v99, v99
    v_exp_f32 v107, v107
    v_exp_f32 v115, v115
    v_exp_f32 v123, v123
    v_pk_add_f32 v[96:97], v[96:97], 1.0 op_sel_hi:[1,0]
    v_pk_add_f32 v[104:105], v[104:105], 1.0 op_sel_hi:[1,0]
    v_pk_add_f32 v[112:113], v[112:113], 1.0 op_sel_hi:[1,0]
    v_pk_add_f32 v[120:121], v[120:121], 1.0 op_sel_hi:[1,0]
    v_pk_add_f32 v[98:99], v[98:99], 1.0 op_sel_hi:[1,0]
    v_pk_add_f32 v[106:107], v[106:107], 1.0 op_sel_hi:[1,0]
    v_pk_add_f32 v[114:115], v[114:115], 1.0 op_sel_hi:[1,0]
    v_pk_add_f32 v[122:123], v[122:123], 1.0 op_sel_hi:[1,0]
    v_rcp_f32 v96, v96
    v_rcp_f32 v104, v104
    v_rcp_f32 v112, v112
    v_rcp_f32 v120, v120
    v_rcp_f32 v97, v97
    v_rcp_f32 v105, v105
    v_rcp_f32 v113, v113
    v_rcp_f32 v121, v121
    v_rcp_f32 v98, v98
    v_rcp_f32 v106, v106
    v_rcp_f32 v114, v114
    v_rcp_f32 v122, v122
    v_rcp_f32 v99, v99
    v_rcp_f32 v107, v107
    v_rcp_f32 v115, v115
    v_rcp_f32 v123, v123
    v_pk_mul_f32 v[96:97], v[96:97], v[176:177]
    v_pk_mul_f32 v[104:105], v[104:105], v[184:185]
    v_pk_mul_f32 v[112:113], v[112:113], v[192:193]
    v_pk_mul_f32 v[120:121], v[120:121], v[200:201]
    v_pk_mul_f32 v[98:99], v[98:99], v[178:179]
    v_pk_mul_f32 v[106:107], v[106:107], v[186:187]
    v_pk_mul_f32 v[114:115], v[114:115], v[194:195]
    v_pk_mul_f32 v[122:123], v[122:123], v[202:203]
    v_pk_fma_f32 v[96:97], v[96:97], v[128:129], v[224:225]
    v_pk_fma_f32 v[104:105], v[104:105], v[136:137], v[232:233]
    v_pk_fma_f32 v[112:113], v[112:113], v[144:145], v[240:241]
    v_pk_fma_f32 v[120:121], v[120:121], v[152:153], v[248:249]
    v_pk_fma_f32 v[98:99], v[98:99], v[130:131], v[226:227]
    v_pk_fma_f32 v[106:107], v[106:107], v[138:139], v[234:235]
    v_pk_fma_f32 v[114:115], v[114:115], v[146:147], v[242:243]
    v_pk_fma_f32 v[122:123], v[122:123], v[154:155], v[250:251]
    v_cvt_pk_bf16_f32 v96, v96, v97
    v_cvt_pk_bf16_f32 v104, v104, v105
    v_cvt_pk_bf16_f32 v112, v112, v113
    v_cvt_pk_bf16_f32 v120, v120, v121
    v_cvt_pk_bf16_f32 v97, v98, v99
    v_cvt_pk_bf16_f32 v105, v106, v107
    v_cvt_pk_bf16_f32 v113, v114, v115
    v_cvt_pk_bf16_f32 v121, v122, v123
    ds_write_b64 v2, v[96:97] offset:0
    ds_write_b64 v3, v[104:105] offset:0
    ds_write_b64 v4, v[112:113] offset:0
    ds_write_b64 v5, v[120:121] offset:0
    v_lshlrev_b32 v68, 16, v210
    v_lshlrev_b32 v76, 16, v214
    v_lshlrev_b32 v84, 16, v218
    v_lshlrev_b32 v92, 16, v222
    v_and_b32 v69, 0xffff0000, v210
    v_and_b32 v77, 0xffff0000, v214
    v_and_b32 v85, 0xffff0000, v218
    v_and_b32 v93, 0xffff0000, v222
    s_waitcnt lgkmcnt(0)
    ds_read_b128 v[128:131], v6
    ds_read_b128 v[136:139], v6 offset:1024
    v_lshlrev_b32 v70, 16, v211
    v_lshlrev_b32 v78, 16, v215
    v_lshlrev_b32 v86, 16, v219
    v_lshlrev_b32 v94, 16, v223
    v_and_b32 v71, 0xffff0000, v211
    v_and_b32 v79, 0xffff0000, v215
    v_and_b32 v87, 0xffff0000, v219
    v_and_b32 v95, 0xffff0000, v223
    v_pk_add_f32 v[180:181], v[180:181], v[68:69]
    v_pk_add_f32 v[188:189], v[188:189], v[76:77]
    v_pk_add_f32 v[196:197], v[196:197], v[84:85]
    v_pk_add_f32 v[204:205], v[204:205], v[92:93]
    v_pk_add_f32 v[182:183], v[182:183], v[70:71]
    v_pk_add_f32 v[190:191], v[190:191], v[78:79]
    v_pk_add_f32 v[198:199], v[198:199], v[86:87]
    v_pk_add_f32 v[206:207], v[206:207], v[94:95]
    v_pk_mul_f32 v[100:101], v[180:181], s[30:31]
    v_pk_mul_f32 v[108:109], v[188:189], s[30:31]
    v_pk_mul_f32 v[116:117], v[196:197], s[30:31]
    v_pk_mul_f32 v[124:125], v[204:205], s[30:31]
    v_pk_mul_f32 v[102:103], v[182:183], s[30:31]
    v_pk_mul_f32 v[110:111], v[190:191], s[30:31]
    v_pk_mul_f32 v[118:119], v[198:199], s[30:31]
    v_pk_mul_f32 v[126:127], v[206:207], s[30:31]
    v_exp_f32 v100, v100
    v_exp_f32 v108, v108
    v_exp_f32 v116, v116
    v_exp_f32 v124, v124
    v_exp_f32 v101, v101
    v_exp_f32 v109, v109
    v_exp_f32 v117, v117
    v_exp_f32 v125, v125
    s_waitcnt lgkmcnt(0)
    buffer_store_dwordx4 v[128:131], v18, s[44:47], s40 offen
    s_add_u32 s40, s40, 16384
    buffer_store_dwordx4 v[136:139], v18, s[44:47], s40 offen
    s_add_u32 s40, s40, 16384
    v_exp_f32 v102, v102
    v_exp_f32 v110, v110
    v_exp_f32 v118, v118
    v_exp_f32 v126, v126
    v_exp_f32 v103, v103
    v_exp_f32 v111, v111
    v_exp_f32 v119, v119
    v_exp_f32 v127, v127
    v_pk_add_f32 v[100:101], v[100:101], 1.0 op_sel_hi:[1,0]
    v_pk_add_f32 v[108:109], v[108:109], 1.0 op_sel_hi:[1,0]
    v_pk_add_f32 v[116:117], v[116:117], 1.0 op_sel_hi:[1,0]
    v_pk_add_f32 v[124:125], v[124:125], 1.0 op_sel_hi:[1,0]
    v_pk_add_f32 v[102:103], v[102:103], 1.0 op_sel_hi:[1,0]
    v_pk_add_f32 v[110:111], v[110:111], 1.0 op_sel_hi:[1,0]
    v_pk_add_f32 v[118:119], v[118:119], 1.0 op_sel_hi:[1,0]
    v_pk_add_f32 v[126:127], v[126:127], 1.0 op_sel_hi:[1,0]
    v_rcp_f32 v100, v100
    v_rcp_f32 v108, v108
    v_rcp_f32 v116, v116
    v_rcp_f32 v124, v124
    v_rcp_f32 v101, v101
    v_rcp_f32 v109, v109
    v_rcp_f32 v117, v117
    v_rcp_f32 v125, v125
    v_rcp_f32 v102, v102
    v_rcp_f32 v110, v110
    v_rcp_f32 v118, v118
    v_rcp_f32 v126, v126
    v_rcp_f32 v103, v103
    v_rcp_f32 v111, v111
    v_rcp_f32 v119, v119
    v_rcp_f32 v127, v127
    v_pk_mul_f32 v[100:101], v[100:101], v[180:181]
    v_pk_mul_f32 v[108:109], v[108:109], v[188:189]
    v_pk_mul_f32 v[116:117], v[116:117], v[196:197]
    v_pk_mul_f32 v[124:125], v[124:125], v[204:205]
    v_pk_mul_f32 v[102:103], v[102:103], v[182:183]
    v_pk_mul_f32 v[110:111], v[110:111], v[190:191]
    v_pk_mul_f32 v[118:119], v[118:119], v[198:199]
    v_pk_mul_f32 v[126:127], v[126:127], v[206:207]
    v_pk_fma_f32 v[100:101], v[100:101], v[132:133], v[228:229]
    v_pk_fma_f32 v[108:109], v[108:109], v[140:141], v[236:237]
    v_pk_fma_f32 v[116:117], v[116:117], v[148:149], v[244:245]
    v_pk_fma_f32 v[124:125], v[124:125], v[156:157], v[252:253]
    v_pk_fma_f32 v[102:103], v[102:103], v[134:135], v[230:231]
    v_pk_fma_f32 v[110:111], v[110:111], v[142:143], v[238:239]
    v_pk_fma_f32 v[118:119], v[118:119], v[150:151], v[246:247]
    v_pk_fma_f32 v[126:127], v[126:127], v[158:159], v[254:255]
    v_cvt_pk_bf16_f32 v100, v100, v101
    v_cvt_pk_bf16_f32 v108, v108, v109
    v_cvt_pk_bf16_f32 v116, v116, v117
    v_cvt_pk_bf16_f32 v124, v124, v125
    v_cvt_pk_bf16_f32 v101, v102, v103
    v_cvt_pk_bf16_f32 v109, v110, v111
    v_cvt_pk_bf16_f32 v117, v118, v119
    v_cvt_pk_bf16_f32 v125, v126, v127
    ds_write_b64 v2, v[100:101] offset:2048
    ds_write_b64 v3, v[108:109] offset:2048
    ds_write_b64 v4, v[116:117] offset:2048
    ds_write_b64 v5, v[124:125] offset:2048
    s_waitcnt lgkmcnt(0)
    ds_read_b128 v[144:147], v6 offset:2048
    ds_read_b128 v[152:155], v6 offset:3072
    s_waitcnt lgkmcnt(1)
    buffer_store_dwordx4 v[144:147], v18, s[44:47], s40 offen
    s_add_u32 s40, s40, 16384
    s_waitcnt lgkmcnt(0)
    buffer_store_dwordx4 v[152:155], v18, s[44:47], s40 offen
    s_endpgm
L_slow_q_1:
    s_sleep 1
    buffer_load_dword v5, v4, s[8:11], s67 offen sc1
    s_waitcnt vmcnt(0)
    v_cmp_gt_u32 vcc, 1, v5
    s_nop 0
    s_cbranch_vccnz L_slow_q_1
    s_branch L_back_q_1
L_slow_q_2:
    s_sleep 1
    buffer_load_dword v22, v60, s[8:11], s57 offen sc1
    s_waitcnt vmcnt(0)
    v_cmp_gt_u32 vcc, 1, v22
    s_nop 0
    s_cbranch_vccnz L_slow_q_2
    s_branch L_back_q_2
L_slow_q_3:
    s_sleep 1
    buffer_load_dword v5, v4, s[8:11], s67 offen sc1
    s_waitcnt vmcnt(0)
    v_cmp_gt_u32 vcc, 2, v5
    s_nop 0
    s_cbranch_vccnz L_slow_q_3
    s_branch L_back_q_3
L_slow_q_4:
    s_sleep 1
    buffer_load_dword v22, v60, s[8:11], s57 offen sc1
    s_waitcnt vmcnt(0)
    v_cmp_gt_u32 vcc, 1, v22
    s_nop 0
    s_cbranch_vccnz L_slow_q_4
    s_branch L_back_q_4
L_slow_q_5:
    s_sleep 1
    buffer_load_dword v22, v20, s[8:11], s66 offen sc1
    s_waitcnt vmcnt(0)
    v_cmp_gt_u32 vcc, 1, v22
    s_nop 0
    s_cbranch_vccnz L_slow_q_5
    s_branch L_back_q_5
L_slow_q_6:
    s_sleep 1
    buffer_load_dword v23, v31, s[8:11], s54 offen sc1
    s_waitcnt vmcnt(0)
    v_cmp_gt_u32 vcc, 1, v23
    s_nop 0
    s_cbranch_vccnz L_slow_q_6
    s_branch L_back_q_6
L_role_h:
    s_mov_b32 s14, 7340032
    s_movk_i32 s30, 2341
    s_movk_i32 s31, 7168
    v_add_u32 v24, 0, v10
    v_mul_u32_u24 v25, s30, v24
    v_lshrrev_b32 v25, 16, v25
    v_mul_u32_u24 v26, 28, v25
    v_sub_u32 v26, v24, v26
    v_lshrrev_b32 v27, 2, v25
    v_and_b32 v27, 2, v27
    v_xor_b32 v26, v26, v27
    v_mul_u32_u24 v25, s31, v25
    v_lshl_add_u32 v2, v26, 4, v25
    v_add_u32 v24, 64, v10
    v_mul_u32_u24 v25, s30, v24
    v_lshrrev_b32 v25, 16, v25
    v_mul_u32_u24 v26, 28, v25
    v_sub_u32 v26, v24, v26
    v_lshrrev_b32 v27, 2, v25
    v_and_b32 v27, 2, v27
    v_xor_b32 v26, v26, v27
    v_mul_u32_u24 v25, s31, v25
    v_lshl_add_u32 v3, v26, 4, v25
    v_subrev_u32 v3, 1024, v3
    v_add_u32 v24, 128, v10
    v_mul_u32_u24 v25, s30, v24
    v_lshrrev_b32 v25, 16, v25
    v_mul_u32_u24 v26, 28, v25
    v_sub_u32 v26, v24, v26
    v_lshrrev_b32 v27, 2, v25
    v_and_b32 v27, 2, v27
    v_xor_b32 v26, v26, v27
    v_mul_u32_u24 v25, s31, v25
    v_lshl_add_u32 v4, v26, 4, v25
    v_subrev_u32 v4, 2048, v4
    v_add_u32 v24, 192, v10
    v_mul_u32_u24 v25, s30, v24
    v_lshrrev_b32 v25, 16, v25
    v_mul_u32_u24 v26, 28, v25
    v_sub_u32 v26, v24, v26
    v_lshrrev_b32 v27, 2, v25
    v_and_b32 v27, 2, v27
    v_xor_b32 v26, v26, v27
    v_mul_u32_u24 v25, s31, v25
    v_lshl_add_u32 v5, v26, 4, v25
    v_subrev_u32 v5, 3072, v5
    v_add_u32 v24, 256, v10
    v_mul_u32_u24 v25, s30, v24
    v_lshrrev_b32 v25, 16, v25
    v_mul_u32_u24 v26, 28, v25
    v_sub_u32 v26, v24, v26
    v_lshrrev_b32 v27, 2, v25
    v_and_b32 v27, 2, v27
    v_xor_b32 v26, v26, v27
    v_mul_u32_u24 v25, s31, v25
    v_lshl_add_u32 v6, v26, 4, v25
    v_add_u32 v24, 320, v10
    v_mul_u32_u24 v25, s30, v24
    v_lshrrev_b32 v25, 16, v25
    v_mul_u32_u24 v26, 28, v25
    v_sub_u32 v26, v24, v26
    v_lshrrev_b32 v27, 2, v25
    v_and_b32 v27, 2, v27
    v_xor_b32 v26, v26, v27
    v_mul_u32_u24 v25, s31, v25
    v_lshl_add_u32 v7, v26, 4, v25
    v_subrev_u32 v7, 1024, v7
    v_add_u32 v24, 384, v10
    v_mul_u32_u24 v25, s30, v24
    v_lshrrev_b32 v25, 16, v25
    v_mul_u32_u24 v26, 28, v25
    v_sub_u32 v26, v24, v26
    v_lshrrev_b32 v27, 2, v25
    v_and_b32 v27, 2, v27
    v_xor_b32 v26, v26, v27
    v_mul_u32_u24 v25, s31, v25
    v_lshl_add_u32 v8, v26, 4, v25
    v_subrev_u32 v8, 2048, v8
    s_mul_i32 s26, s27, 7168
    s_mul_i32 s25, s27, 114688
    s_mul_i32 s30, s29, 448
    s_add_u32 s25, s25, s30
    v_add_u32 v2, s25, v2
    v_add_u32 v3, s25, v3
    v_add_u32 v4, s25, v4
    v_add_u32 v5, s25, v5
    v_add_u32 v6, s25, v6
    v_add_u32 v7, s25, v7
    v_add_u32 v8, s25, v8
    s_add_u32 m0, s26, 0
    s_nop 0
    global_load_lds_dwordx4 v2, s[12:13] offset:0
    v_add_u32 v2, 458752, v2
    global_load_lds_dwordx4 v3, s[12:13] offset:1024
    v_add_u32 v3, 458752, v3
    global_load_lds_dwordx4 v4, s[12:13] offset:2048
    v_add_u32 v4, 458752, v4
    global_load_lds_dwordx4 v5, s[12:13] offset:3072
    v_add_u32 v5, 458752, v5
    s_add_u32 m0, s26, 4096
    s_nop 0
    global_load_lds_dwordx4 v6, s[12:13] offset:0
    v_add_u32 v6, 458752, v6
    global_load_lds_dwordx4 v7, s[12:13] offset:1024
    v_add_u32 v7, 458752, v7
    global_load_lds_dwordx4 v8, s[12:13] offset:2048
    v_add_u32 v8, 458752, v8
    s_lshl_b32 s30, s28, 2
    s_add_u32 s30, s30, s27
    s_lshl_b32 s30, s30, 7
    s_lshl_b32 s31, s29, 2
    s_add_u32 s62, s30, s31
    s_add_u32 s62, s62, 28311552
    s_lshl_b32 s30, s2, 4
    s_lshl_b32 s31, s27, 2
    s_add_u32 s30, s30, s31
    s_add_u32 s51, s30, 28319744
    s_lshl_b32 s24, s28, 2
    s_add_u32 s24, s24, s27
    s_lshl_b32 s24, s24, 17
    v_add_u32 v9, s24, v1
    v_and_b32 v80, 7, v15
    v_xor_b32 v80, v80, v14
    v_lshlrev_b32 v80, 4, v80
    v_lshl_add_u32 v80, v15, 7, v80
    v_add_u32 v80, 143360, v80
    v_lshlrev_b32 v81, 4, v0
    v_add_u32 v81, 143360, v81
    v_lshrrev_b32 v84, 3, v0
    v_xor_b32 v85, v84, v0
    v_and_b32 v85, 7, v85
    v_lshrrev_b32 v86, 2, v84
    v_and_b32 v87, 3, v84
    v_lshlrev_b32 v86, 12, v86
    v_lshl_add_u32 v86, v87, 8, v86
    v_lshl_add_u32 v82, v85, 4, v86
    s_lshr_b32 s60, s57, 3
    s_lshl_b32 s60, s60, 17
    s_and_b32 s30, s57, 7
    s_lshr_b32 s31, s30, 1
    s_lshl_b32 s31, s31, 10
    s_and_b32 s30, s30, 1
    s_lshl_b32 s30, s30, 7
    s_add_u32 s60, s60, s31
    s_add_u32 s60, s60, s30
    s_mov_b32 s61, 0x3a800000
    s_waitcnt vmcnt(10)
    v_lshlrev_b32 v96, 16, v64
    v_and_b32 v97, 0xffff0000, v64
    v_lshlrev_b32 v98, 16, v65
    v_and_b32 v99, 0xffff0000, v65
    v_lshlrev_b32 v100, 16, v66
    v_and_b32 v101, 0xffff0000, v66
    v_lshlrev_b32 v102, 16, v67
    v_and_b32 v103, 0xffff0000, v67
    s_waitcnt vmcnt(9)
    v_lshlrev_b32 v104, 16, v68
    v_and_b32 v105, 0xffff0000, v68
    v_lshlrev_b32 v106, 16, v69
    v_and_b32 v107, 0xffff0000, v69
    v_lshlrev_b32 v108, 16, v70
    v_and_b32 v109, 0xffff0000, v70
    v_lshlrev_b32 v110, 16, v71
    v_and_b32 v111, 0xffff0000, v71
    s_waitcnt vmcnt(8)
    v_lshlrev_b32 v112, 16, v72
    v_and_b32 v113, 0xffff0000, v72
    v_lshlrev_b32 v114, 16, v73
    v_and_b32 v115, 0xffff0000, v73
    v_lshlrev_b32 v116, 16, v74
    v_and_b32 v117, 0xffff0000, v74
    v_lshlrev_b32 v118, 16, v75
    v_and_b32 v119, 0xffff0000, v75
    s_waitcnt vmcnt(7)
    s_cmp_lg_u32 s32, 0
    s_cbranch_scc1 L_nopub_h
    s_lshl_b32 s30, s28, 5
    v_mov_b32 v84, 1
    s_mov_b64 exec, 1
    buffer_store_dword v84, v31, s[44:47], s30 offen sc1
    s_mov_b64 exec, -1
L_nopub_h:
    v_lshlrev_b32 v120, 16, v76
    v_and_b32 v121, 0xffff0000, v76
    v_lshlrev_b32 v122, 16, v77
    v_and_b32 v123, 0xffff0000, v77
    v_lshlrev_b32 v124, 16, v78
    v_and_b32 v125, 0xffff0000, v78
    v_lshlrev_b32 v126, 16, v79
    v_and_b32 v127, 0xffff0000, v79
    v_pk_add_f32 v[84:85], v[96:97], v[98:99]
    v_pk_add_f32 v[86:87], v[100:101], v[102:103]
    v_pk_add_f32 v[84:85], v[84:85], v[104:105]
    v_pk_add_f32 v[86:87], v[86:87], v[106:107]
    v_pk_add_f32 v[84:85], v[84:85], v[108:109]
    v_pk_add_f32 v[86:87], v[86:87], v[110:111]
    v_pk_add_f32 v[84:85], v[84:85], v[112:113]
    v_pk_add_f32 v[86:87], v[86:87], v[114:115]
    v_pk_add_f32 v[84:85], v[84:85], v[116:117]
    v_pk_add_f32 v[86:87], v[86:87], v[118:119]
    v_pk_add_f32 v[84:85], v[84:85], v[120:121]
    v_pk_add_f32 v[86:87], v[86:87], v[122:123]
    v_pk_add_f32 v[84:85], v[84:85], v[124:125]
    v_pk_add_f32 v[86:87], v[86:87], v[126:127]
    v_pk_add_f32 v[84:85], v[84:85], v[86:87]
    v_add_f32 v84, v84, v85
    s_nop 1
    v_add_f32_dpp v84, v84, v84 quad_perm:[1,0,3,2] row_mask:0xf bank_mask:0xf
    s_nop 1
    v_add_f32_dpp v84, v84, v84 quad_perm:[2,3,0,1] row_mask:0xf bank_mask:0xf
    s_nop 1
    v_add_f32_dpp v84, v84, v84 row_half_mirror row_mask:0xf bank_mask:0xf
    s_nop 1
    v_add_f32_dpp v84, v84, v84 row_mirror row_mask:0xf bank_mask:0xf
    v_mov_b32 v85, v84
    s_nop 1
    v_permlane16_swap_b32 v84, v85
    v_add_f32 v84, v84, v85
    v_mul_f32 v84, s61, v84
    v_pk_add_f32 v[96:97], v[96:97], v[84:85] op_sel_hi:[1,0] neg_lo:[0,1] neg_hi:[0,1]
    v_pk_add_f32 v[98:99], v[98:99], v[84:85] op_sel_hi:[1,0] neg_lo:[0,1] neg_hi:[0,1]
    v_pk_add_f32 v[100:101], v[100:101], v[84:85] op_sel_hi:[1,0] neg_lo:[0,1] neg_hi:[0,1]
    v_pk_add_f32 v[102:103], v[102:103], v[84:85] op_sel_hi:[1,0] neg_lo:[0,1] neg_hi:[0,1]
    v_pk_add_f32 v[104:105], v[104:105], v[84:85] op_sel_hi:[1,0] neg_lo:[0,1] neg_hi:[0,1]
    v_pk_add_f32 v[106:107], v[106:107], v[84:85] op_sel_hi:[1,0] neg_lo:[0,1] neg_hi:[0,1]
    v_pk_add_f32 v[108:109], v[108:109], v[84:85] op_sel_hi:[1,0] neg_lo:[0,1] neg_hi:[0,1]
    v_pk_add_f32 v[110:111], v[110:111], v[84:85] op_sel_hi:[1,0] neg_lo:[0,1] neg_hi:[0,1]
    v_pk_add_f32 v[112:113], v[112:113], v[84:85] op_sel_hi:[1,0] neg_lo:[0,1] neg_hi:[0,1]
    v_pk_add_f32 v[114:115], v[114:115], v[84:85] op_sel_hi:[1,0] neg_lo:[0,1] neg_hi:[0,1]
    v_pk_add_f32 v[116:117], v[116:117], v[84:85] op_sel_hi:[1,0] neg_lo:[0,1] neg_hi:[0,1]
    v_pk_add_f32 v[118:119], v[118:119], v[84:85] op_sel_hi:[1,0] neg_lo:[0,1] neg_hi:[0,1]
    v_pk_add_f32 v[120:121], v[120:121], v[84:85] op_sel_hi:[1,0] neg_lo:[0,1] neg_hi:[0,1]
    v_pk_add_f32 v[122:123], v[122:123], v[84:85] op_sel_hi:[1,0] neg_lo:[0,1] neg_hi:[0,1]
    v_pk_add_f32 v[124:125], v[124:125], v[84:85] op_sel_hi:[1,0] neg_lo:[0,1] neg_hi:[0,1]
    v_pk_add_f32 v[126:127], v[126:127], v[84:85] op_sel_hi:[1,0] neg_lo:[0,1] neg_hi:[0,1]
    v_pk_mul_f32 v[86:87], v[96:97], v[96:97]
    v_pk_mul_f32 v[88:89], v[98:99], v[98:99]
    v_pk_fma_f32 v[86:87], v[100:101], v[100:101], v[86:87]
    v_pk_fma_f32 v[88:89], v[102:103], v[102:103], v[88:89]
    v_pk_fma_f32 v[86:87], v[104:105], v[104:105], v[86:87]
    v_pk_fma_f32 v[88:89], v[106:107], v[106:107], v[88:89]
    v_pk_fma_f32 v[86:87], v[108:109], v[108:109], v[86:87]
    v_pk_fma_f32 v[88:89], v[110:111], v[110:111], v[88:89]
    v_pk_fma_f32 v[86:87], v[112:113], v[112:113], v[86:87]
    v_pk_fma_f32 v[88:89], v[114:115], v[114:115], v[88:89]
    v_pk_fma_f32 v[86:87], v[116:117], v[116:117], v[86:87]
    v_pk_fma_f32 v[88:89], v[118:119], v[118:119], v[88:89]
    v_pk_fma_f32 v[86:87], v[120:121], v[120:121], v[86:87]
    v_pk_fma_f32 v[88:89], v[122:123], v[122:123], v[88:89]
    v_pk_fma_f32 v[86:87], v[124:125], v[124:125], v[86:87]
    v_pk_fma_f32 v[88:89], v[126:127], v[126:127], v[88:89]
    v_pk_add_f32 v[86:87], v[86:87], v[88:89]
    v_add_f32 v86, v86, v87
    s_nop 1
    v_add_f32_dpp v86, v86, v86 quad_perm:[1,0,3,2] row_mask:0xf bank_mask:0xf
    s_nop 1
    v_add_f32_dpp v86, v86, v86 quad_perm:[2,3,0,1] row_mask:0xf bank_mask:0xf
    s_nop 1
    v_add_f32_dpp v86, v86, v86 row_half_mirror row_mask:0xf bank_mask:0xf
    s_nop 1
    v_add_f32_dpp v86, v86, v86 row_mirror row_mask:0xf bank_mask:0xf
    v_mov_b32 v87, v86
    s_nop 1
    v_permlane16_swap_b32 v86, v87
    v_add_f32 v86, v86, v87
    v_mul_f32 v86, s61, v86
    v_cvt_pk_bf16_f32 v86, v86, v86
    v_lshlrev_b32 v86, 16, v86
    v_add_f32 v86, 0x3727c5ac, v86
    v_cvt_pk_bf16_f32 v86, v86, v86
    v_lshlrev_b32 v86, 16, v86
    v_sqrt_f32 v86, v86
    s_nop 0
    v_cvt_pk_bf16_f32 v86, v86, v86
    v_lshlrev_b32 v86, 16, v86
    v_rcp_f32 v86, v86
    v_mov_b32 v87, v84
    v_cvt_pk_bf16_f32 v87, v87, v87
    v_lshlrev_b32 v87, 16, v87
    v_sub_f32 v87, v84, v87
    v_mul_f32 v87, v87, v86
    v_pk_fma_f32 v[96:97], v[96:97], v[86:87], v[86:87] op_sel:[0,0,1] op_sel_hi:[1,0,1]
    v_pk_fma_f32 v[98:99], v[98:99], v[86:87], v[86:87] op_sel:[0,0,1] op_sel_hi:[1,0,1]
    v_pk_fma_f32 v[100:101], v[100:101], v[86:87], v[86:87] op_sel:[0,0,1] op_sel_hi:[1,0,1]
    v_pk_fma_f32 v[102:103], v[102:103], v[86:87], v[86:87] op_sel:[0,0,1] op_sel_hi:[1,0,1]
    v_cvt_pk_bf16_f32 v64, v96, v97
    v_cvt_pk_bf16_f32 v65, v98, v99
    v_cvt_pk_bf16_f32 v66, v100, v101
    v_cvt_pk_bf16_f32 v67, v102, v103
    ds_write_b128 v80, v[64:67] offset:0
    v_pk_fma_f32 v[104:105], v[104:105], v[86:87], v[86:87] op_sel:[0,0,1] op_sel_hi:[1,0,1]
    v_pk_fma_f32 v[106:107], v[106:107], v[86:87], v[86:87] op_sel:[0,0,1] op_sel_hi:[1,0,1]
    v_pk_fma_f32 v[108:109], v[108:109], v[86:87], v[86:87] op_sel:[0,0,1] op_sel_hi:[1,0,1]
    v_pk_fma_f32 v[110:111], v[110:111], v[86:87], v[86:87] op_sel:[0,0,1] op_sel_hi:[1,0,1]
    v_cvt_pk_bf16_f32 v68, v104, v105
    v_cvt_pk_bf16_f32 v69, v106, v107
    v_cvt_pk_bf16_f32 v70, v108, v109
    v_cvt_pk_bf16_f32 v71, v110, v111
    ds_write_b128 v80, v[68:71] offset:4096
    v_pk_fma_f32 v[112:113], v[112:113], v[86:87], v[86:87] op_sel:[0,0,1] op_sel_hi:[1,0,1]
    v_pk_fma_f32 v[114:115], v[114:115], v[86:87], v[86:87] op_sel:[0,0,1] op_sel_hi:[1,0,1]
    v_pk_fma_f32 v[116:117], v[116:117], v[86:87], v[86:87] op_sel:[0,0,1] op_sel_hi:[1,0,1]
    v_pk_fma_f32 v[118:119], v[118:119], v[86:87], v[86:87] op_sel:[0,0,1] op_sel_hi:[1,0,1]
    v_cvt_pk_bf16_f32 v72, v112, v113
    v_cvt_pk_bf16_f32 v73, v114, v115
    v_cvt_pk_bf16_f32 v74, v116, v117
    v_cvt_pk_bf16_f32 v75, v118, v119
    ds_write_b128 v80, v[72:75] offset:8192
    v_pk_fma_f32 v[120:121], v[120:121], v[86:87], v[86:87] op_sel:[0,0,1] op_sel_hi:[1,0,1]
    v_pk_fma_f32 v[122:123], v[122:123], v[86:87], v[86:87] op_sel:[0,0,1] op_sel_hi:[1,0,1]
    v_pk_fma_f32 v[124:125], v[124:125], v[86:87], v[86:87] op_sel:[0,0,1] op_sel_hi:[1,0,1]
    v_pk_fma_f32 v[126:127], v[126:127], v[86:87], v[86:87] op_sel:[0,0,1] op_sel_hi:[1,0,1]
    v_cvt_pk_bf16_f32 v76, v120, v121
    v_cvt_pk_bf16_f32 v77, v122, v123
    v_cvt_pk_bf16_f32 v78, v124, v125
    v_cvt_pk_bf16_f32 v79, v126, v127
    ds_write_b128 v80, v[76:79] offset:12288
    s_waitcnt lgkmcnt(0)
    s_barrier
    ds_read_b128 v[96:99], v81 offset:0
    ds_read_b128 v[100:103], v81 offset:4096
    ds_read_b128 v[104:107], v81 offset:8192
    ds_read_b128 v[108:111], v81 offset:12288
    s_waitcnt lgkmcnt(3)
    buffer_store_dwordx4 v[96:99], v82, s[8:11], s60 offen sc1
    s_add_u32 s60, s60, 32768
    s_waitcnt lgkmcnt(2)
    buffer_store_dwordx4 v[100:103], v82, s[8:11], s60 offen sc1
    s_add_u32 s60, s60, 32768
    s_waitcnt lgkmcnt(1)
    buffer_store_dwordx4 v[104:107], v82, s[8:11], s60 offen sc1
    s_add_u32 s60, s60, 32768
    s_waitcnt lgkmcnt(0)
    buffer_store_dwordx4 v[108:111], v82, s[8:11], s60 offen sc1
    s_cmp_eq_u32 s27, 0
    s_cbranch_scc1 L_ln_w0_h
    s_waitcnt vmcnt(0)
    s_barrier
    s_add_u32 m0, s26, 28672
    s_nop 0
    global_load_lds_dwordx4 v2, s[12:13] offset:0
    v_add_u32 v2, 458752, v2
    global_load_lds_dwordx4 v3, s[12:13] offset:1024
    v_add_u32 v3, 458752, v3
    global_load_lds_dwordx4 v4, s[12:13] offset:2048
    v_add_u32 v4, 458752, v4
    global_load_lds_dwordx4 v5, s[12:13] offset:3072
    v_add_u32 v5, 458752, v5
    s_add_u32 m0, s26, 32768
    s_nop 0
    global_load_lds_dwordx4 v6, s[12:13] offset:0
    v_add_u32 v6, 458752, v6
    global_load_lds_dwordx4 v7, s[12:13] offset:1024
    v_add_u32 v7, 458752, v7
    global_load_lds_dwordx4 v8, s[12:13] offset:2048
    v_add_u32 v8, 458752, v8
    s_add_u32 m0, s26, 57344
    s_nop 0
    global_load_lds_dwordx4 v2, s[12:13] offset:0
    v_add_u32 v2, 458752, v2
    global_load_lds_dwordx4 v3, s[12:13] offset:1024
    v_add_u32 v3, 458752, v3
    global_load_lds_dwordx4 v4, s[12:13] offset:2048
    v_add_u32 v4, 458752, v4
    global_load_lds_dwordx4 v5, s[12:13] offset:3072
    v_add_u32 v5, 458752, v5
    s_add_u32 m0, s26, 61440
    s_nop 0
    global_load_lds_dwordx4 v6, s[12:13] offset:0
    v_add_u32 v6, 458752, v6
    global_load_lds_dwordx4 v7, s[12:13] offset:1024
    v_add_u32 v7, 458752, v7
    global_load_lds_dwordx4 v8, s[12:13] offset:2048
    v_add_u32 v8, 458752, v8
    s_add_u32 m0, s26, 86016
    s_nop 0
    global_load_lds_dwordx4 v2, s[12:13] offset:0
    v_add_u32 v2, 458752, v2
    global_load_lds_dwordx4 v3, s[12:13] offset:1024
    v_add_u32 v3, 458752, v3
    global_load_lds_dwordx4 v4, s[12:13] offset:2048
    v_add_u32 v4, 458752, v4
    global_load_lds_dwordx4 v5, s[12:13] offset:3072
    v_add_u32 v5, 458752, v5
    s_add_u32 m0, s26, 90112
    s_nop 0
    global_load_lds_dwordx4 v6, s[12:13] offset:0
    v_add_u32 v6, 458752, v6
    global_load_lds_dwordx4 v7, s[12:13] offset:1024
    v_add_u32 v7, 458752, v7
    global_load_lds_dwordx4 v8, s[12:13] offset:2048
    v_add_u32 v8, 458752, v8
    v_lshl_add_u32 v24, v11, 3, v12
    v_mul_u32_u24 v24, 448, v24
    v_lshl_add_u32 v24, v13, 3, v24
    v_and_b32 v25, 1, v11
    v_lshlrev_b32 v25, 5, v25
    v_add_u32 v18, v24, v25
    v_sub_u32 v19, v24, v25
    v_add_u32 v20, 57344, v18
    v_add_u32 v21, 57344, v19
    v_add_u32 v22, 114688, v18
    v_add_u32 v23, 114688, v19
    s_branch L_ln_wait_h
L_ln_w0_h:
    v_and_b32 v85, 7, v10
    v_lshlrev_b32 v85, 5, v85
L_ln_lead_h:
    buffer_load_dword v84, v85, s[44:47], 0 offen sc1
    s_waitcnt vmcnt(0)
    v_cmp_gt_u32 vcc, 1, v84
    s_nop 0
    s_cbranch_vccnz L_ln_lead_h
    s_barrier
    s_and_b32 s30, s57, 31
    s_lshr_b32 s31, s30, 4
    s_lshl_b32 s31, s31, 7
    s_and_b32 s30, s30, 15
    s_lshl_b32 s30, s30, 2
    s_add_u32 s30, s30, s31
    s_lshl_b32 s60, s28, 9
    s_add_u32 s60, s60, 28323840
    s_add_u32 s30, s30, s60
    v_mov_b32 v84, 1
    v_lshlrev_b32 v85, 8, v10
    s_mov_b64 exec, 1
    buffer_store_dword v84, v85, s[8:11], s30 offen sc1
    s_mov_b64 exec, -1
    s_and_b32 s30, s2, 0
    s_lshl_b32 s30, s30, 8
    s_add_u32 s60, s60, s30
    v_bfe_u32 v85, v10, 3, 2
    v_and_b32 v86, 7, v10
    v_lshlrev_b32 v86, 2, v86
    v_lshl_add_u32 v85, v85, 7, v86
    s_add_u32 m0, s26, 28672
    s_nop 0
    global_load_lds_dwordx4 v2, s[12:13] offset:0
    v_add_u32 v2, 458752, v2
    global_load_lds_dwordx4 v3, s[12:13] offset:1024
    v_add_u32 v3, 458752, v3
    global_load_lds_dwordx4 v4, s[12:13] offset:2048
    v_add_u32 v4, 458752, v4
    global_load_lds_dwordx4 v5, s[12:13] offset:3072
    v_add_u32 v5, 458752, v5
    s_add_u32 m0, s26, 32768
    s_nop 0
    global_load_lds_dwordx4 v6, s[12:13] offset:0
    v_add_u32 v6, 458752, v6
    global_load_lds_dwordx4 v7, s[12:13] offset:1024
    v_add_u32 v7, 458752, v7
    global_load_lds_dwordx4 v8, s[12:13] offset:2048
    v_add_u32 v8, 458752, v8
    s_add_u32 m0, s26, 57344
    s_nop 0
    global_load_lds_dwordx4 v2, s[12:13] offset:0
    v_add_u32 v2, 458752, v2
    global_load_lds_dwordx4 v3, s[12:13] offset:1024
    v_add_u32 v3, 458752, v3
    global_load_lds_dwordx4 v4, s[12:13] offset:2048
    v_add_u32 v4, 458752, v4
    global_load_lds_dwordx4 v5, s[12:13] offset:3072
    v_add_u32 v5, 458752, v5
    s_add_u32 m0, s26, 61440
    s_nop 0
    global_load_lds_dwordx4 v6, s[12:13] offset:0
    v_add_u32 v6, 458752, v6
    global_load_lds_dwordx4 v7, s[12:13] offset:1024
    v_add_u32 v7, 458752, v7
    global_load_lds_dwordx4 v8, s[12:13] offset:2048
    v_add_u32 v8, 458752, v8
    s_add_u32 m0, s26, 86016
    s_nop 0
    global_load_lds_dwordx4 v2, s[12:13] offset:0
    v_add_u32 v2, 458752, v2
    global_load_lds_dwordx4 v3, s[12:13] offset:1024
    v_add_u32 v3, 458752, v3
    global_load_lds_dwordx4 v4, s[12:13] offset:2048
    v_add_u32 v4, 458752, v4
    global_load_lds_dwordx4 v5, s[12:13] offset:3072
    v_add_u32 v5, 458752, v5
    s_add_u32 m0, s26, 90112
    s_nop 0
    global_load_lds_dwordx4 v6, s[12:13] offset:0
    v_add_u32 v6, 458752, v6
    global_load_lds_dwordx4 v7, s[12:13] offset:1024
    v_add_u32 v7, 458752, v7
    global_load_lds_dwordx4 v8, s[12:13] offset:2048
    v_add_u32 v8, 458752, v8
    v_lshl_add_u32 v24, v11, 3, v12
    v_mul_u32_u24 v24, 448, v24
    v_lshl_add_u32 v24, v13, 3, v24
    v_and_b32 v25, 1, v11
    v_lshlrev_b32 v25, 5, v25
    v_add_u32 v18, v24, v25
    v_sub_u32 v19, v24, v25
    v_add_u32 v20, 57344, v18
    v_add_u32 v21, 57344, v19
    v_add_u32 v22, 114688, v18
    v_add_u32 v23, 114688, v19
    s_add_u32 s61, s60, 128
    s_mov_b32 s100, 0
L_ln_poll_h:
    s_load_dwordx16 s[68:83], s[8:9], s60 glc
    s_load_dwordx16 s[84:99], s[8:9], s61 glc
    s_waitcnt lgkmcnt(0)
    s_and_b64 s[68:69], s[68:69], s[84:85]
    s_and_b64 s[70:71], s[70:71], s[86:87]
    s_and_b64 s[72:73], s[72:73], s[88:89]
    s_and_b64 s[74:75], s[74:75], s[90:91]
    s_and_b64 s[76:77], s[76:77], s[92:93]
    s_and_b64 s[78:79], s[78:79], s[94:95]
    s_and_b64 s[80:81], s[80:81], s[96:97]
    s_and_b64 s[82:83], s[82:83], s[98:99]
    s_and_b64 s[68:69], s[68:69], s[76:77]
    s_and_b64 s[70:71], s[70:71], s[78:79]
    s_and_b64 s[72:73], s[72:73], s[80:81]
    s_and_b64 s[74:75], s[74:75], s[82:83]
    s_and_b64 s[68:69], s[68:69], s[72:73]
    s_and_b64 s[70:71], s[70:71], s[74:75]
    s_and_b64 s[68:69], s[68:69], s[70:71]
    s_and_b32 s68, s68, s69
    s_cbranch_scc1 L_ln_out_h
    s_sleep 0
    s_branch L_ln_poll_h
L_ln_out_h:
L_ln_wait_h:
    s_barrier
    global_load_dwordx4 a[0:3], v9, s[8:9] offset:0 sc1
    global_load_dwordx4 a[4:7], v9, s[8:9] offset:1024 sc1
    global_load_dwordx4 a[8:11], v9, s[8:9] offset:2048 sc1
    global_load_dwordx4 a[12:15], v9, s[8:9] offset:3072 sc1
    v_add_u32 v9, 0x1000, v9
    global_load_dwordx4 a[16:19], v9, s[8:9] offset:0 sc1
    global_load_dwordx4 a[20:23], v9, s[8:9] offset:1024 sc1
    global_load_dwordx4 a[24:27], v9, s[8:9] offset:2048 sc1
    global_load_dwordx4 a[28:31], v9, s[8:9] offset:3072 sc1
    v_add_u32 v9, 0x1000, v9
    global_load_dwordx4 a[32:35], v9, s[8:9] offset:0 sc1
    global_load_dwordx4 a[36:39], v9, s[8:9] offset:1024 sc1
    global_load_dwordx4 a[40:43], v9, s[8:9] offset:2048 sc1
    global_load_dwordx4 a[44:47], v9, s[8:9] offset:3072 sc1
    v_add_u32 v9, 0x1000, v9
    global_load_dwordx4 a[48:51], v9, s[8:9] offset:0 sc1
    global_load_dwordx4 a[52:55], v9, s[8:9] offset:1024 sc1
    global_load_dwordx4 a[56:59], v9, s[8:9] offset:2048 sc1
    global_load_dwordx4 a[60:63], v9, s[8:9] offset:3072 sc1
    v_add_u32 v9, 0x1000, v9
    RT 128,18,0
    RT 130,18,1792
    RT 132,19,32
    RT 134,19,1824
    RT 136,18,64
    RT 138,18,1856
    s_waitcnt vmcnt(12) lgkmcnt(4)
    v_mfma_f32_16x16x32_bf16 v[32:35], a[128:131], a[0:3], 0
    RT 140,19,96
    v_mfma_f32_16x16x32_bf16 v[36:39], a[128:131], a[4:7], 0
    RT 142,19,1888
    v_mfma_f32_16x16x32_bf16 v[40:43], a[128:131], a[8:11], 0
    global_load_dwordx4 a[64:67], v9, s[8:9] offset:0 sc1
    v_mfma_f32_16x16x32_bf16 v[44:47], a[128:131], a[12:15], 0
    s_waitcnt lgkmcnt(4)
    v_mfma_f32_16x16x32_bf16 v[60:63], a[132:135], a[12:15], 0
    RT 128,18,128
    v_mfma_f32_16x16x32_bf16 v[56:59], a[132:135], a[8:11], 0
    RT 130,18,1920
    v_mfma_f32_16x16x32_bf16 v[52:55], a[132:135], a[4:7], 0
    global_load_dwordx4 a[68:71], v9, s[8:9] offset:1024 sc1
    v_mfma_f32_16x16x32_bf16 v[48:51], a[132:135], a[0:3], 0
    s_waitcnt lgkmcnt(4)
    v_mfma_f32_16x16x32_bf16 v[64:67], a[136:139], a[0:3], 0
    RT 132,19,160
    v_mfma_f32_16x16x32_bf16 v[68:71], a[136:139], a[4:7], 0
    RT 134,19,1952
    v_mfma_f32_16x16x32_bf16 v[72:75], a[136:139], a[8:11], 0
    global_load_dwordx4 a[72:75], v9, s[8:9] offset:2048 sc1
    v_mfma_f32_16x16x32_bf16 v[76:79], a[136:139], a[12:15], 0
    s_waitcnt lgkmcnt(4)
    v_mfma_f32_16x16x32_bf16 v[92:95], a[140:143], a[12:15], 0
    RT 136,18,192
    v_mfma_f32_16x16x32_bf16 v[88:91], a[140:143], a[8:11], 0
    RT 138,18,1984
    v_mfma_f32_16x16x32_bf16 v[84:87], a[140:143], a[4:7], 0
    global_load_dwordx4 a[76:79], v9, s[8:9] offset:3072 sc1
    v_mfma_f32_16x16x32_bf16 v[80:83], a[140:143], a[0:3], 0
    v_add_u32 v9, 0x1000, v9
    s_waitcnt lgkmcnt(4)
    v_mfma_f32_16x16x32_bf16 v[96:99], a[128:131], a[0:3], 0
    RT 140,19,224
    v_mfma_f32_16x16x32_bf16 v[100:103], a[128:131], a[4:7], 0
    RT 142,19,2016
    v_mfma_f32_16x16x32_bf16 v[104:107], a[128:131], a[8:11], 0
    global_load_dwordx4 a[80:83], v9, s[8:9] offset:0 sc1
    v_mfma_f32_16x16x32_bf16 v[108:111], a[128:131], a[12:15], 0
    s_waitcnt lgkmcnt(4)
    v_mfma_f32_16x16x32_bf16 v[124:127], a[132:135], a[12:15], 0
    RT 128,18,256
    v_mfma_f32_16x16x32_bf16 v[120:123], a[132:135], a[8:11], 0
    RT 130,18,2048
    v_mfma_f32_16x16x32_bf16 v[116:119], a[132:135], a[4:7], 0
    global_load_dwordx4 a[84:87], v9, s[8:9] offset:1024 sc1
    v_mfma_f32_16x16x32_bf16 v[112:115], a[132:135], a[0:3], 0
    s_waitcnt lgkmcnt(4)
    v_mfma_f32_16x16x32_bf16 v[128:131], a[136:139], a[0:3], 0
    RT 132,19,288
    v_mfma_f32_16x16x32_bf16 v[132:135], a[136:139], a[4:7], 0
    RT 134,19,2080
    v_mfma_f32_16x16x32_bf16 v[136:139], a[136:139], a[8:11], 0
    global_load_dwordx4 a[88:91], v9, s[8:9] offset:2048 sc1
    v_mfma_f32_16x16x32_bf16 v[140:143], a[136:139], a[12:15], 0
    s_waitcnt lgkmcnt(4)
    v_mfma_f32_16x16x32_bf16 v[156:159], a[140:143], a[12:15], 0
    RT 136,18,320
    v_mfma_f32_16x16x32_bf16 v[152:155], a[140:143], a[8:11], 0
    RT 138,18,2112
    v_mfma_f32_16x16x32_bf16 v[148:151], a[140:143], a[4:7], 0
    global_load_dwordx4 a[92:95], v9, s[8:9] offset:3072 sc1
    v_mfma_f32_16x16x32_bf16 v[144:147], a[140:143], a[0:3], 0
    v_add_u32 v9, 0x1000, v9
    s_waitcnt lgkmcnt(4)
    v_mfma_f32_16x16x32_bf16 v[160:163], a[128:131], a[0:3], 0
    RT 140,19,352
    v_mfma_f32_16x16x32_bf16 v[164:167], a[128:131], a[4:7], 0
    RT 142,19,2144
    s_add_u32 m0, s26, 114688
    v_mfma_f32_16x16x32_bf16 v[168:171], a[128:131], a[8:11], 0
    global_load_lds_dwordx4 v2, s[12:13] offset:0
    v_mfma_f32_16x16x32_bf16 v[172:175], a[128:131], a[12:15], 0
    v_add_u32 v2, 458752, v2
    s_waitcnt lgkmcnt(4)
    v_mfma_f32_16x16x32_bf16 v[188:191], a[132:135], a[12:15], 0
    RT 128,18,384
    v_mfma_f32_16x16x32_bf16 v[184:187], a[132:135], a[8:11], 0
    RT 130,18,2176
    v_mfma_f32_16x16x32_bf16 v[180:183], a[132:135], a[4:7], 0
    global_load_lds_dwordx4 v3, s[12:13] offset:1024
    v_mfma_f32_16x16x32_bf16 v[176:179], a[132:135], a[0:3], 0
    v_add_u32 v3, 458752, v3
    s_waitcnt lgkmcnt(4)
    v_mfma_f32_16x16x32_bf16 v[192:195], a[136:139], a[0:3], 0
    RT 132,19,416
    v_mfma_f32_16x16x32_bf16 v[196:199], a[136:139], a[4:7], 0
    RT 134,19,2208
    v_mfma_f32_16x16x32_bf16 v[200:203], a[136:139], a[8:11], 0
    v_mfma_f32_16x16x32_bf16 v[204:207], a[136:139], a[12:15], 0
    s_waitcnt lgkmcnt(4)
    v_mfma_f32_16x16x32_bf16 v[220:223], a[140:143], a[12:15], 0
    RT 136,18,14336
    v_mfma_f32_16x16x32_bf16 v[216:219], a[140:143], a[8:11], 0
    RT 138,18,16128
    v_mfma_f32_16x16x32_bf16 v[212:215], a[140:143], a[4:7], 0
    global_load_lds_dwordx4 v4, s[12:13] offset:2048
    v_mfma_f32_16x16x32_bf16 v[208:211], a[140:143], a[0:3], 0
    v_add_u32 v4, 458752, v4
    s_waitcnt lgkmcnt(4)
    v_mfma_f32_16x16x32_bf16 v[224:227], a[128:131], a[0:3], 0
    RT 140,19,14368
    v_mfma_f32_16x16x32_bf16 v[228:231], a[128:131], a[4:7], 0
    RT 142,19,16160
    v_mfma_f32_16x16x32_bf16 v[232:235], a[128:131], a[8:11], 0
    v_mfma_f32_16x16x32_bf16 v[236:239], a[128:131], a[12:15], 0
    s_waitcnt lgkmcnt(4)
    v_mfma_f32_16x16x32_bf16 v[252:255], a[132:135], a[12:15], 0
    RT 128,18,14400
    v_mfma_f32_16x16x32_bf16 v[248:251], a[132:135], a[8:11], 0
    RT 130,18,16192
    v_mfma_f32_16x16x32_bf16 v[244:247], a[132:135], a[4:7], 0
    global_load_lds_dwordx4 v5, s[12:13] offset:3072
    v_mfma_f32_16x16x32_bf16 v[240:243], a[132:135], a[0:3], 0
    v_add_u32 v5, 458752, v5
    s_waitcnt vmcnt(20) lgkmcnt(4)
    s_barrier
    MV 32,136,16
    RT 132,19,14432
    MV 36,136,20
    RT 134,19,16224
    s_add_u32 m0, s26, 118784
    MV 40,136,24
    global_load_lds_dwordx4 v6, s[12:13] offset:0
    MV 44,136,28
    v_add_u32 v6, 458752, v6
    s_waitcnt lgkmcnt(4)
    MV 60,140,28
    RT 136,18,14464
    MV 56,140,24
    RT 138,18,16256
    MV 52,140,20
    MV 48,140,16
    s_waitcnt lgkmcnt(4)
    MV 64,128,16
    RT 140,19,14496
    MV 68,128,20
    RT 142,19,16288
    MV 72,128,24
    global_load_lds_dwordx4 v7, s[12:13] offset:1024
    MV 76,128,28
    v_add_u32 v7, 458752, v7
    s_waitcnt lgkmcnt(4)
    MV 92,132,28
    RT 128,18,14528
    MV 88,132,24
    RT 130,18,16320
    MV 84,132,20
    MV 80,132,16
    s_waitcnt lgkmcnt(4)
    MV 96,136,16
    RT 132,19,14560
    MV 100,136,20
    RT 134,19,16352
    MV 104,136,24
    global_load_lds_dwordx4 v8, s[12:13] offset:2048
    MV 108,136,28
    v_add_u32 v8, 458752, v8
    s_waitcnt lgkmcnt(4)
    MV 124,140,28
    RT 136,18,14592
    MV 120,140,24
    RT 138,18,16384
    MV 116,140,20
    MV 112,140,16
    s_waitcnt lgkmcnt(4)
    MV 128,128,16
    RT 140,19,14624
    MV 132,128,20
    RT 142,19,16416
    MV 136,128,24
    global_load_dwordx4 a[96:99], v9, s[8:9] offset:0 sc1
    MV 140,128,28
    s_waitcnt lgkmcnt(4)
    MV 156,132,28
    RT 128,18,14656
    MV 152,132,24
    RT 130,18,16448
    MV 148,132,20
    global_load_dwordx4 a[100:103], v9, s[8:9] offset:1024 sc1
    MV 144,132,16
    s_waitcnt lgkmcnt(4)
    MV 160,136,16
    RT 132,19,14688
    MV 164,136,20
    RT 134,19,16480
    MV 168,136,24
    MV 172,136,28
    s_waitcnt lgkmcnt(4)
    MV 188,140,28
    RT 136,18,14720
    MV 184,140,24
    RT 138,18,16512
    MV 180,140,20
    global_load_dwordx4 a[104:107], v9, s[8:9] offset:2048 sc1
    MV 176,140,16
    s_waitcnt lgkmcnt(4)
    MV 192,128,16
    RT 140,19,14752
    MV 196,128,20
    RT 142,19,16544
    MV 200,128,24
    MV 204,128,28
    s_waitcnt lgkmcnt(4)
    MV 220,132,28
    RT 128,18,28672
    MV 216,132,24
    RT 130,18,30464
    MV 212,132,20
    global_load_dwordx4 a[108:111], v9, s[8:9] offset:3072 sc1
    MV 208,132,16
    v_add_u32 v9, 0x1000, v9
    s_waitcnt lgkmcnt(4)
    MV 224,136,16
    RT 132,19,28704
    MV 228,136,20
    RT 134,19,30496
    MV 232,136,24
    MV 236,136,28
    s_waitcnt lgkmcnt(4)
    s_barrier
    MV 252,140,28
    RT 136,18,28736
    MV 248,140,24
    RT 138,18,30528
    MV 244,140,20
    global_load_dwordx4 a[112:115], v9, s[8:9] offset:0 sc1
    MV 240,140,16
    s_waitcnt vmcnt(24) lgkmcnt(4)
    MV 32,128,32
    RT 140,19,28768
    MV 36,128,36
    RT 142,19,30560
    MV 40,128,40
    global_load_dwordx4 a[116:119], v9, s[8:9] offset:1024 sc1
    MV 44,128,44
    s_waitcnt lgkmcnt(4)
    MV 60,132,44
    RT 128,18,28800
    MV 56,132,40
    RT 130,18,30592
    MV 52,132,36
    global_load_dwordx4 a[120:123], v9, s[8:9] offset:2048 sc1
    MV 48,132,32
    s_waitcnt lgkmcnt(4)
    MV 64,136,32
    RT 132,19,28832
    MV 68,136,36
    RT 134,19,30624
    MV 72,136,40
    global_load_dwordx4 a[124:127], v9, s[8:9] offset:3072 sc1
    MV 76,136,44
    v_add_u32 v9, 0x1000, v9
    s_waitcnt lgkmcnt(4)
    MV 92,140,44
    RT 136,18,28864
    MV 88,140,40
    RT 138,18,30656
    s_add_u32 m0, s26, 0
    MV 84,140,36
    global_load_lds_dwordx4 v2, s[12:13] offset:0
    MV 80,140,32
    v_add_u32 v2, 458752, v2
    s_waitcnt lgkmcnt(4)
    MV 96,128,32
    RT 140,19,28896
    MV 100,128,36
    RT 142,19,30688
    MV 104,128,40
    global_load_lds_dwordx4 v3, s[12:13] offset:1024
    MV 108,128,44
    v_add_u32 v3, 458752, v3
    s_waitcnt lgkmcnt(4)
    MV 124,132,44
    RT 128,18,28928
    MV 120,132,40
    RT 130,18,30720
    MV 116,132,36
    MV 112,132,32
    s_waitcnt lgkmcnt(4)
    MV 128,136,32
    RT 132,19,28960
    MV 132,136,36
    RT 134,19,30752
    MV 136,136,40
    global_load_lds_dwordx4 v4, s[12:13] offset:2048
    MV 140,136,44
    v_add_u32 v4, 458752, v4
    s_waitcnt lgkmcnt(4)
    MV 156,140,44
    RT 136,18,28992
    MV 152,140,40
    RT 138,18,30784
    MV 148,140,36
    MV 144,140,32
    s_waitcnt lgkmcnt(4)
    MV 160,128,32
    RT 140,19,29024
    MV 164,128,36
    RT 142,19,30816
    MV 168,128,40
    global_load_lds_dwordx4 v5, s[12:13] offset:3072
    MV 172,128,44
    v_add_u32 v5, 458752, v5
    s_waitcnt lgkmcnt(4)
    MV 188,132,44
    RT 128,18,29056
    MV 184,132,40
    RT 130,18,30848
    MV 180,132,36
    MV 176,132,32
    s_waitcnt lgkmcnt(4)
    MV 192,136,32
    RT 132,19,29088
    MV 196,136,36
    RT 134,19,30880
    s_add_u32 m0, s26, 4096
    MV 200,136,40
    global_load_lds_dwordx4 v6, s[12:13] offset:0
    MV 204,136,44
    v_add_u32 v6, 458752, v6
    s_waitcnt lgkmcnt(4)
    MV 220,140,44
    RT 136,18,43008
    MV 216,140,40
    RT 138,18,44800
    MV 212,140,36
    MV 208,140,32
    s_waitcnt lgkmcnt(4)
    MV 224,128,32
    RT 140,19,43040
    MV 228,128,36
    RT 142,19,44832
    MV 232,128,40
    global_load_lds_dwordx4 v7, s[12:13] offset:1024
    MV 236,128,44
    v_add_u32 v7, 458752, v7
    s_waitcnt lgkmcnt(4)
    MV 252,132,44
    RT 128,18,43072
    MV 248,132,40
    RT 130,18,44864
    MV 244,132,36
    MV 240,132,32
    s_waitcnt vmcnt(29) lgkmcnt(4)
    MV 32,136,48
    RT 132,19,43104
    MV 36,136,52
    RT 134,19,44896
    MV 40,136,56
    global_load_lds_dwordx4 v8, s[12:13] offset:2048
    MV 44,136,60
    v_add_u32 v8, 458752, v8
    s_waitcnt lgkmcnt(4)
    MV 60,140,60
    RT 136,18,43136
    MV 56,140,56
    RT 138,18,44928
    MV 52,140,52
    global_load_dwordx4 a[0:3], v9, s[8:9] offset:0 sc1
    MV 48,140,48
    s_waitcnt lgkmcnt(4)
    MV 64,128,48
    RT 140,19,43168
    MV 68,128,52
    RT 142,19,44960
    MV 72,128,56
    MV 76,128,60
    s_waitcnt lgkmcnt(4)
    MV 92,132,60
    RT 128,18,43200
    MV 88,132,56
    RT 130,18,44992
    MV 84,132,52
    global_load_dwordx4 a[4:7], v9, s[8:9] offset:1024 sc1
    MV 80,132,48
    s_waitcnt lgkmcnt(4)
    MV 96,136,48
    RT 132,19,43232
    MV 100,136,52
    RT 134,19,45024
    MV 104,136,56
    MV 108,136,60
    s_waitcnt lgkmcnt(4)
    MV 124,140,60
    RT 136,18,43264
    MV 120,140,56
    RT 138,18,45056
    MV 116,140,52
    global_load_dwordx4 a[8:11], v9, s[8:9] offset:2048 sc1
    MV 112,140,48
    s_waitcnt lgkmcnt(4)
    MV 128,128,48
    RT 140,19,43296
    MV 132,128,52
    RT 142,19,45088
    MV 136,128,56
    MV 140,128,60
    s_waitcnt lgkmcnt(4)
    MV 156,132,60
    RT 128,18,43328
    MV 152,132,56
    RT 130,18,45120
    MV 148,132,52
    global_load_dwordx4 a[12:15], v9, s[8:9] offset:3072 sc1
    MV 144,132,48
    v_add_u32 v9, 0x1000, v9
    s_waitcnt lgkmcnt(4)
    MV 160,136,48
    RT 132,19,43360
    MV 164,136,52
    RT 134,19,45152
    MV 168,136,56
    MV 172,136,60
    s_waitcnt lgkmcnt(4)
    MV 188,140,60
    RT 136,18,43392
    MV 184,140,56
    RT 138,18,45184
    MV 180,140,52
    global_load_dwordx4 a[16:19], v9, s[8:9] offset:0 sc1
    MV 176,140,48
    s_waitcnt lgkmcnt(4)
    MV 192,128,48
    RT 140,19,43424
    MV 196,128,52
    RT 142,19,45216
    MV 200,128,56
    MV 204,128,60
    s_waitcnt lgkmcnt(4)
    MV 220,132,60
    RT 128,20,0
    MV 216,132,56
    RT 130,20,1792
    MV 212,132,52
    global_load_dwordx4 a[20:23], v9, s[8:9] offset:1024 sc1
    MV 208,132,48
    s_waitcnt lgkmcnt(4)
    MV 224,136,48
    RT 132,21,32
    MV 228,136,52
    RT 134,21,1824
    MV 232,136,56
    global_load_dwordx4 a[24:27], v9, s[8:9] offset:2048 sc1
    MV 236,136,60
    s_waitcnt lgkmcnt(4)
    s_barrier
    MV 252,140,60
    RT 136,20,64
    MV 248,140,56
    RT 138,20,1856
    MV 244,140,52
    MV 240,140,48
    s_waitcnt vmcnt(33) lgkmcnt(4)
    MV 32,128,64
    RT 140,21,96
    MV 36,128,68
    RT 142,21,1888
    MV 40,128,72
    global_load_dwordx4 a[28:31], v9, s[8:9] offset:3072 sc1
    MV 44,128,76
    v_add_u32 v9, 0x1000, v9
    s_waitcnt lgkmcnt(4)
    MV 60,132,76
    RT 128,20,128
    MV 56,132,72
    RT 130,20,1920
    s_add_u32 m0, s26, 28672
    MV 52,132,68
    global_load_lds_dwordx4 v2, s[12:13] offset:0
    MV 48,132,64
    v_add_u32 v2, 458752, v2
    s_waitcnt lgkmcnt(4)
    MV 64,136,64
    RT 132,21,160
    MV 68,136,68
    RT 134,21,1952
    MV 72,136,72
    global_load_lds_dwordx4 v3, s[12:13] offset:1024
    MV 76,136,76
    v_add_u32 v3, 458752, v3
    s_waitcnt lgkmcnt(4)
    MV 92,140,76
    RT 136,20,192
    MV 88,140,72
    RT 138,20,1984
    MV 84,140,68
    MV 80,140,64
    s_waitcnt lgkmcnt(4)
    MV 96,128,64
    RT 140,21,224
    MV 100,128,68
    RT 142,21,2016
    MV 104,128,72
    global_load_lds_dwordx4 v4, s[12:13] offset:2048
    MV 108,128,76
    v_add_u32 v4, 458752, v4
    s_waitcnt lgkmcnt(4)
    MV 124,132,76
    RT 128,20,256
    MV 120,132,72
    RT 130,20,2048
    MV 116,132,68
    MV 112,132,64
    s_waitcnt lgkmcnt(4)
    MV 128,136,64
    RT 132,21,288
    MV 132,136,68
    RT 134,21,2080
    MV 136,136,72
    global_load_lds_dwordx4 v5, s[12:13] offset:3072
    MV 140,136,76
    v_add_u32 v5, 458752, v5
    s_waitcnt lgkmcnt(4)
    MV 156,140,76
    RT 136,20,320
    MV 152,140,72
    RT 138,20,2112
    MV 148,140,68
    MV 144,140,64
    s_waitcnt lgkmcnt(4)
    MV 160,128,64
    RT 140,21,352
    MV 164,128,68
    RT 142,21,2144
    s_add_u32 m0, s26, 32768
    MV 168,128,72
    global_load_lds_dwordx4 v6, s[12:13] offset:0
    MV 172,128,76
    v_add_u32 v6, 458752, v6
    s_waitcnt lgkmcnt(4)
    MV 188,132,76
    RT 128,20,384
    MV 184,132,72
    RT 130,20,2176
    MV 180,132,68
    MV 176,132,64
    s_waitcnt lgkmcnt(4)
    MV 192,136,64
    RT 132,21,416
    MV 196,136,68
    RT 134,21,2208
    MV 200,136,72
    global_load_lds_dwordx4 v7, s[12:13] offset:1024
    MV 204,136,76
    v_add_u32 v7, 458752, v7
    s_waitcnt lgkmcnt(4)
    MV 220,140,76
    RT 136,20,14336
    MV 216,140,72
    RT 138,20,16128
    MV 212,140,68
    MV 208,140,64
    s_waitcnt lgkmcnt(4)
    MV 224,128,64
    RT 140,21,14368
    MV 228,128,68
    RT 142,21,16160
    MV 232,128,72
    global_load_lds_dwordx4 v8, s[12:13] offset:2048
    MV 236,128,76
    v_add_u32 v8, 458752, v8
    s_waitcnt lgkmcnt(4)
    MV 252,132,76
    RT 128,20,14400
    MV 248,132,72
    RT 130,20,16192
    MV 244,132,68
    global_load_dwordx4 a[32:35], v9, s[8:9] offset:0 sc1
    MV 240,132,64
    s_waitcnt vmcnt(38) lgkmcnt(4)
    MV 32,136,80
    RT 132,21,14432
    MV 36,136,84
    RT 134,21,16224
    MV 40,136,88
    MV 44,136,92
    s_waitcnt lgkmcnt(4)
    MV 60,140,92
    RT 136,20,14464
    MV 56,140,88
    RT 138,20,16256
    MV 52,140,84
    global_load_dwordx4 a[36:39], v9, s[8:9] offset:1024 sc1
    MV 48,140,80
    s_waitcnt lgkmcnt(4)
    MV 64,128,80
    RT 140,21,14496
    MV 68,128,84
    RT 142,21,16288
    MV 72,128,88
    MV 76,128,92
    s_waitcnt lgkmcnt(4)
    MV 92,132,92
    RT 128,20,14528
    MV 88,132,88
    RT 130,20,16320
    MV 84,132,84
    global_load_dwordx4 a[40:43], v9, s[8:9] offset:2048 sc1
    MV 80,132,80
    s_waitcnt lgkmcnt(4)
    MV 96,136,80
    RT 132,21,14560
    MV 100,136,84
    RT 134,21,16352
    MV 104,136,88
    MV 108,136,92
    s_waitcnt lgkmcnt(4)
    MV 124,140,92
    RT 136,20,14592
    MV 120,140,88
    RT 138,20,16384
    MV 116,140,84
    global_load_dwordx4 a[44:47], v9, s[8:9] offset:3072 sc1
    MV 112,140,80
    v_add_u32 v9, 0x1000, v9
    s_waitcnt lgkmcnt(4)
    MV 128,128,80
    RT 140,21,14624
    MV 132,128,84
    RT 142,21,16416
    MV 136,128,88
    MV 140,128,92
    s_waitcnt lgkmcnt(4)
    MV 156,132,92
    RT 128,20,14656
    MV 152,132,88
    RT 130,20,16448
    MV 148,132,84
    global_load_dwordx4 a[48:51], v9, s[8:9] offset:0 sc1
    MV 144,132,80
    s_waitcnt lgkmcnt(4)
    MV 160,136,80
    RT 132,21,14688
    MV 164,136,84
    RT 134,21,16480
    MV 168,136,88
    MV 172,136,92
    s_waitcnt lgkmcnt(4)
    MV 188,140,92
    RT 136,20,14720
    MV 184,140,88
    RT 138,20,16512
    MV 180,140,84
    global_load_dwordx4 a[52:55], v9, s[8:9] offset:1024 sc1
    MV 176,140,80
    s_waitcnt lgkmcnt(4)
    MV 192,128,80
    RT 140,21,14752
    MV 196,128,84
    RT 142,21,16544
    MV 200,128,88
    global_load_dwordx4 a[56:59], v9, s[8:9] offset:2048 sc1
    MV 204,128,92
    s_waitcnt lgkmcnt(4)
    MV 220,132,92
    RT 128,20,28672
    MV 216,132,88
    RT 130,20,30464
    MV 212,132,84
    MV 208,132,80
    s_waitcnt lgkmcnt(4)
    MV 224,136,80
    RT 132,21,28704
    MV 228,136,84
    RT 134,21,30496
    MV 232,136,88
    global_load_dwordx4 a[60:63], v9, s[8:9] offset:3072 sc1
    MV 236,136,92
    v_add_u32 v9, 0x1000, v9
    s_waitcnt vmcnt(38) lgkmcnt(4)
    s_barrier
    MV 252,140,92
    RT 136,20,28736
    MV 248,140,88
    RT 138,20,30528
    MV 244,140,84
    MV 240,140,80
    s_waitcnt vmcnt(34) lgkmcnt(4)
    MV 32,128,96
    RT 140,21,28768
    MV 36,128,100
    RT 142,21,30560
    s_add_u32 m0, s26, 57344
    MV 40,128,104
    global_load_lds_dwordx4 v2, s[12:13] offset:0
    MV 44,128,108
    v_add_u32 v2, 458752, v2
    s_waitcnt lgkmcnt(4)
    MV 60,132,108
    RT 128,20,28800
    MV 56,132,104
    RT 130,20,30592
    MV 52,132,100
    global_load_lds_dwordx4 v3, s[12:13] offset:1024
    MV 48,132,96
    v_add_u32 v3, 458752, v3
    s_waitcnt lgkmcnt(4)
    MV 64,136,96
    RT 132,21,28832
    MV 68,136,100
    RT 134,21,30624
    MV 72,136,104
    MV 76,136,108
    s_waitcnt lgkmcnt(4)
    MV 92,140,108
    RT 136,20,28864
    MV 88,140,104
    RT 138,20,30656
    MV 84,140,100
    global_load_lds_dwordx4 v4, s[12:13] offset:2048
    MV 80,140,96
    v_add_u32 v4, 458752, v4
    s_waitcnt lgkmcnt(4)
    MV 96,128,96
    RT 140,21,28896
    MV 100,128,100
    RT 142,21,30688
    MV 104,128,104
    MV 108,128,108
    s_waitcnt lgkmcnt(4)
    MV 124,132,108
    RT 128,20,28928
    MV 120,132,104
    RT 130,20,30720
    MV 116,132,100
    global_load_lds_dwordx4 v5, s[12:13] offset:3072
    MV 112,132,96
    v_add_u32 v5, 458752, v5
    s_waitcnt lgkmcnt(4)
    MV 128,136,96
    RT 132,21,28960
    MV 132,136,100
    RT 134,21,30752
    MV 136,136,104
    MV 140,136,108
    s_waitcnt lgkmcnt(4)
    MV 156,140,108
    RT 136,20,28992
    MV 152,140,104
    RT 138,20,30784
    s_add_u32 m0, s26, 61440
    MV 148,140,100
    global_load_lds_dwordx4 v6, s[12:13] offset:0
    MV 144,140,96
    v_add_u32 v6, 458752, v6
    s_waitcnt lgkmcnt(4)
    MV 160,128,96
    RT 140,21,29024
    MV 164,128,100
    RT 142,21,30816
    MV 168,128,104
    MV 172,128,108
    s_waitcnt lgkmcnt(4)
    MV 188,132,108
    RT 128,20,29056
    MV 184,132,104
    RT 130,20,30848
    MV 180,132,100
    global_load_lds_dwordx4 v7, s[12:13] offset:1024
    MV 176,132,96
    v_add_u32 v7, 458752, v7
    s_waitcnt lgkmcnt(4)
    MV 192,136,96
    RT 132,21,29088
    MV 196,136,100
    RT 134,21,30880
    MV 200,136,104
    MV 204,136,108
    s_waitcnt lgkmcnt(4)
    MV 220,140,108
    RT 136,20,43008
    MV 216,140,104
    RT 138,20,44800
    MV 212,140,100
    global_load_lds_dwordx4 v8, s[12:13] offset:2048
    MV 208,140,96
    v_add_u32 v8, 458752, v8
    s_waitcnt lgkmcnt(4)
    MV 224,128,96
    RT 140,21,43040
    MV 228,128,100
    RT 142,21,44832
    MV 232,128,104
    global_load_dwordx4 a[64:67], v9, s[8:9] offset:0 sc1
    MV 236,128,108
    s_waitcnt lgkmcnt(4)
    MV 252,132,108
    RT 128,20,43072
    MV 248,132,104
    RT 130,20,44864
    MV 244,132,100
    MV 240,132,96
    s_waitcnt vmcnt(38) lgkmcnt(4)
    MV 32,136,112
    RT 132,21,43104
    MV 36,136,116
    RT 134,21,44896
    MV 40,136,120
    global_load_dwordx4 a[68:71], v9, s[8:9] offset:1024 sc1
    MV 44,136,124
    s_waitcnt lgkmcnt(4)
    MV 60,140,124
    RT 136,20,43136
    MV 56,140,120
    RT 138,20,44928
    MV 52,140,116
    MV 48,140,112
    s_waitcnt lgkmcnt(4)
    MV 64,128,112
    RT 140,21,43168
    MV 68,128,116
    RT 142,21,44960
    MV 72,128,120
    global_load_dwordx4 a[72:75], v9, s[8:9] offset:2048 sc1
    MV 76,128,124
    s_waitcnt lgkmcnt(4)
    MV 92,132,124
    RT 128,20,43200
    MV 88,132,120
    RT 130,20,44992
    MV 84,132,116
    MV 80,132,112
    s_waitcnt lgkmcnt(4)
    MV 96,136,112
    RT 132,21,43232
    MV 100,136,116
    RT 134,21,45024
    MV 104,136,120
    global_load_dwordx4 a[76:79], v9, s[8:9] offset:3072 sc1
    MV 108,136,124
    v_add_u32 v9, 0x1000, v9
    s_waitcnt lgkmcnt(4)
    MV 124,140,124
    RT 136,20,43264
    MV 120,140,120
    RT 138,20,45056
    MV 116,140,116
    MV 112,140,112
    s_waitcnt lgkmcnt(4)
    MV 128,128,112
    RT 140,21,43296
    MV 132,128,116
    RT 142,21,45088
    MV 136,128,120
    global_load_dwordx4 a[80:83], v9, s[8:9] offset:0 sc1
    MV 140,128,124
    s_waitcnt lgkmcnt(4)
    MV 156,132,124
    RT 128,20,43328
    MV 152,132,120
    RT 130,20,45120
    MV 148,132,116
    MV 144,132,112
    s_waitcnt lgkmcnt(4)
    MV 160,136,112
    RT 132,21,43360
    MV 164,136,116
    RT 134,21,45152
    MV 168,136,120
    global_load_dwordx4 a[84:87], v9, s[8:9] offset:1024 sc1
    MV 172,136,124
    s_waitcnt lgkmcnt(4)
    MV 188,140,124
    RT 136,20,43392
    MV 184,140,120
    RT 138,20,45184
    MV 180,140,116
    global_load_dwordx4 a[88:91], v9, s[8:9] offset:2048 sc1
    MV 176,140,112
    s_waitcnt lgkmcnt(4)
    MV 192,128,112
    RT 140,21,43424
    MV 196,128,116
    RT 142,21,45216
    MV 200,128,120
    MV 204,128,124
    s_waitcnt lgkmcnt(4)
    MV 220,132,124
    RT 128,22,0
    MV 216,132,120
    RT 130,22,1792
    MV 212,132,116
    global_load_dwordx4 a[92:95], v9, s[8:9] offset:3072 sc1
    MV 208,132,112
    v_add_u32 v9, 0x1000, v9
    s_waitcnt lgkmcnt(4)
    MV 224,136,112
    RT 132,23,32
    MV 228,136,116
    RT 134,23,1824
    MV 232,136,120
    MV 236,136,124
    s_waitcnt vmcnt(38) lgkmcnt(4)
    s_barrier
    MV 252,140,124
    RT 136,22,64
    MV 248,140,120
    RT 138,22,1856
    s_add_u32 m0, s26, 86016
    MV 244,140,116
    global_load_lds_dwordx4 v2, s[12:13] offset:0
    MV 240,140,112
    v_add_u32 v2, 458752, v2
    s_waitcnt vmcnt(35) lgkmcnt(4)
    MV 32,128,0
    RT 140,23,96
    MV 36,128,4
    RT 142,23,1888
    MV 40,128,8
    MV 44,128,12
    s_waitcnt lgkmcnt(4)
    MV 60,132,12
    RT 128,22,128
    MV 56,132,8
    RT 130,22,1920
    MV 52,132,4
    global_load_lds_dwordx4 v3, s[12:13] offset:1024
    MV 48,132,0
    v_add_u32 v3, 458752, v3
    s_waitcnt lgkmcnt(4)
    MV 64,136,0
    RT 132,23,160
    MV 68,136,4
    RT 134,23,1952
    MV 72,136,8
    MV 76,136,12
    s_waitcnt lgkmcnt(4)
    MV 92,140,12
    RT 136,22,192
    MV 88,140,8
    RT 138,22,1984
    MV 84,140,4
    global_load_lds_dwordx4 v4, s[12:13] offset:2048
    MV 80,140,0
    v_add_u32 v4, 458752, v4
    s_waitcnt lgkmcnt(4)
    MV 96,128,0
    RT 140,23,224
    MV 100,128,4
    RT 142,23,2016
    MV 104,128,8
    MV 108,128,12
    s_waitcnt lgkmcnt(4)
    MV 124,132,12
    RT 128,22,256
    MV 120,132,8
    RT 130,22,2048
    MV 116,132,4
    global_load_lds_dwordx4 v5, s[12:13] offset:3072
    MV 112,132,0
    v_add_u32 v5, 458752, v5
    s_waitcnt lgkmcnt(4)
    MV 128,136,0
    RT 132,23,288
    MV 132,136,4
    RT 134,23,2080
    s_add_u32 m0, s26, 90112
    MV 136,136,8
    global_load_lds_dwordx4 v6, s[12:13] offset:0
    MV 140,136,12
    v_add_u32 v6, 458752, v6
    s_waitcnt lgkmcnt(4)
    MV 156,140,12
    RT 136,22,320
    MV 152,140,8
    RT 138,22,2112
    MV 148,140,4
    MV 144,140,0
    s_waitcnt lgkmcnt(4)
    MV 160,128,0
    RT 140,23,352
    MV 164,128,4
    RT 142,23,2144
    MV 168,128,8
    global_load_lds_dwordx4 v7, s[12:13] offset:1024
    MV 172,128,12
    v_add_u32 v7, 458752, v7
    s_waitcnt lgkmcnt(4)
    MV 188,132,12
    RT 128,22,384
    MV 184,132,8
    RT 130,22,2176
    MV 180,132,4
    MV 176,132,0
    s_waitcnt lgkmcnt(4)
    MV 192,136,0
    RT 132,23,416
    MV 196,136,4
    RT 134,23,2208
    MV 200,136,8
    global_load_lds_dwordx4 v8, s[12:13] offset:2048
    MV 204,136,12
    v_add_u32 v8, 458752, v8
    s_waitcnt lgkmcnt(4)
    MV 220,140,12
    RT 136,22,14336
    MV 216,140,8
    RT 138,22,16128
    MV 212,140,4
    MV 208,140,0
    s_waitcnt lgkmcnt(4)
    MV 224,128,0
    RT 140,23,14368
    MV 228,128,4
    RT 142,23,16160
    MV 232,128,8
    global_load_dwordx4 a[96:99], v9, s[8:9] offset:0 sc1
    MV 236,128,12
    s_waitcnt lgkmcnt(4)
    MV 252,132,12
    RT 128,22,14400
    MV 248,132,8
    RT 130,22,16192
    MV 244,132,4
    MV 240,132,0
    s_waitcnt vmcnt(38) lgkmcnt(4)
    MV 32,136,16
    RT 132,23,14432
    MV 36,136,20
    RT 134,23,16224
    MV 40,136,24
    global_load_dwordx4 a[100:103], v9, s[8:9] offset:1024 sc1
    MV 44,136,28
    s_waitcnt lgkmcnt(4)
    MV 60,140,28
    RT 136,22,14464
    MV 56,140,24
    RT 138,22,16256
    MV 52,140,20
    MV 48,140,16
    s_waitcnt lgkmcnt(4)
    MV 64,128,16
    RT 140,23,14496
    MV 68,128,20
    RT 142,23,16288
    MV 72,128,24
    global_load_dwordx4 a[104:107], v9, s[8:9] offset:2048 sc1
    MV 76,128,28
    s_waitcnt lgkmcnt(4)
    MV 92,132,28
    RT 128,22,14528
    MV 88,132,24
    RT 130,22,16320
    MV 84,132,20
    global_load_dwordx4 a[108:111], v9, s[8:9] offset:3072 sc1
    MV 80,132,16
    v_add_u32 v9, 0x1000, v9
    s_waitcnt lgkmcnt(4)
    MV 96,136,16
    RT 132,23,14560
    MV 100,136,20
    RT 134,23,16352
    MV 104,136,24
    MV 108,136,28
    s_waitcnt lgkmcnt(4)
    MV 124,140,28
    RT 136,22,14592
    MV 120,140,24
    RT 138,22,16384
    MV 116,140,20
    global_load_dwordx4 a[112:115], v9, s[8:9] offset:0 sc1
    MV 112,140,16
    s_waitcnt lgkmcnt(4)
    MV 128,128,16
    RT 140,23,14624
    MV 132,128,20
    RT 142,23,16416
    MV 136,128,24
    MV 140,128,28
    s_waitcnt lgkmcnt(4)
    MV 156,132,28
    RT 128,22,14656
    MV 152,132,24
    RT 130,22,16448
    MV 148,132,20
    global_load_dwordx4 a[116:119], v9, s[8:9] offset:1024 sc1
    MV 144,132,16
    s_waitcnt lgkmcnt(4)
    MV 160,136,16
    RT 132,23,14688
    MV 164,136,20
    RT 134,23,16480
    MV 168,136,24
    MV 172,136,28
    s_waitcnt lgkmcnt(4)
    MV 188,140,28
    RT 136,22,14720
    MV 184,140,24
    RT 138,22,16512
    MV 180,140,20
    global_load_dwordx4 a[120:123], v9, s[8:9] offset:2048 sc1
    MV 176,140,16
    s_waitcnt lgkmcnt(4)
    MV 192,128,16
    RT 140,23,14752
    MV 196,128,20
    RT 142,23,16544
    MV 200,128,24
    MV 204,128,28
    s_waitcnt lgkmcnt(4)
    MV 220,132,28
    RT 128,18,0
    MV 216,132,24
    RT 130,18,1792
    MV 212,132,20
    global_load_dwordx4 a[124:127], v9, s[8:9] offset:3072 sc1
    MV 208,132,16
    v_add_u32 v9, 0x1000, v9
    s_waitcnt lgkmcnt(4)
    MV 224,136,16
    RT 132,19,32
    MV 228,136,20
    RT 134,19,1824
    MV 232,136,24
    MV 236,136,28
    s_waitcnt vmcnt(38) lgkmcnt(4)
    s_barrier
    MV 252,140,28
    RT 136,18,64
    MV 248,140,24
    RT 138,18,1856
    s_add_u32 m0, s26, 114688
    MV 244,140,20
    global_load_lds_dwordx4 v2, s[12:13] offset:0
    MV 240,140,16
    v_add_u32 v2, 458752, v2
    s_waitcnt vmcnt(35) lgkmcnt(4)
    MV 32,128,32
    RT 140,19,96
    MV 36,128,36
    RT 142,19,1888
    MV 40,128,40
    global_load_lds_dwordx4 v3, s[12:13] offset:1024
    MV 44,128,44
    v_add_u32 v3, 458752, v3
    s_waitcnt lgkmcnt(4)
    MV 60,132,44
    RT 128,18,128
    MV 56,132,40
    RT 130,18,1920
    MV 52,132,36
    MV 48,132,32
    s_waitcnt lgkmcnt(4)
    MV 64,136,32
    RT 132,19,160
    MV 68,136,36
    RT 134,19,1952
    MV 72,136,40
    global_load_lds_dwordx4 v4, s[12:13] offset:2048
    MV 76,136,44
    v_add_u32 v4, 458752, v4
    s_waitcnt lgkmcnt(4)
    MV 92,140,44
    RT 136,18,192
    MV 88,140,40
    RT 138,18,1984
    MV 84,140,36
    MV 80,140,32
    s_waitcnt lgkmcnt(4)
    MV 96,128,32
    RT 140,19,224
    MV 100,128,36
    RT 142,19,2016
    MV 104,128,40
    global_load_lds_dwordx4 v5, s[12:13] offset:3072
    MV 108,128,44
    v_add_u32 v5, 458752, v5
    s_waitcnt lgkmcnt(4)
    MV 124,132,44
    RT 128,18,256
    MV 120,132,40
    RT 130,18,2048
    MV 116,132,36
    MV 112,132,32
    s_waitcnt lgkmcnt(4)
    MV 128,136,32
    RT 132,19,288
    MV 132,136,36
    RT 134,19,2080
    s_add_u32 m0, s26, 118784
    MV 136,136,40
    global_load_lds_dwordx4 v6, s[12:13] offset:0
    MV 140,136,44
    v_add_u32 v6, 458752, v6
    s_waitcnt lgkmcnt(4)
    MV 156,140,44
    RT 136,18,320
    MV 152,140,40
    RT 138,18,2112
    MV 148,140,36
    MV 144,140,32
    s_waitcnt lgkmcnt(4)
    MV 160,128,32
    RT 140,19,352
    MV 164,128,36
    RT 142,19,2144
    MV 168,128,40
    global_load_lds_dwordx4 v7, s[12:13] offset:1024
    MV 172,128,44
    v_add_u32 v7, 458752, v7
    s_waitcnt lgkmcnt(4)
    MV 188,132,44
    RT 128,18,384
    MV 184,132,40
    RT 130,18,2176
    MV 180,132,36
    MV 176,132,32
    s_waitcnt lgkmcnt(4)
    MV 192,136,32
    RT 132,19,416
    MV 196,136,36
    RT 134,19,2208
    MV 200,136,40
    global_load_lds_dwordx4 v8, s[12:13] offset:2048
    MV 204,136,44
    v_add_u32 v8, 458752, v8
    s_waitcnt lgkmcnt(4)
    MV 220,140,44
    RT 136,18,14336
    MV 216,140,40
    RT 138,18,16128
    MV 212,140,36
    global_load_dwordx4 a[0:3], v9, s[8:9] offset:0 sc1
    MV 208,140,32
    s_waitcnt lgkmcnt(4)
    MV 224,128,32
    RT 140,19,14368
    MV 228,128,36
    RT 142,19,16160
    MV 232,128,40
    MV 236,128,44
    s_waitcnt lgkmcnt(4)
    MV 252,132,44
    RT 128,18,14400
    MV 248,132,40
    RT 130,18,16192
    MV 244,132,36
    global_load_dwordx4 a[4:7], v9, s[8:9] offset:1024 sc1
    MV 240,132,32
    s_waitcnt vmcnt(39) lgkmcnt(4)
    MV 32,136,48
    RT 132,19,14432
    MV 36,136,52
    RT 134,19,16224
    MV 40,136,56
    MV 44,136,60
    s_waitcnt lgkmcnt(4)
    MV 60,140,60
    RT 136,18,14464
    MV 56,140,56
    RT 138,18,16256
    MV 52,140,52
    global_load_dwordx4 a[8:11], v9, s[8:9] offset:2048 sc1
    MV 48,140,48
    s_waitcnt lgkmcnt(4)
    MV 64,128,48
    RT 140,19,14496
    MV 68,128,52
    RT 142,19,16288
    MV 72,128,56
    MV 76,128,60
    s_waitcnt lgkmcnt(4)
    MV 92,132,60
    RT 128,18,14528
    MV 88,132,56
    RT 130,18,16320
    MV 84,132,52
    global_load_dwordx4 a[12:15], v9, s[8:9] offset:3072 sc1
    MV 80,132,48
    v_add_u32 v9, 0x1000, v9
    s_waitcnt lgkmcnt(4)
    MV 96,136,48
    RT 132,19,14560
    MV 100,136,52
    RT 134,19,16352
    MV 104,136,56
    MV 108,136,60
    s_waitcnt lgkmcnt(4)
    MV 124,140,60
    RT 136,18,14592
    MV 120,140,56
    RT 138,18,16384
    MV 116,140,52
    global_load_dwordx4 a[16:19], v9, s[8:9] offset:0 sc1
    MV 112,140,48
    s_waitcnt lgkmcnt(4)
    MV 128,128,48
    RT 140,19,14624
    MV 132,128,52
    RT 142,19,16416
    MV 136,128,56
    MV 140,128,60
    s_waitcnt lgkmcnt(4)
    MV 156,132,60
    RT 128,18,14656
    MV 152,132,56
    RT 130,18,16448
    MV 148,132,52
    global_load_dwordx4 a[20:23], v9, s[8:9] offset:1024 sc1
    MV 144,132,48
    s_waitcnt lgkmcnt(4)
    MV 160,136,48
    RT 132,19,14688
    MV 164,136,52
    RT 134,19,16480
    MV 168,136,56
    global_load_dwordx4 a[24:27], v9, s[8:9] offset:2048 sc1
    MV 172,136,60
    s_waitcnt lgkmcnt(4)
    MV 188,140,60
    RT 136,18,14720
    MV 184,140,56
    RT 138,18,16512
    MV 180,140,52
    MV 176,140,48
    s_waitcnt lgkmcnt(4)
    MV 192,128,48
    RT 140,19,14752
    MV 196,128,52
    RT 142,19,16544
    MV 200,128,56
    global_load_dwordx4 a[28:31], v9, s[8:9] offset:3072 sc1
    MV 204,128,60
    v_add_u32 v9, 0x1000, v9
    s_waitcnt lgkmcnt(4)
    MV 220,132,60
    RT 128,18,28672
    MV 216,132,56
    RT 130,18,30464
    MV 212,132,52
    MV 208,132,48
    s_waitcnt lgkmcnt(4)
    MV 224,136,48
    RT 132,19,28704
    MV 228,136,52
    RT 134,19,30496
    MV 232,136,56
    global_load_dwordx4 a[32:35], v9, s[8:9] offset:0 sc1
    MV 236,136,60
    s_waitcnt vmcnt(39) lgkmcnt(4)
    s_barrier
    MV 252,140,60
    RT 136,18,28736
    MV 248,140,56
    RT 138,18,30528
    MV 244,140,52
    MV 240,140,48
    s_waitcnt vmcnt(35) lgkmcnt(4)
    MV 32,128,64
    RT 140,19,28768
    MV 36,128,68
    RT 142,19,30560
    s_add_u32 m0, s26, 0
    MV 40,128,72
    global_load_lds_dwordx4 v2, s[12:13] offset:0
    MV 44,128,76
    v_add_u32 v2, 458752, v2
    s_waitcnt lgkmcnt(4)
    MV 60,132,76
    RT 128,18,28800
    MV 56,132,72
    RT 130,18,30592
    MV 52,132,68
    MV 48,132,64
    s_waitcnt lgkmcnt(4)
    MV 64,136,64
    RT 132,19,28832
    MV 68,136,68
    RT 134,19,30624
    MV 72,136,72
    global_load_lds_dwordx4 v3, s[12:13] offset:1024
    MV 76,136,76
    v_add_u32 v3, 458752, v3
    s_waitcnt lgkmcnt(4)
    MV 92,140,76
    RT 136,18,28864
    MV 88,140,72
    RT 138,18,30656
    MV 84,140,68
    MV 80,140,64
    s_waitcnt lgkmcnt(4)
    MV 96,128,64
    RT 140,19,28896
    MV 100,128,68
    RT 142,19,30688
    MV 104,128,72
    global_load_lds_dwordx4 v4, s[12:13] offset:2048
    MV 108,128,76
    v_add_u32 v4, 458752, v4
    s_waitcnt lgkmcnt(4)
    MV 124,132,76
    RT 128,18,28928
    MV 120,132,72
    RT 130,18,30720
    MV 116,132,68
    global_load_lds_dwordx4 v5, s[12:13] offset:3072
    MV 112,132,64
    v_add_u32 v5, 458752, v5
    s_waitcnt lgkmcnt(4)
    MV 128,136,64
    RT 132,19,28960
    MV 132,136,68
    RT 134,19,30752
    MV 136,136,72
    MV 140,136,76
    s_waitcnt lgkmcnt(4)
    MV 156,140,76
    RT 136,18,28992
    MV 152,140,72
    RT 138,18,30784
    s_add_u32 m0, s26, 4096
    MV 148,140,68
    global_load_lds_dwordx4 v6, s[12:13] offset:0
    MV 144,140,64
    v_add_u32 v6, 458752, v6
    s_waitcnt lgkmcnt(4)
    MV 160,128,64
    RT 140,19,29024
    MV 164,128,68
    RT 142,19,30816
    MV 168,128,72
    MV 172,128,76
    s_waitcnt lgkmcnt(4)
    MV 188,132,76
    RT 128,18,29056
    MV 184,132,72
    RT 130,18,30848
    MV 180,132,68
    global_load_lds_dwordx4 v7, s[12:13] offset:1024
    MV 176,132,64
    v_add_u32 v7, 458752, v7
    s_waitcnt lgkmcnt(4)
    MV 192,136,64
    RT 132,19,29088
    MV 196,136,68
    RT 134,19,30880
    MV 200,136,72
    MV 204,136,76
    s_waitcnt lgkmcnt(4)
    MV 220,140,76
    RT 136,18,43008
    MV 216,140,72
    RT 138,18,44800
    MV 212,140,68
    global_load_lds_dwordx4 v8, s[12:13] offset:2048
    MV 208,140,64
    v_add_u32 v8, 458752, v8
    s_waitcnt lgkmcnt(4)
    MV 224,128,64
    RT 140,19,43040
    MV 228,128,68
    RT 142,19,44832
    MV 232,128,72
    MV 236,128,76
    s_waitcnt lgkmcnt(4)
    MV 252,132,76
    RT 128,18,43072
    MV 248,132,72
    RT 130,18,44864
    MV 244,132,68
    global_load_dwordx4 a[36:39], v9, s[8:9] offset:1024 sc1
    MV 240,132,64
    s_waitcnt vmcnt(39) lgkmcnt(4)
    MV 32,136,80
    RT 132,19,43104
    MV 36,136,84
    RT 134,19,44896
    MV 40,136,88
    MV 44,136,92
    s_waitcnt lgkmcnt(4)
    MV 60,140,92
    RT 136,18,43136
    MV 56,140,88
    RT 138,18,44928
    MV 52,140,84
    global_load_dwordx4 a[40:43], v9, s[8:9] offset:2048 sc1
    MV 48,140,80
    s_waitcnt lgkmcnt(4)
    MV 64,128,80
    RT 140,19,43168
    MV 68,128,84
    RT 142,19,44960
    MV 72,128,88
    global_load_dwordx4 a[44:47], v9, s[8:9] offset:3072 sc1
    MV 76,128,92
    v_add_u32 v9, 0x1000, v9
    s_waitcnt lgkmcnt(4)
    MV 92,132,92
    RT 128,18,43200
    MV 88,132,88
    RT 130,18,44992
    MV 84,132,84
    MV 80,132,80
    s_waitcnt lgkmcnt(4)
    MV 96,136,80
    RT 132,19,43232
    MV 100,136,84
    RT 134,19,45024
    MV 104,136,88
    global_load_dwordx4 a[48:51], v9, s[8:9] offset:0 sc1
    MV 108,136,92
    s_waitcnt lgkmcnt(4)
    MV 124,140,92
    RT 136,18,43264
    MV 120,140,88
    RT 138,18,45056
    MV 116,140,84
    MV 112,140,80
    s_waitcnt lgkmcnt(4)
    MV 128,128,80
    RT 140,19,43296
    MV 132,128,84
    RT 142,19,45088
    MV 136,128,88
    global_load_dwordx4 a[52:55], v9, s[8:9] offset:1024 sc1
    MV 140,128,92
    s_waitcnt lgkmcnt(4)
    MV 156,132,92
    RT 128,18,43328
    MV 152,132,88
    RT 130,18,45120
    MV 148,132,84
    MV 144,132,80
    s_waitcnt lgkmcnt(4)
    MV 160,136,80
    RT 132,19,43360
    MV 164,136,84
    RT 134,19,45152
    MV 168,136,88
    global_load_dwordx4 a[56:59], v9, s[8:9] offset:2048 sc1
    MV 172,136,92
    s_waitcnt lgkmcnt(4)
    MV 188,140,92
    RT 136,18,43392
    MV 184,140,88
    RT 138,18,45184
    MV 180,140,84
    MV 176,140,80
    s_waitcnt lgkmcnt(4)
    MV 192,128,80
    RT 140,19,43424
    MV 196,128,84
    RT 142,19,45216
    MV 200,128,88
    global_load_dwordx4 a[60:63], v9, s[8:9] offset:3072 sc1
    MV 204,128,92
    v_add_u32 v9, 0x1000, v9
    s_waitcnt lgkmcnt(4)
    MV 220,132,92
    RT 128,20,0
    MV 216,132,88
    RT 130,20,1792
    MV 212,132,84
    MV 208,132,80
    s_waitcnt lgkmcnt(4)
    MV 224,136,80
    RT 132,21,32
    MV 228,136,84
    RT 134,21,1824
    MV 232,136,88
    global_load_dwordx4 a[64:67], v9, s[8:9] offset:0 sc1
    MV 236,136,92
    s_waitcnt vmcnt(39) lgkmcnt(4)
    s_barrier
    MV 252,140,92
    RT 136,20,64
    MV 248,140,88
    RT 138,20,1856
    s_add_u32 m0, s26, 28672
    MV 244,140,84
    global_load_lds_dwordx4 v2, s[12:13] offset:0
    MV 240,140,80
    v_add_u32 v2, 458752, v2
    s_waitcnt vmcnt(36) lgkmcnt(4)
    MV 32,128,96
    RT 140,21,96
    MV 36,128,100
    RT 142,21,1888
    MV 40,128,104
    MV 44,128,108
    s_waitcnt lgkmcnt(4)
    MV 60,132,108
    RT 128,20,128
    MV 56,132,104
    RT 130,20,1920
    MV 52,132,100
    global_load_lds_dwordx4 v3, s[12:13] offset:1024
    MV 48,132,96
    v_add_u32 v3, 458752, v3
    s_waitcnt lgkmcnt(4)
    MV 64,136,96
    RT 132,21,160
    MV 68,136,100
    RT 134,21,1952
    MV 72,136,104
    MV 76,136,108
    s_waitcnt lgkmcnt(4)
    MV 92,140,108
    RT 136,20,192
    MV 88,140,104
    RT 138,20,1984
    MV 84,140,100
    global_load_lds_dwordx4 v4, s[12:13] offset:2048
    MV 80,140,96
    v_add_u32 v4, 458752, v4
    s_waitcnt lgkmcnt(4)
    MV 96,128,96
    RT 140,21,224
    MV 100,128,100
    RT 142,21,2016
    MV 104,128,104
    MV 108,128,108
    s_waitcnt lgkmcnt(4)
    MV 124,132,108
    RT 128,20,256
    MV 120,132,104
    RT 130,20,2048
    MV 116,132,100
    global_load_lds_dwordx4 v5, s[12:13] offset:3072
    MV 112,132,96
    v_add_u32 v5, 458752, v5
    s_waitcnt lgkmcnt(4)
    MV 128,136,96
    RT 132,21,288
    MV 132,136,100
    RT 134,21,2080
    MV 136,136,104
    MV 140,136,108
    s_waitcnt lgkmcnt(4)
    MV 156,140,108
    RT 136,20,320
    MV 152,140,104
    RT 138,20,2112
    s_add_u32 m0, s26, 32768
    MV 148,140,100
    global_load_lds_dwordx4 v6, s[12:13] offset:0
    MV 144,140,96
    v_add_u32 v6, 458752, v6
    s_waitcnt lgkmcnt(4)
    MV 160,128,96
    RT 140,21,352
    MV 164,128,100
    RT 142,21,2144
    MV 168,128,104
    MV 172,128,108
    s_waitcnt lgkmcnt(4)
    MV 188,132,108
    RT 128,20,384
    MV 184,132,104
    RT 130,20,2176
    MV 180,132,100
    global_load_lds_dwordx4 v7, s[12:13] offset:1024
    MV 176,132,96
    v_add_u32 v7, 458752, v7
    s_waitcnt lgkmcnt(4)
    MV 192,136,96
    RT 132,21,416
    MV 196,136,100
    RT 134,21,2208
    MV 200,136,104
    global_load_lds_dwordx4 v8, s[12:13] offset:2048
    MV 204,136,108
    v_add_u32 v8, 458752, v8
    s_waitcnt lgkmcnt(4)
    MV 220,140,108
    RT 136,20,14336
    MV 216,140,104
    RT 138,20,16128
    MV 212,140,100
    MV 208,140,96
    s_waitcnt lgkmcnt(4)
    MV 224,128,96
    RT 140,21,14368
    MV 228,128,100
    RT 142,21,16160
    MV 232,128,104
    global_load_dwordx4 a[68:71], v9, s[8:9] offset:1024 sc1
    MV 236,128,108
    s_waitcnt lgkmcnt(4)
    MV 252,132,108
    RT 128,20,14400
    MV 248,132,104
    RT 130,20,16192
    MV 244,132,100
    MV 240,132,96
    s_waitcnt vmcnt(39) lgkmcnt(4)
    MV 32,136,112
    RT 132,21,14432
    MV 36,136,116
    RT 134,21,16224
    MV 40,136,120
    global_load_dwordx4 a[72:75], v9, s[8:9] offset:2048 sc1
    MV 44,136,124
    s_waitcnt lgkmcnt(4)
    MV 60,140,124
    RT 136,20,14464
    MV 56,140,120
    RT 138,20,16256
    MV 52,140,116
    MV 48,140,112
    s_waitcnt lgkmcnt(4)
    MV 64,128,112
    RT 140,21,14496
    MV 68,128,116
    RT 142,21,16288
    MV 72,128,120
    global_load_dwordx4 a[76:79], v9, s[8:9] offset:3072 sc1
    MV 76,128,124
    v_add_u32 v9, 0x1000, v9
    s_waitcnt lgkmcnt(4)
    MV 92,132,124
    RT 128,20,14528
    MV 88,132,120
    RT 130,20,16320
    MV 84,132,116
    MV 80,132,112
    s_waitcnt lgkmcnt(4)
    MV 96,136,112
    RT 132,21,14560
    MV 100,136,116
    RT 134,21,16352
    MV 104,136,120
    global_load_dwordx4 a[80:83], v9, s[8:9] offset:0 sc1
    MV 108,136,124
    s_waitcnt lgkmcnt(4)
    MV 124,140,124
    RT 136,20,14592
    MV 120,140,120
    RT 138,20,16384
    MV 116,140,116
    MV 112,140,112
    s_waitcnt lgkmcnt(4)
    MV 128,128,112
    RT 140,21,14624
    MV 132,128,116
    RT 142,21,16416
    MV 136,128,120
    global_load_dwordx4 a[84:87], v9, s[8:9] offset:1024 sc1
    MV 140,128,124
    s_waitcnt lgkmcnt(4)
    MV 156,132,124
    RT 128,20,14656
    MV 152,132,120
    RT 130,20,16448
    MV 148,132,116
    global_load_dwordx4 a[88:91], v9, s[8:9] offset:2048 sc1
    MV 144,132,112
    s_waitcnt lgkmcnt(4)
    MV 160,136,112
    RT 132,21,14688
    MV 164,136,116
    RT 134,21,16480
    MV 168,136,120
    MV 172,136,124
    s_waitcnt lgkmcnt(4)
    MV 188,140,124
    RT 136,20,14720
    MV 184,140,120
    RT 138,20,16512
    MV 180,140,116
    global_load_dwordx4 a[92:95], v9, s[8:9] offset:3072 sc1
    MV 176,140,112
    v_add_u32 v9, 0x1000, v9
    s_waitcnt lgkmcnt(4)
    MV 192,128,112
    RT 140,21,14752
    MV 196,128,116
    RT 142,21,16544
    MV 200,128,120
    MV 204,128,124
    s_waitcnt lgkmcnt(4)
    MV 220,132,124
    RT 128,20,28672
    MV 216,132,120
    RT 130,20,30464
    MV 212,132,116
    global_load_dwordx4 a[96:99], v9, s[8:9] offset:0 sc1
    MV 208,132,112
    s_waitcnt lgkmcnt(4)
    MV 224,136,112
    RT 132,21,28704
    MV 228,136,116
    RT 134,21,30496
    MV 232,136,120
    MV 236,136,124
    s_waitcnt vmcnt(39) lgkmcnt(4)
    s_barrier
    MV 252,140,124
    RT 136,20,28736
    MV 248,140,120
    RT 138,20,30528
    s_add_u32 m0, s26, 57344
    MV 244,140,116
    global_load_lds_dwordx4 v2, s[12:13] offset:0
    MV 240,140,112
    v_add_u32 v2, 458752, v2
    s_waitcnt vmcnt(36) lgkmcnt(4)
    MV 32,128,0
    RT 140,21,28768
    MV 36,128,4
    RT 142,21,30560
    MV 40,128,8
    MV 44,128,12
    s_waitcnt lgkmcnt(4)
    MV 60,132,12
    RT 128,20,28800
    MV 56,132,8
    RT 130,20,30592
    MV 52,132,4
    global_load_lds_dwordx4 v3, s[12:13] offset:1024
    MV 48,132,0
    v_add_u32 v3, 458752, v3
    s_waitcnt lgkmcnt(4)
    MV 64,136,0
    RT 132,21,28832
    MV 68,136,4
    RT 134,21,30624
    MV 72,136,8
    MV 76,136,12
    s_waitcnt lgkmcnt(4)
    MV 92,140,12
    RT 136,20,28864
    MV 88,140,8
    RT 138,20,30656
    MV 84,140,4
    global_load_lds_dwordx4 v4, s[12:13] offset:2048
    MV 80,140,0
    v_add_u32 v4, 458752, v4
    s_waitcnt lgkmcnt(4)
    MV 96,128,0
    RT 140,21,28896
    MV 100,128,4
    RT 142,21,30688
    MV 104,128,8
    global_load_lds_dwordx4 v5, s[12:13] offset:3072
    MV 108,128,12
    v_add_u32 v5, 458752, v5
    s_waitcnt lgkmcnt(4)
    MV 124,132,12
    RT 128,20,28928
    MV 120,132,8
    RT 130,20,30720
    MV 116,132,4
    MV 112,132,0
    s_waitcnt lgkmcnt(4)
    MV 128,136,0
    RT 132,21,28960
    MV 132,136,4
    RT 134,21,30752
    s_add_u32 m0, s26, 61440
    MV 136,136,8
    global_load_lds_dwordx4 v6, s[12:13] offset:0
    MV 140,136,12
    v_add_u32 v6, 458752, v6
    s_waitcnt lgkmcnt(4)
    MV 156,140,12
    RT 136,20,28992
    MV 152,140,8
    RT 138,20,30784
    MV 148,140,4
    MV 144,140,0
    s_waitcnt lgkmcnt(4)
    MV 160,128,0
    RT 140,21,29024
    MV 164,128,4
    RT 142,21,30816
    MV 168,128,8
    global_load_lds_dwordx4 v7, s[12:13] offset:1024
    MV 172,128,12
    v_add_u32 v7, 458752, v7
    s_waitcnt lgkmcnt(4)
    MV 188,132,12
    RT 128,20,29056
    MV 184,132,8
    RT 130,20,30848
    MV 180,132,4
    MV 176,132,0
    s_waitcnt lgkmcnt(4)
    MV 192,136,0
    RT 132,21,29088
    MV 196,136,4
    RT 134,21,30880
    MV 200,136,8
    global_load_lds_dwordx4 v8, s[12:13] offset:2048
    MV 204,136,12
    v_add_u32 v8, 458752, v8
    s_waitcnt lgkmcnt(4)
    MV 220,140,12
    RT 136,20,43008
    MV 216,140,8
    RT 138,20,44800
    MV 212,140,4
    MV 208,140,0
    s_waitcnt lgkmcnt(4)
    MV 224,128,0
    RT 140,21,43040
    MV 228,128,4
    RT 142,21,44832
    MV 232,128,8
    global_load_dwordx4 a[100:103], v9, s[8:9] offset:1024 sc1
    MV 236,128,12
    s_waitcnt lgkmcnt(4)
    MV 252,132,12
    RT 128,20,43072
    MV 248,132,8
    RT 130,20,44864
    MV 244,132,4
    MV 240,132,0
    s_waitcnt vmcnt(39) lgkmcnt(4)
    MV 32,136,16
    RT 132,21,43104
    MV 36,136,20
    RT 134,21,44896
    MV 40,136,24
    global_load_dwordx4 a[104:107], v9, s[8:9] offset:2048 sc1
    MV 44,136,28
    s_waitcnt lgkmcnt(4)
    MV 60,140,28
    RT 136,20,43136
    MV 56,140,24
    RT 138,20,44928
    MV 52,140,20
    global_load_dwordx4 a[108:111], v9, s[8:9] offset:3072 sc1
    MV 48,140,16
    v_add_u32 v9, 0x1000, v9
    s_waitcnt lgkmcnt(4)
    MV 64,128,16
    RT 140,21,43168
    MV 68,128,20
    RT 142,21,44960
    MV 72,128,24
    MV 76,128,28
    s_waitcnt lgkmcnt(4)
    MV 92,132,28
    RT 128,20,43200
    MV 88,132,24
    RT 130,20,44992
    MV 84,132,20
    global_load_dwordx4 a[112:115], v9, s[8:9] offset:0 sc1
    MV 80,132,16
    s_waitcnt lgkmcnt(4)
    MV 96,136,16
    RT 132,21,43232
    MV 100,136,20
    RT 134,21,45024
    MV 104,136,24
    MV 108,136,28
    s_waitcnt lgkmcnt(4)
    MV 124,140,28
    RT 136,20,43264
    MV 120,140,24
    RT 138,20,45056
    MV 116,140,20
    global_load_dwordx4 a[116:119], v9, s[8:9] offset:1024 sc1
    MV 112,140,16
    s_waitcnt lgkmcnt(4)
    MV 128,128,16
    RT 140,21,43296
    MV 132,128,20
    RT 142,21,45088
    MV 136,128,24
    MV 140,128,28
    s_waitcnt lgkmcnt(4)
    MV 156,132,28
    RT 128,20,43328
    MV 152,132,24
    RT 130,20,45120
    MV 148,132,20
    global_load_dwordx4 a[120:123], v9, s[8:9] offset:2048 sc1
    MV 144,132,16
    s_waitcnt lgkmcnt(4)
    MV 160,136,16
    RT 132,21,43360
    MV 164,136,20
    RT 134,21,45152
    MV 168,136,24
    MV 172,136,28
    s_waitcnt lgkmcnt(4)
    MV 188,140,28
    RT 136,20,43392
    MV 184,140,24
    RT 138,20,45184
    MV 180,140,20
    global_load_dwordx4 a[124:127], v9, s[8:9] offset:3072 sc1
    MV 176,140,16
    v_add_u32 v9, 0x1000, v9
    s_waitcnt lgkmcnt(4)
    MV 192,128,16
    RT 140,21,43424
    MV 196,128,20
    RT 142,21,45216
    MV 200,128,24
    MV 204,128,28
    s_waitcnt lgkmcnt(4)
    MV 220,132,28
    RT 128,22,0
    MV 216,132,24
    RT 130,22,1792
    MV 212,132,20
    global_load_dwordx4 a[0:3], v9, s[8:9] offset:0 sc1
    MV 208,132,16
    s_waitcnt lgkmcnt(4)
    MV 224,136,16
    RT 132,23,32
    MV 228,136,20
    RT 134,23,1824
    MV 232,136,24
    global_load_dwordx4 a[4:7], v9, s[8:9] offset:1024 sc1
    MV 236,136,28
    s_waitcnt vmcnt(39) lgkmcnt(4)
    s_barrier
    MV 252,140,28
    RT 136,22,64
    MV 248,140,24
    RT 138,22,1856
    MV 244,140,20
    MV 240,140,16
    s_waitcnt vmcnt(36) lgkmcnt(4)
    MV 32,128,32
    RT 140,23,96
    MV 36,128,36
    RT 142,23,1888
    s_add_u32 m0, s26, 86016
    MV 40,128,40
    global_load_lds_dwordx4 v2, s[12:13] offset:0
    MV 44,128,44
    v_add_u32 v2, 458752, v2
    s_waitcnt lgkmcnt(4)
    MV 60,132,44
    RT 128,22,128
    MV 56,132,40
    RT 130,22,1920
    MV 52,132,36
    MV 48,132,32
    s_waitcnt lgkmcnt(4)
    MV 64,136,32
    RT 132,23,160
    MV 68,136,36
    RT 134,23,1952
    MV 72,136,40
    global_load_lds_dwordx4 v3, s[12:13] offset:1024
    MV 76,136,44
    v_add_u32 v3, 458752, v3
    s_waitcnt lgkmcnt(4)
    MV 92,140,44
    RT 136,22,192
    MV 88,140,40
    RT 138,22,1984
    MV 84,140,36
    MV 80,140,32
    s_waitcnt lgkmcnt(4)
    MV 96,128,32
    RT 140,23,224
    MV 100,128,36
    RT 142,23,2016
    MV 104,128,40
    global_load_lds_dwordx4 v4, s[12:13] offset:2048
    MV 108,128,44
    v_add_u32 v4, 458752, v4
    s_waitcnt lgkmcnt(4)
    MV 124,132,44
    RT 128,22,256
    MV 120,132,40
    RT 130,22,2048
    MV 116,132,36
    MV 112,132,32
    s_waitcnt lgkmcnt(4)
    MV 128,136,32
    RT 132,23,288
    MV 132,136,36
    RT 134,23,2080
    MV 136,136,40
    global_load_lds_dwordx4 v5, s[12:13] offset:3072
    MV 140,136,44
    v_add_u32 v5, 458752, v5
    s_waitcnt lgkmcnt(4)
    MV 156,140,44
    RT 136,22,320
    MV 152,140,40
    RT 138,22,2112
    MV 148,140,36
    MV 144,140,32
    s_waitcnt lgkmcnt(4)
    MV 160,128,32
    RT 140,23,352
    MV 164,128,36
    RT 142,23,2144
    s_add_u32 m0, s26, 90112
    MV 168,128,40
    global_load_lds_dwordx4 v6, s[12:13] offset:0
    MV 172,128,44
    v_add_u32 v6, 458752, v6
    s_waitcnt lgkmcnt(4)
    MV 188,132,44
    RT 128,22,384
    MV 184,132,40
    RT 130,22,2176
    MV 180,132,36
    global_load_lds_dwordx4 v7, s[12:13] offset:1024
    MV 176,132,32
    v_add_u32 v7, 458752, v7
    s_waitcnt lgkmcnt(4)
    MV 192,136,32
    RT 132,23,416
    MV 196,136,36
    RT 134,23,2208
    MV 200,136,40
    MV 204,136,44
    s_waitcnt lgkmcnt(4)
    MV 220,140,44
    RT 136,22,14336
    MV 216,140,40
    RT 138,22,16128
    MV 212,140,36
    global_load_lds_dwordx4 v8, s[12:13] offset:2048
    MV 208,140,32
    v_add_u32 v8, 458752, v8
    s_waitcnt lgkmcnt(4)
    MV 224,128,32
    RT 140,23,14368
    MV 228,128,36
    RT 142,23,16160
    MV 232,128,40
    MV 236,128,44
    s_waitcnt lgkmcnt(4)
    MV 252,132,44
    RT 128,22,14400
    MV 248,132,40
    RT 130,22,16192
    MV 244,132,36
    global_load_dwordx4 a[8:11], v9, s[8:9] offset:2048 sc1
    MV 240,132,32
    s_waitcnt vmcnt(40) lgkmcnt(4)
    MV 32,136,48
    RT 132,23,14432
    MV 36,136,52
    RT 134,23,16224
    MV 40,136,56
    MV 44,136,60
    s_waitcnt lgkmcnt(4)
    MV 60,140,60
    RT 136,22,14464
    MV 56,140,56
    RT 138,22,16256
    MV 52,140,52
    global_load_dwordx4 a[12:15], v9, s[8:9] offset:3072 sc1
    MV 48,140,48
    v_add_u32 v9, 0x1000, v9
    s_waitcnt lgkmcnt(4)
    MV 64,128,48
    RT 140,23,14496
    MV 68,128,52
    RT 142,23,16288
    MV 72,128,56
    MV 76,128,60
    s_waitcnt lgkmcnt(4)
    MV 92,132,60
    RT 128,22,14528
    MV 88,132,56
    RT 130,22,16320
    MV 84,132,52
    global_load_dwordx4 a[16:19], v9, s[8:9] offset:0 sc1
    MV 80,132,48
    s_waitcnt lgkmcnt(4)
    MV 96,136,48
    RT 132,23,14560
    MV 100,136,52
    RT 134,23,16352
    MV 104,136,56
    MV 108,136,60
    s_waitcnt lgkmcnt(4)
    MV 124,140,60
    RT 136,22,14592
    MV 120,140,56
    RT 138,22,16384
    MV 116,140,52
    global_load_dwordx4 a[20:23], v9, s[8:9] offset:1024 sc1
    MV 112,140,48
    s_waitcnt lgkmcnt(4)
    MV 128,128,48
    RT 140,23,14624
    MV 132,128,52
    RT 142,23,16416
    MV 136,128,56
    global_load_dwordx4 a[24:27], v9, s[8:9] offset:2048 sc1
    MV 140,128,60
    s_waitcnt lgkmcnt(4)
    MV 156,132,60
    RT 128,22,14656
    MV 152,132,56
    RT 130,22,16448
    MV 148,132,52
    MV 144,132,48
    s_waitcnt lgkmcnt(4)
    MV 160,136,48
    RT 132,23,14688
    MV 164,136,52
    RT 134,23,16480
    MV 168,136,56
    global_load_dwordx4 a[28:31], v9, s[8:9] offset:3072 sc1
    MV 172,136,60
    v_add_u32 v9, 0x1000, v9
    s_waitcnt lgkmcnt(4)
    MV 188,140,60
    RT 136,22,14720
    MV 184,140,56
    RT 138,22,16512
    MV 180,140,52
    MV 176,140,48
    s_waitcnt lgkmcnt(4)
    MV 192,128,48
    RT 140,23,14752
    MV 196,128,52
    RT 142,23,16544
    MV 200,128,56
    global_load_dwordx4 a[32:35], v9, s[8:9] offset:0 sc1
    MV 204,128,60
    s_waitcnt lgkmcnt(4)
    MV 220,132,60
    RT 128,18,0
    MV 216,132,56
    RT 130,18,1792
    MV 212,132,52
    MV 208,132,48
    s_waitcnt lgkmcnt(4)
    MV 224,136,48
    RT 132,19,32
    MV 228,136,52
    RT 134,19,1824
    MV 232,136,56
    global_load_dwordx4 a[36:39], v9, s[8:9] offset:1024 sc1
    MV 236,136,60
    s_waitcnt vmcnt(39) lgkmcnt(4)
    s_barrier
    MV 252,140,60
    RT 136,18,64
    MV 248,140,56
    RT 138,18,1856
    MV 244,140,52
    MV 240,140,48
    s_waitcnt vmcnt(36) lgkmcnt(4)
    MV 32,128,64
    RT 140,19,96
    MV 36,128,68
    RT 142,19,1888
    s_add_u32 m0, s26, 114688
    MV 40,128,72
    global_load_lds_dwordx4 v2, s[12:13] offset:0
    MV 44,128,76
    v_add_u32 v2, 458752, v2
    s_waitcnt lgkmcnt(4)
    MV 60,132,76
    RT 128,18,128
    MV 56,132,72
    RT 130,18,1920
    MV 52,132,68
    MV 48,132,64
    s_waitcnt lgkmcnt(4)
    MV 64,136,64
    RT 132,19,160
    MV 68,136,68
    RT 134,19,1952
    MV 72,136,72
    global_load_lds_dwordx4 v3, s[12:13] offset:1024
    MV 76,136,76
    v_add_u32 v3, 458752, v3
    s_waitcnt lgkmcnt(4)
    MV 92,140,76
    RT 136,18,192
    MV 88,140,72
    RT 138,18,1984
    MV 84,140,68
    global_load_lds_dwordx4 v4, s[12:13] offset:2048
    MV 80,140,64
    v_add_u32 v4, 458752, v4
    s_waitcnt lgkmcnt(4)
    MV 96,128,64
    RT 140,19,224
    MV 100,128,68
    RT 142,19,2016
    MV 104,128,72
    MV 108,128,76
    s_waitcnt lgkmcnt(4)
    MV 124,132,76
    RT 128,18,256
    MV 120,132,72
    RT 130,18,2048
    MV 116,132,68
    global_load_lds_dwordx4 v5, s[12:13] offset:3072
    MV 112,132,64
    v_add_u32 v5, 458752, v5
    s_waitcnt lgkmcnt(4)
    MV 128,136,64
    RT 132,19,288
    MV 132,136,68
    RT 134,19,2080
    MV 136,136,72
    MV 140,136,76
    s_waitcnt lgkmcnt(4)
    MV 156,140,76
    RT 136,18,320
    MV 152,140,72
    RT 138,18,2112
    s_add_u32 m0, s26, 118784
    MV 148,140,68
    global_load_lds_dwordx4 v6, s[12:13] offset:0
    MV 144,140,64
    v_add_u32 v6, 458752, v6
    s_waitcnt lgkmcnt(4)
    MV 160,128,64
    RT 140,19,352
    MV 164,128,68
    RT 142,19,2144
    MV 168,128,72
    MV 172,128,76
    s_waitcnt lgkmcnt(4)
    MV 188,132,76
    RT 128,18,384
    MV 184,132,72
    RT 130,18,2176
    MV 180,132,68
    global_load_lds_dwordx4 v7, s[12:13] offset:1024
    MV 176,132,64
    v_add_u32 v7, 458752, v7
    s_waitcnt lgkmcnt(4)
    MV 192,136,64
    RT 132,19,416
    MV 196,136,68
    RT 134,19,2208
    MV 200,136,72
    MV 204,136,76
    s_waitcnt lgkmcnt(4)
    MV 220,140,76
    RT 136,18,14336
    MV 216,140,72
    RT 138,18,16128
    MV 212,140,68
    global_load_lds_dwordx4 v8, s[12:13] offset:2048
    MV 208,140,64
    v_add_u32 v8, 458752, v8
    s_waitcnt lgkmcnt(4)
    MV 224,128,64
    RT 140,19,14368
    MV 228,128,68
    RT 142,19,16160
    MV 232,128,72
    MV 236,128,76
    s_waitcnt lgkmcnt(4)
    MV 252,132,76
    RT 128,18,14400
    MV 248,132,72
    RT 130,18,16192
    MV 244,132,68
    global_load_dwordx4 a[40:43], v9, s[8:9] offset:2048 sc1
    MV 240,132,64
    s_waitcnt vmcnt(40) lgkmcnt(4)
    MV 32,136,80
    RT 132,19,14432
    MV 36,136,84
    RT 134,19,16224
    MV 40,136,88
    global_load_dwordx4 a[44:47], v9, s[8:9] offset:3072 sc1
    MV 44,136,92
    v_add_u32 v9, 0x1000, v9
    s_waitcnt lgkmcnt(4)
    MV 60,140,92
    RT 136,18,14464
    MV 56,140,88
    RT 138,18,16256
    MV 52,140,84
    MV 48,140,80
    s_waitcnt lgkmcnt(4)
    MV 64,128,80
    RT 140,19,14496
    MV 68,128,84
    RT 142,19,16288
    MV 72,128,88
    global_load_dwordx4 a[48:51], v9, s[8:9] offset:0 sc1
    MV 76,128,92
    s_waitcnt lgkmcnt(4)
    MV 92,132,92
    RT 128,18,14528
    MV 88,132,88
    RT 130,18,16320
    MV 84,132,84
    MV 80,132,80
    s_waitcnt lgkmcnt(4)
    MV 96,136,80
    RT 132,19,14560
    MV 100,136,84
    RT 134,19,16352
    MV 104,136,88
    global_load_dwordx4 a[52:55], v9, s[8:9] offset:1024 sc1
    MV 108,136,92
    s_waitcnt lgkmcnt(4)
    MV 124,140,92
    RT 136,18,14592
    MV 120,140,88
    RT 138,18,16384
    MV 116,140,84
    MV 112,140,80
    s_waitcnt lgkmcnt(4)
    MV 128,128,80
    RT 140,19,14624
    MV 132,128,84
    RT 142,19,16416
    MV 136,128,88
    global_load_dwordx4 a[56:59], v9, s[8:9] offset:2048 sc1
    MV 140,128,92
    s_waitcnt lgkmcnt(4)
    MV 156,132,92
    RT 128,18,14656
    MV 152,132,88
    RT 130,18,16448
    MV 148,132,84
    MV 144,132,80
    s_waitcnt lgkmcnt(4)
    MV 160,136,80
    RT 132,19,14688
    MV 164,136,84
    RT 134,19,16480
    MV 168,136,88
    global_load_dwordx4 a[60:63], v9, s[8:9] offset:3072 sc1
    MV 172,136,92
    v_add_u32 v9, 0x1000, v9
    s_waitcnt lgkmcnt(4)
    MV 188,140,92
    RT 136,18,14720
    MV 184,140,88
    RT 138,18,16512
    MV 180,140,84
    MV 176,140,80
    s_waitcnt lgkmcnt(4)
    MV 192,128,80
    RT 140,19,14752
    MV 196,128,84
    RT 142,19,16544
    MV 200,128,88
    global_load_dwordx4 a[64:67], v9, s[8:9] offset:0 sc1
    MV 204,128,92
    s_waitcnt lgkmcnt(4)
    MV 220,132,92
    RT 128,18,28672
    MV 216,132,88
    RT 130,18,30464
    MV 212,132,84
    global_load_dwordx4 a[68:71], v9, s[8:9] offset:1024 sc1
    MV 208,132,80
    s_waitcnt lgkmcnt(4)
    MV 224,136,80
    RT 132,19,28704
    MV 228,136,84
    RT 134,19,30496
    MV 232,136,88
    MV 236,136,92
    s_waitcnt vmcnt(39) lgkmcnt(4)
    s_barrier
    MV 252,140,92
    RT 136,18,28736
    MV 248,140,88
    RT 138,18,30528
    s_add_u32 m0, s26, 0
    MV 244,140,84
    global_load_lds_dwordx4 v2, s[12:13] offset:0
    MV 240,140,80
    v_add_u32 v2, 458752, v2
    s_waitcnt vmcnt(37) lgkmcnt(4)
    MV 32,128,96
    RT 140,19,28768
    MV 36,128,100
    RT 142,19,30560
    MV 40,128,104
    MV 44,128,108
    s_waitcnt lgkmcnt(4)
    MV 60,132,108
    RT 128,18,28800
    MV 56,132,104
    RT 130,18,30592
    MV 52,132,100
    global_load_lds_dwordx4 v3, s[12:13] offset:1024
    MV 48,132,96
    v_add_u32 v3, 458752, v3
    s_waitcnt lgkmcnt(4)
    MV 64,136,96
    RT 132,19,28832
    MV 68,136,100
    RT 134,19,30624
    MV 72,136,104
    MV 76,136,108
    s_waitcnt lgkmcnt(4)
    MV 92,140,108
    RT 136,18,28864
    MV 88,140,104
    RT 138,18,30656
    MV 84,140,100
    global_load_lds_dwordx4 v4, s[12:13] offset:2048
    MV 80,140,96
    v_add_u32 v4, 458752, v4
    s_waitcnt lgkmcnt(4)
    MV 96,128,96
    RT 140,19,28896
    MV 100,128,100
    RT 142,19,30688
    MV 104,128,104
    MV 108,128,108
    s_waitcnt lgkmcnt(4)
    MV 124,132,108
    RT 128,18,28928
    MV 120,132,104
    RT 130,18,30720
    MV 116,132,100
    global_load_lds_dwordx4 v5, s[12:13] offset:3072
    MV 112,132,96
    v_add_u32 v5, 458752, v5
    s_waitcnt lgkmcnt(4)
    MV 128,136,96
    RT 132,19,28960
    MV 132,136,100
    RT 134,19,30752
    MV 136,136,104
    MV 140,136,108
    s_waitcnt lgkmcnt(4)
    MV 156,140,108
    RT 136,18,28992
    MV 152,140,104
    RT 138,18,30784
    s_add_u32 m0, s26, 4096
    MV 148,140,100
    global_load_lds_dwordx4 v6, s[12:13] offset:0
    MV 144,140,96
    v_add_u32 v6, 458752, v6
    s_waitcnt lgkmcnt(4)
    MV 160,128,96
    RT 140,19,29024
    MV 164,128,100
    RT 142,19,30816
    MV 168,128,104
    global_load_lds_dwordx4 v7, s[12:13] offset:1024
    MV 172,128,108
    v_add_u32 v7, 458752, v7
    s_waitcnt lgkmcnt(4)
    MV 188,132,108
    RT 128,18,29056
    MV 184,132,104
    RT 130,18,30848
    MV 180,132,100
    MV 176,132,96
    s_waitcnt lgkmcnt(4)
    MV 192,136,96
    RT 132,19,29088
    MV 196,136,100
    RT 134,19,30880
    MV 200,136,104
    global_load_lds_dwordx4 v8, s[12:13] offset:2048
    MV 204,136,108
    v_add_u32 v8, 458752, v8
    s_waitcnt lgkmcnt(4)
    MV 220,140,108
    RT 136,18,43008
    MV 216,140,104
    RT 138,18,44800
    MV 212,140,100
    MV 208,140,96
    s_waitcnt lgkmcnt(4)
    MV 224,128,96
    RT 140,19,43040
    MV 228,128,100
    RT 142,19,44832
    MV 232,128,104
    global_load_dwordx4 a[72:75], v9, s[8:9] offset:2048 sc1
    MV 236,128,108
    s_waitcnt lgkmcnt(4)
    MV 252,132,108
    RT 128,18,43072
    MV 248,132,104
    RT 130,18,44864
    MV 244,132,100
    MV 240,132,96
    s_waitcnt vmcnt(40) lgkmcnt(4)
    MV 32,136,112
    RT 132,19,43104
    MV 36,136,116
    RT 134,19,44896
    MV 40,136,120
    global_load_dwordx4 a[76:79], v9, s[8:9] offset:3072 sc1
    MV 44,136,124
    v_add_u32 v9, 0x1000, v9
    s_waitcnt lgkmcnt(4)
    MV 60,140,124
    RT 136,18,43136
    MV 56,140,120
    RT 138,18,44928
    MV 52,140,116
    MV 48,140,112
    s_waitcnt lgkmcnt(4)
    MV 64,128,112
    RT 140,19,43168
    MV 68,128,116
    RT 142,19,44960
    MV 72,128,120
    global_load_dwordx4 a[80:83], v9, s[8:9] offset:0 sc1
    MV 76,128,124
    s_waitcnt lgkmcnt(4)
    MV 92,132,124
    RT 128,18,43200
    MV 88,132,120
    RT 130,18,44992
    MV 84,132,116
    MV 80,132,112
    s_waitcnt lgkmcnt(4)
    MV 96,136,112
    RT 132,19,43232
    MV 100,136,116
    RT 134,19,45024
    MV 104,136,120
    global_load_dwordx4 a[84:87], v9, s[8:9] offset:1024 sc1
    MV 108,136,124
    s_waitcnt lgkmcnt(4)
    MV 124,140,124
    RT 136,18,43264
    MV 120,140,120
    RT 138,18,45056
    MV 116,140,116
    global_load_dwordx4 a[88:91], v9, s[8:9] offset:2048 sc1
    MV 112,140,112
    s_waitcnt lgkmcnt(4)
    MV 128,128,112
    RT 140,19,43296
    MV 132,128,116
    RT 142,19,45088
    MV 136,128,120
    MV 140,128,124
    s_waitcnt lgkmcnt(4)
    MV 156,132,124
    RT 128,18,43328
    MV 152,132,120
    RT 130,18,45120
    MV 148,132,116
    global_load_dwordx4 a[92:95], v9, s[8:9] offset:3072 sc1
    MV 144,132,112
    v_add_u32 v9, 0x1000, v9
    s_waitcnt lgkmcnt(4)
    MV 160,136,112
    RT 132,19,43360
    MV 164,136,116
    RT 134,19,45152
    MV 168,136,120
    MV 172,136,124
    s_waitcnt lgkmcnt(4)
    MV 188,140,124
    RT 136,18,43392
    MV 184,140,120
    RT 138,18,45184
    MV 180,140,116
    global_load_dwordx4 a[96:99], v9, s[8:9] offset:0 sc1
    MV 176,140,112
    s_waitcnt lgkmcnt(4)
    MV 192,128,112
    RT 140,19,43424
    MV 196,128,116
    RT 142,19,45216
    MV 200,128,120
    MV 204,128,124
    s_waitcnt lgkmcnt(4)
    MV 220,132,124
    RT 128,20,0
    MV 216,132,120
    RT 130,20,1792
    MV 212,132,116
    global_load_dwordx4 a[100:103], v9, s[8:9] offset:1024 sc1
    MV 208,132,112
    s_waitcnt lgkmcnt(4)
    MV 224,136,112
    RT 132,21,32
    MV 228,136,116
    RT 134,21,1824
    MV 232,136,120
    MV 236,136,124
    s_waitcnt vmcnt(38) lgkmcnt(4)
    s_barrier
    MV 252,140,124
    RT 136,20,64
    MV 248,140,120
    RT 138,20,1856
    MV 244,140,116
    global_load_dwordx4 a[104:107], v9, s[8:9] offset:2048 sc1
    MV 240,140,112
    s_waitcnt vmcnt(37) lgkmcnt(4)
    MV 32,128,0
    RT 140,21,96
    MV 36,128,4
    RT 142,21,1888
    MV 40,128,8
    MV 44,128,12
    s_waitcnt lgkmcnt(4)
    MV 60,132,12
    RT 128,20,128
    MV 56,132,8
    RT 130,20,1920
    MV 52,132,4
    global_load_dwordx4 a[108:111], v9, s[8:9] offset:3072 sc1
    MV 48,132,0
    v_add_u32 v9, 0x1000, v9
    s_waitcnt lgkmcnt(4)
    MV 64,136,0
    RT 132,21,160
    MV 68,136,4
    RT 134,21,1952
    MV 72,136,8
    global_load_dwordx4 a[112:115], v9, s[8:9] offset:0 sc1
    MV 76,136,12
    s_waitcnt lgkmcnt(4)
    MV 92,140,12
    RT 136,20,192
    MV 88,140,8
    RT 138,20,1984
    MV 84,140,4
    MV 80,140,0
    s_waitcnt lgkmcnt(4)
    MV 96,128,0
    RT 140,21,224
    MV 100,128,4
    RT 142,21,2016
    MV 104,128,8
    global_load_dwordx4 a[116:119], v9, s[8:9] offset:1024 sc1
    MV 108,128,12
    s_waitcnt lgkmcnt(4)
    MV 124,132,12
    RT 128,20,256
    MV 120,132,8
    RT 130,20,2048
    MV 116,132,4
    MV 112,132,0
    s_waitcnt lgkmcnt(4)
    MV 128,136,0
    RT 132,21,288
    MV 132,136,4
    RT 134,21,2080
    MV 136,136,8
    global_load_dwordx4 a[120:123], v9, s[8:9] offset:2048 sc1
    MV 140,136,12
    s_waitcnt lgkmcnt(4)
    MV 156,140,12
    RT 136,20,320
    MV 152,140,8
    RT 138,20,2112
    MV 148,140,4
    MV 144,140,0
    s_waitcnt lgkmcnt(4)
    MV 160,128,0
    RT 140,21,352
    MV 164,128,4
    RT 142,21,2144
    MV 168,128,8
    global_load_dwordx4 a[124:127], v9, s[8:9] offset:3072 sc1
    MV 172,128,12
    v_add_u32 v9, 0x1000, v9
    s_waitcnt lgkmcnt(4)
    MV 188,132,12
    RT 128,20,384
    MV 184,132,8
    RT 130,20,2176
    MV 180,132,4
    MV 176,132,0
    global_load_dword v0, v30, s[48:49]
    s_waitcnt lgkmcnt(4)
    MV 192,136,0
    RT 132,21,416
    MV 196,136,4
    RT 134,21,2208
    MV 200,136,8
    MV 204,136,12
    s_waitcnt lgkmcnt(4)
    MV 220,140,12
    RT 136,20,14336
    MV 216,140,8
    RT 138,20,16128
    MV 212,140,4
    MV 208,140,0
    s_lshr_b32 s30, s2, 1
    s_lshl_b32 s30, s30, 2
    s_add_u32 s30, s30, s27
    s_mul_i32 s31, s30, 7168
    s_mul_i32 s32, s33, 3670016
    s_add_u32 s31, s31, s32
    v_min_u32 v28, 55, v10
    v_lshlrev_b32 v28, 7, v28
    s_mov_b32 s16, s34
    s_mov_b32 s17, s35
    s_mov_b32 s18, 7340032
    s_mov_b32 s19, 0x00020000
    buffer_load_dword v0, v28, s[16:19], s31 offen
    s_waitcnt lgkmcnt(4)
    MV 224,128,0
    RT 140,21,14368
    MV 228,128,4
    RT 142,21,16160
    MV 232,128,8
    MV 236,128,12
    s_waitcnt lgkmcnt(4)
    MV 252,132,12
    RT 128,20,14400
    MV 248,132,8
    RT 130,20,16192
    MV 244,132,4
    MV 240,132,0
    s_lshr_b32 s60, s2, 3
    s_lshl_b32 s60, s60, 2
    s_add_u32 s60, s60, s27
    s_lshl_b32 s30, s60, 4
    s_mul_i32 s31, s33, 1536
    s_add_u32 s30, s30, s31
    s_lshl_b32 s31, s30, 11
    s_add_u32 s31, s31, 384
    v_and_b32 v28, 31, v10
    v_lshlrev_b32 v28, 10, v28
    buffer_load_dword v0, v28, s[16:19], s31 offen
    s_waitcnt vmcnt(41) lgkmcnt(4)
    MV 32,136,16
    RT 132,21,14432
    MV 36,136,20
    RT 134,21,16224
    MV 40,136,24
    MV 44,136,28
    s_waitcnt lgkmcnt(4)
    MV 60,140,28
    RT 136,20,14464
    MV 56,140,24
    RT 138,20,16256
    MV 52,140,20
    MV 48,140,16
    s_lshl_b32 s30, s2, 2
    s_add_u32 s30, s30, s27
    s_lshl_b32 s31, s30, 11
    v_and_b32 v28, 15, v10
    v_lshlrev_b32 v28, 7, v28
    s_mov_b32 s16, s36
    s_mov_b32 s17, s37
    s_mov_b32 s18, 2097152
    buffer_load_dword v0, v28, s[16:19], s31 offen
    s_waitcnt lgkmcnt(4)
    MV 64,128,16
    RT 140,21,14496
    MV 68,128,20
    RT 142,21,16288
    MV 72,128,24
    MV 76,128,28
    s_waitcnt lgkmcnt(4)
    MV 92,132,28
    RT 128,20,14528
    MV 88,132,24
    RT 130,20,16320
    MV 84,132,20
    MV 80,132,16
    s_lshl_b32 s31, s55, 2
    s_add_u32 s31, s31, s27
    s_lshl_b32 s31, s31, 16
    s_lshl_b32 s30, s56, 8
    s_add_u32 s31, s31, s30
    s_lshl_b32 s30, s33, 7
    s_add_u32 s31, s31, s30
    v_and_b32 v28, 31, v10
    v_lshlrev_b32 v28, 11, v28
    buffer_load_dword v0, v28, s[20:23], s31 offen
    s_waitcnt lgkmcnt(4)
    MV 96,136,16
    RT 132,21,14560
    MV 100,136,20
    RT 134,21,16352
    MV 104,136,24
    MV 108,136,28
    s_waitcnt lgkmcnt(4)
    MV 124,140,28
    RT 136,20,14592
    MV 120,140,24
    RT 138,20,16384
    MV 116,140,20
    MV 112,140,16
    s_waitcnt lgkmcnt(4)
    MV 128,128,16
    RT 140,21,14624
    MV 132,128,20
    RT 142,21,16416
    MV 136,128,24
    s_mov_b32 s12, s34
    MV 140,128,28
    s_mov_b32 s13, s35
    s_waitcnt lgkmcnt(4)
    MV 156,132,28
    RT 128,20,14656
    MV 152,132,24
    RT 130,20,16448
    MV 148,132,20
    s_mov_b32 s14, 7340032
    s_xor_b32 s30, s33, 1
    MV 144,132,16
    s_lshl_b32 s30, s30, 3
    s_waitcnt lgkmcnt(4)
    MV 160,136,16
    RT 132,21,14688
    MV 164,136,20
    RT 134,21,16480
    MV 168,136,24
    v_and_b32 v8, 15, v10
    v_min_u32 v4, 8, v8
    MV 172,136,28
    v_xor_b32 v8, s30, v8
    s_waitcnt lgkmcnt(4)
    MV 188,140,28
    RT 136,20,14720
    MV 184,140,24
    RT 138,20,16512
    MV 180,140,20
    v_add_u32 v7, 0, v11
    v_lshlrev_b32 v9, 1, v7
    MV 176,140,16
    v_xor_b32 v9, v9, v8
    s_waitcnt lgkmcnt(4)
    MV 192,128,16
    RT 140,21,14752
    MV 196,128,20
    RT 142,21,16544
    MV 200,128,24
    v_lshlrev_b32 v9, 4, v9
    v_lshl_add_u32 v2, v7, 11, v9
    MV 204,128,28
    v_add_u32 v7, 4, v11
    s_waitcnt lgkmcnt(4)
    MV 220,132,28
    RT 128,20,28672
    MV 216,132,24
    RT 130,20,30464
    MV 212,132,20
    v_lshlrev_b32 v9, 1, v7
    v_xor_b32 v9, v9, v8
    MV 208,132,16
    v_lshlrev_b32 v9, 4, v9
    s_waitcnt lgkmcnt(4)
    MV 224,136,16
    RT 132,20,43008
    MV 228,136,20
    RT 134,20,44800
    MV 232,136,24
    v_lshl_add_u32 v3, v7, 11, v9
    v_subrev_u32 v3, 1024, v3
    MV 236,136,28
    s_lshl_b32 s26, s27, 11
    s_waitcnt vmcnt(19) lgkmcnt(4)
    s_barrier
    MV 252,140,28
    RT 136,22,0
    MV 248,140,24
    RT 138,22,1792
    MV 244,140,20
    s_lshl_b32 s25, s27, 14
    s_lshl_b32 s30, s56, 8
    MV 240,140,16
    s_add_u32 s25, s25, s30
    s_waitcnt lgkmcnt(4)
    MV 32,128,32
    RT 140,22,14336
    MV 36,128,36
    RT 142,22,16128
    MV 40,128,40
    s_mul_i32 s31, s33, 6881280
    s_add_u32 s25, s25, s31
    MV 44,128,44
    s_lshl_b32 s3, s33, 1
    s_waitcnt lgkmcnt(4)
    MV 44,132,60
    RT 128,18,0
    MV 40,132,56
    RT 130,18,1792
    MV 36,132,52
    s_sub_u32 s3, 1, s3
    s_mul_i32 s3, s3, 458752
    MV 32,132,48
    s_ashr_i32 s58, s3, 4
    s_waitcnt vmcnt(17) lgkmcnt(4)
    MV 32,136,64
    RT 132,18,14336
    MV 36,136,68
    RT 134,18,16128
    MV 40,136,72
    s_lshl_b32 s30, s55, 1
    MV 44,136,76
    s_lshr_b32 s31, s27, 1
    s_waitcnt vmcnt(13) lgkmcnt(4)
    MV 44,140,92
    RT 136,21,28704
    MV 40,140,88
    RT 138,21,30496
    MV 36,140,84
    s_add_u32 s30, s30, s31
    s_mul_i32 s24, s30, 589824
    MV 32,140,80
    s_and_b32 s31, s27, 1
    s_waitcnt vmcnt(9) lgkmcnt(4)
    MV 32,128,96
    RT 140,21,43040
    MV 36,128,100
    RT 142,21,44832
    MV 40,128,104
    s_lshl_b32 s31, s31, 11
    s_add_u32 s24, s24, s31
    MV 44,128,108
    s_add_u32 s24, s24, 4194304
    s_waitcnt vmcnt(5) lgkmcnt(4)
    MV 44,132,124
    RT 128,23,32
    MV 40,132,120
    RT 130,23,1824
    MV 36,132,116
    s_add_u32 s42, s24, 458752
    s_mul_i32 s31, s33, 430080
    MV 32,132,112
    s_add_u32 s24, s24, s31
    s_waitcnt lgkmcnt(4)
    MV 48,136,32
    RT 132,23,14368
    MV 52,136,36
    RT 134,23,16160
    MV 56,136,40
    s_lshl_b32 s30, s30, 7
    s_add_u32 s66, s30, 28311616
    MV 60,136,44
    s_add_u32 s67, s30, 28311552
    s_waitcnt lgkmcnt(4)
    MV 60,140,60
    RT 136,19,32
    MV 56,140,56
    RT 138,19,1824
    MV 52,140,52
    s_mul_i32 s31, s33, 15
    v_xor_b32 v4, s31, v4
    MV 48,140,48
    v_lshlrev_b32 v4, 2, v4
    s_waitcnt lgkmcnt(4)
    MV 48,128,64
    RT 140,19,14368
    MV 52,128,68
    RT 142,19,16160
    MV 56,128,72
    v_add_u32 v2, s25, v2
    v_add_u32 v3, s25, v3
    MV 60,128,76
    v_add_u32 v28, s24, v1
    s_waitcnt lgkmcnt(4)
    MV 60,132,92
    RT 128,20,28736
    MV 56,132,88
    RT 130,20,30528
    MV 52,132,84
    s_lshl_b32 s60, s28, 2
    s_add_u32 s60, s60, s27
    MV 48,132,80
    s_mul_i32 s60, s60, 589824
    s_waitcnt lgkmcnt(4)
    MV 48,136,96
    RT 132,20,43072
    MV 52,136,100
    RT 134,20,44864
    MV 56,136,104
    s_mul_i32 s30, s29, 28672
    s_add_u32 s60, s60, s30
    MV 60,136,108
    s_add_u32 s60, s60, 4194304
    s_waitcnt lgkmcnt(4)
    MV 60,140,124
    RT 136,22,64
    MV 56,140,120
    RT 138,22,1856
    MV 52,140,116
    v_add_u32 v30, s60, v1
    s_mov_b32 s4, 3216550459
    MV 48,140,112
    s_mov_b32 s5, 3216550459
    s_waitcnt lgkmcnt(4)
    MV 64,128,32
    RT 140,22,14400
    MV 68,128,36
    RT 142,22,16192
    MV 72,128,40
    MV 76,128,44
    s_waitcnt lgkmcnt(4)
    MV 76,132,60
    RT 128,18,64
    v_mul_f32 v14, s4, v32
    v_mul_f32 v15, s4, v33
    v_mul_f32 v16, s4, v34
    MV 72,132,56
    RT 130,18,1856
    v_mul_f32 v17, s4, v35
    v_mul_f32 v24, s4, v48
    v_mul_f32 v25, s4, v49
    v_mul_f32 v26, s4, v50
    MV 68,132,52
    v_mul_f32 v27, s4, v51
    v_exp_f32 v14, v14
    v_exp_f32 v15, v15
    v_exp_f32 v16, v16
    v_exp_f32 v17, v17
    MV 64,132,48
    v_exp_f32 v24, v24
    v_exp_f32 v25, v25
    v_exp_f32 v26, v26
    v_exp_f32 v27, v27
    s_waitcnt lgkmcnt(4)
    MV 64,136,64
    RT 132,18,14400
    v_add_f32 v14, 1.0, v14
    v_add_f32 v15, 1.0, v15
    v_add_f32 v16, 1.0, v16
    MV 68,136,68
    RT 134,18,16192
    v_add_f32 v17, 1.0, v17
    v_add_f32 v24, 1.0, v24
    v_add_f32 v25, 1.0, v25
    v_add_f32 v26, 1.0, v26
    MV 72,136,72
    v_add_f32 v27, 1.0, v27
    v_rcp_f32 v14, v14
    v_rcp_f32 v15, v15
    v_rcp_f32 v16, v16
    v_rcp_f32 v17, v17
    MV 76,136,76
    v_rcp_f32 v24, v24
    v_rcp_f32 v25, v25
    v_rcp_f32 v26, v26
    v_rcp_f32 v27, v27
    s_waitcnt lgkmcnt(4)
    MV 76,140,92
    RT 136,21,28768
    v_mul_f32 v14, v14, v32
    v_mul_f32 v15, v15, v33
    v_mul_f32 v16, v16, v34
    v_mul_f32 v17, v17, v35
    MV 72,140,88
    RT 138,21,30560
    v_mul_f32 v24, v24, v48
    v_mul_f32 v25, v25, v49
    v_mul_f32 v26, v26, v50
    v_mul_f32 v27, v27, v51
    MV 68,140,84
    v_cvt_pk_bf16_f32 v32, v14, v15
    v_cvt_pk_bf16_f32 v33, v16, v17
    v_cvt_pk_bf16_f32 v34, v24, v25
    v_cvt_pk_bf16_f32 v35, v26, v27
    MV 64,140,80
    global_store_dwordx4 v30, v[32:35], s[8:9] offset:0 sc1
    v_mul_f32 v14, s4, v36
    v_mul_f32 v15, s4, v37
    v_mul_f32 v16, s4, v38
    v_mul_f32 v17, s4, v39
    s_waitcnt lgkmcnt(4)
    MV 64,128,96
    RT 140,21,43104
    v_mul_f32 v24, s4, v52
    v_mul_f32 v25, s4, v53
    v_mul_f32 v26, s4, v54
    MV 68,128,100
    RT 142,21,44896
    v_mul_f32 v27, s4, v55
    v_exp_f32 v14, v14
    v_exp_f32 v15, v15
    v_exp_f32 v16, v16
    MV 72,128,104
    v_exp_f32 v17, v17
    v_exp_f32 v24, v24
    v_exp_f32 v25, v25
    v_exp_f32 v26, v26
    v_exp_f32 v27, v27
    MV 76,128,108
    v_add_f32 v14, 1.0, v14
    v_add_f32 v15, 1.0, v15
    v_add_f32 v16, 1.0, v16
    v_add_f32 v17, 1.0, v17
    s_waitcnt lgkmcnt(4)
    MV 76,132,124
    RT 128,23,96
    v_add_f32 v24, 1.0, v24
    v_add_f32 v25, 1.0, v25
    v_add_f32 v26, 1.0, v26
    v_add_f32 v27, 1.0, v27
    MV 72,132,120
    RT 130,23,1888
    v_rcp_f32 v14, v14
    v_rcp_f32 v15, v15
    v_rcp_f32 v16, v16
    v_rcp_f32 v17, v17
    MV 68,132,116
    v_rcp_f32 v24, v24
    v_rcp_f32 v25, v25
    v_rcp_f32 v26, v26
    v_rcp_f32 v27, v27
    MV 64,132,112
    v_mul_f32 v14, v14, v36
    v_mul_f32 v15, v15, v37
    v_mul_f32 v16, v16, v38
    v_mul_f32 v17, v17, v39
    v_mul_f32 v24, v24, v52
    s_waitcnt lgkmcnt(4)
    MV 80,136,32
    RT 132,23,14432
    v_mul_f32 v25, v25, v53
    v_mul_f32 v26, v26, v54
    v_mul_f32 v27, v27, v55
    MV 84,136,36
    RT 134,23,16224
    v_cvt_pk_bf16_f32 v36, v14, v15
    v_cvt_pk_bf16_f32 v37, v16, v17
    v_cvt_pk_bf16_f32 v38, v24, v25
    v_cvt_pk_bf16_f32 v39, v26, v27
    MV 88,136,40
    global_store_dwordx4 v30, v[36:39], s[8:9] offset:1024 sc1
    v_mul_f32 v14, s4, v40
    v_mul_f32 v15, s4, v41
    v_mul_f32 v16, s4, v42
    v_mul_f32 v17, s4, v43
    MV 92,136,44
    v_mul_f32 v24, s4, v56
    v_mul_f32 v25, s4, v57
    v_mul_f32 v26, s4, v58
    v_mul_f32 v27, s4, v59
    s_waitcnt lgkmcnt(4)
    MV 92,140,60
    RT 136,19,96
    v_exp_f32 v14, v14
    v_exp_f32 v15, v15
    v_exp_f32 v16, v16
    v_exp_f32 v17, v17
    MV 88,140,56
    RT 138,19,1888
    v_exp_f32 v24, v24
    v_exp_f32 v25, v25
    v_exp_f32 v26, v26
    v_exp_f32 v27, v27
    MV 84,140,52
    v_add_f32 v14, 1.0, v14
    v_add_f32 v15, 1.0, v15
    v_add_f32 v16, 1.0, v16
    v_add_f32 v17, 1.0, v17
    MV 80,140,48
    v_add_f32 v24, 1.0, v24
    v_add_f32 v25, 1.0, v25
    v_add_f32 v26, 1.0, v26
    v_add_f32 v27, 1.0, v27
    v_rcp_f32 v14, v14
    s_waitcnt lgkmcnt(4)
    MV 80,128,64
    RT 140,19,14432
    v_rcp_f32 v15, v15
    v_rcp_f32 v16, v16
    v_rcp_f32 v17, v17
    MV 84,128,68
    RT 142,19,16224
    v_rcp_f32 v24, v24
    v_rcp_f32 v25, v25
    v_rcp_f32 v26, v26
    v_rcp_f32 v27, v27
    MV 88,128,72
    v_mul_f32 v14, v14, v40
    v_mul_f32 v15, v15, v41
    v_mul_f32 v16, v16, v42
    v_mul_f32 v17, v17, v43
    v_mul_f32 v24, v24, v56
    MV 92,128,76
    v_mul_f32 v25, v25, v57
    v_mul_f32 v26, v26, v58
    v_mul_f32 v27, v27, v59
    v_cvt_pk_bf16_f32 v40, v14, v15
    s_waitcnt lgkmcnt(4)
    MV 92,132,92
    RT 128,20,28800
    v_cvt_pk_bf16_f32 v41, v16, v17
    v_cvt_pk_bf16_f32 v42, v24, v25
    v_cvt_pk_bf16_f32 v43, v26, v27
    global_store_dwordx4 v30, v[40:43], s[8:9] offset:2048 sc1
    MV 88,132,88
    RT 130,20,30592
    v_mul_f32 v14, s4, v44
    v_mul_f32 v15, s4, v45
    v_mul_f32 v16, s4, v46
    v_mul_f32 v17, s4, v47
    MV 84,132,84
    v_mul_f32 v24, s4, v60
    v_mul_f32 v25, s4, v61
    v_mul_f32 v26, s4, v62
    v_mul_f32 v27, s4, v63
    MV 80,132,80
    v_exp_f32 v14, v14
    v_exp_f32 v15, v15
    v_exp_f32 v16, v16
    v_exp_f32 v17, v17
    v_exp_f32 v24, v24
    s_waitcnt lgkmcnt(4)
    MV 80,136,96
    RT 132,20,43136
    v_exp_f32 v25, v25
    v_exp_f32 v26, v26
    v_exp_f32 v27, v27
    MV 84,136,100
    RT 134,20,44928
    v_add_f32 v14, 1.0, v14
    v_add_f32 v15, 1.0, v15
    v_add_f32 v16, 1.0, v16
    v_add_f32 v17, 1.0, v17
    MV 88,136,104
    v_add_f32 v24, 1.0, v24
    v_add_f32 v25, 1.0, v25
    v_add_f32 v26, 1.0, v26
    v_add_f32 v27, 1.0, v27
    v_rcp_f32 v14, v14
    MV 92,136,108
    v_rcp_f32 v15, v15
    v_rcp_f32 v16, v16
    v_rcp_f32 v17, v17
    v_rcp_f32 v24, v24
    s_waitcnt lgkmcnt(4)
    MV 92,140,124
    RT 136,22,128
    v_rcp_f32 v25, v25
    v_rcp_f32 v26, v26
    v_rcp_f32 v27, v27
    v_mul_f32 v14, v14, v44
    MV 88,140,120
    RT 138,22,1920
    v_mul_f32 v15, v15, v45
    v_mul_f32 v16, v16, v46
    v_mul_f32 v17, v17, v47
    v_mul_f32 v24, v24, v60
    MV 84,140,116
    v_mul_f32 v25, v25, v61
    v_mul_f32 v26, v26, v62
    v_mul_f32 v27, v27, v63
    v_cvt_pk_bf16_f32 v44, v14, v15
    MV 80,140,112
    v_cvt_pk_bf16_f32 v45, v16, v17
    v_cvt_pk_bf16_f32 v46, v24, v25
    v_cvt_pk_bf16_f32 v47, v26, v27
    global_store_dwordx4 v30, v[44:47], s[8:9] offset:3072 sc1
    v_add_u32 v30, 0x1000, v30
    s_waitcnt lgkmcnt(4)
    MV 96,128,32
    RT 140,22,14464
    MV 100,128,36
    RT 142,22,16256
    MV 104,128,40
    MV 108,128,44
    s_waitcnt lgkmcnt(4)
    MV 108,132,60
    RT 128,18,128
    v_mul_f32 v14, s4, v64
    s_add_u32 m0, s26, 32768
    s_nop 0
    global_load_lds_dwordx4 v2, s[12:13] offset:0
    v_add_u32 v2, 65536, v2
    v_mul_f32 v15, s4, v65
    v_mul_f32 v16, s4, v66
    MV 104,132,56
    RT 130,18,1920
    v_mul_f32 v17, s4, v67
    v_mul_f32 v24, s4, v80
    v_mul_f32 v25, s4, v81
    v_mul_f32 v26, s4, v82
    MV 100,132,52
    v_mul_f32 v27, s4, v83
    v_exp_f32 v14, v14
    v_exp_f32 v15, v15
    v_exp_f32 v16, v16
    v_exp_f32 v17, v17
    v_exp_f32 v24, v24
    MV 96,132,48
    v_exp_f32 v25, v25
    v_exp_f32 v26, v26
    v_exp_f32 v27, v27
    v_add_f32 v14, 1.0, v14
    v_add_f32 v15, 1.0, v15
    s_waitcnt lgkmcnt(4)
    MV 96,136,64
    RT 132,18,14464
    v_add_f32 v16, 1.0, v16
    v_add_f32 v17, 1.0, v17
    v_add_f32 v24, 1.0, v24
    v_add_f32 v25, 1.0, v25
    MV 100,136,68
    RT 134,18,16256
    v_add_f32 v26, 1.0, v26
    v_add_f32 v27, 1.0, v27
    v_rcp_f32 v14, v14
    v_rcp_f32 v15, v15
    MV 104,136,72
    v_rcp_f32 v16, v16
    v_rcp_f32 v17, v17
    v_rcp_f32 v24, v24
    v_rcp_f32 v25, v25
    v_rcp_f32 v26, v26
    v_rcp_f32 v27, v27
    MV 108,136,76
    v_mul_f32 v14, v14, v64
    v_mul_f32 v15, v15, v65
    v_mul_f32 v16, v16, v66
    v_mul_f32 v17, v17, v67
    v_mul_f32 v24, v24, v80
    s_waitcnt lgkmcnt(4)
    MV 108,140,92
    RT 136,21,28832
    v_mul_f32 v25, v25, v81
    v_mul_f32 v26, v26, v82
    v_mul_f32 v27, v27, v83
    v_cvt_pk_bf16_f32 v64, v14, v15
    v_cvt_pk_bf16_f32 v65, v16, v17
    MV 104,140,88
    RT 138,21,30624
    v_cvt_pk_bf16_f32 v66, v24, v25
    v_cvt_pk_bf16_f32 v67, v26, v27
    global_store_dwordx4 v30, v[64:67], s[8:9] offset:0 sc1
    v_mul_f32 v14, s4, v68
    MV 100,140,84
    global_load_lds_dwordx4 v3, s[12:13] offset:1024
    v_add_u32 v3, 65536, v3
    v_mul_f32 v15, s4, v69
    v_mul_f32 v16, s4, v70
    v_mul_f32 v17, s4, v71
    v_mul_f32 v24, s4, v84
    MV 96,140,80
    v_mul_f32 v25, s4, v85
    v_mul_f32 v26, s4, v86
    v_mul_f32 v27, s4, v87
    v_exp_f32 v14, v14
    v_exp_f32 v15, v15
    v_exp_f32 v16, v16
    s_waitcnt lgkmcnt(4)
    MV 96,128,96
    RT 140,21,43168
    v_exp_f32 v17, v17
    v_exp_f32 v24, v24
    v_exp_f32 v25, v25
    v_exp_f32 v26, v26
    MV 100,128,100
    RT 142,21,44960
    v_exp_f32 v27, v27
    v_add_f32 v14, 1.0, v14
    v_add_f32 v15, 1.0, v15
    v_add_f32 v16, 1.0, v16
    MV 104,128,104
    v_add_f32 v17, 1.0, v17
    v_add_f32 v24, 1.0, v24
    v_add_f32 v25, 1.0, v25
    v_add_f32 v26, 1.0, v26
    v_add_f32 v27, 1.0, v27
    v_rcp_f32 v14, v14
    MV 108,128,108
    v_rcp_f32 v15, v15
    v_rcp_f32 v16, v16
    v_rcp_f32 v17, v17
    v_rcp_f32 v24, v24
    v_rcp_f32 v25, v25
    s_waitcnt lgkmcnt(4)
    MV 108,132,124
    RT 128,23,160
    v_rcp_f32 v26, v26
    v_rcp_f32 v27, v27
    v_mul_f32 v14, v14, v68
    v_mul_f32 v15, v15, v69
    MV 104,132,120
    RT 130,23,1952
    v_mul_f32 v16, v16, v70
    v_mul_f32 v17, v17, v71
    v_mul_f32 v24, v24, v84
    v_mul_f32 v25, v25, v85
    MV 100,132,116
    v_mul_f32 v26, v26, v86
    v_mul_f32 v27, v27, v87
    v_cvt_pk_bf16_f32 v68, v14, v15
    v_cvt_pk_bf16_f32 v69, v16, v17
    v_cvt_pk_bf16_f32 v70, v24, v25
    v_cvt_pk_bf16_f32 v71, v26, v27
    MV 96,132,112
    global_store_dwordx4 v30, v[68:71], s[8:9] offset:1024 sc1
    v_mul_f32 v14, s4, v72
    s_add_u32 m0, s26, 40960
    s_nop 0
    global_load_lds_dwordx4 v2, s[12:13] offset:0
    v_add_u32 v2, 65536, v2
    v_mul_f32 v15, s4, v73
    v_mul_f32 v16, s4, v74
    s_waitcnt lgkmcnt(4)
    MV 112,136,32
    RT 132,23,14496
    v_mul_f32 v17, s4, v75
    v_mul_f32 v24, s4, v88
    v_mul_f32 v25, s4, v89
    v_mul_f32 v26, s4, v90
    v_mul_f32 v27, s4, v91
    MV 116,136,36
    RT 134,23,16288
    v_exp_f32 v14, v14
    v_exp_f32 v15, v15
    v_exp_f32 v16, v16
    v_exp_f32 v17, v17
    MV 120,136,40
    v_exp_f32 v24, v24
    v_exp_f32 v25, v25
    v_exp_f32 v26, v26
    v_exp_f32 v27, v27
    v_add_f32 v14, 1.0, v14
    MV 124,136,44
    v_add_f32 v15, 1.0, v15
    v_add_f32 v16, 1.0, v16
    v_add_f32 v17, 1.0, v17
    v_add_f32 v24, 1.0, v24
    v_add_f32 v25, 1.0, v25
    v_add_f32 v26, 1.0, v26
    s_waitcnt lgkmcnt(4)
    MV 124,140,60
    RT 136,19,160
    v_add_f32 v27, 1.0, v27
    v_rcp_f32 v14, v14
    v_rcp_f32 v15, v15
    v_rcp_f32 v16, v16
    MV 120,140,56
    RT 138,19,1952
    v_rcp_f32 v17, v17
    v_rcp_f32 v24, v24
    v_rcp_f32 v25, v25
    v_rcp_f32 v26, v26
    MV 116,140,52
    v_rcp_f32 v27, v27
    v_mul_f32 v14, v14, v72
    v_mul_f32 v15, v15, v73
    v_mul_f32 v16, v16, v74
    v_mul_f32 v17, v17, v75
    v_mul_f32 v24, v24, v88
    MV 112,140,48
    v_mul_f32 v25, v25, v89
    v_mul_f32 v26, v26, v90
    v_mul_f32 v27, v27, v91
    v_cvt_pk_bf16_f32 v72, v14, v15
    v_cvt_pk_bf16_f32 v73, v16, v17
    s_waitcnt lgkmcnt(4)
    MV 112,128,64
    RT 140,19,14496
    v_cvt_pk_bf16_f32 v74, v24, v25
    v_cvt_pk_bf16_f32 v75, v26, v27
    global_store_dwordx4 v30, v[72:75], s[8:9] offset:2048 sc1
    v_mul_f32 v14, s4, v76
    MV 116,128,68
    RT 142,19,16288
    global_load_lds_dwordx4 v3, s[12:13] offset:1024
    v_add_u32 v3, 65536, v3
    v_mul_f32 v15, s4, v77
    v_mul_f32 v16, s4, v78
    v_mul_f32 v17, s4, v79
    MV 120,128,72
    v_mul_f32 v24, s4, v92
    v_mul_f32 v25, s4, v93
    v_mul_f32 v26, s4, v94
    v_mul_f32 v27, s4, v95
    v_exp_f32 v14, v14
    v_exp_f32 v15, v15
    MV 124,128,76
    v_exp_f32 v16, v16
    v_exp_f32 v17, v17
    v_exp_f32 v24, v24
    v_exp_f32 v25, v25
    v_exp_f32 v26, v26
    s_waitcnt lgkmcnt(4)
    MV 124,132,92
    RT 128,20,28864
    v_exp_f32 v27, v27
    v_add_f32 v14, 1.0, v14
    v_add_f32 v15, 1.0, v15
    v_add_f32 v16, 1.0, v16
    v_add_f32 v17, 1.0, v17
    MV 120,132,88
    RT 130,20,30656
    v_add_f32 v24, 1.0, v24
    v_add_f32 v25, 1.0, v25
    v_add_f32 v26, 1.0, v26
    v_add_f32 v27, 1.0, v27
    MV 116,132,84
    v_rcp_f32 v14, v14
    v_rcp_f32 v15, v15
    v_rcp_f32 v16, v16
    v_rcp_f32 v17, v17
    v_rcp_f32 v24, v24
    MV 112,132,80
    v_rcp_f32 v25, v25
    v_rcp_f32 v26, v26
    v_rcp_f32 v27, v27
    v_mul_f32 v14, v14, v76
    v_mul_f32 v15, v15, v77
    v_mul_f32 v16, v16, v78
    s_waitcnt lgkmcnt(4)
    MV 112,136,96
    RT 132,20,43200
    v_mul_f32 v17, v17, v79
    v_mul_f32 v24, v24, v92
    v_mul_f32 v25, v25, v93
    v_mul_f32 v26, v26, v94
    MV 116,136,100
    RT 134,20,44992
    v_mul_f32 v27, v27, v95
    v_cvt_pk_bf16_f32 v76, v14, v15
    v_cvt_pk_bf16_f32 v77, v16, v17
    v_cvt_pk_bf16_f32 v78, v24, v25
    MV 120,136,104
    v_cvt_pk_bf16_f32 v79, v26, v27
    global_store_dwordx4 v30, v[76:79], s[8:9] offset:3072 sc1
    v_add_u32 v30, 0x1000, v30
    v_lshl_add_u32 v7, v11, 2, v12
    v_and_b32 v8, 7, v7
    v_lshlrev_b32 v7, 8, v7
    MV 124,136,108
    v_lshl_add_u32 v7, v13, 3, v7
    v_xor_b32 v9, 0, v8
    v_lshl_add_u32 v32, v9, 5, v7
    v_add_u32 v40, 65536, v32
    v_xor_b32 v9, 1, v8
    s_waitcnt lgkmcnt(4)
    MV 124,140,124
    RT 136,22,192
    v_lshl_add_u32 v33, v9, 5, v7
    v_add_u32 v41, 65536, v33
    v_xor_b32 v9, 2, v8
    v_lshl_add_u32 v34, v9, 5, v7
    v_add_u32 v42, 65536, v34
    MV 120,140,120
    RT 138,22,1984
    v_xor_b32 v9, 3, v8
    v_lshl_add_u32 v35, v9, 5, v7
    v_add_u32 v43, 65536, v35
    v_xor_b32 v9, 4, v8
    MV 116,140,116
    v_lshl_add_u32 v36, v9, 5, v7
    v_add_u32 v44, 65536, v36
    v_xor_b32 v9, 5, v8
    v_lshl_add_u32 v37, v9, 5, v7
    v_add_u32 v45, 65536, v37
    MV 112,140,112
    v_xor_b32 v9, 6, v8
    v_lshl_add_u32 v38, v9, 5, v7
    v_add_u32 v46, 65536, v38
    v_xor_b32 v9, 7, v8
    v_lshl_add_u32 v39, v9, 5, v7
    v_add_u32 v47, 65536, v39
    s_waitcnt lgkmcnt(4)
    MV 128,128,32
    RT 140,22,14528
    MV 132,128,36
    RT 142,22,16320
    MV 136,128,40
    MV 140,128,44
    s_waitcnt lgkmcnt(4)
    MV 140,132,60
    RT 128,18,192
    v_mul_f32 v14, s4, v96
    v_mul_f32 v15, s4, v97
    v_mul_f32 v16, s4, v98
    MV 136,132,56
    RT 130,18,1984
    v_mul_f32 v17, s4, v99
    v_mul_f32 v24, s4, v112
    v_mul_f32 v25, s4, v113
    v_mul_f32 v26, s4, v114
    MV 132,132,52
    v_mul_f32 v27, s4, v115
    v_exp_f32 v14, v14
    v_exp_f32 v15, v15
    v_exp_f32 v16, v16
    v_exp_f32 v17, v17
    MV 128,132,48
    v_exp_f32 v24, v24
    v_exp_f32 v25, v25
    v_exp_f32 v26, v26
    v_exp_f32 v27, v27
    s_waitcnt lgkmcnt(4)
    MV 128,136,64
    RT 132,18,14528
    v_add_f32 v14, 1.0, v14
    v_add_f32 v15, 1.0, v15
    v_add_f32 v16, 1.0, v16
    MV 132,136,68
    RT 134,18,16320
    v_add_f32 v17, 1.0, v17
    v_add_f32 v24, 1.0, v24
    v_add_f32 v25, 1.0, v25
    v_add_f32 v26, 1.0, v26
    MV 136,136,72
    v_add_f32 v27, 1.0, v27
    v_rcp_f32 v14, v14
    v_rcp_f32 v15, v15
    v_rcp_f32 v16, v16
    v_rcp_f32 v17, v17
    MV 140,136,76
    v_rcp_f32 v24, v24
    v_rcp_f32 v25, v25
    v_rcp_f32 v26, v26
    v_rcp_f32 v27, v27
    s_waitcnt lgkmcnt(4)
    MV 140,140,92
    RT 136,21,28896
    v_mul_f32 v14, v14, v96
    v_mul_f32 v15, v15, v97
    v_mul_f32 v16, v16, v98
    v_mul_f32 v17, v17, v99
    MV 136,140,88
    RT 138,21,30688
    v_mul_f32 v24, v24, v112
    v_mul_f32 v25, v25, v113
    v_mul_f32 v26, v26, v114
    v_mul_f32 v27, v27, v115
    MV 132,140,84
    v_cvt_pk_bf16_f32 v96, v14, v15
    v_cvt_pk_bf16_f32 v97, v16, v17
    v_cvt_pk_bf16_f32 v98, v24, v25
    v_cvt_pk_bf16_f32 v99, v26, v27
    MV 128,140,80
    global_store_dwordx4 v30, v[96:99], s[8:9] offset:0 sc1
    v_mul_f32 v14, s4, v100
    v_mul_f32 v15, s4, v101
    v_mul_f32 v16, s4, v102
    v_mul_f32 v17, s4, v103
    s_waitcnt lgkmcnt(4)
    MV 128,128,96
    RT 140,21,43232
    v_mul_f32 v24, s4, v116
    v_mul_f32 v25, s4, v117
    v_mul_f32 v26, s4, v118
    MV 132,128,100
    RT 142,21,45024
    v_mul_f32 v27, s4, v119
    v_exp_f32 v14, v14
    v_exp_f32 v15, v15
    v_exp_f32 v16, v16
    MV 136,128,104
    v_exp_f32 v17, v17
    v_exp_f32 v24, v24
    v_exp_f32 v25, v25
    v_exp_f32 v26, v26
    v_exp_f32 v27, v27
    MV 140,128,108
    v_add_f32 v14, 1.0, v14
    v_add_f32 v15, 1.0, v15
    v_add_f32 v16, 1.0, v16
    v_add_f32 v17, 1.0, v17
    s_waitcnt lgkmcnt(4)
    MV 140,132,124
    RT 128,23,224
    v_add_f32 v24, 1.0, v24
    v_add_f32 v25, 1.0, v25
    v_add_f32 v26, 1.0, v26
    v_add_f32 v27, 1.0, v27
    MV 136,132,120
    RT 130,23,2016
    v_rcp_f32 v14, v14
    v_rcp_f32 v15, v15
    v_rcp_f32 v16, v16
    v_rcp_f32 v17, v17
    MV 132,132,116
    v_rcp_f32 v24, v24
    v_rcp_f32 v25, v25
    v_rcp_f32 v26, v26
    v_rcp_f32 v27, v27
    MV 128,132,112
    v_mul_f32 v14, v14, v100
    v_mul_f32 v15, v15, v101
    v_mul_f32 v16, v16, v102
    v_mul_f32 v17, v17, v103
    v_mul_f32 v24, v24, v116
    s_waitcnt lgkmcnt(4)
    MV 144,136,32
    RT 132,23,14560
    v_mul_f32 v25, v25, v117
    v_mul_f32 v26, v26, v118
    v_mul_f32 v27, v27, v119
    MV 148,136,36
    RT 134,23,16352
    v_cvt_pk_bf16_f32 v100, v14, v15
    v_cvt_pk_bf16_f32 v101, v16, v17
    v_cvt_pk_bf16_f32 v102, v24, v25
    v_cvt_pk_bf16_f32 v103, v26, v27
    MV 152,136,40
    global_store_dwordx4 v30, v[100:103], s[8:9] offset:1024 sc1
    v_mul_f32 v14, s4, v104
    v_mul_f32 v15, s4, v105
    v_mul_f32 v16, s4, v106
    v_mul_f32 v17, s4, v107
    MV 156,136,44
    v_mul_f32 v24, s4, v120
    v_mul_f32 v25, s4, v121
    v_mul_f32 v26, s4, v122
    v_mul_f32 v27, s4, v123
    s_waitcnt lgkmcnt(4)
    MV 156,140,60
    RT 136,19,224
    v_exp_f32 v14, v14
    v_exp_f32 v15, v15
    v_exp_f32 v16, v16
    v_exp_f32 v17, v17
    MV 152,140,56
    RT 138,19,2016
    v_exp_f32 v24, v24
    v_exp_f32 v25, v25
    v_exp_f32 v26, v26
    v_exp_f32 v27, v27
    MV 148,140,52
    v_add_f32 v14, 1.0, v14
    v_add_f32 v15, 1.0, v15
    v_add_f32 v16, 1.0, v16
    v_add_f32 v17, 1.0, v17
    MV 144,140,48
    v_add_f32 v24, 1.0, v24
    v_add_f32 v25, 1.0, v25
    v_add_f32 v26, 1.0, v26
    v_add_f32 v27, 1.0, v27
    v_rcp_f32 v14, v14
    s_waitcnt lgkmcnt(4)
    MV 144,128,64
    RT 140,19,14560
    v_rcp_f32 v15, v15
    v_rcp_f32 v16, v16
    v_rcp_f32 v17, v17
    MV 148,128,68
    RT 142,19,16352
    v_rcp_f32 v24, v24
    v_rcp_f32 v25, v25
    v_rcp_f32 v26, v26
    v_rcp_f32 v27, v27
    MV 152,128,72
    v_mul_f32 v14, v14, v104
    v_mul_f32 v15, v15, v105
    v_mul_f32 v16, v16, v106
    v_mul_f32 v17, v17, v107
    v_mul_f32 v24, v24, v120
    MV 156,128,76
    v_mul_f32 v25, v25, v121
    v_mul_f32 v26, v26, v122
    v_mul_f32 v27, v27, v123
    v_cvt_pk_bf16_f32 v104, v14, v15
    s_waitcnt lgkmcnt(4)
    MV 156,132,92
    RT 128,20,28928
    v_cvt_pk_bf16_f32 v105, v16, v17
    v_cvt_pk_bf16_f32 v106, v24, v25
    v_cvt_pk_bf16_f32 v107, v26, v27
    global_store_dwordx4 v30, v[104:107], s[8:9] offset:2048 sc1
    MV 152,132,88
    RT 130,20,30720
    v_mul_f32 v14, s4, v108
    v_mul_f32 v15, s4, v109
    v_mul_f32 v16, s4, v110
    v_mul_f32 v17, s4, v111
    MV 148,132,84
    v_mul_f32 v24, s4, v124
    v_mul_f32 v25, s4, v125
    v_mul_f32 v26, s4, v126
    v_mul_f32 v27, s4, v127
    MV 144,132,80
    v_exp_f32 v14, v14
    v_exp_f32 v15, v15
    v_exp_f32 v16, v16
    v_exp_f32 v17, v17
    v_exp_f32 v24, v24
    s_waitcnt lgkmcnt(4)
    MV 144,136,96
    RT 132,20,43264
    v_exp_f32 v25, v25
    v_exp_f32 v26, v26
    v_exp_f32 v27, v27
    MV 148,136,100
    RT 134,20,45056
    v_add_f32 v14, 1.0, v14
    v_add_f32 v15, 1.0, v15
    v_add_f32 v16, 1.0, v16
    v_add_f32 v17, 1.0, v17
    MV 152,136,104
    v_add_f32 v24, 1.0, v24
    v_add_f32 v25, 1.0, v25
    v_add_f32 v26, 1.0, v26
    v_add_f32 v27, 1.0, v27
    v_rcp_f32 v14, v14
    MV 156,136,108
    v_rcp_f32 v15, v15
    v_rcp_f32 v16, v16
    v_rcp_f32 v17, v17
    v_rcp_f32 v24, v24
    s_waitcnt lgkmcnt(4)
    MV 156,140,124
    RT 136,22,256
    v_rcp_f32 v25, v25
    v_rcp_f32 v26, v26
    v_rcp_f32 v27, v27
    v_mul_f32 v14, v14, v108
    MV 152,140,120
    RT 138,22,2048
    v_mul_f32 v15, v15, v109
    v_mul_f32 v16, v16, v110
    v_mul_f32 v17, v17, v111
    v_mul_f32 v24, v24, v124
    MV 148,140,116
    v_mul_f32 v25, v25, v125
    v_mul_f32 v26, v26, v126
    v_mul_f32 v27, v27, v127
    v_cvt_pk_bf16_f32 v108, v14, v15
    MV 144,140,112
    v_cvt_pk_bf16_f32 v109, v16, v17
    v_cvt_pk_bf16_f32 v110, v24, v25
    v_cvt_pk_bf16_f32 v111, v26, v27
    global_store_dwordx4 v30, v[108:111], s[8:9] offset:3072 sc1
    v_add_u32 v30, 0x1000, v30
    s_waitcnt lgkmcnt(4)
    MV 160,128,32
    RT 140,22,14592
    MV 164,128,36
    RT 142,22,16384
    MV 168,128,40
    MV 172,128,44
    s_waitcnt lgkmcnt(4)
    MV 172,132,60
    RT 128,18,256
    v_mul_f32 v14, s4, v128
    s_add_u32 m0, s26, 49152
    s_nop 0
    global_load_lds_dwordx4 v2, s[12:13] offset:0
    s_add_u32 s59, s3, 4294836224
    v_add_u32 v2, s59, v2
    v_mul_f32 v15, s4, v129
    MV 168,132,56
    RT 130,18,2048
    v_mul_f32 v16, s4, v130
    v_mul_f32 v17, s4, v131
    v_mul_f32 v24, s4, v144
    v_mul_f32 v25, s4, v145
    MV 164,132,52
    v_mul_f32 v26, s4, v146
    v_mul_f32 v27, s4, v147
    v_exp_f32 v14, v14
    v_exp_f32 v15, v15
    v_exp_f32 v16, v16
    MV 160,132,48
    v_exp_f32 v17, v17
    v_exp_f32 v24, v24
    v_exp_f32 v25, v25
    v_exp_f32 v26, v26
    s_waitcnt lgkmcnt(4)
    MV 160,136,64
    RT 132,18,14592
    v_exp_f32 v27, v27
    v_add_f32 v14, 1.0, v14
    v_add_f32 v15, 1.0, v15
    v_add_f32 v16, 1.0, v16
    MV 164,136,68
    RT 134,18,16384
    v_add_f32 v17, 1.0, v17
    v_add_f32 v24, 1.0, v24
    v_add_f32 v25, 1.0, v25
    v_add_f32 v26, 1.0, v26
    MV 168,136,72
    v_add_f32 v27, 1.0, v27
    v_rcp_f32 v14, v14
    v_rcp_f32 v15, v15
    v_rcp_f32 v16, v16
    MV 172,136,76
    v_rcp_f32 v17, v17
    v_rcp_f32 v24, v24
    v_rcp_f32 v25, v25
    v_rcp_f32 v26, v26
    v_rcp_f32 v27, v27
    s_waitcnt lgkmcnt(4)
    MV 172,140,92
    RT 136,21,28960
    v_mul_f32 v14, v14, v128
    v_mul_f32 v15, v15, v129
    v_mul_f32 v16, v16, v130
    v_mul_f32 v17, v17, v131
    MV 168,140,88
    RT 138,21,30752
    v_mul_f32 v24, v24, v144
    v_mul_f32 v25, v25, v145
    v_mul_f32 v26, v26, v146
    v_mul_f32 v27, v27, v147
    MV 164,140,84
    v_cvt_pk_bf16_f32 v128, v14, v15
    v_cvt_pk_bf16_f32 v129, v16, v17
    v_cvt_pk_bf16_f32 v130, v24, v25
    v_cvt_pk_bf16_f32 v131, v26, v27
    MV 160,140,80
    global_store_dwordx4 v30, v[128:131], s[8:9] offset:0 sc1
    v_mul_f32 v14, s4, v132
    global_load_lds_dwordx4 v3, s[12:13] offset:1024
    s_add_u32 s59, s3, 4294836224
    v_add_u32 v3, s59, v3
    v_mul_f32 v15, s4, v133
    v_mul_f32 v16, s4, v134
    s_waitcnt lgkmcnt(4)
    MV 160,128,96
    RT 140,21,43296
    v_mul_f32 v17, s4, v135
    v_mul_f32 v24, s4, v148
    v_mul_f32 v25, s4, v149
    v_mul_f32 v26, s4, v150
    MV 164,128,100
    RT 142,21,45088
    v_mul_f32 v27, s4, v151
    v_exp_f32 v14, v14
    v_exp_f32 v15, v15
    v_exp_f32 v16, v16
    MV 168,128,104
    v_exp_f32 v17, v17
    v_exp_f32 v24, v24
    v_exp_f32 v25, v25
    v_exp_f32 v26, v26
    MV 172,128,108
    v_exp_f32 v27, v27
    v_add_f32 v14, 1.0, v14
    v_add_f32 v15, 1.0, v15
    v_add_f32 v16, 1.0, v16
    v_add_f32 v17, 1.0, v17
    s_waitcnt lgkmcnt(4)
    MV 172,132,124
    RT 128,23,288
    v_add_f32 v24, 1.0, v24
    v_add_f32 v25, 1.0, v25
    v_add_f32 v26, 1.0, v26
    v_add_f32 v27, 1.0, v27
    MV 168,132,120
    RT 130,23,2080
    v_rcp_f32 v14, v14
    v_rcp_f32 v15, v15
    v_rcp_f32 v16, v16
    v_rcp_f32 v17, v17
    MV 164,132,116
    v_rcp_f32 v24, v24
    v_rcp_f32 v25, v25
    v_rcp_f32 v26, v26
    v_rcp_f32 v27, v27
    MV 160,132,112
    v_mul_f32 v14, v14, v132
    v_mul_f32 v15, v15, v133
    v_mul_f32 v16, v16, v134
    v_mul_f32 v17, v17, v135
    v_mul_f32 v24, v24, v148
    s_waitcnt lgkmcnt(4)
    MV 176,136,32
    RT 132,23,14624
    v_mul_f32 v25, v25, v149
    v_mul_f32 v26, v26, v150
    v_mul_f32 v27, v27, v151
    MV 180,136,36
    RT 134,23,16416
    v_cvt_pk_bf16_f32 v132, v14, v15
    v_cvt_pk_bf16_f32 v133, v16, v17
    v_cvt_pk_bf16_f32 v134, v24, v25
    v_cvt_pk_bf16_f32 v135, v26, v27
    MV 184,136,40
    global_store_dwordx4 v30, v[132:135], s[8:9] offset:1024 sc1
    v_mul_f32 v14, s4, v136
    s_add_u32 m0, s26, 57344
    s_nop 0
    global_load_lds_dwordx4 v2, s[12:13] offset:0
    v_add_u32 v2, 65536, v2
    v_mul_f32 v15, s4, v137
    v_mul_f32 v16, s4, v138
    MV 188,136,44
    v_mul_f32 v17, s4, v139
    v_mul_f32 v24, s4, v152
    v_mul_f32 v25, s4, v153
    v_mul_f32 v26, s4, v154
    s_waitcnt lgkmcnt(4)
    MV 188,140,60
    RT 136,19,288
    v_mul_f32 v27, s4, v155
    v_exp_f32 v14, v14
    v_exp_f32 v15, v15
    v_exp_f32 v16, v16
    MV 184,140,56
    RT 138,19,2080
    v_exp_f32 v17, v17
    v_exp_f32 v24, v24
    v_exp_f32 v25, v25
    v_exp_f32 v26, v26
    MV 180,140,52
    v_exp_f32 v27, v27
    v_add_f32 v14, 1.0, v14
    v_add_f32 v15, 1.0, v15
    v_add_f32 v16, 1.0, v16
    MV 176,140,48
    v_add_f32 v17, 1.0, v17
    v_add_f32 v24, 1.0, v24
    v_add_f32 v25, 1.0, v25
    v_add_f32 v26, 1.0, v26
    v_add_f32 v27, 1.0, v27
    s_waitcnt lgkmcnt(4)
    MV 176,128,64
    RT 140,19,14624
    v_rcp_f32 v14, v14
    v_rcp_f32 v15, v15
    v_rcp_f32 v16, v16
    v_rcp_f32 v17, v17
    MV 180,128,68
    RT 142,19,16416
    v_rcp_f32 v24, v24
    v_rcp_f32 v25, v25
    v_rcp_f32 v26, v26
    v_rcp_f32 v27, v27
    MV 184,128,72
    v_mul_f32 v14, v14, v136
    v_mul_f32 v15, v15, v137
    v_mul_f32 v16, v16, v138
    v_mul_f32 v17, v17, v139
    MV 188,128,76
    v_mul_f32 v24, v24, v152
    v_mul_f32 v25, v25, v153
    v_mul_f32 v26, v26, v154
    v_mul_f32 v27, v27, v155
    v_cvt_pk_bf16_f32 v136, v14, v15
    s_waitcnt lgkmcnt(4)
    MV 188,132,92
    RT 128,20,28992
    v_cvt_pk_bf16_f32 v137, v16, v17
    v_cvt_pk_bf16_f32 v138, v24, v25
    v_cvt_pk_bf16_f32 v139, v26, v27
    global_store_dwordx4 v30, v[136:139], s[8:9] offset:2048 sc1
    MV 184,132,88
    RT 130,20,30784
    v_mul_f32 v14, s4, v140
    global_load_lds_dwordx4 v3, s[12:13] offset:1024
    v_add_u32 v3, 65536, v3
    v_mul_f32 v15, s4, v141
    v_mul_f32 v16, s4, v142
    MV 180,132,84
    v_mul_f32 v17, s4, v143
    v_mul_f32 v24, s4, v156
    v_mul_f32 v25, s4, v157
    v_mul_f32 v26, s4, v158
    MV 176,132,80
    v_mul_f32 v27, s4, v159
    v_exp_f32 v14, v14
    v_exp_f32 v15, v15
    v_exp_f32 v16, v16
    v_exp_f32 v17, v17
    s_waitcnt lgkmcnt(4)
    MV 176,136,96
    RT 132,20,43328
    v_exp_f32 v24, v24
    v_exp_f32 v25, v25
    v_exp_f32 v26, v26
    v_exp_f32 v27, v27
    MV 180,136,100
    RT 134,20,45120
    v_add_f32 v14, 1.0, v14
    v_add_f32 v15, 1.0, v15
    v_add_f32 v16, 1.0, v16
    v_add_f32 v17, 1.0, v17
    MV 184,136,104
    v_add_f32 v24, 1.0, v24
    v_add_f32 v25, 1.0, v25
    v_add_f32 v26, 1.0, v26
    v_add_f32 v27, 1.0, v27
    MV 188,136,108
    v_rcp_f32 v14, v14
    v_rcp_f32 v15, v15
    v_rcp_f32 v16, v16
    v_rcp_f32 v17, v17
    v_rcp_f32 v24, v24
    s_waitcnt lgkmcnt(4)
    MV 188,140,124
    RT 136,22,320
    v_rcp_f32 v25, v25
    v_rcp_f32 v26, v26
    v_rcp_f32 v27, v27
    v_mul_f32 v14, v14, v140
    MV 184,140,120
    RT 138,22,2112
    v_mul_f32 v15, v15, v141
    v_mul_f32 v16, v16, v142
    v_mul_f32 v17, v17, v143
    v_mul_f32 v24, v24, v156
    MV 180,140,116
    v_mul_f32 v25, v25, v157
    v_mul_f32 v26, v26, v158
    v_mul_f32 v27, v27, v159
    v_cvt_pk_bf16_f32 v140, v14, v15
    MV 176,140,112
    v_cvt_pk_bf16_f32 v141, v16, v17
    v_cvt_pk_bf16_f32 v142, v24, v25
    v_cvt_pk_bf16_f32 v143, v26, v27
    global_store_dwordx4 v30, v[140:143], s[8:9] offset:3072 sc1
    v_add_u32 v30, 0x1000, v30
    s_waitcnt lgkmcnt(4)
    MV 192,128,32
    RT 140,22,14656
    MV 196,128,36
    RT 142,22,16448
    MV 200,128,40
    MV 204,128,44
    s_waitcnt lgkmcnt(4)
    MV 204,132,60
    RT 128,18,320
    s_waitcnt vmcnt(8)
    v_mov_b32 v6, 1
    s_mov_b64 exec, 1
    buffer_store_dword v6, v31, s[8:11], s62 offen sc1
    s_mov_b64 exec, -1
    v_mul_f32 v14, s4, v160
    v_mul_f32 v15, s4, v161
    MV 200,132,56
    RT 130,18,2112
    v_mul_f32 v16, s4, v162
    v_mul_f32 v17, s4, v163
    v_mul_f32 v24, s4, v176
    v_mul_f32 v25, s4, v177
    MV 196,132,52
    v_mul_f32 v26, s4, v178
    v_mul_f32 v27, s4, v179
    v_exp_f32 v14, v14
    v_exp_f32 v15, v15
    v_exp_f32 v16, v16
    MV 192,132,48
    v_exp_f32 v17, v17
    v_exp_f32 v24, v24
    v_exp_f32 v25, v25
    v_exp_f32 v26, v26
    s_waitcnt lgkmcnt(4)
    MV 192,136,64
    RT 132,18,14656
    v_exp_f32 v27, v27
    v_add_f32 v14, 1.0, v14
    v_add_f32 v15, 1.0, v15
    v_add_f32 v16, 1.0, v16
    MV 196,136,68
    RT 134,18,16448
    v_add_f32 v17, 1.0, v17
    v_add_f32 v24, 1.0, v24
    v_add_f32 v25, 1.0, v25
    v_add_f32 v26, 1.0, v26
    MV 200,136,72
    v_add_f32 v27, 1.0, v27
    v_rcp_f32 v14, v14
    v_rcp_f32 v15, v15
    v_rcp_f32 v16, v16
    MV 204,136,76
    v_rcp_f32 v17, v17
    v_rcp_f32 v24, v24
    v_rcp_f32 v25, v25
    v_rcp_f32 v26, v26
    v_rcp_f32 v27, v27
    s_waitcnt lgkmcnt(4)
    MV 204,140,92
    RT 136,21,29024
    v_mul_f32 v14, v14, v160
    v_mul_f32 v15, v15, v161
    v_mul_f32 v16, v16, v162
    MV 200,140,88
    RT 138,21,30816
    v_mul_f32 v17, v17, v163
    v_mul_f32 v24, v24, v176
    v_mul_f32 v25, v25, v177
    v_mul_f32 v26, v26, v178
    MV 196,140,84
    v_mul_f32 v27, v27, v179
    v_cvt_pk_bf16_f32 v160, v14, v15
    v_cvt_pk_bf16_f32 v161, v16, v17
    v_cvt_pk_bf16_f32 v162, v24, v25
    v_cvt_pk_bf16_f32 v163, v26, v27
    MV 192,140,80
    global_store_dwordx4 v30, v[160:163], s[8:9] offset:0 sc1
    v_mul_f32 v14, s4, v164
    v_mul_f32 v15, s4, v165
    v_mul_f32 v16, s4, v166
    s_waitcnt lgkmcnt(4)
    MV 192,128,96
    RT 140,21,43360
    v_mul_f32 v17, s4, v167
    v_mul_f32 v24, s4, v180
    v_mul_f32 v25, s4, v181
    v_mul_f32 v26, s4, v182
    MV 196,128,100
    RT 142,21,45152
    v_mul_f32 v27, s4, v183
    v_exp_f32 v14, v14
    v_exp_f32 v15, v15
    v_exp_f32 v16, v16
    MV 200,128,104
    v_exp_f32 v17, v17
    v_exp_f32 v24, v24
    v_exp_f32 v25, v25
    v_exp_f32 v26, v26
    MV 204,128,108
    v_exp_f32 v27, v27
    v_add_f32 v14, 1.0, v14
    v_add_f32 v15, 1.0, v15
    v_add_f32 v16, 1.0, v16
    v_add_f32 v17, 1.0, v17
    s_waitcnt lgkmcnt(4)
    MV 204,132,124
    RT 128,23,352
    v_add_f32 v24, 1.0, v24
    v_add_f32 v25, 1.0, v25
    v_add_f32 v26, 1.0, v26
    MV 200,132,120
    RT 130,23,2144
    v_add_f32 v27, 1.0, v27
    v_rcp_f32 v14, v14
    v_rcp_f32 v15, v15
    v_rcp_f32 v16, v16
    MV 196,132,116
    v_rcp_f32 v17, v17
    v_rcp_f32 v24, v24
    v_rcp_f32 v25, v25
    v_rcp_f32 v26, v26
    v_rcp_f32 v27, v27
    MV 192,132,112
    v_mul_f32 v14, v14, v164
    v_mul_f32 v15, v15, v165
    v_mul_f32 v16, v16, v166
    v_mul_f32 v17, v17, v167
    s_waitcnt lgkmcnt(4)
    MV 208,136,32
    RT 132,23,14688
    v_mul_f32 v24, v24, v180
    v_mul_f32 v25, v25, v181
    v_mul_f32 v26, v26, v182
    v_mul_f32 v27, v27, v183
    MV 212,136,36
    RT 134,23,16480
    v_cvt_pk_bf16_f32 v164, v14, v15
    v_cvt_pk_bf16_f32 v165, v16, v17
    v_cvt_pk_bf16_f32 v166, v24, v25
    v_cvt_pk_bf16_f32 v167, v26, v27
    MV 216,136,40
    global_store_dwordx4 v30, v[164:167], s[8:9] offset:1024 sc1
    v_mul_f32 v14, s4, v168
    v_mul_f32 v15, s4, v169
    v_mul_f32 v16, s4, v170
    MV 220,136,44
    v_mul_f32 v17, s4, v171
    v_mul_f32 v24, s4, v184
    v_mul_f32 v25, s4, v185
    v_mul_f32 v26, s4, v186
    v_mul_f32 v27, s4, v187
    s_waitcnt lgkmcnt(4)
    MV 220,140,60
    RT 136,19,352
    v_exp_f32 v14, v14
    v_exp_f32 v15, v15
    v_exp_f32 v16, v16
    MV 216,140,56
    RT 138,19,2144
    v_exp_f32 v17, v17
    v_exp_f32 v24, v24
    v_exp_f32 v25, v25
    v_exp_f32 v26, v26
    MV 212,140,52
    v_exp_f32 v27, v27
    v_add_f32 v14, 1.0, v14
    v_add_f32 v15, 1.0, v15
    v_add_f32 v16, 1.0, v16
    v_add_f32 v17, 1.0, v17
    MV 208,140,48
    v_add_f32 v24, 1.0, v24
    v_add_f32 v25, 1.0, v25
    v_add_f32 v26, 1.0, v26
    v_add_f32 v27, 1.0, v27
    s_waitcnt lgkmcnt(4)
    MV 208,128,64
    RT 140,19,14688
    v_rcp_f32 v14, v14
    v_rcp_f32 v15, v15
    v_rcp_f32 v16, v16
    v_rcp_f32 v17, v17
    MV 212,128,68
    RT 142,19,16480
    v_rcp_f32 v24, v24
    v_rcp_f32 v25, v25
    v_rcp_f32 v26, v26
    v_rcp_f32 v27, v27
    MV 216,128,72
    v_mul_f32 v14, v14, v168
    v_mul_f32 v15, v15, v169
    v_mul_f32 v16, v16, v170
    v_mul_f32 v17, v17, v171
    MV 220,128,76
    v_mul_f32 v24, v24, v184
    v_mul_f32 v25, v25, v185
    v_mul_f32 v26, v26, v186
    v_mul_f32 v27, v27, v187
    v_cvt_pk_bf16_f32 v168, v14, v15
    s_waitcnt lgkmcnt(4)
    MV 220,132,92
    RT 128,20,29056
    v_cvt_pk_bf16_f32 v169, v16, v17
    v_cvt_pk_bf16_f32 v170, v24, v25
    v_cvt_pk_bf16_f32 v171, v26, v27
    MV 216,132,88
    RT 130,20,30848
    global_store_dwordx4 v30, v[168:171], s[8:9] offset:2048 sc1
    v_mul_f32 v14, s4, v172
    v_mul_f32 v15, s4, v173
    v_mul_f32 v16, s4, v174
    MV 212,132,84
    v_mul_f32 v17, s4, v175
    v_mul_f32 v24, s4, v188
    v_mul_f32 v25, s4, v189
    v_mul_f32 v26, s4, v190
    v_mul_f32 v27, s4, v191
    MV 208,132,80
    v_exp_f32 v14, v14
    v_exp_f32 v15, v15
    v_exp_f32 v16, v16
    v_exp_f32 v17, v17
    s_waitcnt lgkmcnt(4)
    MV 208,136,96
    RT 132,20,43392
    v_exp_f32 v24, v24
    v_exp_f32 v25, v25
    v_exp_f32 v26, v26
    v_exp_f32 v27, v27
    MV 212,136,100
    RT 134,20,45184
    v_add_f32 v14, 1.0, v14
    v_add_f32 v15, 1.0, v15
    v_add_f32 v16, 1.0, v16
    v_add_f32 v17, 1.0, v17
    MV 216,136,104
    v_add_f32 v24, 1.0, v24
    v_add_f32 v25, 1.0, v25
    v_add_f32 v26, 1.0, v26
    v_add_f32 v27, 1.0, v27
    MV 220,136,108
    v_rcp_f32 v14, v14
    v_rcp_f32 v15, v15
    v_rcp_f32 v16, v16
    v_rcp_f32 v17, v17
    v_rcp_f32 v24, v24
    s_waitcnt lgkmcnt(4)
    MV 220,140,124
    RT 136,22,384
    v_rcp_f32 v25, v25
    v_rcp_f32 v26, v26
    v_rcp_f32 v27, v27
    v_mul_f32 v14, v14, v172
    MV 216,140,120
    RT 138,22,2176
    v_mul_f32 v15, v15, v173
    v_mul_f32 v16, v16, v174
    v_mul_f32 v17, v17, v175
    v_mul_f32 v24, v24, v188
    MV 212,140,116
    v_mul_f32 v25, v25, v189
    v_mul_f32 v26, v26, v190
    v_mul_f32 v27, v27, v191
    v_cvt_pk_bf16_f32 v172, v14, v15
    MV 208,140,112
    v_cvt_pk_bf16_f32 v173, v16, v17
    v_cvt_pk_bf16_f32 v174, v24, v25
    v_cvt_pk_bf16_f32 v175, v26, v27
    global_store_dwordx4 v30, v[172:175], s[8:9] offset:3072 sc1
    v_add_u32 v30, 0x1000, v30
    s_waitcnt lgkmcnt(4)
    MV 224,128,32
    RT 140,22,14720
    MV 228,128,36
    RT 142,22,16512
    MV 232,128,40
    MV 236,128,44
    s_waitcnt lgkmcnt(4)
    MV 236,132,60
    RT 128,18,384
    v_mul_f32 v14, s4, v192
    s_add_u32 m0, s26, 65536
    s_nop 0
    global_load_lds_dwordx4 v2, s[12:13] offset:0
    v_add_u32 v2, 65536, v2
    v_mul_f32 v15, s4, v193
    MV 232,132,56
    RT 130,18,2176
    v_mul_f32 v16, s4, v194
    v_mul_f32 v17, s4, v195
    v_mul_f32 v24, s4, v208
    v_mul_f32 v25, s4, v209
    MV 228,132,52
    v_mul_f32 v26, s4, v210
    v_mul_f32 v27, s4, v211
    v_exp_f32 v14, v14
    v_exp_f32 v15, v15
    v_exp_f32 v16, v16
    MV 224,132,48
    v_exp_f32 v17, v17
    v_exp_f32 v24, v24
    v_exp_f32 v25, v25
    v_exp_f32 v26, v26
    s_waitcnt lgkmcnt(4)
    MV 224,136,64
    RT 132,18,14720
    v_exp_f32 v27, v27
    v_add_f32 v14, 1.0, v14
    v_add_f32 v15, 1.0, v15
    v_add_f32 v16, 1.0, v16
    MV 228,136,68
    RT 134,18,16512
    v_add_f32 v17, 1.0, v17
    v_add_f32 v24, 1.0, v24
    v_add_f32 v25, 1.0, v25
    v_add_f32 v26, 1.0, v26
    MV 232,136,72
    v_add_f32 v27, 1.0, v27
    v_rcp_f32 v14, v14
    v_rcp_f32 v15, v15
    v_rcp_f32 v16, v16
    MV 236,136,76
    v_rcp_f32 v17, v17
    v_rcp_f32 v24, v24
    v_rcp_f32 v25, v25
    v_rcp_f32 v26, v26
    v_rcp_f32 v27, v27
    s_waitcnt lgkmcnt(4)
    MV 236,140,92
    RT 136,21,29088
    v_mul_f32 v14, v14, v192
    v_mul_f32 v15, v15, v193
    v_mul_f32 v16, v16, v194
    v_mul_f32 v17, v17, v195
    MV 232,140,88
    RT 138,21,30880
    v_mul_f32 v24, v24, v208
    v_mul_f32 v25, v25, v209
    v_mul_f32 v26, v26, v210
    v_mul_f32 v27, v27, v211
    MV 228,140,84
    v_cvt_pk_bf16_f32 v192, v14, v15
    v_cvt_pk_bf16_f32 v193, v16, v17
    v_cvt_pk_bf16_f32 v194, v24, v25
    v_cvt_pk_bf16_f32 v195, v26, v27
    MV 224,140,80
    global_store_dwordx4 v30, v[192:195], s[8:9] offset:0 sc1
    v_mul_f32 v14, s4, v196
    global_load_lds_dwordx4 v3, s[12:13] offset:1024
    v_add_u32 v3, 65536, v3
    v_mul_f32 v15, s4, v197
    v_mul_f32 v16, s4, v198
    s_waitcnt lgkmcnt(4)
    MV 224,128,96
    RT 140,21,43424
    v_mul_f32 v17, s4, v199
    v_mul_f32 v24, s4, v212
    v_mul_f32 v25, s4, v213
    v_mul_f32 v26, s4, v214
    MV 228,128,100
    RT 142,21,45216
    v_mul_f32 v27, s4, v215
    v_exp_f32 v14, v14
    v_exp_f32 v15, v15
    v_exp_f32 v16, v16
    MV 232,128,104
    v_exp_f32 v17, v17
    v_exp_f32 v24, v24
    v_exp_f32 v25, v25
    v_exp_f32 v26, v26
    MV 236,128,108
    v_exp_f32 v27, v27
    v_add_f32 v14, 1.0, v14
    v_add_f32 v15, 1.0, v15
    v_add_f32 v16, 1.0, v16
    v_add_f32 v17, 1.0, v17
    s_waitcnt lgkmcnt(4)
    MV 236,132,124
    RT 128,23,416
    v_add_f32 v24, 1.0, v24
    v_add_f32 v25, 1.0, v25
    v_add_f32 v26, 1.0, v26
    v_add_f32 v27, 1.0, v27
    MV 232,132,120
    RT 130,23,2208
    v_rcp_f32 v14, v14
    v_rcp_f32 v15, v15
    v_rcp_f32 v16, v16
    v_rcp_f32 v17, v17
    MV 228,132,116
    v_rcp_f32 v24, v24
    v_rcp_f32 v25, v25
    v_rcp_f32 v26, v26
    v_rcp_f32 v27, v27
    MV 224,132,112
    v_mul_f32 v14, v14, v196
    v_mul_f32 v15, v15, v197
    v_mul_f32 v16, v16, v198
    v_mul_f32 v17, v17, v199
    v_mul_f32 v24, v24, v212
    s_waitcnt lgkmcnt(4)
    MV 240,136,32
    RT 132,23,14752
    v_mul_f32 v25, v25, v213
    v_mul_f32 v26, v26, v214
    v_mul_f32 v27, v27, v215
    MV 244,136,36
    RT 134,23,16544
    v_cvt_pk_bf16_f32 v196, v14, v15
    v_cvt_pk_bf16_f32 v197, v16, v17
    v_cvt_pk_bf16_f32 v198, v24, v25
    v_cvt_pk_bf16_f32 v199, v26, v27
    MV 248,136,40
    global_store_dwordx4 v30, v[196:199], s[8:9] offset:1024 sc1
    v_mul_f32 v14, s4, v200
    s_add_u32 m0, s26, 73728
    s_nop 0
    global_load_lds_dwordx4 v2, s[12:13] offset:0
    s_add_u32 s59, s3, 4294836224
    v_add_u32 v2, s59, v2
    v_mul_f32 v15, s4, v201
    v_mul_f32 v16, s4, v202
    MV 252,136,44
    v_mul_f32 v17, s4, v203
    v_mul_f32 v24, s4, v216
    v_mul_f32 v25, s4, v217
    v_mul_f32 v26, s4, v218
    s_waitcnt lgkmcnt(4)
    MV 252,140,60
    RT 136,19,416
    v_mul_f32 v27, s4, v219
    v_exp_f32 v14, v14
    v_exp_f32 v15, v15
    v_exp_f32 v16, v16
    MV 248,140,56
    RT 138,19,2208
    v_exp_f32 v17, v17
    v_exp_f32 v24, v24
    v_exp_f32 v25, v25
    v_exp_f32 v26, v26
    MV 244,140,52
    v_exp_f32 v27, v27
    v_add_f32 v14, 1.0, v14
    v_add_f32 v15, 1.0, v15
    v_add_f32 v16, 1.0, v16
    MV 240,140,48
    v_add_f32 v17, 1.0, v17
    v_add_f32 v24, 1.0, v24
    v_add_f32 v25, 1.0, v25
    v_add_f32 v26, 1.0, v26
    v_add_f32 v27, 1.0, v27
    s_waitcnt lgkmcnt(4)
    MV 240,128,64
    RT 140,19,14752
    v_rcp_f32 v14, v14
    v_rcp_f32 v15, v15
    v_rcp_f32 v16, v16
    v_rcp_f32 v17, v17
    MV 244,128,68
    RT 142,19,16544
    v_rcp_f32 v24, v24
    v_rcp_f32 v25, v25
    v_rcp_f32 v26, v26
    v_rcp_f32 v27, v27
    MV 248,128,72
    v_mul_f32 v14, v14, v200
    v_mul_f32 v15, v15, v201
    v_mul_f32 v16, v16, v202
    v_mul_f32 v17, v17, v203
    MV 252,128,76
    v_mul_f32 v24, v24, v216
    v_mul_f32 v25, v25, v217
    v_mul_f32 v26, v26, v218
    v_mul_f32 v27, v27, v219
    v_cvt_pk_bf16_f32 v200, v14, v15
    s_waitcnt lgkmcnt(4)
    MV 252,132,92
    v_cvt_pk_bf16_f32 v201, v16, v17
    v_cvt_pk_bf16_f32 v202, v24, v25
    v_cvt_pk_bf16_f32 v203, v26, v27
    global_store_dwordx4 v30, v[200:203], s[8:9] offset:2048 sc1
    MV 248,132,88
    v_mul_f32 v14, s4, v204
    global_load_lds_dwordx4 v3, s[12:13] offset:1024
    s_add_u32 s59, s3, 4294836224
    v_add_u32 v3, s59, v3
    v_mul_f32 v15, s4, v205
    v_mul_f32 v16, s4, v206
    MV 244,132,84
    v_mul_f32 v17, s4, v207
    v_mul_f32 v24, s4, v220
    v_mul_f32 v25, s4, v221
    v_mul_f32 v26, s4, v222
    v_mul_f32 v27, s4, v223
    MV 240,132,80
    v_exp_f32 v14, v14
    v_exp_f32 v15, v15
    v_exp_f32 v16, v16
    v_exp_f32 v17, v17
    s_waitcnt lgkmcnt(2)
    MV 240,136,96
    v_exp_f32 v24, v24
    v_exp_f32 v25, v25
    v_exp_f32 v26, v26
    v_exp_f32 v27, v27
    MV 244,136,100
    v_add_f32 v14, 1.0, v14
    v_add_f32 v15, 1.0, v15
    v_add_f32 v16, 1.0, v16
    v_add_f32 v17, 1.0, v17
    MV 248,136,104
    v_add_f32 v24, 1.0, v24
    v_add_f32 v25, 1.0, v25
    v_add_f32 v26, 1.0, v26
    v_add_f32 v27, 1.0, v27
    v_rcp_f32 v14, v14
    MV 252,136,108
    v_rcp_f32 v15, v15
    v_rcp_f32 v16, v16
    v_rcp_f32 v17, v17
    v_rcp_f32 v24, v24
    s_waitcnt lgkmcnt(0)
    MV 252,140,124
    v_rcp_f32 v25, v25
    v_rcp_f32 v26, v26
    v_rcp_f32 v27, v27
    v_mul_f32 v14, v14, v204
    MV 248,140,120
    v_mul_f32 v15, v15, v205
    v_mul_f32 v16, v16, v206
    v_mul_f32 v17, v17, v207
    v_mul_f32 v24, v24, v220
    MV 244,140,116
    v_mul_f32 v25, v25, v221
    v_mul_f32 v26, v26, v222
    v_mul_f32 v27, v27, v223
    v_cvt_pk_bf16_f32 v204, v14, v15
    v_cvt_pk_bf16_f32 v205, v16, v17
    MV 240,140,112
    v_cvt_pk_bf16_f32 v206, v24, v25
    v_cvt_pk_bf16_f32 v207, v26, v27
    global_store_dwordx4 v30, v[204:207], s[8:9] offset:3072 sc1
    v_add_u32 v30, 0x1000, v30
    s_barrier
    buffer_load_dword v5, v4, s[8:11], s67 offen sc1
    s_add_u32 m0, s26, 81920
    s_nop 0
    global_load_lds_dwordx4 v2, s[12:13] offset:0
    v_add_u32 v2, 65536, v2
    v_pk_mul_f32 v[14:15], v[224:225], s[4:5]
    v_pk_mul_f32 v[16:17], v[226:227], s[4:5]
    v_pk_mul_f32 v[24:25], v[240:241], s[4:5]
    v_pk_mul_f32 v[26:27], v[242:243], s[4:5]
    v_exp_f32 v14, v14
    v_exp_f32 v15, v15
    v_exp_f32 v16, v16
    v_exp_f32 v17, v17
    v_exp_f32 v24, v24
    v_exp_f32 v25, v25
    v_exp_f32 v26, v26
    global_load_lds_dwordx4 v3, s[12:13] offset:1024
    v_add_u32 v3, 65536, v3
    v_exp_f32 v27, v27
    v_pk_add_f32 v[14:15], v[14:15], 1.0 op_sel_hi:[1,0]
    v_pk_add_f32 v[16:17], v[16:17], 1.0 op_sel_hi:[1,0]
    v_pk_add_f32 v[24:25], v[24:25], 1.0 op_sel_hi:[1,0]
    v_pk_add_f32 v[26:27], v[26:27], 1.0 op_sel_hi:[1,0]
    v_rcp_f32 v14, v14
    v_rcp_f32 v15, v15
    v_rcp_f32 v16, v16
    v_rcp_f32 v17, v17
    v_rcp_f32 v24, v24
    v_rcp_f32 v25, v25
    s_add_u32 m0, s26, 90112
    s_nop 0
    global_load_lds_dwordx4 v2, s[12:13] offset:0
    v_add_u32 v2, 65536, v2
    v_rcp_f32 v26, v26
    v_rcp_f32 v27, v27
    v_pk_mul_f32 v[14:15], v[14:15], v[224:225]
    v_pk_mul_f32 v[16:17], v[16:17], v[226:227]
    v_pk_mul_f32 v[24:25], v[24:25], v[240:241]
    v_pk_mul_f32 v[26:27], v[26:27], v[242:243]
    v_cvt_pk_bf16_f32 v224, v14, v15
    v_cvt_pk_bf16_f32 v225, v16, v17
    v_cvt_pk_bf16_f32 v226, v24, v25
    v_cvt_pk_bf16_f32 v227, v26, v27
    global_store_dwordx4 v30, v[224:227], s[8:9] offset:0 sc1
    global_load_lds_dwordx4 v3, s[12:13] offset:1024
    v_add_u32 v3, 65536, v3
    v_pk_mul_f32 v[14:15], v[228:229], s[4:5]
    v_pk_mul_f32 v[16:17], v[230:231], s[4:5]
    v_pk_mul_f32 v[24:25], v[244:245], s[4:5]
    v_pk_mul_f32 v[26:27], v[246:247], s[4:5]
    v_exp_f32 v14, v14
    v_exp_f32 v15, v15
    v_exp_f32 v16, v16
    v_exp_f32 v17, v17
    v_exp_f32 v24, v24
    v_exp_f32 v25, v25
    v_exp_f32 v26, v26
    s_add_u32 m0, s26, 98304
    s_nop 0
    global_load_lds_dwordx4 v2, s[12:13] offset:0
    s_add_u32 s59, s3, 4294836224
    v_add_u32 v2, s59, v2
    v_exp_f32 v27, v27
    v_pk_add_f32 v[14:15], v[14:15], 1.0 op_sel_hi:[1,0]
    v_pk_add_f32 v[16:17], v[16:17], 1.0 op_sel_hi:[1,0]
    v_pk_add_f32 v[24:25], v[24:25], 1.0 op_sel_hi:[1,0]
    v_pk_add_f32 v[26:27], v[26:27], 1.0 op_sel_hi:[1,0]
    v_rcp_f32 v14, v14
    v_rcp_f32 v15, v15
    v_rcp_f32 v16, v16
    v_rcp_f32 v17, v17
    v_rcp_f32 v24, v24
    v_rcp_f32 v25, v25
    global_load_lds_dwordx4 v3, s[12:13] offset:1024
    s_add_u32 s59, s3, 4294836224
    v_add_u32 v3, s59, v3
    v_rcp_f32 v26, v26
    v_rcp_f32 v27, v27
    v_pk_mul_f32 v[14:15], v[14:15], v[228:229]
    v_pk_mul_f32 v[16:17], v[16:17], v[230:231]
    v_pk_mul_f32 v[24:25], v[24:25], v[244:245]
    v_pk_mul_f32 v[26:27], v[26:27], v[246:247]
    v_cvt_pk_bf16_f32 v228, v14, v15
    v_cvt_pk_bf16_f32 v229, v16, v17
    v_cvt_pk_bf16_f32 v230, v24, v25
    v_cvt_pk_bf16_f32 v231, v26, v27
    global_store_dwordx4 v30, v[228:231], s[8:9] offset:1024 sc1
    s_add_u32 m0, s26, 106496
    s_nop 0
    global_load_lds_dwordx4 v2, s[12:13] offset:0
    v_add_u32 v2, 65536, v2
    s_waitcnt vmcnt(9)
    v_cmp_gt_u32 vcc, 1, v5
    s_nop 0
    s_cbranch_vccnz L_slow_h_1
L_back_h_1:
    v_pk_mul_f32 v[14:15], v[232:233], s[4:5]
    global_load_dwordx4 a[0:3], v28, s[8:9] offset:0 sc1
    v_pk_mul_f32 v[16:17], v[234:235], s[4:5]
    v_pk_mul_f32 v[24:25], v[248:249], s[4:5]
    v_pk_mul_f32 v[26:27], v[250:251], s[4:5]
    global_load_dwordx4 a[4:7], v28, s[8:9] offset:1024 sc1
    v_add_u32 v28, 4096, v28
    v_exp_f32 v14, v14
    v_exp_f32 v15, v15
    v_exp_f32 v16, v16
    global_load_dwordx4 a[8:11], v28, s[8:9] offset:0 sc1
    global_load_lds_dwordx4 v3, s[12:13] offset:1024
    v_add_u32 v3, 65536, v3
    v_exp_f32 v17, v17
    v_exp_f32 v24, v24
    v_exp_f32 v25, v25
    global_load_dwordx4 a[12:15], v28, s[8:9] offset:1024 sc1
    v_add_u32 v28, 4096, v28
    v_exp_f32 v26, v26
    v_exp_f32 v27, v27
    v_pk_add_f32 v[14:15], v[14:15], 1.0 op_sel_hi:[1,0]
    global_load_dwordx4 a[16:19], v28, s[8:9] offset:0 sc1
    v_pk_add_f32 v[16:17], v[16:17], 1.0 op_sel_hi:[1,0]
    v_pk_add_f32 v[24:25], v[24:25], 1.0 op_sel_hi:[1,0]
    v_pk_add_f32 v[26:27], v[26:27], 1.0 op_sel_hi:[1,0]
    s_add_u32 m0, s26, 114688
    s_nop 0
    global_load_lds_dwordx4 v2, s[12:13] offset:0
    v_add_u32 v2, 65536, v2
    global_load_dwordx4 a[20:23], v28, s[8:9] offset:1024 sc1
    s_add_u32 s59, s58, 4294959104
    v_add_u32 v28, s59, v28
    v_rcp_f32 v14, v14
    v_rcp_f32 v15, v15
    v_rcp_f32 v16, v16
    global_load_dwordx4 a[24:27], v28, s[8:9] offset:0 sc1
    v_rcp_f32 v17, v17
    v_rcp_f32 v24, v24
    v_rcp_f32 v25, v25
    global_load_dwordx4 a[28:31], v28, s[8:9] offset:1024 sc1
    v_add_u32 v28, 4096, v28
    v_rcp_f32 v26, v26
    v_rcp_f32 v27, v27
    global_load_lds_dwordx4 v3, s[12:13] offset:1024
    v_add_u32 v3, 65536, v3
    v_pk_mul_f32 v[14:15], v[14:15], v[232:233]
    v_pk_mul_f32 v[16:17], v[16:17], v[234:235]
    v_pk_mul_f32 v[24:25], v[24:25], v[248:249]
    v_pk_mul_f32 v[26:27], v[26:27], v[250:251]
    v_cvt_pk_bf16_f32 v232, v14, v15
    v_cvt_pk_bf16_f32 v233, v16, v17
    v_cvt_pk_bf16_f32 v234, v24, v25
    v_cvt_pk_bf16_f32 v235, v26, v27
    global_store_dwordx4 v30, v[232:235], s[8:9] offset:2048 sc1
    v_pk_mul_f32 v[14:15], v[236:237], s[4:5]
    v_pk_mul_f32 v[16:17], v[238:239], s[4:5]
    s_add_u32 m0, s26, 122880
    s_nop 0
    global_load_lds_dwordx4 v2, s[12:13] offset:0
    s_add_u32 s59, s3, 4294836224
    v_add_u32 v2, s59, v2
    v_pk_mul_f32 v[24:25], v[252:253], s[4:5]
    v_pk_mul_f32 v[26:27], v[254:255], s[4:5]
    v_exp_f32 v14, v14
    v_exp_f32 v15, v15
    v_exp_f32 v16, v16
    v_exp_f32 v17, v17
    v_exp_f32 v24, v24
    v_exp_f32 v25, v25
    v_exp_f32 v26, v26
    v_exp_f32 v27, v27
    v_pk_add_f32 v[14:15], v[14:15], 1.0 op_sel_hi:[1,0]
    global_load_lds_dwordx4 v3, s[12:13] offset:1024
    s_add_u32 s59, s3, 4294836224
    v_add_u32 v3, s59, v3
    v_pk_add_f32 v[16:17], v[16:17], 1.0 op_sel_hi:[1,0]
    v_pk_add_f32 v[24:25], v[24:25], 1.0 op_sel_hi:[1,0]
    v_pk_add_f32 v[26:27], v[26:27], 1.0 op_sel_hi:[1,0]
    v_rcp_f32 v14, v14
    v_rcp_f32 v15, v15
    v_rcp_f32 v16, v16
    v_rcp_f32 v17, v17
    v_rcp_f32 v24, v24
    v_rcp_f32 v25, v25
    v_rcp_f32 v26, v26
    v_rcp_f32 v27, v27
    v_pk_mul_f32 v[14:15], v[14:15], v[236:237]
    v_pk_mul_f32 v[16:17], v[16:17], v[238:239]
    v_pk_mul_f32 v[24:25], v[24:25], v[252:253]
    v_pk_mul_f32 v[26:27], v[26:27], v[254:255]
    v_cvt_pk_bf16_f32 v236, v14, v15
    v_cvt_pk_bf16_f32 v237, v16, v17
    v_cvt_pk_bf16_f32 v238, v24, v25
    v_cvt_pk_bf16_f32 v239, v26, v27
    global_store_dwordx4 v30, v[236:239], s[8:9] offset:3072 sc1
    global_load_dwordx4 a[32:35], v28, s[8:9] offset:0 sc1
    global_load_dwordx4 a[36:39], v28, s[8:9] offset:1024 sc1
    v_add_u32 v28, 4096, v28
    global_load_dwordx4 a[40:43], v28, s[8:9] offset:0 sc1
    global_load_dwordx4 a[44:47], v28, s[8:9] offset:1024 sc1
    s_add_u32 s59, s58, 4294959104
    v_add_u32 v28, s59, v28
    s_waitcnt vmcnt(63)
    s_barrier
    RT 128,32,32768
    RT 130,32,36864
    RT 132,33,32768
    RT 134,33,36864
    RT 136,34,32768
    RT 138,34,36864
    RT 140,35,32768
    RT 142,35,36864
    RT 144,36,32768
    RT 146,36,36864
    RT 148,37,32768
    RT 150,37,36864
    s_waitcnt vmcnt(17) lgkmcnt(8)
    v_mfma_f32_16x16x32_bf16 v[208:211], a[128:131], a[0:3], 0
    RT 152,38,32768
    RT 154,38,36864
    v_mfma_f32_16x16x32_bf16 v[212:215], a[128:131], a[4:7], 0
    global_load_dwordx4 a[48:51], v28, s[8:9] offset:0 sc1
    v_mfma_f32_16x16x32_bf16 v[220:223], a[132:135], a[4:7], 0
    RT 128,39,32768
    RT 130,39,36864
    v_mfma_f32_16x16x32_bf16 v[216:219], a[132:135], a[0:3], 0
    global_load_dwordx4 a[52:55], v28, s[8:9] offset:1024 sc1
    s_waitcnt lgkmcnt(8)
    v_mfma_f32_16x16x32_bf16 v[240:243], a[136:139], a[0:3], 0
    RT 132,32,40960
    v_add_u32 v28, 4096, v28
    v_mfma_f32_16x16x32_bf16 v[244:247], a[136:139], a[4:7], 0
    RT 134,32,45056
    v_mfma_f32_16x16x32_bf16 v[252:255], a[140:143], a[4:7], 0
    RT 136,33,40960
    RT 138,33,45056
    v_mfma_f32_16x16x32_bf16 v[248:251], a[140:143], a[0:3], 0
    global_load_dwordx4 a[56:59], v28, s[8:9] offset:0 sc1
    s_waitcnt lgkmcnt(8)
    v_mfma_f32_16x16x32_bf16 v[176:179], a[144:147], a[0:3], 0
    RT 140,34,40960
    RT 142,34,45056
    v_mfma_f32_16x16x32_bf16 v[180:183], a[144:147], a[4:7], 0
    global_load_dwordx4 a[60:63], v28, s[8:9] offset:1024 sc1
    v_mfma_f32_16x16x32_bf16 v[188:191], a[148:151], a[4:7], 0
    RT 144,35,40960
    v_add_u32 v28, 4096, v28
    v_mfma_f32_16x16x32_bf16 v[184:187], a[148:151], a[0:3], 0
    RT 146,35,45056
    s_waitcnt lgkmcnt(8)
    v_mfma_f32_16x16x32_bf16 v[192:195], a[152:155], a[0:3], 0
    RT 148,36,40960
    RT 150,36,45056
    v_mfma_f32_16x16x32_bf16 v[196:199], a[152:155], a[4:7], 0
    global_load_dwordx4 a[64:67], v28, s[8:9] offset:0 sc1
    v_mfma_f32_16x16x32_bf16 v[204:207], a[128:131], a[4:7], 0
    RT 152,37,40960
    RT 154,37,45056
    v_mfma_f32_16x16x32_bf16 v[200:203], a[128:131], a[0:3], 0
    global_load_dwordx4 a[68:71], v28, s[8:9] offset:1024 sc1
    s_waitcnt vmcnt(20) lgkmcnt(8)
    s_barrier
    MV 208,132,8
    RT 128,38,40960
    s_add_u32 s59, s58, 4294959104
    MV 212,132,12
    RT 130,38,45056
    v_add_u32 v28, s59, v28
    MV 220,136,12
    RT 132,39,40960
    RT 134,39,45056
    MV 216,136,8
    global_load_dwordx4 a[72:75], v28, s[8:9] offset:0 sc1
    s_waitcnt lgkmcnt(8)
    MV 240,140,8
    RT 136,32,49152
    RT 138,32,53248
    MV 244,140,12
    global_load_dwordx4 a[76:79], v28, s[8:9] offset:1024 sc1
    MV 252,144,12
    RT 140,33,49152
    v_add_u32 v28, 4096, v28
    MV 248,144,8
    RT 142,33,53248
    s_waitcnt lgkmcnt(8)
    s_add_u32 m0, s26, 0
    MV 176,148,8
    RT 144,34,49152
    RT 146,34,53248
    MV 180,148,12
    global_load_lds_dwordx4 v2, s[12:13] offset:0
    MV 188,152,12
    RT 148,35,49152
    RT 150,35,53248
    MV 184,152,8
    v_add_u32 v2, 65536, v2
    global_load_lds_dwordx4 v3, s[12:13] offset:1024
    s_waitcnt lgkmcnt(8)
    MV 192,128,8
    RT 152,36,49152
    v_add_u32 v3, 65536, v3
    MV 196,128,12
    RT 154,36,53248
    s_waitcnt lgkmcnt(10)
    s_barrier
    s_add_u32 m0, s26, 8192
    MV 204,132,12
    RT 128,37,49152
    RT 130,37,53248
    MV 200,132,8
    global_load_lds_dwordx4 v2, s[12:13] offset:0
    s_waitcnt vmcnt(22) lgkmcnt(8)
    MV 208,136,16
    RT 132,38,49152
    RT 134,38,53248
    MV 212,136,20
    v_add_u32 v2, 65536, v2
    global_load_lds_dwordx4 v3, s[12:13] offset:1024
    MV 220,140,20
    RT 136,39,49152
    v_add_u32 v3, 65536, v3
    MV 216,140,16
    RT 138,39,53248
    s_waitcnt lgkmcnt(8)
    MV 240,144,16
    RT 140,32,57344
    RT 142,32,61440
    MV 244,144,20
    global_load_dwordx4 a[80:83], v28, s[8:9] offset:0 sc1
    MV 252,148,20
    RT 144,33,57344
    RT 146,33,61440
    MV 248,148,16
    global_load_dwordx4 a[84:87], v28, s[8:9] offset:1024 sc1
    s_waitcnt lgkmcnt(8)
    MV 176,152,16
    RT 148,34,57344
    v_add_u32 v28, 4096, v28
    MV 180,152,20
    RT 150,34,61440
    s_waitcnt vmcnt(18)
    v_mov_b32 v24, 2
    s_mov_b64 exec, 1
    buffer_store_dword v24, v31, s[8:11], s62 offen sc1
    s_mov_b64 exec, -1
    MV 188,128,20
    RT 152,35,57344
    RT 154,35,61440
    MV 184,128,16
    global_load_dwordx4 a[88:91], v28, s[8:9] offset:0 sc1
    s_waitcnt lgkmcnt(8)
    MV 192,132,16
    RT 128,36,57344
    RT 130,36,61440
    MV 196,132,20
    global_load_dwordx4 a[92:95], v28, s[8:9] offset:1024 sc1
    MV 204,136,20
    RT 132,37,57344
    s_add_u32 s59, s58, 4294959104
    MV 200,136,16
    RT 134,37,61440
    v_add_u32 v28, s59, v28
    s_waitcnt lgkmcnt(8)
    s_add_u32 m0, s26, 16384
    MV 208,140,24
    RT 136,38,57344
    RT 138,38,61440
    MV 212,140,28
    global_load_lds_dwordx4 v2, s[12:13] offset:0
    MV 220,144,28
    RT 140,39,57344
    RT 142,39,61440
    MV 216,144,24
    s_add_u32 s59, s3, 4294836224
    v_add_u32 v2, s59, v2
    global_load_lds_dwordx4 v3, s[12:13] offset:1024
    s_waitcnt lgkmcnt(8)
    MV 240,148,24
    RT 144,40,0
    s_add_u32 s59, s3, 4294836224
    MV 244,148,28
    RT 146,40,4096
    v_add_u32 v3, s59, v3
    s_add_u32 m0, s26, 24576
    MV 252,152,28
    RT 148,41,0
    RT 150,41,4096
    MV 248,152,24
    global_load_lds_dwordx4 v2, s[12:13] offset:0
    s_waitcnt lgkmcnt(8)
    MV 176,128,24
    RT 152,42,0
    RT 154,42,4096
    MV 180,128,28
    v_add_u32 v2, 65536, v2
    global_load_lds_dwordx4 v3, s[12:13] offset:1024
    MV 188,132,28
    RT 128,43,0
    v_add_u32 v3, 65536, v3
    MV 184,132,24
    RT 130,43,4096
    s_waitcnt lgkmcnt(8)
    MV 192,136,24
    RT 132,44,0
    MV 196,136,28
    RT 134,44,4096
    s_waitcnt lgkmcnt(10)
    s_barrier
    MV 204,140,28
    RT 136,45,0
    RT 138,45,4096
    MV 200,140,24
    global_load_dwordx4 a[96:99], v28, s[8:9] offset:0 sc1
    s_waitcnt vmcnt(24) lgkmcnt(8)
    MV 208,144,32
    RT 140,46,0
    RT 142,46,4096
    MV 212,144,36
    global_load_dwordx4 a[100:103], v28, s[8:9] offset:1024 sc1
    MV 220,148,36
    RT 144,47,0
    v_add_u32 v28, 4096, v28
    MV 216,148,32
    RT 146,47,4096
    s_waitcnt lgkmcnt(8)
    MV 240,152,32
    RT 148,40,8192
    RT 150,40,12288
    MV 244,152,36
    global_load_dwordx4 a[104:107], v28, s[8:9] offset:0 sc1
    MV 252,128,36
    RT 152,41,8192
    RT 154,41,12288
    MV 248,128,32
    global_load_dwordx4 a[108:111], v28, s[8:9] offset:1024 sc1
    s_waitcnt lgkmcnt(8)
    MV 176,132,32
    RT 128,42,8192
    v_add_u32 v28, 4096, v28
    MV 180,132,36
    RT 130,42,12288
    s_add_u32 m0, s26, 32768
    MV 188,136,36
    RT 132,43,8192
    RT 134,43,12288
    MV 184,136,32
    global_load_lds_dwordx4 v2, s[12:13] offset:0
    s_waitcnt lgkmcnt(8)
    MV 192,140,32
    RT 136,44,8192
    RT 138,44,12288
    MV 196,140,36
    v_add_u32 v2, 65536, v2
    global_load_lds_dwordx4 v3, s[12:13] offset:1024
    MV 204,144,36
    RT 140,45,8192
    v_add_u32 v3, 65536, v3
    MV 200,144,32
    RT 142,45,12288
    s_waitcnt vmcnt(27) lgkmcnt(8)
    s_add_u32 m0, s26, 40960
    MV 208,148,40
    RT 144,46,8192
    RT 146,46,12288
    MV 212,148,44
    global_load_lds_dwordx4 v2, s[12:13] offset:0
    MV 220,152,44
    RT 148,47,8192
    RT 150,47,12288
    MV 216,152,40
    s_add_u32 s59, s3, 4294836224
    v_add_u32 v2, s59, v2
    global_load_lds_dwordx4 v3, s[12:13] offset:1024
    s_waitcnt lgkmcnt(8)
    MV 240,128,40
    RT 152,40,16384
    s_add_u32 s59, s3, 4294836224
    MV 244,128,44
    RT 154,40,20480
    v_add_u32 v3, s59, v3
    MV 252,132,44
    RT 128,41,16384
    RT 130,41,20480
    MV 248,132,40
    global_load_dwordx4 a[112:115], v28, s[8:9] offset:0 sc1
    s_waitcnt lgkmcnt(8)
    MV 176,136,40
    RT 132,42,16384
    MV 180,136,44
    RT 134,42,20480
    MV 188,140,44
    RT 136,43,16384
    RT 138,43,20480
    MV 184,140,40
    global_load_dwordx4 a[116:119], v28, s[8:9] offset:1024 sc1
    s_waitcnt lgkmcnt(8)
    MV 192,144,40
    RT 140,44,16384
    s_add_u32 s59, s58, 4294959104
    MV 196,144,44
    RT 142,44,20480
    v_add_u32 v28, s59, v28
    s_waitcnt lgkmcnt(10)
    s_barrier
    MV 204,148,44
    RT 144,45,16384
    RT 146,45,20480
    MV 200,148,40
    global_load_dwordx4 a[120:123], v28, s[8:9] offset:0 sc1
    s_waitcnt vmcnt(30) lgkmcnt(8)
    MV 208,152,48
    RT 148,46,16384
    RT 150,46,20480
    MV 212,152,52
    global_load_dwordx4 a[124:127], v28, s[8:9] offset:1024 sc1
    MV 220,128,52
    RT 152,47,16384
    v_add_u32 v28, 4096, v28
    MV 216,128,48
    RT 154,47,20480
    s_waitcnt lgkmcnt(8)
    s_add_u32 m0, s26, 49152
    MV 240,132,48
    RT 128,40,24576
    RT 130,40,28672
    MV 244,132,52
    global_load_lds_dwordx4 v2, s[12:13] offset:0
    MV 252,136,52
    RT 132,41,24576
    RT 134,41,28672
    MV 248,136,48
    v_add_u32 v2, 65536, v2
    global_load_lds_dwordx4 v3, s[12:13] offset:1024
    s_waitcnt lgkmcnt(8)
    MV 176,140,48
    RT 136,42,24576
    v_add_u32 v3, 65536, v3
    MV 180,140,52
    RT 138,42,28672
    s_add_u32 m0, s26, 57344
    MV 188,144,52
    RT 140,43,24576
    RT 142,43,28672
    MV 184,144,48
    global_load_lds_dwordx4 v2, s[12:13] offset:0
    s_waitcnt lgkmcnt(8)
    MV 192,148,48
    RT 144,44,24576
    v_add_u32 v2, 65536, v2
    MV 196,148,52
    RT 146,44,28672
    MV 204,152,52
    RT 148,45,24576
    RT 150,45,28672
    MV 200,152,48
    global_load_lds_dwordx4 v3, s[12:13] offset:1024
    s_waitcnt vmcnt(33) lgkmcnt(8)
    MV 208,128,56
    RT 152,46,24576
    v_add_u32 v3, 65536, v3
    MV 212,128,60
    RT 154,46,28672
    MV 220,132,60
    RT 128,47,24576
    RT 130,47,28672
    MV 216,132,56
    global_load_dwordx4 a[0:3], v28, s[8:9] offset:0 sc1
    s_waitcnt lgkmcnt(8)
    MV 240,136,56
    RT 132,40,32768
    MV 244,136,60
    RT 134,40,36864
    MV 252,140,60
    RT 136,41,32768
    RT 138,41,36864
    MV 248,140,56
    global_load_dwordx4 a[4:7], v28, s[8:9] offset:1024 sc1
    s_waitcnt lgkmcnt(8)
    MV 176,144,56
    RT 140,42,32768
    v_add_u32 v28, 4096, v28
    MV 180,144,60
    RT 142,42,36864
    MV 188,148,60
    RT 144,43,32768
    RT 146,43,36864
    MV 184,148,56
    global_load_dwordx4 a[8:11], v28, s[8:9] offset:0 sc1
    s_waitcnt lgkmcnt(8)
    MV 192,152,56
    RT 148,44,32768
    MV 196,152,60
    RT 150,44,36864
    s_waitcnt lgkmcnt(10)
    s_barrier
    MV 204,128,60
    RT 152,45,32768
    RT 154,45,36864
    MV 200,128,56
    global_load_dwordx4 a[12:15], v28, s[8:9] offset:1024 sc1
    s_waitcnt vmcnt(35) lgkmcnt(8)
    s_add_u32 m0, s26, 65536
    MV 208,132,64
    RT 128,46,32768
    RT 130,46,36864
    MV 212,132,68
    s_add_u32 s59, s58, 4294959104
    v_add_u32 v28, s59, v28
    global_load_lds_dwordx4 v2, s[12:13] offset:0
    MV 220,136,68
    RT 132,47,32768
    s_add_u32 s59, s3, 4294836224
    MV 216,136,64
    RT 134,47,36864
    v_add_u32 v2, s59, v2
    s_waitcnt lgkmcnt(8)
    MV 240,140,64
    RT 136,40,40960
    RT 138,40,45056
    MV 244,140,68
    global_load_lds_dwordx4 v3, s[12:13] offset:1024
    s_add_u32 m0, s26, 73728
    MV 252,144,68
    RT 140,41,40960
    RT 142,41,45056
    MV 248,144,64
    s_add_u32 s59, s3, 4294836224
    v_add_u32 v3, s59, v3
    global_load_lds_dwordx4 v2, s[12:13] offset:0
    s_waitcnt lgkmcnt(8)
    MV 176,148,64
    RT 144,42,40960
    v_add_u32 v2, 65536, v2
    MV 180,148,68
    RT 146,42,45056
    MV 188,152,68
    RT 148,43,40960
    RT 150,43,45056
    MV 184,152,64
    global_load_lds_dwordx4 v3, s[12:13] offset:1024
    s_waitcnt lgkmcnt(8)
    MV 192,128,64
    RT 152,44,40960
    v_add_u32 v3, 65536, v3
    MV 196,128,68
    RT 154,44,45056
    s_mov_b32 s16, s36
    MV 204,132,68
    RT 128,45,40960
    RT 130,45,45056
    MV 200,132,64
    global_load_dwordx4 a[16:19], v28, s[8:9] offset:0 sc1
    s_mov_b32 s17, s37
    s_waitcnt vmcnt(38) lgkmcnt(8)
    MV 208,136,72
    RT 132,46,40960
    s_mov_b32 s18, 2097152
    MV 212,136,76
    RT 134,46,45056
    MV 220,140,76
    RT 136,47,40960
    RT 138,47,45056
    MV 216,140,72
    global_load_dwordx4 a[20:23], v28, s[8:9] offset:1024 sc1
    s_mov_b32 s19, 0x00020000
    s_waitcnt lgkmcnt(8)
    MV 240,144,72
    RT 140,40,49152
    v_add_u32 v28, 4096, v28
    MV 244,144,76
    RT 142,40,53248
    s_lshl_b32 s30, s56, 8
    MV 252,148,76
    RT 144,41,49152
    RT 146,41,53248
    MV 248,148,72
    global_load_dwordx4 a[24:27], v28, s[8:9] offset:0 sc1
    s_lshl_b32 s31, s33, 7
    s_waitcnt lgkmcnt(8)
    MV 176,152,72
    RT 148,42,49152
    s_add_u32 s30, s30, s31
    MV 180,152,76
    RT 150,42,53248
    MV 188,128,76
    RT 152,43,49152
    RT 154,43,53248
    MV 184,128,72
    global_load_dwordx4 a[28:31], v28, s[8:9] offset:1024 sc1
    s_lshl_b32 s43, s27, 16
    s_waitcnt lgkmcnt(8)
    MV 192,132,72
    RT 128,44,49152
    v_add_u32 v28, 4096, v28
    MV 196,132,76
    RT 130,44,53248
    s_add_u32 s43, s43, s30
    s_waitcnt vmcnt(37) lgkmcnt(10)
    s_barrier
    s_add_u32 m0, s26, 81920
    MV 204,136,76
    RT 132,45,49152
    RT 134,45,53248
    MV 200,136,72
    global_load_lds_dwordx4 v2, s[12:13] offset:0
    s_lshl_b32 s40, s55, 2
    s_waitcnt vmcnt(36) lgkmcnt(8)
    MV 208,140,80
    RT 136,46,49152
    RT 138,46,53248
    MV 212,140,84
    v_add_u32 v2, 65536, v2
    global_load_lds_dwordx4 v3, s[12:13] offset:1024
    s_add_u32 s40, s40, s27
    MV 220,144,84
    RT 140,47,49152
    v_add_u32 v3, 65536, v3
    MV 216,144,80
    RT 142,47,53248
    s_lshl_b32 s40, s40, 16
    s_waitcnt lgkmcnt(8)
    MV 240,148,80
    RT 144,40,57344
    s_add_u32 s40, s40, s30
    MV 244,148,84
    RT 146,40,61440
    s_add_u32 m0, s26, 90112
    MV 252,152,84
    RT 148,41,57344
    RT 150,41,61440
    MV 248,152,80
    global_load_lds_dwordx4 v2, s[12:13] offset:0
    v_lshrrev_b32 v25, 3, v10
    s_waitcnt lgkmcnt(8)
    MV 176,128,80
    RT 152,42,57344
    s_add_u32 s59, s3, 4294836224
    MV 180,128,84
    RT 154,42,61440
    v_add_u32 v2, s59, v2
    v_and_b32 v26, 7, v10
    MV 188,132,84
    RT 128,43,57344
    RT 130,43,61440
    MV 184,132,80
    global_load_lds_dwordx4 v3, s[12:13] offset:1024
    v_and_b32 v27, 6, v25
    s_waitcnt lgkmcnt(8)
    MV 192,136,80
    RT 132,44,57344
    s_add_u32 s59, s3, 4294836224
    MV 196,136,84
    RT 134,44,61440
    v_add_u32 v3, s59, v3
    v_xor_b32 v27, v26, v27
    MV 204,140,84
    RT 136,45,57344
    RT 138,45,61440
    MV 200,140,80
    global_load_dwordx4 a[32:35], v28, s[8:9] offset:0 sc1
    v_lshlrev_b32 v27, 4, v27
    s_waitcnt vmcnt(37) lgkmcnt(8)
    MV 208,144,88
    RT 140,46,57344
    v_lshl_add_u32 v6, v25, 11, v27
    MV 212,144,92
    RT 142,46,61440
    v_add_u32 v7, 15360, v6
    MV 220,148,92
    RT 144,47,57344
    RT 146,47,61440
    MV 216,148,88
    global_load_dwordx4 a[36:39], v28, s[8:9] offset:1024 sc1
    v_add_u32 v8, 30720, v6
    s_waitcnt lgkmcnt(8)
    MV 240,152,88
    RT 148,32,0
    s_add_u32 s59, s58, 4294959104
    MV 244,152,92
    RT 150,32,4096
    v_add_u32 v28, s59, v28
    v_add_u32 v9, 46080, v6
    MV 252,128,92
    RT 152,33,0
    RT 154,33,4096
    MV 248,128,88
    global_load_dwordx4 a[40:43], v28, s[8:9] offset:0 sc1
    v_xor_b32 v26, v25, v26
    s_waitcnt lgkmcnt(8)
    MV 176,132,88
    RT 128,34,0
    v_lshlrev_b32 v26, 4, v26
    MV 180,132,92
    RT 130,34,4096
    MV 188,136,92
    RT 132,35,0
    RT 134,35,4096
    MV 184,136,88
    global_load_dwordx4 a[44:47], v28, s[8:9] offset:1024 sc1
    v_lshl_add_u32 v18, v25, 11, v26
    s_waitcnt lgkmcnt(8)
    MV 192,140,88
    RT 136,36,0
    v_add_u32 v28, 4096, v28
    MV 196,140,92
    RT 138,36,4096
    v_lshl_add_u32 v25, v11, 2, v12
    s_waitcnt vmcnt(36) lgkmcnt(10)
    s_barrier
    s_add_u32 m0, s26, 98304
    MV 204,144,92
    RT 140,37,0
    RT 142,37,4096
    MV 200,144,88
    global_load_lds_dwordx4 v2, s[12:13] offset:0
    v_bfe_u32 v26, v25, 1, 2
    s_waitcnt vmcnt(35) lgkmcnt(8)
    MV 208,148,96
    RT 144,38,0
    RT 146,38,4096
    MV 212,148,100
    v_add_u32 v2, 65536, v2
    global_load_lds_dwordx4 v3, s[12:13] offset:1024
    v_lshlrev_b32 v25, 7, v25
    MV 220,152,100
    RT 148,39,0
    v_add_u32 v3, 65536, v3
    MV 216,152,96
    RT 150,39,4096
    v_lshl_add_u32 v25, v13, 3, v25
    s_waitcnt lgkmcnt(8)
    MV 240,128,96
    RT 152,32,8192
    v_xor_b32 v27, 0, v26
    MV 244,128,100
    RT 154,32,12288
    s_add_u32 m0, s26, 106496
    MV 252,132,100
    RT 128,33,8192
    RT 130,33,12288
    MV 248,132,96
    global_load_lds_dwordx4 v2, s[12:13] offset:0
    v_lshl_add_u32 v48, v27, 5, v25
    s_waitcnt lgkmcnt(8)
    MV 176,136,96
    RT 132,34,8192
    v_add_u32 v2, 65536, v2
    MV 180,136,100
    RT 134,34,12288
    v_add_u32 v52, 65536, v48
    MV 188,140,100
    RT 136,35,8192
    RT 138,35,12288
    MV 184,140,96
    global_load_lds_dwordx4 v3, s[12:13] offset:1024
    v_xor_b32 v27, 1, v26
    s_waitcnt lgkmcnt(8)
    MV 192,144,96
    RT 140,36,8192
    v_add_u32 v3, 65536, v3
    MV 196,144,100
    RT 142,36,12288
    v_lshl_add_u32 v49, v27, 5, v25
    MV 204,148,100
    RT 144,37,8192
    RT 146,37,12288
    MV 200,148,96
    global_load_dwordx4 a[48:51], v28, s[8:9] offset:0 sc1
    v_add_u32 v53, 65536, v49
    s_waitcnt vmcnt(37) lgkmcnt(8)
    MV 208,152,104
    RT 148,38,8192
    v_xor_b32 v27, 2, v26
    MV 212,152,108
    RT 150,38,12288
    MV 220,128,108
    RT 152,39,8192
    RT 154,39,12288
    MV 216,128,104
    global_load_dwordx4 a[52:55], v28, s[8:9] offset:1024 sc1
    v_lshl_add_u32 v50, v27, 5, v25
    s_waitcnt lgkmcnt(8)
    MV 240,132,104
    RT 128,32,16384
    v_add_u32 v28, 4096, v28
    MV 244,132,108
    RT 130,32,20480
    v_add_u32 v54, 65536, v50
    MV 252,136,108
    RT 132,33,16384
    RT 134,33,20480
    MV 248,136,104
    global_load_dwordx4 a[56:59], v28, s[8:9] offset:0 sc1
    v_xor_b32 v27, 3, v26
    v_lshl_add_u32 v51, v27, 5, v25
    s_waitcnt lgkmcnt(8)
    MV 176,140,104
    RT 136,34,16384
    v_add_u32 v55, 65536, v51
    MV 180,140,108
    RT 138,34,20480
    MV 188,144,108
    RT 140,35,16384
    RT 142,35,20480
    MV 184,144,104
    global_load_dwordx4 a[60:63], v28, s[8:9] offset:1024 sc1
    v_and_b32 v20, 15, v10
    s_waitcnt lgkmcnt(8)
    MV 192,148,104
    RT 144,36,16384
    s_add_u32 s59, s58, 4294959104
    MV 196,148,108
    RT 146,36,20480
    v_add_u32 v28, s59, v28
    v_lshlrev_b32 v20, 2, v20
    s_waitcnt vmcnt(36) lgkmcnt(10)
    s_barrier
    s_add_u32 m0, s26, 114688
    MV 204,152,108
    RT 148,37,16384
    RT 150,37,20480
    MV 200,152,104
    global_load_lds_dwordx4 v2, s[12:13] offset:0
    s_lshl_b32 s48, s2, 2
    s_waitcnt vmcnt(35) lgkmcnt(8)
    MV 208,128,112
    RT 152,38,16384
    RT 154,38,20480
    s_add_u32 s48, s48, s27
    MV 212,128,116
    s_mul_i32 s59, s3, -8
    s_add_u32 s59, s59, 65536
    v_add_u32 v2, s59, v2
    global_load_lds_dwordx4 v3, s[12:13] offset:1024
    MV 220,132,116
    RT 128,39,16384
    s_mul_i32 s59, s3, -8
    s_add_u32 s59, s59, 65536
    MV 216,132,112
    RT 130,39,20480
    v_add_u32 v3, s59, v3
    s_lshl_b32 s49, s48, 13
    s_waitcnt lgkmcnt(8)
    MV 240,136,112
    RT 132,32,24576
    s_add_u32 s49, s49, 33554432
    MV 244,136,116
    RT 134,32,28672
    s_add_u32 m0, s26, 122880
    MV 252,140,116
    RT 136,33,24576
    RT 138,33,28672
    MV 248,140,112
    global_load_lds_dwordx4 v2, s[12:13] offset:0
    s_xor_b32 s50, s49, 4227072
    s_waitcnt lgkmcnt(8)
    MV 176,144,112
    RT 140,34,24576
    v_add_u32 v2, 65536, v2
    MV 180,144,116
    RT 142,34,28672
    buffer_load_dword v5, v4, s[8:11], s67 offen sc1
    s_add_u32 s52, s49, 4096
    MV 188,148,116
    RT 144,35,24576
    RT 146,35,28672
    MV 184,148,112
    global_load_lds_dwordx4 v3, s[12:13] offset:1024
    s_add_u32 s53, s50, 4096
    s_waitcnt lgkmcnt(8)
    MV 192,152,112
    RT 148,36,24576
    v_add_u32 v3, 65536, v3
    MV 196,152,116
    RT 150,36,28672
    s_xor_b32 s54, s51, 2064
    MV 204,128,116
    RT 152,37,24576
    RT 154,37,28672
    MV 200,128,112
    global_load_dwordx4 a[64:67], v28, s[8:9] offset:0 sc1
    s_lshl_b32 s48, s27, 12
    s_waitcnt vmcnt(38) lgkmcnt(8)
    MV 208,132,120
    RT 128,38,24576
    v_add_u32 v6, s43, v6
    MV 212,132,124
    RT 130,38,28672
    MV 220,136,124
    RT 132,39,24576
    RT 134,39,28672
    MV 216,136,120
    global_load_dwordx4 a[68:71], v28, s[8:9] offset:1024 sc1
    v_add_u32 v7, s43, v7
    s_waitcnt lgkmcnt(8)
    MV 240,140,120
    RT 136,32,32768
    v_add_u32 v28, 4096, v28
    MV 244,140,124
    RT 138,32,36864
    v_add_u32 v8, s43, v8
    MV 252,144,124
    RT 140,33,32768
    RT 142,33,36864
    MV 248,144,120
    global_load_dwordx4 a[72:75], v28, s[8:9] offset:0 sc1
    v_add_u32 v9, s43, v9
    s_waitcnt lgkmcnt(8)
    MV 176,148,120
    RT 144,34,32768
    s_mov_b32 s44, s38
    MV 180,148,124
    RT 146,34,36864
    MV 188,152,124
    RT 148,35,32768
    RT 150,35,36864
    MV 184,152,120
    global_load_dwordx4 a[76:79], v28, s[8:9] offset:1024 sc1
    s_mov_b32 s45, s39
    s_mov_b32 s46, 4194304
    s_waitcnt lgkmcnt(8)
    MV 192,128,120
    RT 152,36,32768
    v_add_u32 v28, 4096, v28
    MV 196,128,124
    RT 154,36,36864
    s_waitcnt vmcnt(37) lgkmcnt(10)
    s_barrier
    s_add_u32 m0, s26, 0
    MV 204,132,124
    RT 128,37,32768
    RT 130,37,36864
    MV 200,132,120
    global_load_lds_dwordx4 v2, s[12:13] offset:0
    s_waitcnt vmcnt(36) lgkmcnt(8)
    MV 208,136,0
    RT 132,38,32768
    RT 134,38,36864
    MV 212,136,4
    v_add_u32 v2, 65536, v2
    global_load_lds_dwordx4 v3, s[12:13] offset:1024
    MV 220,140,4
    RT 136,39,32768
    v_add_u32 v3, 65536, v3
    MV 216,140,0
    RT 138,39,36864
    s_waitcnt lgkmcnt(8)
    MV 240,144,0
    RT 140,32,40960
    MV 244,144,4
    RT 142,32,45056
    s_add_u32 m0, s26, 8192
    MV 252,148,4
    RT 144,33,40960
    RT 146,33,45056
    MV 248,148,0
    global_load_lds_dwordx4 v2, s[12:13] offset:0
    s_waitcnt lgkmcnt(8)
    MV 176,152,0
    RT 148,34,40960
    v_add_u32 v2, 65536, v2
    MV 180,152,4
    RT 150,34,45056
    MV 188,128,4
    RT 152,35,40960
    RT 154,35,45056
    MV 184,128,0
    global_load_lds_dwordx4 v3, s[12:13] offset:1024
    s_waitcnt lgkmcnt(8)
    MV 192,132,0
    RT 128,36,40960
    v_add_u32 v3, 65536, v3
    MV 196,132,4
    RT 130,36,45056
    MV 204,136,4
    RT 132,37,40960
    RT 134,37,45056
    MV 200,136,0
    global_load_dwordx4 a[80:83], v28, s[8:9] offset:0 sc1
    s_waitcnt vmcnt(38) lgkmcnt(8)
    MV 208,140,8
    RT 136,38,40960
    MV 212,140,12
    RT 138,38,45056
    MV 220,144,12
    RT 140,39,40960
    RT 142,39,45056
    MV 216,144,8
    global_load_dwordx4 a[84:87], v28, s[8:9] offset:1024 sc1
    s_waitcnt lgkmcnt(8)
    MV 240,148,8
    RT 144,32,49152
    s_mul_i32 s59, s58, -8
    s_add_u32 s59, s59, 4096
    MV 244,148,12
    RT 146,32,53248
    v_add_u32 v28, s59, v28
    MV 252,152,12
    RT 148,33,49152
    RT 150,33,53248
    MV 248,152,8
    s_waitcnt vmcnt(11)
    v_cmp_gt_u32 vcc, 2, v5
    s_nop 0
    s_cbranch_vccnz L_slow_h_2
L_back_h_2:
    global_load_dwordx4 a[88:91], v28, s[8:9] offset:0 sc1
    s_waitcnt lgkmcnt(8)
    MV 176,128,8
    RT 152,34,49152
    MV 180,128,12
    RT 154,34,53248
    MV 188,132,12
    RT 128,35,49152
    RT 130,35,53248
    MV 184,132,8
    global_load_dwordx4 a[92:95], v28, s[8:9] offset:1024 sc1
    s_waitcnt lgkmcnt(8)
    MV 192,136,8
    RT 132,36,49152
    v_add_u32 v28, 4096, v28
    MV 196,136,12
    RT 134,36,53248
    s_waitcnt lgkmcnt(10)
    s_barrier
    s_add_u32 m0, s26, 16384
    MV 204,140,12
    RT 136,37,49152
    RT 138,37,53248
    MV 200,140,8
    global_load_lds_dwordx4 v2, s[12:13] offset:0
    s_waitcnt lgkmcnt(8)
    MV 208,144,16
    RT 140,38,49152
    RT 142,38,53248
    MV 212,144,20
    s_add_u32 s59, s3, 4294770688
    v_add_u32 v2, s59, v2
    global_load_lds_dwordx4 v3, s[12:13] offset:1024
    MV 220,148,20
    RT 144,39,49152
    s_add_u32 s59, s3, 4294770688
    MV 216,148,16
    RT 146,39,53248
    v_add_u32 v3, s59, v3
    s_waitcnt lgkmcnt(8)
    MV 240,152,16
    RT 148,32,57344
    MV 244,152,20
    RT 150,32,61440
    s_add_u32 m0, s26, 24576
    MV 252,128,20
    RT 152,33,57344
    RT 154,33,61440
    MV 248,128,16
    global_load_lds_dwordx4 v2, s[12:13] offset:0
    s_waitcnt lgkmcnt(8)
    MV 176,132,16
    RT 128,34,57344
    v_add_u32 v2, 65536, v2
    MV 180,132,20
    RT 130,34,61440
    MV 188,136,20
    RT 132,35,57344
    RT 134,35,61440
    MV 184,136,16
    global_load_lds_dwordx4 v3, s[12:13] offset:1024
    s_waitcnt lgkmcnt(8)
    MV 192,140,16
    RT 136,36,57344
    v_add_u32 v3, 65536, v3
    MV 196,140,20
    RT 138,36,61440
    MV 204,144,20
    RT 140,37,57344
    RT 142,37,61440
    MV 200,144,16
    global_load_dwordx4 a[96:99], v28, s[8:9] offset:0 sc1
    s_waitcnt lgkmcnt(8)
    MV 208,148,24
    RT 144,38,57344
    MV 212,148,28
    RT 146,38,61440
    MV 220,152,28
    RT 148,39,57344
    RT 150,39,61440
    MV 216,152,24
    global_load_dwordx4 a[100:103], v28, s[8:9] offset:1024 sc1
    s_waitcnt lgkmcnt(8)
    MV 240,128,24
    RT 152,40,0
    v_add_u32 v28, 4096, v28
    MV 244,128,28
    RT 154,40,4096
    MV 252,132,28
    RT 128,41,0
    RT 130,41,4096
    MV 248,132,24
    global_load_dwordx4 a[104:107], v28, s[8:9] offset:0 sc1
    s_waitcnt lgkmcnt(8)
    MV 176,136,24
    RT 132,42,0
    MV 180,136,28
    RT 134,42,4096
    MV 188,140,28
    RT 136,43,0
    RT 138,43,4096
    MV 184,140,24
    global_load_dwordx4 a[108:111], v28, s[8:9] offset:1024 sc1
    s_waitcnt lgkmcnt(8)
    MV 192,144,24
    RT 140,44,0
    v_add_u32 v28, 4096, v28
    MV 196,144,28
    RT 142,44,4096
    s_waitcnt lgkmcnt(10)
    s_barrier
    s_add_u32 m0, s26, 32768
    MV 204,148,28
    RT 144,45,0
    RT 146,45,4096
    MV 200,148,24
    global_load_lds_dwordx4 v2, s[12:13] offset:0
    s_waitcnt lgkmcnt(8)
    MV 208,152,32
    RT 148,46,0
    RT 150,46,4096
    MV 212,152,36
    v_add_u32 v2, 65536, v2
    global_load_lds_dwordx4 v3, s[12:13] offset:1024
    MV 220,128,36
    RT 152,47,0
    v_add_u32 v3, 65536, v3
    MV 216,128,32
    RT 154,47,4096
    s_waitcnt lgkmcnt(8)
    MV 240,132,32
    RT 128,40,8192
    MV 244,132,36
    RT 130,40,12288
    s_add_u32 m0, s26, 40960
    MV 252,136,36
    RT 132,41,8192
    RT 134,41,12288
    MV 248,136,32
    global_load_lds_dwordx4 v2, s[12:13] offset:0
    s_waitcnt lgkmcnt(8)
    MV 176,140,32
    RT 136,42,8192
    v_add_u32 v2, 65536, v2
    MV 180,140,36
    RT 138,42,12288
    MV 188,144,36
    RT 140,43,8192
    RT 142,43,12288
    MV 184,144,32
    global_load_lds_dwordx4 v3, s[12:13] offset:1024
    s_waitcnt lgkmcnt(8)
    MV 192,148,32
    RT 144,44,8192
    v_add_u32 v3, 65536, v3
    MV 196,148,36
    RT 146,44,12288
    MV 204,152,36
    RT 148,45,8192
    RT 150,45,12288
    MV 200,152,32
    global_load_dwordx4 a[112:115], v28, s[8:9] offset:0 sc1
    s_waitcnt lgkmcnt(8)
    MV 208,128,40
    RT 152,46,8192
    MV 212,128,44
    RT 154,46,12288
    MV 220,132,44
    RT 128,47,8192
    RT 130,47,12288
    MV 216,132,40
    global_load_dwordx4 a[116:119], v28, s[8:9] offset:1024 sc1
    s_waitcnt lgkmcnt(8)
    MV 240,136,40
    RT 132,40,16384
    s_add_u32 s59, s58, 4294955008
    MV 244,136,44
    RT 134,40,20480
    v_add_u32 v28, s59, v28
    MV 252,140,44
    RT 136,41,16384
    RT 138,41,20480
    MV 248,140,40
    global_load_dwordx4 a[120:123], v28, s[8:9] offset:0 sc1
    s_waitcnt lgkmcnt(8)
    MV 176,144,40
    RT 140,42,16384
    MV 180,144,44
    RT 142,42,20480
    MV 188,148,44
    RT 144,43,16384
    RT 146,43,20480
    MV 184,148,40
    global_load_dwordx4 a[124:127], v28, s[8:9] offset:1024 sc1
    s_waitcnt lgkmcnt(8)
    MV 192,152,40
    RT 148,44,16384
    v_add_u32 v28, 4096, v28
    MV 196,152,44
    RT 150,44,20480
    s_waitcnt lgkmcnt(10)
    s_barrier
    s_add_u32 m0, s26, 49152
    MV 204,128,44
    RT 152,45,16384
    RT 154,45,20480
    MV 200,128,40
    global_load_lds_dwordx4 v2, s[12:13] offset:0
    s_waitcnt lgkmcnt(8)
    MV 208,132,48
    RT 128,46,16384
    RT 130,46,20480
    MV 212,132,52
    s_add_u32 s59, s3, 4294770688
    v_add_u32 v2, s59, v2
    global_load_lds_dwordx4 v3, s[12:13] offset:1024
    MV 220,136,52
    RT 132,47,16384
    s_add_u32 s59, s3, 4294770688
    MV 216,136,48
    RT 134,47,20480
    v_add_u32 v3, s59, v3
    s_waitcnt lgkmcnt(8)
    MV 240,140,48
    RT 136,40,24576
    MV 244,140,52
    RT 138,40,28672
    s_add_u32 m0, s26, 57344
    MV 252,144,52
    RT 140,41,24576
    RT 142,41,28672
    MV 248,144,48
    global_load_lds_dwordx4 v2, s[12:13] offset:0
    s_waitcnt lgkmcnt(8)
    MV 176,148,48
    RT 144,42,24576
    v_add_u32 v2, 65536, v2
    MV 180,148,52
    RT 146,42,28672
    MV 188,152,52
    RT 148,43,24576
    RT 150,43,28672
    MV 184,152,48
    global_load_lds_dwordx4 v3, s[12:13] offset:1024
    s_waitcnt lgkmcnt(8)
    MV 192,128,48
    RT 152,44,24576
    v_add_u32 v3, 65536, v3
    MV 196,128,52
    RT 154,44,28672
    MV 204,132,52
    RT 128,45,24576
    RT 130,45,28672
    MV 200,132,48
    global_load_dwordx4 a[0:3], v28, s[8:9] offset:0 sc1
    s_waitcnt lgkmcnt(8)
    MV 208,136,56
    RT 132,46,24576
    MV 212,136,60
    RT 134,46,28672
    MV 220,140,60
    RT 136,47,24576
    RT 138,47,28672
    MV 216,140,56
    global_load_dwordx4 a[4:7], v28, s[8:9] offset:1024 sc1
    s_waitcnt lgkmcnt(8)
    MV 240,144,56
    RT 140,40,32768
    v_add_u32 v28, 4096, v28
    MV 244,144,60
    RT 142,40,36864
    MV 252,148,60
    RT 144,41,32768
    RT 146,41,36864
    MV 248,148,56
    global_load_dwordx4 a[8:11], v28, s[8:9] offset:0 sc1
    s_waitcnt lgkmcnt(8)
    MV 176,152,56
    RT 148,42,32768
    MV 180,152,60
    RT 150,42,36864
    MV 188,128,60
    RT 152,43,32768
    RT 154,43,36864
    MV 184,128,56
    global_load_dwordx4 a[12:15], v28, s[8:9] offset:1024 sc1
    s_waitcnt lgkmcnt(8)
    MV 192,132,56
    RT 128,44,32768
    v_add_u32 v28, 4096, v28
    MV 196,132,60
    RT 130,44,36864
    s_waitcnt vmcnt(36) lgkmcnt(10)
    s_barrier
    s_add_u32 m0, s26, 65536
    MV 204,136,60
    RT 132,45,32768
    RT 134,45,36864
    MV 200,136,56
    global_load_lds_dwordx4 v2, s[12:13] offset:0
    s_waitcnt vmcnt(35) lgkmcnt(8)
    MV 208,140,64
    RT 136,46,32768
    RT 138,46,36864
    MV 212,140,68
    v_add_u32 v2, 65536, v2
    global_load_lds_dwordx4 v3, s[12:13] offset:1024
    MV 220,144,68
    RT 140,47,32768
    v_add_u32 v3, 65536, v3
    MV 216,144,64
    RT 142,47,36864
    s_waitcnt lgkmcnt(8)
    MV 240,148,64
    RT 144,40,40960
    MV 244,148,68
    RT 146,40,45056
    s_add_u32 m0, s26, 73728
    MV 252,152,68
    RT 148,41,40960
    RT 150,41,45056
    MV 248,152,64
    global_load_lds_dwordx4 v2, s[12:13] offset:0
    s_waitcnt lgkmcnt(8)
    MV 176,128,64
    RT 152,42,40960
    v_add_u32 v2, 65536, v2
    MV 180,128,68
    RT 154,42,45056
    MV 188,132,68
    RT 128,43,40960
    RT 130,43,45056
    MV 184,132,64
    global_load_lds_dwordx4 v3, s[12:13] offset:1024
    s_waitcnt lgkmcnt(8)
    MV 192,136,64
    RT 132,44,40960
    v_add_u32 v3, 65536, v3
    MV 196,136,68
    RT 134,44,45056
    MV 204,140,68
    RT 136,45,40960
    RT 138,45,45056
    MV 200,140,64
    global_load_dwordx4 a[16:19], v28, s[8:9] offset:0 sc1
    s_waitcnt vmcnt(37) lgkmcnt(8)
    MV 208,144,72
    RT 140,46,40960
    MV 212,144,76
    RT 142,46,45056
    MV 220,148,76
    RT 144,47,40960
    RT 146,47,45056
    MV 216,148,72
    global_load_dwordx4 a[20:23], v28, s[8:9] offset:1024 sc1
    s_waitcnt lgkmcnt(8)
    MV 240,152,72
    RT 148,40,49152
    s_add_u32 s59, s58, 4294955008
    MV 244,152,76
    RT 150,40,53248
    v_add_u32 v28, s59, v28
    MV 252,128,76
    RT 152,41,49152
    RT 154,41,53248
    MV 248,128,72
    global_load_dwordx4 a[24:27], v28, s[8:9] offset:0 sc1
    s_waitcnt lgkmcnt(8)
    MV 176,132,72
    RT 128,42,49152
    MV 180,132,76
    RT 130,42,53248
    MV 188,136,76
    RT 132,43,49152
    RT 134,43,53248
    MV 184,136,72
    global_load_dwordx4 a[28:31], v28, s[8:9] offset:1024 sc1
    s_waitcnt lgkmcnt(8)
    MV 192,140,72
    RT 136,44,49152
    v_add_u32 v28, 4096, v28
    MV 196,140,76
    RT 138,44,53248
    s_waitcnt vmcnt(36) lgkmcnt(10)
    s_barrier
    s_add_u32 m0, s26, 81920
    MV 204,144,76
    RT 140,45,49152
    RT 142,45,53248
    MV 200,144,72
    global_load_lds_dwordx4 v2, s[12:13] offset:0
    s_waitcnt vmcnt(35) lgkmcnt(8)
    MV 208,148,80
    RT 144,46,49152
    RT 146,46,53248
    MV 212,148,84
    s_add_u32 s59, s3, 4294770688
    v_add_u32 v2, s59, v2
    global_load_lds_dwordx4 v3, s[12:13] offset:1024
    MV 220,152,84
    RT 148,47,49152
    s_add_u32 s59, s3, 4294770688
    MV 216,152,80
    RT 150,47,53248
    v_add_u32 v3, s59, v3
    s_waitcnt lgkmcnt(8)
    MV 240,128,80
    RT 152,40,57344
    MV 244,128,84
    RT 154,40,61440
    s_add_u32 m0, s26, 90112
    MV 252,132,84
    RT 128,41,57344
    RT 130,41,61440
    MV 248,132,80
    global_load_lds_dwordx4 v2, s[12:13] offset:0
    s_waitcnt lgkmcnt(8)
    MV 176,136,80
    RT 132,42,57344
    v_add_u32 v2, 65536, v2
    MV 180,136,84
    RT 134,42,61440
    MV 188,140,84
    RT 136,43,57344
    RT 138,43,61440
    MV 184,140,80
    global_load_lds_dwordx4 v3, s[12:13] offset:1024
    s_waitcnt lgkmcnt(8)
    MV 192,144,80
    RT 140,44,57344
    v_add_u32 v3, 65536, v3
    MV 196,144,84
    RT 142,44,61440
    MV 204,148,84
    RT 144,45,57344
    RT 146,45,61440
    MV 200,148,80
    global_load_dwordx4 a[32:35], v28, s[8:9] offset:0 sc1
    s_waitcnt vmcnt(37) lgkmcnt(8)
    MV 208,152,88
    RT 148,46,57344
    MV 212,152,92
    RT 150,46,61440
    MV 220,128,92
    RT 152,47,57344
    RT 154,47,61440
    MV 216,128,88
    global_load_dwordx4 a[36:39], v28, s[8:9] offset:1024 sc1
    s_waitcnt lgkmcnt(8)
    MV 240,132,88
    RT 128,32,0
    v_add_u32 v28, 4096, v28
    MV 244,132,92
    RT 130,32,4096
    MV 252,136,92
    RT 132,33,0
    RT 134,33,4096
    MV 248,136,88
    global_load_dwordx4 a[40:43], v28, s[8:9] offset:0 sc1
    s_waitcnt lgkmcnt(8)
    MV 176,140,88
    RT 136,34,0
    MV 180,140,92
    RT 138,34,4096
    MV 188,144,92
    RT 140,35,0
    RT 142,35,4096
    MV 184,144,88
    global_load_dwordx4 a[44:47], v28, s[8:9] offset:1024 sc1
    s_waitcnt lgkmcnt(8)
    MV 192,148,88
    RT 144,36,0
    v_add_u32 v28, 4096, v28
    MV 196,148,92
    RT 146,36,4096
    s_waitcnt vmcnt(36) lgkmcnt(10)
    s_barrier
    s_add_u32 m0, s26, 98304
    MV 204,152,92
    RT 148,37,0
    RT 150,37,4096
    MV 200,152,88
    global_load_lds_dwordx4 v2, s[12:13] offset:0
    s_waitcnt vmcnt(35) lgkmcnt(8)
    MV 208,128,96
    RT 152,38,0
    RT 154,38,4096
    MV 212,128,100
    v_add_u32 v2, 65536, v2
    global_load_lds_dwordx4 v3, s[12:13] offset:1024
    MV 220,132,100
    RT 128,39,0
    v_add_u32 v3, 65536, v3
    MV 216,132,96
    RT 130,39,4096
    s_waitcnt lgkmcnt(8)
    MV 240,136,96
    RT 132,32,8192
    MV 244,136,100
    RT 134,32,12288
    s_add_u32 m0, s26, 106496
    MV 252,140,100
    RT 136,33,8192
    RT 138,33,12288
    MV 248,140,96
    global_load_lds_dwordx4 v2, s[12:13] offset:0
    s_waitcnt lgkmcnt(8)
    MV 176,144,96
    RT 140,34,8192
    v_add_u32 v2, 65536, v2
    MV 180,144,100
    RT 142,34,12288
    MV 188,148,100
    RT 144,35,8192
    RT 146,35,12288
    MV 184,148,96
    global_load_lds_dwordx4 v3, s[12:13] offset:1024
    s_waitcnt lgkmcnt(8)
    MV 192,152,96
    RT 148,36,8192
    v_add_u32 v3, 65536, v3
    MV 196,152,100
    RT 150,36,12288
    MV 204,128,100
    RT 152,37,8192
    RT 154,37,12288
    MV 200,128,96
    global_load_dwordx4 a[48:51], v28, s[8:9] offset:0 sc1
    s_waitcnt vmcnt(37) lgkmcnt(8)
    MV 208,132,104
    RT 128,38,8192
    MV 212,132,108
    RT 130,38,12288
    MV 220,136,108
    RT 132,39,8192
    RT 134,39,12288
    MV 216,136,104
    global_load_dwordx4 a[52:55], v28, s[8:9] offset:1024 sc1
    s_waitcnt lgkmcnt(8)
    MV 240,140,104
    RT 136,32,16384
    s_add_u32 s59, s58, 4294955008
    MV 244,140,108
    RT 138,32,20480
    v_add_u32 v28, s59, v28
    MV 252,144,108
    RT 140,33,16384
    RT 142,33,20480
    MV 248,144,104
    global_load_dwordx4 a[56:59], v28, s[8:9] offset:0 sc1
    s_waitcnt lgkmcnt(8)
    MV 176,148,104
    RT 144,34,16384
    MV 180,148,108
    RT 146,34,20480
    MV 188,152,108
    RT 148,35,16384
    RT 150,35,20480
    MV 184,152,104
    global_load_dwordx4 a[60:63], v28, s[8:9] offset:1024 sc1
    s_waitcnt lgkmcnt(8)
    MV 192,128,104
    RT 152,36,16384
    v_add_u32 v28, 4096, v28
    MV 196,128,108
    RT 154,36,20480
    s_waitcnt vmcnt(36) lgkmcnt(10)
    s_barrier
    s_add_u32 m0, s26, 114688
    MV 204,132,108
    RT 128,37,16384
    RT 130,37,20480
    MV 200,132,104
    global_load_lds_dwordx4 v2, s[12:13] offset:0
    s_waitcnt vmcnt(35) lgkmcnt(8)
    MV 208,136,112
    RT 132,38,16384
    RT 134,38,20480
    MV 212,136,116
    s_add_u32 s59, s3, 4294770688
    v_add_u32 v2, s59, v2
    global_load_lds_dwordx4 v3, s[12:13] offset:1024
    MV 220,140,116
    RT 136,39,16384
    s_add_u32 s59, s3, 4294770688
    MV 216,140,112
    RT 138,39,20480
    v_add_u32 v3, s59, v3
    s_waitcnt lgkmcnt(8)
    MV 240,144,112
    RT 140,32,24576
    MV 244,144,116
    RT 142,32,28672
    s_add_u32 m0, s26, 122880
    MV 252,148,116
    RT 144,33,24576
    RT 146,33,28672
    MV 248,148,112
    global_load_lds_dwordx4 v2, s[12:13] offset:0
    s_waitcnt lgkmcnt(8)
    MV 176,152,112
    RT 148,34,24576
    v_add_u32 v2, 65536, v2
    MV 180,152,116
    RT 150,34,28672
    MV 188,128,116
    RT 152,35,24576
    RT 154,35,28672
    MV 184,128,112
    global_load_lds_dwordx4 v3, s[12:13] offset:1024
    s_waitcnt lgkmcnt(8)
    MV 192,132,112
    RT 128,36,24576
    v_add_u32 v3, 65536, v3
    MV 196,132,116
    RT 130,36,28672
    MV 204,136,116
    RT 132,37,24576
    RT 134,37,28672
    MV 200,136,112
    global_load_dwordx4 a[64:67], v28, s[8:9] offset:0 sc1
    s_waitcnt vmcnt(37) lgkmcnt(8)
    MV 208,140,120
    RT 136,38,24576
    MV 212,140,124
    RT 138,38,28672
    MV 220,144,124
    RT 140,39,24576
    RT 142,39,28672
    MV 216,144,120
    global_load_dwordx4 a[68:71], v28, s[8:9] offset:1024 sc1
    s_waitcnt lgkmcnt(8)
    MV 240,148,120
    RT 144,32,32768
    v_add_u32 v28, 4096, v28
    MV 244,148,124
    RT 146,32,36864
    MV 252,152,124
    RT 148,33,32768
    RT 150,33,36864
    MV 248,152,120
    global_load_dwordx4 a[72:75], v28, s[8:9] offset:0 sc1
    s_waitcnt lgkmcnt(8)
    MV 176,128,120
    RT 152,34,32768
    MV 180,128,124
    RT 154,34,36864
    MV 188,132,124
    RT 128,35,32768
    RT 130,35,36864
    MV 184,132,120
    global_load_dwordx4 a[76:79], v28, s[8:9] offset:1024 sc1
    s_waitcnt lgkmcnt(8)
    MV 192,136,120
    RT 132,36,32768
    v_add_u32 v28, 4096, v28
    MV 196,136,124
    RT 134,36,36864
    s_waitcnt vmcnt(36) lgkmcnt(10)
    s_barrier
    s_add_u32 m0, s26, 0
    MV 204,140,124
    RT 136,37,32768
    RT 138,37,36864
    MV 200,140,120
    global_load_lds_dwordx4 v2, s[12:13] offset:0
    s_waitcnt vmcnt(35) lgkmcnt(8)
    MV 208,144,0
    RT 140,38,32768
    RT 142,38,36864
    MV 212,144,4
    v_add_u32 v2, 65536, v2
    global_load_lds_dwordx4 v3, s[12:13] offset:1024
    MV 220,148,4
    RT 144,39,32768
    v_add_u32 v3, 65536, v3
    MV 216,148,0
    RT 146,39,36864
    s_waitcnt lgkmcnt(8)
    MV 240,152,0
    RT 148,32,40960
    MV 244,152,4
    RT 150,32,45056
    s_add_u32 m0, s26, 8192
    MV 252,128,4
    RT 152,33,40960
    RT 154,33,45056
    MV 248,128,0
    global_load_lds_dwordx4 v2, s[12:13] offset:0
    s_waitcnt lgkmcnt(8)
    MV 176,132,0
    RT 128,34,40960
    v_add_u32 v2, 65536, v2
    MV 180,132,4
    RT 130,34,45056
    MV 188,136,4
    RT 132,35,40960
    RT 134,35,45056
    MV 184,136,0
    global_load_lds_dwordx4 v3, s[12:13] offset:1024
    s_waitcnt lgkmcnt(8)
    MV 192,140,0
    RT 136,36,40960
    v_add_u32 v3, 65536, v3
    MV 196,140,4
    RT 138,36,45056
    MV 204,144,4
    RT 140,37,40960
    RT 142,37,45056
    MV 200,144,0
    global_load_dwordx4 a[80:83], v28, s[8:9] offset:0 sc1
    s_waitcnt vmcnt(37) lgkmcnt(8)
    MV 208,148,8
    RT 144,38,40960
    MV 212,148,12
    RT 146,38,45056
    MV 220,152,12
    RT 148,39,40960
    RT 150,39,45056
    MV 216,152,8
    global_load_dwordx4 a[84:87], v28, s[8:9] offset:1024 sc1
    s_waitcnt lgkmcnt(8)
    MV 240,128,8
    RT 152,32,49152
    s_add_u32 s59, s58, 4294955008
    MV 244,128,12
    RT 154,32,53248
    v_add_u32 v28, s59, v28
    MV 252,132,12
    RT 128,33,49152
    RT 130,33,53248
    MV 248,132,8
    global_load_dwordx4 a[88:91], v28, s[8:9] offset:0 sc1
    s_waitcnt lgkmcnt(8)
    MV 176,136,8
    RT 132,34,49152
    MV 180,136,12
    RT 134,34,53248
    MV 188,140,12
    RT 136,35,49152
    RT 138,35,53248
    MV 184,140,8
    global_load_dwordx4 a[92:95], v28, s[8:9] offset:1024 sc1
    s_waitcnt lgkmcnt(8)
    MV 192,144,8
    RT 140,36,49152
    v_add_u32 v28, 4096, v28
    MV 196,144,12
    RT 142,36,53248
    s_waitcnt vmcnt(36) lgkmcnt(10)
    s_barrier
    s_add_u32 m0, s26, 16384
    MV 204,148,12
    RT 144,37,49152
    RT 146,37,53248
    MV 200,148,8
    global_load_lds_dwordx4 v2, s[12:13] offset:0
    s_waitcnt vmcnt(35) lgkmcnt(8)
    MV 208,152,16
    RT 148,38,49152
    RT 150,38,53248
    MV 212,152,20
    s_add_u32 s59, s3, 4294770688
    v_add_u32 v2, s59, v2
    global_load_lds_dwordx4 v3, s[12:13] offset:1024
    MV 220,128,20
    RT 152,39,49152
    s_add_u32 s59, s3, 4294770688
    MV 216,128,16
    RT 154,39,53248
    v_add_u32 v3, s59, v3
    s_waitcnt lgkmcnt(8)
    MV 240,132,16
    RT 128,32,57344
    MV 244,132,20
    RT 130,32,61440
    s_add_u32 m0, s26, 24576
    MV 252,136,20
    RT 132,33,57344
    RT 134,33,61440
    MV 248,136,16
    global_load_lds_dwordx4 v2, s[12:13] offset:0
    s_waitcnt lgkmcnt(8)
    MV 176,140,16
    RT 136,34,57344
    v_add_u32 v2, 65536, v2
    MV 180,140,20
    RT 138,34,61440
    MV 188,144,20
    RT 140,35,57344
    RT 142,35,61440
    MV 184,144,16
    global_load_lds_dwordx4 v3, s[12:13] offset:1024
    s_waitcnt lgkmcnt(8)
    MV 192,148,16
    RT 144,36,57344
    v_add_u32 v3, 65536, v3
    MV 196,148,20
    RT 146,36,61440
    MV 204,152,20
    RT 148,37,57344
    RT 150,37,61440
    MV 200,152,16
    global_load_dwordx4 a[96:99], v28, s[8:9] offset:0 sc1
    s_waitcnt vmcnt(37) lgkmcnt(8)
    MV 208,128,24
    RT 152,38,57344
    MV 212,128,28
    RT 154,38,61440
    MV 220,132,28
    RT 128,39,57344
    RT 130,39,61440
    MV 216,132,24
    global_load_dwordx4 a[100:103], v28, s[8:9] offset:1024 sc1
    s_waitcnt lgkmcnt(8)
    MV 240,136,24
    RT 132,40,0
    v_add_u32 v28, 4096, v28
    MV 244,136,28
    RT 134,40,4096
    MV 252,140,28
    RT 136,41,0
    RT 138,41,4096
    MV 248,140,24
    global_load_dwordx4 a[104:107], v28, s[8:9] offset:0 sc1
    s_waitcnt lgkmcnt(8)
    MV 176,144,24
    RT 140,42,0
    MV 180,144,28
    RT 142,42,4096
    MV 188,148,28
    RT 144,43,0
    RT 146,43,4096
    MV 184,148,24
    global_load_dwordx4 a[108:111], v28, s[8:9] offset:1024 sc1
    s_waitcnt lgkmcnt(8)
    MV 192,152,24
    RT 148,44,0
    v_add_u32 v28, 4096, v28
    MV 196,152,28
    RT 150,44,4096
    s_waitcnt vmcnt(36) lgkmcnt(10)
    s_barrier
    s_add_u32 m0, s26, 32768
    MV 204,128,28
    RT 152,45,0
    RT 154,45,4096
    MV 200,128,24
    global_load_lds_dwordx4 v2, s[12:13] offset:0
    s_waitcnt vmcnt(35) lgkmcnt(8)
    MV 208,132,32
    RT 128,46,0
    RT 130,46,4096
    MV 212,132,36
    v_add_u32 v2, 65536, v2
    global_load_lds_dwordx4 v3, s[12:13] offset:1024
    MV 220,136,36
    RT 132,47,0
    v_add_u32 v3, 65536, v3
    MV 216,136,32
    RT 134,47,4096
    s_waitcnt lgkmcnt(8)
    MV 240,140,32
    RT 136,40,8192
    MV 244,140,36
    RT 138,40,12288
    s_add_u32 m0, s26, 40960
    MV 252,144,36
    RT 140,41,8192
    RT 142,41,12288
    MV 248,144,32
    global_load_lds_dwordx4 v2, s[12:13] offset:0
    s_waitcnt lgkmcnt(8)
    MV 176,148,32
    RT 144,42,8192
    v_add_u32 v2, 65536, v2
    MV 180,148,36
    RT 146,42,12288
    MV 188,152,36
    RT 148,43,8192
    RT 150,43,12288
    MV 184,152,32
    global_load_lds_dwordx4 v3, s[12:13] offset:1024
    s_waitcnt lgkmcnt(8)
    MV 192,128,32
    RT 152,44,8192
    v_add_u32 v3, 65536, v3
    MV 196,128,36
    RT 154,44,12288
    MV 204,132,36
    RT 128,45,8192
    RT 130,45,12288
    MV 200,132,32
    global_load_dwordx4 a[112:115], v28, s[8:9] offset:0 sc1
    s_waitcnt vmcnt(37) lgkmcnt(8)
    MV 208,136,40
    RT 132,46,8192
    MV 212,136,44
    RT 134,46,12288
    MV 220,140,44
    RT 136,47,8192
    RT 138,47,12288
    MV 216,140,40
    global_load_dwordx4 a[116:119], v28, s[8:9] offset:1024 sc1
    s_waitcnt lgkmcnt(8)
    MV 240,144,40
    RT 140,40,16384
    s_add_u32 s59, s58, 4294955008
    MV 244,144,44
    RT 142,40,20480
    v_add_u32 v28, s59, v28
    MV 252,148,44
    RT 144,41,16384
    RT 146,41,20480
    MV 248,148,40
    global_load_dwordx4 a[120:123], v28, s[8:9] offset:0 sc1
    s_waitcnt lgkmcnt(8)
    MV 176,152,40
    RT 148,42,16384
    MV 180,152,44
    RT 150,42,20480
    MV 188,128,44
    RT 152,43,16384
    RT 154,43,20480
    MV 184,128,40
    global_load_dwordx4 a[124:127], v28, s[8:9] offset:1024 sc1
    s_waitcnt lgkmcnt(8)
    MV 192,132,40
    RT 128,44,16384
    v_add_u32 v28, 4096, v28
    MV 196,132,44
    RT 130,44,20480
    s_waitcnt vmcnt(36) lgkmcnt(10)
    s_barrier
    s_add_u32 m0, s26, 49152
    MV 204,136,44
    RT 132,45,16384
    RT 134,45,20480
    MV 200,136,40
    global_load_lds_dwordx4 v2, s[12:13] offset:0
    s_waitcnt vmcnt(35) lgkmcnt(8)
    MV 208,140,48
    RT 136,46,16384
    RT 138,46,20480
    MV 212,140,52
    s_add_u32 s59, s3, 4294770688
    v_add_u32 v2, s59, v2
    global_load_lds_dwordx4 v3, s[12:13] offset:1024
    MV 220,144,52
    RT 140,47,16384
    s_add_u32 s59, s3, 4294770688
    MV 216,144,48
    RT 142,47,20480
    v_add_u32 v3, s59, v3
    s_waitcnt lgkmcnt(8)
    MV 240,148,48
    RT 144,40,24576
    MV 244,148,52
    RT 146,40,28672
    s_add_u32 m0, s26, 57344
    MV 252,152,52
    RT 148,41,24576
    RT 150,41,28672
    MV 248,152,48
    global_load_lds_dwordx4 v2, s[12:13] offset:0
    s_waitcnt lgkmcnt(8)
    MV 176,128,48
    RT 152,42,24576
    v_add_u32 v2, 65536, v2
    MV 180,128,52
    RT 154,42,28672
    MV 188,132,52
    RT 128,43,24576
    RT 130,43,28672
    MV 184,132,48
    global_load_lds_dwordx4 v3, s[12:13] offset:1024
    s_waitcnt lgkmcnt(8)
    MV 192,136,48
    RT 132,44,24576
    v_add_u32 v3, 65536, v3
    MV 196,136,52
    RT 134,44,28672
    MV 204,140,52
    RT 136,45,24576
    RT 138,45,28672
    MV 200,140,48
    global_load_dwordx4 a[0:3], v28, s[8:9] offset:0 sc1
    s_waitcnt vmcnt(37) lgkmcnt(8)
    MV 208,144,56
    RT 140,46,24576
    MV 212,144,60
    RT 142,46,28672
    MV 220,148,60
    RT 144,47,24576
    RT 146,47,28672
    MV 216,148,56
    global_load_dwordx4 a[4:7], v28, s[8:9] offset:1024 sc1
    s_waitcnt lgkmcnt(8)
    MV 240,152,56
    RT 148,40,32768
    v_add_u32 v28, 4096, v28
    MV 244,152,60
    RT 150,40,36864
    MV 252,128,60
    RT 152,41,32768
    RT 154,41,36864
    MV 248,128,56
    global_load_dwordx4 a[8:11], v28, s[8:9] offset:0 sc1
    s_waitcnt lgkmcnt(8)
    MV 176,132,56
    RT 128,42,32768
    MV 180,132,60
    RT 130,42,36864
    MV 188,136,60
    RT 132,43,32768
    RT 134,43,36864
    MV 184,136,56
    global_load_dwordx4 a[12:15], v28, s[8:9] offset:1024 sc1
    s_waitcnt lgkmcnt(8)
    MV 192,140,56
    RT 136,44,32768
    v_add_u32 v28, 4096, v28
    MV 196,140,60
    RT 138,44,36864
    s_waitcnt vmcnt(36) lgkmcnt(10)
    s_barrier
    s_add_u32 m0, s26, 65536
    MV 204,144,60
    RT 140,45,32768
    RT 142,45,36864
    MV 200,144,56
    global_load_lds_dwordx4 v2, s[12:13] offset:0
    s_waitcnt vmcnt(35) lgkmcnt(8)
    MV 208,148,64
    RT 144,46,32768
    RT 146,46,36864
    MV 212,148,68
    v_add_u32 v2, 65536, v2
    global_load_lds_dwordx4 v3, s[12:13] offset:1024
    MV 220,152,68
    RT 148,47,32768
    v_add_u32 v3, 65536, v3
    MV 216,152,64
    RT 150,47,36864
    s_waitcnt lgkmcnt(8)
    MV 240,128,64
    RT 152,40,40960
    MV 244,128,68
    RT 154,40,45056
    s_add_u32 m0, s26, 73728
    MV 252,132,68
    RT 128,41,40960
    RT 130,41,45056
    MV 248,132,64
    global_load_lds_dwordx4 v2, s[12:13] offset:0
    s_waitcnt lgkmcnt(8)
    MV 176,136,64
    RT 132,42,40960
    v_add_u32 v2, 65536, v2
    MV 180,136,68
    RT 134,42,45056
    MV 188,140,68
    RT 136,43,40960
    RT 138,43,45056
    MV 184,140,64
    global_load_lds_dwordx4 v3, s[12:13] offset:1024
    s_waitcnt lgkmcnt(8)
    MV 192,144,64
    RT 140,44,40960
    v_add_u32 v3, 65536, v3
    MV 196,144,68
    RT 142,44,45056
    MV 204,148,68
    RT 144,45,40960
    RT 146,45,45056
    MV 200,148,64
    global_load_dwordx4 a[16:19], v28, s[8:9] offset:0 sc1
    s_waitcnt vmcnt(37) lgkmcnt(8)
    MV 208,152,72
    RT 148,46,40960
    MV 212,152,76
    RT 150,46,45056
    MV 220,128,76
    RT 152,47,40960
    RT 154,47,45056
    MV 216,128,72
    global_load_dwordx4 a[20:23], v28, s[8:9] offset:1024 sc1
    s_waitcnt lgkmcnt(8)
    MV 240,132,72
    RT 128,40,49152
    s_add_u32 s59, s58, 4294955008
    MV 244,132,76
    RT 130,40,53248
    v_add_u32 v28, s59, v28
    MV 252,136,76
    RT 132,41,49152
    RT 134,41,53248
    MV 248,136,72
    global_load_dwordx4 a[24:27], v28, s[8:9] offset:0 sc1
    s_waitcnt lgkmcnt(8)
    MV 176,140,72
    RT 136,42,49152
    MV 180,140,76
    RT 138,42,53248
    MV 188,144,76
    RT 140,43,49152
    RT 142,43,53248
    MV 184,144,72
    global_load_dwordx4 a[28:31], v28, s[8:9] offset:1024 sc1
    s_waitcnt lgkmcnt(8)
    MV 192,148,72
    RT 144,44,49152
    v_add_u32 v28, 4096, v28
    MV 196,148,76
    RT 146,44,53248
    s_waitcnt vmcnt(36) lgkmcnt(10)
    s_barrier
    s_add_u32 m0, s26, 81920
    MV 204,152,76
    RT 148,45,49152
    RT 150,45,53248
    MV 200,152,72
    global_load_lds_dwordx4 v2, s[12:13] offset:0
    s_waitcnt vmcnt(35) lgkmcnt(8)
    MV 208,128,80
    RT 152,46,49152
    RT 154,46,53248
    MV 212,128,84
    s_add_u32 s59, s3, 4294770688
    v_add_u32 v2, s59, v2
    global_load_lds_dwordx4 v3, s[12:13] offset:1024
    MV 220,132,84
    RT 128,47,49152
    s_add_u32 s59, s3, 4294770688
    MV 216,132,80
    RT 130,47,53248
    v_add_u32 v3, s59, v3
    s_waitcnt lgkmcnt(8)
    MV 240,136,80
    RT 132,40,57344
    MV 244,136,84
    RT 134,40,61440
    s_add_u32 m0, s26, 90112
    MV 252,140,84
    RT 136,41,57344
    RT 138,41,61440
    MV 248,140,80
    global_load_lds_dwordx4 v2, s[12:13] offset:0
    s_waitcnt lgkmcnt(8)
    MV 176,144,80
    RT 140,42,57344
    v_add_u32 v2, 65536, v2
    MV 180,144,84
    RT 142,42,61440
    MV 188,148,84
    RT 144,43,57344
    RT 146,43,61440
    MV 184,148,80
    global_load_lds_dwordx4 v3, s[12:13] offset:1024
    s_waitcnt lgkmcnt(8)
    MV 192,152,80
    RT 148,44,57344
    v_add_u32 v3, 65536, v3
    MV 196,152,84
    RT 150,44,61440
    MV 204,128,84
    RT 152,45,57344
    RT 154,45,61440
    MV 200,128,80
    global_load_dwordx4 a[32:35], v28, s[8:9] offset:0 sc1
    s_waitcnt vmcnt(37) lgkmcnt(8)
    MV 208,132,88
    RT 128,46,57344
    MV 212,132,92
    RT 130,46,61440
    MV 220,136,92
    RT 132,47,57344
    RT 134,47,61440
    MV 216,136,88
    global_load_dwordx4 a[36:39], v28, s[8:9] offset:1024 sc1
    s_waitcnt lgkmcnt(8)
    MV 240,140,88
    RT 136,32,0
    v_add_u32 v28, 4096, v28
    MV 244,140,92
    RT 138,32,4096
    MV 252,144,92
    RT 140,33,0
    RT 142,33,4096
    MV 248,144,88
    global_load_dwordx4 a[40:43], v28, s[8:9] offset:0 sc1
    s_waitcnt lgkmcnt(8)
    MV 176,148,88
    RT 144,34,0
    MV 180,148,92
    RT 146,34,4096
    MV 188,152,92
    RT 148,35,0
    RT 150,35,4096
    MV 184,152,88
    global_load_dwordx4 a[44:47], v28, s[8:9] offset:1024 sc1
    s_waitcnt lgkmcnt(8)
    MV 192,128,88
    RT 152,36,0
    v_add_u32 v28, 4096, v28
    MV 196,128,92
    RT 154,36,4096
    s_waitcnt vmcnt(36) lgkmcnt(10)
    s_barrier
    s_add_u32 m0, s26, 98304
    MV 204,132,92
    RT 128,37,0
    RT 130,37,4096
    MV 200,132,88
    global_load_lds_dwordx4 v2, s[12:13] offset:0
    s_waitcnt vmcnt(35) lgkmcnt(8)
    MV 208,136,96
    RT 132,38,0
    RT 134,38,4096
    MV 212,136,100
    v_add_u32 v2, 65536, v2
    global_load_lds_dwordx4 v3, s[12:13] offset:1024
    MV 220,140,100
    RT 136,39,0
    v_add_u32 v3, 65536, v3
    MV 216,140,96
    RT 138,39,4096
    s_waitcnt lgkmcnt(8)
    MV 240,144,96
    RT 140,32,8192
    MV 244,144,100
    RT 142,32,12288
    s_add_u32 m0, s26, 106496
    MV 252,148,100
    RT 144,33,8192
    RT 146,33,12288
    MV 248,148,96
    global_load_lds_dwordx4 v2, s[12:13] offset:0
    s_waitcnt lgkmcnt(8)
    MV 176,152,96
    RT 148,34,8192
    v_add_u32 v2, 65536, v2
    MV 180,152,100
    RT 150,34,12288
    MV 188,128,100
    RT 152,35,8192
    RT 154,35,12288
    MV 184,128,96
    global_load_lds_dwordx4 v3, s[12:13] offset:1024
    s_waitcnt lgkmcnt(8)
    MV 192,132,96
    RT 128,36,8192
    v_add_u32 v3, 65536, v3
    MV 196,132,100
    RT 130,36,12288
    MV 204,136,100
    RT 132,37,8192
    RT 134,37,12288
    MV 200,136,96
    global_load_dwordx4 a[48:51], v28, s[8:9] offset:0 sc1
    s_waitcnt vmcnt(37) lgkmcnt(8)
    MV 208,140,104
    RT 136,38,8192
    MV 212,140,108
    RT 138,38,12288
    MV 220,144,108
    RT 140,39,8192
    RT 142,39,12288
    MV 216,144,104
    global_load_dwordx4 a[52:55], v28, s[8:9] offset:1024 sc1
    s_waitcnt lgkmcnt(8)
    MV 240,148,104
    RT 144,32,16384
    s_add_u32 s59, s58, 4294955008
    MV 244,148,108
    RT 146,32,20480
    v_add_u32 v28, s59, v28
    MV 252,152,108
    RT 148,33,16384
    RT 150,33,20480
    MV 248,152,104
    global_load_dwordx4 a[56:59], v28, s[8:9] offset:0 sc1
    s_waitcnt lgkmcnt(8)
    MV 176,128,104
    RT 152,34,16384
    MV 180,128,108
    RT 154,34,20480
    MV 188,132,108
    RT 128,35,16384
    RT 130,35,20480
    MV 184,132,104
    global_load_dwordx4 a[60:63], v28, s[8:9] offset:1024 sc1
    s_waitcnt lgkmcnt(8)
    MV 192,136,104
    RT 132,36,16384
    v_add_u32 v28, 4096, v28
    MV 196,136,108
    RT 134,36,20480
    s_waitcnt vmcnt(36) lgkmcnt(10)
    s_barrier
    s_add_u32 m0, s26, 114688
    MV 204,140,108
    RT 136,37,16384
    RT 138,37,20480
    MV 200,140,104
    global_load_lds_dwordx4 v2, s[12:13] offset:0
    s_waitcnt vmcnt(35) lgkmcnt(8)
    MV 208,144,112
    RT 140,38,16384
    RT 142,38,20480
    MV 212,144,116
    s_add_u32 s59, s3, 4294770688
    v_add_u32 v2, s59, v2
    global_load_lds_dwordx4 v3, s[12:13] offset:1024
    MV 220,148,116
    RT 144,39,16384
    s_add_u32 s59, s3, 4294770688
    MV 216,148,112
    RT 146,39,20480
    v_add_u32 v3, s59, v3
    s_waitcnt lgkmcnt(8)
    MV 240,152,112
    RT 148,32,24576
    MV 244,152,116
    RT 150,32,28672
    s_add_u32 m0, s26, 122880
    MV 252,128,116
    RT 152,33,24576
    RT 154,33,28672
    MV 248,128,112
    global_load_lds_dwordx4 v2, s[12:13] offset:0
    s_waitcnt lgkmcnt(8)
    MV 176,132,112
    RT 128,34,24576
    v_add_u32 v2, 65536, v2
    MV 180,132,116
    RT 130,34,28672
    MV 188,136,116
    RT 132,35,24576
    RT 134,35,28672
    MV 184,136,112
    global_load_lds_dwordx4 v3, s[12:13] offset:1024
    s_waitcnt lgkmcnt(8)
    MV 192,140,112
    RT 136,36,24576
    v_add_u32 v3, 65536, v3
    MV 196,140,116
    RT 138,36,28672
    MV 204,144,116
    RT 140,37,24576
    RT 142,37,28672
    MV 200,144,112
    global_load_dwordx4 a[64:67], v28, s[8:9] offset:0 sc1
    s_waitcnt vmcnt(37) lgkmcnt(8)
    MV 208,148,120
    RT 144,38,24576
    MV 212,148,124
    RT 146,38,28672
    MV 220,152,124
    RT 148,39,24576
    RT 150,39,28672
    MV 216,152,120
    global_load_dwordx4 a[68:71], v28, s[8:9] offset:1024 sc1
    buffer_load_dword v22, v20, s[8:11], s66 offen sc1
    s_waitcnt lgkmcnt(8)
    MV 240,128,120
    RT 152,32,32768
    v_add_u32 v28, 4096, v28
    MV 244,128,124
    RT 154,32,36864
    MV 252,132,124
    RT 128,33,32768
    RT 130,33,36864
    MV 248,132,120
    global_load_dwordx4 a[72:75], v28, s[8:9] offset:0 sc1
    s_waitcnt lgkmcnt(8)
    MV 176,136,120
    RT 132,34,32768
    MV 180,136,124
    RT 134,34,36864
    MV 188,140,124
    RT 136,35,32768
    RT 138,35,36864
    MV 184,140,120
    global_load_dwordx4 a[76:79], v28, s[8:9] offset:1024 sc1
    s_waitcnt lgkmcnt(8)
    MV 192,144,120
    RT 140,36,32768
    v_add_u32 v28, 4096, v28
    MV 196,144,124
    RT 142,36,36864
    s_waitcnt vmcnt(37) lgkmcnt(10)
    s_barrier
    s_add_u32 m0, s26, 0
    MV 204,148,124
    RT 144,37,32768
    RT 146,37,36864
    MV 200,148,120
    global_load_lds_dwordx4 v2, s[12:13] offset:0
    s_waitcnt vmcnt(36) lgkmcnt(8)
    MV 208,152,0
    RT 148,38,32768
    RT 150,38,36864
    MV 212,152,4
    v_add_u32 v2, 65536, v2
    global_load_lds_dwordx4 v3, s[12:13] offset:1024
    MV 220,128,4
    RT 152,39,32768
    v_add_u32 v3, 65536, v3
    MV 216,128,0
    RT 154,39,36864
    s_waitcnt lgkmcnt(8)
    MV 240,132,0
    RT 128,32,40960
    MV 244,132,4
    RT 130,32,45056
    s_add_u32 m0, s26, 8192
    MV 252,136,4
    RT 132,33,40960
    RT 134,33,45056
    MV 248,136,0
    global_load_lds_dwordx4 v2, s[12:13] offset:0
    s_waitcnt lgkmcnt(8)
    MV 176,140,0
    RT 136,34,40960
    MV 180,140,4
    RT 138,34,45056
    MV 188,144,4
    RT 140,35,40960
    RT 142,35,45056
    MV 184,144,0
    global_load_lds_dwordx4 v3, s[12:13] offset:1024
    s_waitcnt lgkmcnt(8)
    MV 192,148,0
    RT 144,36,40960
    MV 196,148,4
    RT 146,36,45056
    MV 204,152,4
    RT 148,37,40960
    RT 150,37,45056
    MV 200,152,0
    global_load_dwordx4 a[80:83], v28, s[8:9] offset:0 sc1
    s_waitcnt vmcnt(38) lgkmcnt(8)
    MV 208,128,8
    RT 152,38,40960
    MV 212,128,12
    RT 154,38,45056
    MV 220,132,12
    RT 128,39,40960
    RT 130,39,45056
    MV 216,132,8
    global_load_dwordx4 a[84:87], v28, s[8:9] offset:1024 sc1
    s_waitcnt lgkmcnt(8)
    MV 240,136,8
    RT 132,32,49152
    s_add_u32 s59, s58, 4294955008
    MV 244,136,12
    RT 134,32,53248
    v_add_u32 v28, s59, v28
    MV 252,140,12
    RT 136,33,49152
    RT 138,33,53248
    MV 248,140,8
    global_load_dwordx4 a[88:91], v28, s[8:9] offset:0 sc1
    s_waitcnt lgkmcnt(8)
    MV 176,144,8
    RT 140,34,49152
    MV 180,144,12
    RT 142,34,53248
    MV 188,148,12
    RT 144,35,49152
    RT 146,35,53248
    MV 184,148,8
    global_load_dwordx4 a[92:95], v28, s[8:9] offset:1024 sc1
    s_waitcnt lgkmcnt(8)
    MV 192,152,8
    RT 148,36,49152
    v_add_u32 v28, 4096, v28
    MV 196,152,12
    RT 150,36,53248
    s_waitcnt vmcnt(37) lgkmcnt(10)
    s_barrier
    s_add_u32 m0, s48, 16384
    MV 204,128,12
    RT 152,37,49152
    RT 154,37,53248
    MV 200,128,8
    s_add_u32 s41, s48, 16384
    global_load_lds_dwordx4 v6, s[16:17] offset:0
    s_waitcnt vmcnt(36) lgkmcnt(8)
    MV 208,132,16
    RT 128,38,49152
    RT 130,38,53248
    MV 212,132,20
    v_add_u32 v6, 262144, v6
    global_load_lds_dwordx4 v7, s[16:17] offset:1024
    MV 220,136,20
    RT 132,39,49152
    RT 134,39,53248
    MV 216,136,16
    v_add_u32 v7, 262144, v7
    global_load_lds_dwordx4 v8, s[16:17] offset:2048
    s_waitcnt lgkmcnt(8)
    MV 240,140,16
    RT 136,32,57344
    RT 138,32,61440
    MV 244,140,20
    v_add_u32 v8, 262144, v8
    global_load_lds_dwordx4 v9, s[16:17] offset:3072
    MV 252,144,20
    RT 140,33,57344
    RT 142,33,61440
    MV 248,144,16
    v_add_u32 v9, 262144, v9
    global_load_dwordx4 a[96:99], v28, s[8:9] offset:0 sc1
    s_waitcnt lgkmcnt(8)
    MV 176,148,16
    RT 144,34,57344
    RT 146,34,61440
    MV 180,148,20
    global_load_dwordx4 a[100:103], v28, s[8:9] offset:1024 sc1
    s_add_u32 m0, s48, 32768
    MV 188,152,20
    RT 148,35,57344
    RT 150,35,61440
    MV 184,152,16
    v_add_u32 v28, 4096, v28
    s_add_u32 s41, s48, 32768
    global_load_lds_dwordx4 v6, s[16:17] offset:0
    s_waitcnt lgkmcnt(8)
    MV 192,128,16
    RT 152,36,57344
    RT 154,36,61440
    MV 196,128,20
    v_add_u32 v6, 262144, v6
    global_load_lds_dwordx4 v7, s[16:17] offset:1024
    MV 204,132,20
    RT 128,37,57344
    RT 130,37,61440
    MV 200,132,16
    v_add_u32 v7, 262144, v7
    global_load_lds_dwordx4 v8, s[16:17] offset:2048
    s_waitcnt vmcnt(42) lgkmcnt(8)
    MV 208,136,24
    RT 132,38,57344
    RT 134,38,61440
    MV 212,136,28
    v_add_u32 v8, 262144, v8
    global_load_dwordx4 a[104:107], v28, s[8:9] offset:0 sc1
    MV 220,140,28
    RT 136,39,57344
    RT 138,39,61440
    MV 216,140,24
    global_load_dwordx4 a[108:111], v28, s[8:9] offset:1024 sc1
    s_waitcnt lgkmcnt(8)
    MV 240,144,24
    RT 140,40,0
    RT 142,40,4096
    MV 244,144,28
    v_add_u32 v28, s42, v1
    global_load_lds_dwordx4 v9, s[16:17] offset:3072
    MV 252,148,28
    RT 144,41,0
    RT 146,41,4096
    MV 248,148,24
    v_add_u32 v9, 262144, v9
    s_waitcnt vmcnt(22)
    v_cmp_gt_u32 vcc, 1, v22
    s_nop 0
    s_cbranch_vccnz L_slow_h_3
L_back_h_3:
    global_load_dwordx4 a[112:115], v28, s[8:9] offset:0 sc1
    s_waitcnt lgkmcnt(8)
    MV 176,152,24
    RT 148,42,0
    RT 150,42,4096
    MV 180,152,28
    global_load_dwordx4 a[116:119], v28, s[8:9] offset:1024 sc1
    MV 188,128,28
    RT 152,43,0
    RT 154,43,4096
    MV 184,128,24
    v_add_u32 v28, 0x1000, v28
    global_load_dwordx4 a[120:123], v28, s[8:9] offset:0 sc1
    s_waitcnt lgkmcnt(8)
    MV 192,132,24
    RT 128,44,0
    RT 130,44,4096
    MV 196,132,28
    global_load_dwordx4 a[124:127], v28, s[8:9] offset:1024 sc1
    s_waitcnt lgkmcnt(10)
    s_barrier
    MV 204,136,28
    RT 132,45,0
    RT 134,45,4096
    MV 200,136,24
    v_add_u32 v28, 0x1000, v28
    global_load_dwordx4 a[0:3], v28, s[8:9] offset:0 sc1
    s_waitcnt lgkmcnt(8)
    MV 208,140,32
    RT 136,46,0
    RT 138,46,4096
    MV 212,140,36
    global_load_dwordx4 a[4:7], v28, s[8:9] offset:1024 sc1
    MV 220,144,36
    RT 140,47,0
    RT 142,47,4096
    MV 216,144,32
    v_add_u32 v28, 0x1000, v28
    global_load_dwordx4 a[8:11], v28, s[8:9] offset:0 sc1
    s_waitcnt lgkmcnt(8)
    MV 240,148,32
    RT 144,40,8192
    RT 146,40,12288
    MV 244,148,36
    global_load_dwordx4 a[12:15], v28, s[8:9] offset:1024 sc1
    s_add_u32 m0, s48, 49152
    MV 252,152,36
    RT 148,41,8192
    RT 150,41,12288
    MV 248,152,32
    v_add_u32 v28, 0x1000, v28
    s_add_u32 s41, s48, 49152
    global_load_lds_dwordx4 v6, s[16:17] offset:0
    s_waitcnt lgkmcnt(8)
    MV 176,128,32
    RT 152,42,8192
    RT 154,42,12288
    MV 180,128,36
    v_add_u32 v6, 262144, v6
    global_load_lds_dwordx4 v7, s[16:17] offset:1024
    MV 188,132,36
    RT 128,43,8192
    RT 130,43,12288
    MV 184,132,32
    v_add_u32 v7, 262144, v7
    global_load_lds_dwordx4 v8, s[16:17] offset:2048
    s_waitcnt lgkmcnt(8)
    MV 192,136,32
    RT 132,44,8192
    RT 134,44,12288
    MV 196,136,36
    v_add_u32 v8, 262144, v8
    global_load_lds_dwordx4 v9, s[16:17] offset:3072
    MV 204,140,36
    RT 136,45,8192
    RT 138,45,12288
    MV 200,140,32
    v_add_u32 v9, 262144, v9
    global_load_dwordx4 a[16:19], v28, s[8:9] offset:0 sc1
    s_waitcnt lgkmcnt(8)
    MV 208,144,40
    RT 140,46,8192
    RT 142,46,12288
    MV 212,144,44
    global_load_dwordx4 a[20:23], v28, s[8:9] offset:1024 sc1
    MV 220,148,44
    RT 144,47,8192
    RT 146,47,12288
    MV 216,148,40
    v_add_u32 v28, 0x1000, v28
    global_load_dwordx4 a[24:27], v28, s[8:9] offset:0 sc1
    s_waitcnt lgkmcnt(8)
    MV 240,152,40
    RT 148,40,16384
    RT 150,40,20480
    MV 244,152,44
    global_load_dwordx4 a[28:31], v28, s[8:9] offset:1024 sc1
    MV 252,128,44
    RT 152,41,16384
    RT 154,41,20480
    MV 248,128,40
    v_add_u32 v28, 0x1000, v28
    global_load_dwordx4 a[32:35], v28, s[8:9] offset:0 sc1
    s_waitcnt lgkmcnt(8)
    MV 176,132,40
    RT 128,42,16384
    RT 130,42,20480
    MV 180,132,44
    global_load_dwordx4 a[36:39], v28, s[8:9] offset:1024 sc1
    MV 188,136,44
    RT 132,43,16384
    v_add_u32 v28, 0x1000, v28
    MV 184,136,40
    RT 134,43,20480
    s_waitcnt lgkmcnt(8)
    MV 192,140,40
    RT 136,44,16384
    MV 196,140,44
    RT 138,44,20480
    s_waitcnt lgkmcnt(10)
    s_barrier
    s_add_u32 m0, s48, 65536
    MV 204,144,44
    RT 140,45,16384
    RT 142,45,20480
    MV 200,144,40
    s_add_u32 s41, s48, 65536
    global_load_lds_dwordx4 v6, s[16:17] offset:0
    s_waitcnt lgkmcnt(8)
    MV 208,148,48
    RT 144,46,16384
    RT 146,46,20480
    MV 212,148,52
    v_add_u32 v6, 262144, v6
    global_load_dwordx4 a[40:43], v28, s[8:9] offset:0 sc1
    MV 220,152,52
    RT 148,47,16384
    RT 150,47,20480
    MV 216,152,48
    global_load_dwordx4 a[44:47], v28, s[8:9] offset:1024 sc1
    s_waitcnt lgkmcnt(8)
    MV 240,128,48
    RT 152,40,24576
    RT 154,40,28672
    MV 244,128,52
    v_add_u32 v28, 0x1000, v28
    global_load_lds_dwordx4 v7, s[16:17] offset:1024
    MV 252,132,52
    RT 128,41,24576
    RT 130,41,28672
    MV 248,132,48
    v_add_u32 v7, 262144, v7
    global_load_lds_dwordx4 v8, s[16:17] offset:2048
    s_waitcnt lgkmcnt(8)
    MV 176,136,48
    RT 132,42,24576
    RT 134,42,28672
    MV 180,136,52
    v_add_u32 v8, 262144, v8
    global_load_lds_dwordx4 v9, s[16:17] offset:3072
    MV 188,140,52
    RT 136,43,24576
    v_add_u32 v9, 262144, v9
    MV 184,140,48
    RT 138,43,28672
    s_waitcnt lgkmcnt(8)
    MV 192,144,48
    RT 140,44,24576
    MV 196,144,52
    RT 142,44,28672
    MV 204,148,52
    RT 144,45,24576
    MV 200,148,48
    RT 146,45,28672
    s_waitcnt lgkmcnt(8)
    MV 208,152,56
    RT 148,46,24576
    RT 150,46,28672
    MV 212,152,60
    global_load_dwordx4 a[48:51], v28, s[8:9] offset:0 sc1
    MV 220,128,60
    RT 152,47,24576
    RT 154,47,28672
    MV 216,128,56
    global_load_dwordx4 a[52:55], v28, s[8:9] offset:1024 sc1
    s_waitcnt lgkmcnt(8)
    MV 240,132,56
    RT 128,40,32768
    v_add_u32 v28, 0x1000, v28
    MV 244,132,60
    RT 130,40,36864
    MV 252,136,60
    RT 132,41,32768
    MV 248,136,56
    RT 134,41,36864
    s_waitcnt lgkmcnt(8)
    MV 176,140,56
    RT 136,42,32768
    MV 180,140,60
    RT 138,42,36864
    MV 188,144,60
    RT 140,43,32768
    MV 184,144,56
    RT 142,43,36864
    s_waitcnt lgkmcnt(8)
    MV 192,148,56
    RT 144,44,32768
    MV 196,148,60
    RT 146,44,36864
    s_waitcnt lgkmcnt(10)
    s_barrier
    s_add_u32 m0, s48, 81920
    MV 204,152,60
    RT 148,45,32768
    RT 150,45,36864
    MV 200,152,56
    s_add_u32 s41, s48, 81920
    global_load_lds_dwordx4 v6, s[16:17] offset:0
    s_waitcnt lgkmcnt(8)
    MV 208,128,64
    RT 152,46,32768
    RT 154,46,36864
    MV 212,128,68
    v_add_u32 v6, 262144, v6
    global_load_dwordx4 a[56:59], v28, s[8:9] offset:0 sc1
    MV 220,132,68
    RT 128,47,32768
    RT 130,47,36864
    MV 216,132,64
    global_load_dwordx4 a[60:63], v28, s[8:9] offset:1024 sc1
    s_waitcnt lgkmcnt(8)
    MV 240,136,64
    RT 132,40,40960
    RT 134,40,45056
    MV 244,136,68
    v_add_u32 v28, 0x1000, v28
    global_load_lds_dwordx4 v7, s[16:17] offset:1024
    MV 252,140,68
    RT 136,41,40960
    RT 138,41,45056
    MV 248,140,64
    v_add_u32 v7, 262144, v7
    global_load_lds_dwordx4 v8, s[16:17] offset:2048
    s_waitcnt lgkmcnt(8)
    MV 176,144,64
    RT 140,42,40960
    v_add_u32 v8, 262144, v8
    MV 180,144,68
    RT 142,42,45056
    MV 188,148,68
    RT 144,43,40960
    MV 184,148,64
    RT 146,43,45056
    s_waitcnt lgkmcnt(8)
    MV 192,152,64
    RT 148,44,40960
    MV 196,152,68
    RT 150,44,45056
    MV 204,128,68
    RT 152,45,40960
    MV 200,128,64
    RT 154,45,45056
    s_waitcnt vmcnt(51) lgkmcnt(8)
    MV 208,132,72
    RT 128,46,40960
    RT 130,46,45056
    MV 212,132,76
    global_load_dwordx4 a[64:67], v28, s[8:9] offset:0 sc1
    MV 220,136,76
    RT 132,47,40960
    RT 134,47,45056
    MV 216,136,72
    global_load_dwordx4 a[68:71], v28, s[8:9] offset:1024 sc1
    s_waitcnt lgkmcnt(8)
    MV 240,140,72
    RT 136,40,49152
    v_add_u32 v28, 0x1000, v28
    MV 244,140,76
    RT 138,40,53248
    MV 252,144,76
    RT 140,41,49152
    MV 248,144,72
    RT 142,41,53248
    s_waitcnt lgkmcnt(8)
    MV 176,148,72
    RT 144,42,49152
    MV 180,148,76
    RT 146,42,53248
    MV 188,152,76
    RT 148,43,49152
    MV 184,152,72
    RT 150,43,53248
    s_waitcnt lgkmcnt(8)
    MV 192,128,72
    RT 152,44,49152
    MV 196,128,76
    RT 154,44,53248
    s_waitcnt vmcnt(49) lgkmcnt(10)
    s_barrier
    MV 204,132,76
    RT 128,45,49152
    RT 130,45,53248
    MV 200,132,72
    global_load_lds_dwordx4 v9, s[16:17] offset:3072
    s_waitcnt vmcnt(48) lgkmcnt(8)
    MV 208,136,80
    RT 132,46,49152
    RT 134,46,53248
    MV 212,136,84
    v_add_u32 v9, 262144, v9
    global_load_dwordx4 a[72:75], v28, s[8:9] offset:0 sc1
    MV 220,140,84
    RT 136,47,49152
    RT 138,47,53248
    MV 216,140,80
    global_load_dwordx4 a[76:79], v28, s[8:9] offset:1024 sc1
    s_waitcnt lgkmcnt(8)
    s_add_u32 m0, s48, 98304
    MV 240,144,80
    RT 140,40,57344
    RT 142,40,61440
    MV 244,144,84
    v_add_u32 v28, 0x1000, v28
    s_add_u32 s41, s48, 98304
    global_load_lds_dwordx4 v6, s[16:17] offset:0
    MV 252,148,84
    RT 144,41,57344
    RT 146,41,61440
    MV 248,148,80
    v_add_u32 v6, 262144, v6
    global_load_lds_dwordx4 v7, s[16:17] offset:1024
    s_waitcnt lgkmcnt(8)
    MV 176,152,80
    RT 148,42,57344
    RT 150,42,61440
    MV 180,152,84
    v_add_u32 v7, 262144, v7
    global_load_lds_dwordx4 v8, s[16:17] offset:2048
    MV 188,128,84
    RT 152,43,57344
    v_add_u32 v8, 262144, v8
    MV 184,128,80
    RT 154,43,61440
    s_waitcnt lgkmcnt(8)
    MV 192,132,80
    RT 128,44,57344
    MV 196,132,84
    RT 130,44,61440
    MV 204,136,84
    RT 132,45,57344
    MV 200,136,80
    RT 134,45,61440
    s_waitcnt vmcnt(51) lgkmcnt(8)
    MV 208,140,88
    RT 136,46,57344
    RT 138,46,61440
    MV 212,140,92
    global_load_dwordx4 a[80:83], v28, s[8:9] offset:0 sc1
    MV 220,144,92
    RT 140,47,57344
    RT 142,47,61440
    MV 216,144,88
    global_load_dwordx4 a[84:87], v28, s[8:9] offset:1024 sc1
    s_waitcnt lgkmcnt(8)
    MV 240,148,88
    RT 144,32,0
    v_add_u32 v28, 0x1000, v28
    MV 244,148,92
    RT 146,32,4096
    MV 252,152,92
    RT 148,33,0
    MV 248,152,88
    RT 150,33,4096
    s_waitcnt lgkmcnt(8)
    MV 176,128,88
    RT 152,34,0
    MV 180,128,92
    RT 154,34,4096
    MV 188,132,92
    RT 128,35,0
    MV 184,132,88
    RT 130,35,4096
    s_waitcnt lgkmcnt(8)
    MV 192,136,88
    RT 132,36,0
    MV 196,136,92
    RT 134,36,4096
    s_waitcnt vmcnt(49) lgkmcnt(10)
    s_barrier
    MV 204,140,92
    RT 136,37,0
    RT 138,37,4096
    MV 200,140,88
    global_load_lds_dwordx4 v9, s[16:17] offset:3072
    s_waitcnt vmcnt(48) lgkmcnt(8)
    MV 208,144,96
    RT 140,38,0
    RT 142,38,4096
    MV 212,144,100
    v_add_u32 v9, 262144, v9
    global_load_dwordx4 a[88:91], v28, s[8:9] offset:0 sc1
    MV 220,148,100
    RT 144,39,0
    RT 146,39,4096
    MV 216,148,96
    global_load_dwordx4 a[92:95], v28, s[8:9] offset:1024 sc1
    s_waitcnt lgkmcnt(8)
    s_add_u32 m0, s48, 114688
    MV 240,152,96
    RT 148,32,8192
    RT 150,32,12288
    MV 244,152,100
    v_add_u32 v28, 0x1000, v28
    s_add_u32 s41, s48, 114688
    global_load_lds_dwordx4 v6, s[16:17] offset:0
    MV 252,128,100
    RT 152,33,8192
    RT 154,33,12288
    MV 248,128,96
    v_add_u32 v6, 262144, v6
    global_load_lds_dwordx4 v7, s[16:17] offset:1024
    s_waitcnt lgkmcnt(8)
    MV 176,132,96
    RT 128,34,8192
    RT 130,34,12288
    MV 180,132,100
    v_add_u32 v7, 262144, v7
    global_load_lds_dwordx4 v8, s[16:17] offset:2048
    MV 188,136,100
    RT 132,35,8192
    v_add_u32 v8, 262144, v8
    MV 184,136,96
    RT 134,35,12288
    s_waitcnt lgkmcnt(8)
    MV 192,140,96
    RT 136,36,8192
    MV 196,140,100
    RT 138,36,12288
    MV 204,144,100
    RT 140,37,8192
    MV 200,144,96
    RT 142,37,12288
    s_waitcnt vmcnt(48) lgkmcnt(8)
    MV 208,148,104
    RT 144,38,8192
    RT 146,38,12288
    MV 212,148,108
    global_load_dwordx4 a[96:99], v28, s[8:9] offset:0 sc1
    MV 220,152,108
    RT 148,39,8192
    RT 150,39,12288
    MV 216,152,104
    global_load_dwordx4 a[100:103], v28, s[8:9] offset:1024 sc1
    s_waitcnt lgkmcnt(8)
    MV 240,128,104
    RT 152,48,16384
    RT 154,48,18432
    MV 244,128,108
    v_add_u32 v28, 0x1000, v28
    global_load_lds_dwordx4 v9, s[16:17] offset:3072
    MV 252,132,108
    RT 128,49,16384
    v_add_u32 v9, 262144, v9
    MV 248,132,104
    RT 130,49,18432
    s_waitcnt lgkmcnt(8)
    MV 176,136,104
    RT 132,50,16384
    MV 180,136,108
    RT 134,50,18432
    MV 188,140,108
    RT 136,51,16384
    MV 184,140,104
    RT 138,51,18432
    s_waitcnt lgkmcnt(8)
    MV 192,144,104
    RT 140,48,20480
    MV 196,144,108
    RT 142,48,22528
    s_waitcnt vmcnt(50) lgkmcnt(10)
    s_barrier
    s_add_u32 m0, s48, 0
    MV 204,148,108
    RT 144,49,20480
    RT 146,49,22528
    MV 200,148,104
    s_add_u32 s41, s48, 0
    global_load_lds_dwordx4 v6, s[16:17] offset:0
    s_waitcnt vmcnt(49) lgkmcnt(8)
    v_mfma_f32_16x16x32_bf16 v[128:131], a[152:155], a[112:115], 0
    RT 148,50,20480
    RT 150,50,22528
    v_mfma_f32_16x16x32_bf16 v[132:135], a[152:155], a[116:119], 0
    v_add_u32 v6, 262144, v6
    global_load_dwordx4 a[104:107], v28, s[8:9] offset:0 sc1
    v_mfma_f32_16x16x32_bf16 v[140:143], a[128:131], a[116:119], 0
    RT 152,51,20480
    v_mfma_f32_16x16x32_bf16 v[136:139], a[128:131], a[112:115], 0
    RT 154,51,22528
    s_waitcnt lgkmcnt(8)
    v_mfma_f32_16x16x32_bf16 v[144:147], a[132:135], a[112:115], 0
    RT 128,48,24576
    RT 130,48,26624
    v_mfma_f32_16x16x32_bf16 v[148:151], a[132:135], a[116:119], 0
    global_load_dwordx4 a[108:111], v28, s[8:9] offset:1024 sc1
    v_cvt_pk_bf16_f32 v208, v208, v209
    v_cvt_pk_bf16_f32 v209, v210, v211
    v_cvt_pk_bf16_f32 v210, v212, v213
    v_cvt_pk_bf16_f32 v211, v214, v215
    v_mfma_f32_16x16x32_bf16 v[156:159], a[136:139], a[116:119], 0
    RT 132,49,24576
    RT 134,49,26624
    v_mfma_f32_16x16x32_bf16 v[152:155], a[136:139], a[112:115], 0
    v_add_u32 v28, 0x1000, v28
    global_load_lds_dwordx4 v7, s[16:17] offset:1024
    buffer_store_dwordx4 v[208:211], v1, s[8:11], s49 offen offset:0 sc1
    s_waitcnt vmcnt(51) lgkmcnt(8)
    MV 128,140,120
    RT 136,50,24576
    v_add_u32 v7, 262144, v7
    MV 132,140,124
    RT 138,50,26624
    v_cvt_pk_bf16_f32 v216, v216, v217
    v_cvt_pk_bf16_f32 v217, v218, v219
    v_cvt_pk_bf16_f32 v218, v220, v221
    v_cvt_pk_bf16_f32 v219, v222, v223
    MV 140,144,124
    RT 140,51,24576
    RT 142,51,26624
    MV 136,144,120
    global_load_dwordx4 a[112:115], v28, s[8:9] offset:0 sc1
    buffer_store_dwordx4 v[216:219], v1, s[8:11], s49 offen offset:1024 sc1
    s_waitcnt lgkmcnt(8)
    MV 144,148,120
    RT 144,48,28672
    MV 148,148,124
    RT 146,48,30720
    v_cvt_pk_bf16_f32 v240, v240, v241
    v_cvt_pk_bf16_f32 v241, v242, v243
    v_cvt_pk_bf16_f32 v242, v244, v245
    v_cvt_pk_bf16_f32 v243, v246, v247
    MV 156,152,124
    RT 148,49,28672
    MV 152,152,120
    RT 150,49,30720
    buffer_store_dwordx4 v[240:243], v1, s[8:11], s49 offen offset:2048 sc1
    s_waitcnt vmcnt(52) lgkmcnt(8)
    MV 128,128,0
    RT 152,50,28672
    RT 154,50,30720
    MV 132,128,4
    global_load_dwordx4 a[116:119], v28, s[8:9] offset:1024 sc1
    v_cvt_pk_bf16_f32 v248, v248, v249
    v_cvt_pk_bf16_f32 v249, v250, v251
    v_cvt_pk_bf16_f32 v250, v252, v253
    v_cvt_pk_bf16_f32 v251, v254, v255
    MV 140,132,4
    RT 128,51,28672
    v_add_u32 v28, 0x1000, v28
    MV 136,132,0
    RT 130,51,30720
    buffer_store_dwordx4 v[248:251], v1, s[8:11], s49 offen offset:3072 sc1
    s_waitcnt lgkmcnt(8)
    MV 144,136,0
    RT 132,48,32768
    MV 148,136,4
    RT 134,48,34816
    MV 156,140,4
    RT 136,49,32768
    MV 152,140,0
    RT 138,49,34816
    s_waitcnt vmcnt(52) lgkmcnt(8)
    MV 128,144,8
    RT 140,50,32768
    RT 142,50,34816
    MV 132,144,12
    global_load_dwordx4 a[120:123], v28, s[8:9] offset:0 sc1
    MV 140,148,12
    RT 144,51,32768
    MV 136,148,8
    RT 146,51,34816
    s_waitcnt lgkmcnt(8)
    MV 144,152,8
    RT 148,48,36864
    MV 148,152,12
    RT 150,48,38912
    s_waitcnt vmcnt(49) lgkmcnt(10)
    s_barrier
    MV 156,128,12
    RT 152,49,36864
    RT 154,49,38912
    MV 152,128,8
    global_load_dwordx4 a[124:127], v28, s[8:9] offset:1024 sc1
    s_waitcnt vmcnt(48) lgkmcnt(8)
    MV 128,132,16
    RT 128,50,36864
    RT 130,50,38912
    MV 132,132,20
    v_add_u32 v28, 0x1000, v28
    global_load_dwordx4 a[0:3], v28, s[8:9] offset:0 sc1
    MV 140,136,20
    RT 132,51,36864
    MV 136,136,16
    RT 134,51,38912
    s_waitcnt lgkmcnt(8)
    MV 144,140,16
    RT 136,48,40960
    RT 138,48,43008
    MV 148,140,20
    global_load_dwordx4 a[4:7], v28, s[8:9] offset:1024 sc1
    MV 156,144,20
    RT 140,49,40960
    RT 142,49,43008
    MV 152,144,16
    v_add_u32 v28, 0x1000, v28
    global_load_dwordx4 a[8:11], v28, s[8:9] offset:0 sc1
    s_waitcnt vmcnt(49) lgkmcnt(8)
    MV 128,148,24
    RT 144,50,40960
    MV 132,148,28
    RT 146,50,43008
    MV 140,152,28
    RT 148,51,40960
    RT 150,51,43008
    MV 136,152,24
    global_load_dwordx4 a[12:15], v28, s[8:9] offset:1024 sc1
    s_waitcnt lgkmcnt(8)
    MV 144,128,24
    RT 152,48,45056
    RT 154,48,47104
    MV 148,128,28
    v_add_u32 v28, 0x1000, v28
    global_load_dwordx4 a[16:19], v28, s[8:9] offset:0 sc1
    MV 156,132,28
    RT 128,49,45056
    MV 152,132,24
    RT 130,49,47104
    s_waitcnt vmcnt(49) lgkmcnt(8)
    MV 128,136,32
    RT 132,50,45056
    RT 134,50,47104
    MV 132,136,36
    global_load_dwordx4 a[20:23], v28, s[8:9] offset:1024 sc1
    MV 140,140,36
    RT 136,51,45056
    RT 138,51,47104
    MV 136,140,32
    v_add_u32 v28, 0x1000, v28
    global_load_dwordx4 a[24:27], v28, s[8:9] offset:0 sc1
    s_waitcnt lgkmcnt(8)
    MV 144,144,32
    RT 140,48,49152
    MV 148,144,36
    RT 142,48,51200
    MV 156,148,36
    RT 144,49,49152
    RT 146,49,51200
    MV 152,148,32
    global_load_dwordx4 a[28:31], v28, s[8:9] offset:1024 sc1
    s_waitcnt vmcnt(49) lgkmcnt(8)
    MV 128,152,40
    RT 148,50,49152
    RT 150,50,51200
    MV 132,152,44
    v_add_u32 v28, 0x1000, v28
    global_load_dwordx4 a[32:35], v28, s[8:9] offset:0 sc1
    MV 140,128,44
    RT 152,51,49152
    MV 136,128,40
    RT 154,51,51200
    s_waitcnt lgkmcnt(8)
    MV 144,132,40
    RT 128,48,53248
    RT 130,48,55296
    MV 148,132,44
    global_load_dwordx4 a[36:39], v28, s[8:9] offset:1024 sc1
    s_waitcnt vmcnt(48) lgkmcnt(10)
    s_barrier
    MV 156,136,44
    RT 132,49,53248
    RT 134,49,55296
    MV 152,136,40
    v_add_u32 v28, 0x1000, v28
    global_load_lds_dwordx4 v8, s[16:17] offset:2048
    s_waitcnt vmcnt(47) lgkmcnt(8)
    s_waitcnt vmcnt(13)
    v_mov_b32 v24, 1
    s_mov_b64 exec, 1
    buffer_store_dword v24, v31, s[8:11], s51 offen sc1
    s_mov_b64 exec, -1
    MV 128,140,48
    RT 136,50,53248
    v_add_u32 v8, 262144, v8
    MV 132,140,52
    RT 138,50,55296
    MV 140,144,52
    RT 140,51,53248
    RT 142,51,55296
    MV 136,144,48
    global_load_dwordx4 a[40:43], v28, s[8:9] offset:0 sc1
    s_waitcnt lgkmcnt(8)
    MV 144,148,48
    RT 144,48,57344
    RT 146,48,59392
    MV 148,148,52
    global_load_dwordx4 a[44:47], v28, s[8:9] offset:1024 sc1
    MV 156,152,52
    RT 148,49,57344
    v_add_u32 v28, 0x1000, v28
    MV 152,152,48
    RT 150,49,59392
    s_waitcnt lgkmcnt(8)
    MV 128,128,56
    RT 152,50,57344
    RT 154,50,59392
    MV 132,128,60
    global_load_lds_dwordx4 v9, s[16:17] offset:3072
    MV 140,132,60
    RT 128,51,57344
    RT 130,51,59392
    MV 136,132,56
    v_add_u32 v9, 262144, v9
    global_load_dwordx4 a[48:51], v28, s[8:9] offset:0 sc1
    s_waitcnt lgkmcnt(8)
    MV 144,136,56
    RT 132,48,61440
    MV 148,136,60
    RT 134,48,63488
    MV 156,140,60
    RT 136,49,61440
    RT 138,49,63488
    MV 152,140,56
    global_load_dwordx4 a[52:55], v28, s[8:9] offset:1024 sc1
    s_waitcnt lgkmcnt(8)
    MV 128,144,64
    RT 140,50,61440
    RT 142,50,63488
    MV 132,144,68
    v_add_u32 v28, 0x1000, v28
    global_load_dwordx4 a[56:59], v28, s[8:9] offset:0 sc1
    MV 140,148,68
    RT 144,51,61440
    MV 136,148,64
    RT 146,51,63488
    s_waitcnt lgkmcnt(8)
    MV 144,152,64
    RT 148,52,0
    RT 150,52,2048
    MV 148,152,68
    global_load_dwordx4 a[60:63], v28, s[8:9] offset:1024 sc1
    MV 156,128,68
    RT 152,53,0
    v_add_u32 v28, 0x1000, v28
    MV 152,128,64
    RT 154,53,2048
    s_waitcnt lgkmcnt(8)
    MV 128,132,72
    RT 128,54,0
    RT 130,54,2048
    MV 132,132,76
    global_load_dwordx4 a[64:67], v28, s[8:9] offset:0 sc1
    MV 140,136,76
    RT 132,55,0
    RT 134,55,2048
    MV 136,136,72
    global_load_dwordx4 a[68:71], v28, s[8:9] offset:1024 sc1
    s_waitcnt lgkmcnt(8)
    MV 144,140,72
    RT 136,52,4096
    v_add_u32 v28, 0x1000, v28
    MV 148,140,76
    RT 138,52,6144
    s_waitcnt lgkmcnt(10)
    s_barrier
    MV 156,144,76
    RT 140,53,4096
    MV 152,144,72
    RT 142,53,6144
    s_waitcnt lgkmcnt(8)
    MV 128,148,80
    RT 144,54,4096
    RT 146,54,6144
    MV 132,148,84
    global_load_dwordx4 a[72:75], v28, s[8:9] offset:0 sc1
    MV 140,152,84
    RT 148,55,4096
    RT 150,55,6144
    MV 136,152,80
    global_load_dwordx4 a[76:79], v28, s[8:9] offset:1024 sc1
    s_waitcnt lgkmcnt(8)
    MV 144,128,80
    RT 152,52,8192
    v_add_u32 v28, 0x1000, v28
    MV 148,128,84
    RT 154,52,10240
    MV 156,132,84
    RT 128,53,8192
    MV 152,132,80
    RT 130,53,10240
    s_waitcnt lgkmcnt(8)
    MV 128,136,88
    RT 132,54,8192
    RT 134,54,10240
    MV 132,136,92
    global_load_dwordx4 a[80:83], v28, s[8:9] offset:0 sc1
    MV 140,140,92
    RT 136,55,8192
    RT 138,55,10240
    MV 136,140,88
    global_load_dwordx4 a[84:87], v28, s[8:9] offset:1024 sc1
    s_waitcnt lgkmcnt(8)
    MV 144,144,88
    RT 140,52,12288
    v_add_u32 v28, 0x1000, v28
    MV 148,144,92
    RT 142,52,14336
    MV 156,148,92
    RT 144,53,12288
    MV 152,148,88
    RT 146,53,14336
    s_waitcnt lgkmcnt(8)
    MV 128,152,96
    RT 148,54,12288
    RT 150,54,14336
    MV 132,152,100
    global_load_dwordx4 a[88:91], v28, s[8:9] offset:0 sc1
    s_add_u32 m0, s48, 131072
    s_add_u32 s59, s40, 0
    buffer_load_dwordx4 v18, s[20:23], s59 offen lds
    s_mov_b32 m0, s41
    MV 140,128,100
    RT 152,55,12288
    RT 154,55,14336
    MV 136,128,96
    global_load_dwordx4 a[92:95], v28, s[8:9] offset:1024 sc1
    s_waitcnt lgkmcnt(8)
    MV 144,132,96
    RT 128,52,16384
    v_add_u32 v28, 0x1000, v28
    MV 148,132,100
    RT 130,52,18432
    MV 156,136,100
    RT 132,53,16384
    MV 152,136,96
    RT 134,53,18432
    s_waitcnt lgkmcnt(8)
    MV 128,140,104
    RT 136,54,16384
    RT 138,54,18432
    MV 132,140,108
    global_load_dwordx4 a[96:99], v28, s[8:9] offset:0 sc1
    s_add_u32 m0, s48, 132096
    s_add_u32 s59, s40, 16384
    buffer_load_dwordx4 v18, s[20:23], s59 offen lds
    s_mov_b32 m0, s41
    MV 140,144,108
    RT 140,55,16384
    RT 142,55,18432
    MV 136,144,104
    global_load_dwordx4 a[100:103], v28, s[8:9] offset:1024 sc1
    s_waitcnt lgkmcnt(8)
    MV 144,148,104
    RT 144,52,20480
    v_add_u32 v28, 0x1000, v28
    MV 148,148,108
    RT 146,52,22528
    s_waitcnt lgkmcnt(10)
    s_barrier
    MV 156,152,108
    RT 148,53,20480
    MV 152,152,104
    RT 150,53,22528
    s_waitcnt lgkmcnt(8)
    MV 128,128,112
    RT 152,54,20480
    RT 154,54,22528
    MV 132,128,116
    global_load_dwordx4 a[104:107], v28, s[8:9] offset:0 sc1
    s_add_u32 m0, s48, 133120
    s_add_u32 s59, s40, 32768
    buffer_load_dwordx4 v18, s[20:23], s59 offen lds
    s_mov_b32 m0, s41
    MV 140,132,116
    RT 128,55,20480
    RT 130,55,22528
    MV 136,132,112
    global_load_dwordx4 a[108:111], v28, s[8:9] offset:1024 sc1
    s_waitcnt lgkmcnt(8)
    MV 144,136,112
    RT 132,52,24576
    v_add_u32 v28, 0x1000, v28
    MV 148,136,116
    RT 134,52,26624
    MV 156,140,116
    RT 136,53,24576
    MV 152,140,112
    RT 138,53,26624
    s_waitcnt vmcnt(34) lgkmcnt(8)
    MV 128,144,120
    RT 140,54,24576
    MV 132,144,124
    RT 142,54,26624
    s_add_u32 m0, s48, 134144
    s_add_u32 s59, s40, 49152
    buffer_load_dwordx4 v18, s[20:23], s59 offen lds
    s_mov_b32 m0, s41
    MV 140,148,124
    RT 144,55,24576
    MV 136,148,120
    RT 146,55,26624
    s_waitcnt lgkmcnt(8)
    MV 144,152,120
    RT 148,52,28672
    MV 148,152,124
    RT 150,52,30720
    MV 156,128,124
    RT 152,53,28672
    MV 152,128,120
    RT 154,53,30720
    s_waitcnt vmcnt(33) lgkmcnt(8)
    MV 128,132,0
    RT 128,54,28672
    s_mov_b32 s30, 3216550459
    MV 132,132,4
    RT 130,54,30720
    MV 140,136,4
    RT 132,55,28672
    s_mov_b32 s31, 3216550459
    MV 136,136,0
    RT 134,55,30720
    s_waitcnt lgkmcnt(8)
    MV 144,140,0
    RT 136,52,32768
    v_and_b32 v26, 15, v10
    MV 148,140,4
    RT 138,52,34816
    MV 156,144,4
    RT 140,53,32768
    v_lshrrev_b32 v25, 1, v11
    MV 152,144,0
    RT 142,53,34816
    s_waitcnt vmcnt(31) lgkmcnt(8)
    MV 128,148,8
    RT 144,54,32768
    v_xor_b32 v25, v25, v26
    MV 132,148,12
    RT 146,54,34816
    MV 140,152,12
    RT 148,55,32768
    v_and_b32 v25, 7, v25
    MV 136,152,8
    RT 150,55,34816
    s_waitcnt lgkmcnt(8)
    MV 144,128,8
    RT 152,52,36864
    v_lshlrev_b32 v25, 4, v25
    MV 148,128,12
    RT 154,52,38912
    s_waitcnt lgkmcnt(10)
    s_barrier
    MV 156,132,12
    RT 128,53,36864
    v_lshl_add_u32 v25, v26, 7, v25
    MV 152,132,8
    RT 130,53,38912
    s_waitcnt vmcnt(29) lgkmcnt(8)
    MV 128,136,16
    RT 132,54,36864
    v_and_b32 v26, 1, v11
    MV 132,136,20
    RT 134,54,38912
    MV 140,140,20
    RT 136,55,36864
    v_lshl_add_u32 v25, v26, 3, v25
    MV 136,140,16
    RT 138,55,38912
    s_waitcnt lgkmcnt(8)
    MV 144,144,16
    RT 140,52,40960
    s_add_u32 s59, s48, 131072
    MV 148,144,20
    RT 142,52,43008
    MV 156,148,20
    RT 144,53,40960
    v_add_u32 v2, s59, v25
    MV 152,148,16
    RT 146,53,43008
    s_waitcnt vmcnt(27) lgkmcnt(8)
    buffer_load_dword v23, v31, s[8:11], s54 offen sc1
    MV 128,152,24
    RT 148,54,40960
    v_xor_b32 v3, 32, v2
    MV 132,152,28
    RT 150,54,43008
    MV 140,128,28
    RT 152,55,40960
    v_xor_b32 v4, 64, v2
    MV 136,128,24
    RT 154,55,43008
    s_waitcnt lgkmcnt(8)
    MV 144,132,24
    RT 128,52,45056
    v_xor_b32 v5, 96, v2
    MV 148,132,28
    RT 130,52,47104
    MV 156,136,28
    RT 132,53,45056
    v_lshl_add_u32 v6, v10, 4, s59
    MV 152,136,24
    RT 134,53,47104
    s_waitcnt vmcnt(26) lgkmcnt(8)
    MV 128,140,32
    RT 136,54,45056
    MV 132,140,36
    RT 138,54,47104
    MV 140,144,36
    RT 140,55,45056
    MV 136,144,32
    RT 142,55,47104
    s_waitcnt lgkmcnt(8)
    MV 144,148,32
    RT 144,52,49152
    MV 148,148,36
    RT 146,52,51200
    s_waitcnt vmcnt(1)
    MV 156,152,36
    RT 148,53,49152
    ds_read_b64 v[160:161], v2 offset:0
    MV 152,152,32
    RT 150,53,51200
    s_waitcnt lgkmcnt(8)
    MV 128,128,40
    RT 152,54,49152
    ds_read_b64 v[168:169], v2 offset:2048
    MV 132,128,44
    RT 154,54,51200
    MV 140,132,44
    RT 128,55,49152
    ds_read_b64 v[162:163], v3 offset:0
    MV 136,132,40
    RT 130,55,51200
    s_waitcnt lgkmcnt(8)
    MV 144,136,40
    RT 132,52,53248
    ds_read_b64 v[170:171], v3 offset:2048
    MV 148,136,44
    RT 134,52,55296
    s_waitcnt lgkmcnt(10)
    s_barrier
    MV 156,140,44
    RT 136,53,53248
    ds_read_b64 v[164:165], v4 offset:0
    MV 152,140,40
    RT 138,53,55296
    s_waitcnt lgkmcnt(8)
    s_waitcnt vmcnt(0)
    v_cmp_gt_u32 vcc, 1, v23
    s_nop 0
    s_cbranch_vccnz L_slow_h_4
L_back_h_4:
    buffer_load_dwordx4 v[208:211], v1, s[8:11], s50 offen offset:0 sc1
    buffer_load_dwordx4 v[212:215], v1, s[8:11], s50 offen offset:1024 sc1
    buffer_load_dwordx4 v[216:219], v1, s[8:11], s50 offen offset:2048 sc1
    buffer_load_dwordx4 v[220:223], v1, s[8:11], s50 offen offset:3072 sc1
    MV 128,144,48
    RT 140,54,53248
    ds_read_b64 v[172:173], v4 offset:2048
    MV 132,144,52
    RT 142,54,55296
    MV 140,148,52
    RT 144,55,53248
    ds_read_b64 v[166:167], v5 offset:0
    MV 136,148,48
    RT 146,55,55296
    s_waitcnt lgkmcnt(8)
    MV 144,152,48
    RT 148,52,57344
    ds_read_b64 v[174:175], v5 offset:2048
    MV 148,152,52
    RT 150,52,59392
    MV 156,128,52
    RT 152,53,57344
    MV 152,128,48
    RT 154,53,59392
    s_waitcnt lgkmcnt(8)
    MV 128,132,56
    RT 128,54,57344
    MV 132,132,60
    RT 130,54,59392
    MV 140,136,60
    RT 132,55,57344
    MV 136,136,56
    RT 134,55,59392
    s_waitcnt lgkmcnt(8)
    MV 144,140,56
    RT 136,52,61440
    MV 148,140,60
    RT 138,52,63488
    MV 156,144,60
    RT 140,53,61440
    MV 152,144,56
    RT 142,53,63488
    s_waitcnt lgkmcnt(8)
    MV 128,148,64
    RT 144,54,61440
    MV 132,148,68
    RT 146,54,63488
    MV 140,152,68
    RT 148,55,61440
    MV 136,152,64
    RT 150,55,63488
    s_waitcnt lgkmcnt(8)
    MV 144,128,64
    RT 152,48,0
    MV 148,128,68
    RT 154,48,2048
    MV 156,132,68
    RT 128,49,0
    MV 152,132,64
    RT 130,49,2048
    s_waitcnt lgkmcnt(8)
    MV 128,136,72
    RT 132,50,0
    v_lshlrev_b32 v224, 16, v160
    MV 132,136,76
    RT 134,50,2048
    MV 140,140,76
    RT 136,51,0
    v_and_b32 v225, 0xffff0000, v160
    MV 136,140,72
    RT 138,51,2048
    v_lshlrev_b32 v226, 16, v161
    s_waitcnt lgkmcnt(8)
    MV 144,144,72
    RT 140,48,4096
    v_and_b32 v227, 0xffff0000, v161
    MV 148,144,76
    RT 142,48,6144
    v_lshlrev_b32 v228, 16, v168
    s_barrier
    MV 156,148,76
    RT 144,49,4096
    v_and_b32 v229, 0xffff0000, v168
    MV 152,148,72
    RT 146,49,6144
    v_lshlrev_b32 v230, 16, v169
    s_waitcnt lgkmcnt(8)
    MV 128,152,80
    RT 148,50,4096
    v_and_b32 v231, 0xffff0000, v169
    MV 132,152,84
    RT 150,50,6144
    MV 140,128,84
    RT 152,51,4096
    v_lshlrev_b32 v232, 16, v162
    MV 136,128,80
    RT 154,51,6144
    v_and_b32 v233, 0xffff0000, v162
    s_waitcnt lgkmcnt(8)
    MV 144,132,80
    RT 128,48,8192
    v_lshlrev_b32 v234, 16, v163
    MV 148,132,84
    RT 130,48,10240
    v_and_b32 v235, 0xffff0000, v163
    MV 156,136,84
    RT 132,49,8192
    v_lshlrev_b32 v236, 16, v170
    MV 152,136,80
    RT 134,49,10240
    v_and_b32 v237, 0xffff0000, v170
    s_waitcnt lgkmcnt(8)
    MV 128,140,88
    RT 136,50,8192
    v_lshlrev_b32 v238, 16, v171
    MV 132,140,92
    RT 138,50,10240
    v_and_b32 v239, 0xffff0000, v171
    MV 140,144,92
    RT 140,51,8192
    v_lshlrev_b32 v240, 16, v164
    MV 136,144,88
    RT 142,51,10240
    s_waitcnt lgkmcnt(8)
    MV 144,148,88
    RT 144,48,12288
    v_and_b32 v241, 0xffff0000, v164
    MV 148,148,92
    RT 146,48,14336
    v_lshlrev_b32 v242, 16, v165
    MV 156,152,92
    RT 148,49,12288
    v_and_b32 v243, 0xffff0000, v165
    MV 152,152,88
    RT 150,49,14336
    v_lshlrev_b32 v244, 16, v172
    s_waitcnt lgkmcnt(8)
    MV 128,128,96
    RT 152,50,12288
    v_and_b32 v245, 0xffff0000, v172
    MV 132,128,100
    RT 154,50,14336
    v_lshlrev_b32 v246, 16, v173
    MV 140,132,100
    RT 128,51,12288
    v_and_b32 v247, 0xffff0000, v173
    MV 136,132,96
    RT 130,51,14336
    s_waitcnt lgkmcnt(8)
    MV 144,136,96
    v_lshlrev_b32 v248, 16, v166
    MV 148,136,100
    v_and_b32 v249, 0xffff0000, v166
    MV 156,140,100
    v_lshlrev_b32 v250, 16, v167
    MV 152,140,96
    v_and_b32 v251, 0xffff0000, v167
    s_waitcnt lgkmcnt(4)
    MV 128,144,104
    v_lshlrev_b32 v252, 16, v174
    MV 132,144,108
    v_and_b32 v253, 0xffff0000, v174
    MV 140,148,108
    v_lshlrev_b32 v254, 16, v175
    MV 136,148,104
    v_and_b32 v255, 0xffff0000, v175
    s_waitcnt lgkmcnt(0)
    MV 144,152,104
    MV 148,152,108
    MV 156,128,108
    MV 152,128,104
    s_waitcnt vmcnt(0)
    v_lshlrev_b32 v64, 16, v208
    v_lshlrev_b32 v72, 16, v212
    v_lshlrev_b32 v80, 16, v216
    v_lshlrev_b32 v88, 16, v220
    v_and_b32 v65, 0xffff0000, v208
    v_and_b32 v73, 0xffff0000, v212
    v_and_b32 v81, 0xffff0000, v216
    v_and_b32 v89, 0xffff0000, v220
    v_lshlrev_b32 v66, 16, v209
    v_lshlrev_b32 v74, 16, v213
    v_lshlrev_b32 v82, 16, v217
    v_lshlrev_b32 v90, 16, v221
    v_and_b32 v67, 0xffff0000, v209
    v_and_b32 v75, 0xffff0000, v213
    v_and_b32 v83, 0xffff0000, v217
    v_and_b32 v91, 0xffff0000, v221
    v_pk_add_f32 v[176:177], v[176:177], v[64:65]
    v_pk_add_f32 v[184:185], v[184:185], v[72:73]
    v_pk_add_f32 v[192:193], v[192:193], v[80:81]
    v_pk_add_f32 v[200:201], v[200:201], v[88:89]
    v_pk_add_f32 v[178:179], v[178:179], v[66:67]
    v_pk_add_f32 v[186:187], v[186:187], v[74:75]
    v_pk_add_f32 v[194:195], v[194:195], v[82:83]
    v_pk_add_f32 v[202:203], v[202:203], v[90:91]
    v_pk_mul_f32 v[96:97], v[176:177], s[30:31]
    v_pk_mul_f32 v[104:105], v[184:185], s[30:31]
    v_pk_mul_f32 v[112:113], v[192:193], s[30:31]
    v_pk_mul_f32 v[120:121], v[200:201], s[30:31]
    v_pk_mul_f32 v[98:99], v[178:179], s[30:31]
    v_pk_mul_f32 v[106:107], v[186:187], s[30:31]
    v_pk_mul_f32 v[114:115], v[194:195], s[30:31]
    v_pk_mul_f32 v[122:123], v[202:203], s[30:31]
    v_exp_f32 v96, v96
    v_exp_f32 v104, v104
    v_exp_f32 v112, v112
    v_exp_f32 v120, v120
    v_exp_f32 v97, v97
    v_exp_f32 v105, v105
    v_exp_f32 v113, v113
    v_exp_f32 v121, v121
    v_exp_f32 v98, v98
    v_exp_f32 v106, v106
    v_exp_f32 v114, v114
    v_exp_f32 v122, v122
    v_exp_f32 v99, v99
    v_exp_f32 v107, v107
    v_exp_f32 v115, v115
    v_exp_f32 v123, v123
    v_pk_add_f32 v[96:97], v[96:97], 1.0 op_sel_hi:[1,0]
    v_pk_add_f32 v[104:105], v[104:105], 1.0 op_sel_hi:[1,0]
    v_pk_add_f32 v[112:113], v[112:113], 1.0 op_sel_hi:[1,0]
    v_pk_add_f32 v[120:121], v[120:121], 1.0 op_sel_hi:[1,0]
    v_pk_add_f32 v[98:99], v[98:99], 1.0 op_sel_hi:[1,0]
    v_pk_add_f32 v[106:107], v[106:107], 1.0 op_sel_hi:[1,0]
    v_pk_add_f32 v[114:115], v[114:115], 1.0 op_sel_hi:[1,0]
    v_pk_add_f32 v[122:123], v[122:123], 1.0 op_sel_hi:[1,0]
    v_rcp_f32 v96, v96
    v_rcp_f32 v104, v104
    v_rcp_f32 v112, v112
    v_rcp_f32 v120, v120
    v_rcp_f32 v97, v97
    v_rcp_f32 v105, v105
    v_rcp_f32 v113, v113
    v_rcp_f32 v121, v121
    v_rcp_f32 v98, v98
    v_rcp_f32 v106, v106
    v_rcp_f32 v114, v114
    v_rcp_f32 v122, v122
    v_rcp_f32 v99, v99
    v_rcp_f32 v107, v107
    v_rcp_f32 v115, v115
    v_rcp_f32 v123, v123
    v_pk_mul_f32 v[96:97], v[96:97], v[176:177]
    v_pk_mul_f32 v[104:105], v[104:105], v[184:185]
    v_pk_mul_f32 v[112:113], v[112:113], v[192:193]
    v_pk_mul_f32 v[120:121], v[120:121], v[200:201]
    v_pk_mul_f32 v[98:99], v[98:99], v[178:179]
    v_pk_mul_f32 v[106:107], v[106:107], v[186:187]
    v_pk_mul_f32 v[114:115], v[114:115], v[194:195]
    v_pk_mul_f32 v[122:123], v[122:123], v[202:203]
    v_pk_fma_f32 v[96:97], v[96:97], v[128:129], v[224:225]
    v_pk_fma_f32 v[104:105], v[104:105], v[136:137], v[232:233]
    v_pk_fma_f32 v[112:113], v[112:113], v[144:145], v[240:241]
    v_pk_fma_f32 v[120:121], v[120:121], v[152:153], v[248:249]
    v_pk_fma_f32 v[98:99], v[98:99], v[130:131], v[226:227]
    v_pk_fma_f32 v[106:107], v[106:107], v[138:139], v[234:235]
    v_pk_fma_f32 v[114:115], v[114:115], v[146:147], v[242:243]
    v_pk_fma_f32 v[122:123], v[122:123], v[154:155], v[250:251]
    v_cvt_pk_bf16_f32 v96, v96, v97
    v_cvt_pk_bf16_f32 v104, v104, v105
    v_cvt_pk_bf16_f32 v112, v112, v113
    v_cvt_pk_bf16_f32 v120, v120, v121
    v_cvt_pk_bf16_f32 v97, v98, v99
    v_cvt_pk_bf16_f32 v105, v106, v107
    v_cvt_pk_bf16_f32 v113, v114, v115
    v_cvt_pk_bf16_f32 v121, v122, v123
    ds_write_b64 v2, v[96:97] offset:0
    ds_write_b64 v3, v[104:105] offset:0
    ds_write_b64 v4, v[112:113] offset:0
    ds_write_b64 v5, v[120:121] offset:0
    v_lshlrev_b32 v68, 16, v210
    v_lshlrev_b32 v76, 16, v214
    v_lshlrev_b32 v84, 16, v218
    v_lshlrev_b32 v92, 16, v222
    v_and_b32 v69, 0xffff0000, v210
    v_and_b32 v77, 0xffff0000, v214
    v_and_b32 v85, 0xffff0000, v218
    v_and_b32 v93, 0xffff0000, v222
    s_waitcnt lgkmcnt(0)
    ds_read_b128 v[128:131], v6
    ds_read_b128 v[136:139], v6 offset:1024
    v_lshlrev_b32 v70, 16, v211
    v_lshlrev_b32 v78, 16, v215
    v_lshlrev_b32 v86, 16, v219
    v_lshlrev_b32 v94, 16, v223
    v_and_b32 v71, 0xffff0000, v211
    v_and_b32 v79, 0xffff0000, v215
    v_and_b32 v87, 0xffff0000, v219
    v_and_b32 v95, 0xffff0000, v223
    v_pk_add_f32 v[180:181], v[180:181], v[68:69]
    v_pk_add_f32 v[188:189], v[188:189], v[76:77]
    v_pk_add_f32 v[196:197], v[196:197], v[84:85]
    v_pk_add_f32 v[204:205], v[204:205], v[92:93]
    v_pk_add_f32 v[182:183], v[182:183], v[70:71]
    v_pk_add_f32 v[190:191], v[190:191], v[78:79]
    v_pk_add_f32 v[198:199], v[198:199], v[86:87]
    v_pk_add_f32 v[206:207], v[206:207], v[94:95]
    v_pk_mul_f32 v[100:101], v[180:181], s[30:31]
    v_pk_mul_f32 v[108:109], v[188:189], s[30:31]
    v_pk_mul_f32 v[116:117], v[196:197], s[30:31]
    v_pk_mul_f32 v[124:125], v[204:205], s[30:31]
    v_pk_mul_f32 v[102:103], v[182:183], s[30:31]
    v_pk_mul_f32 v[110:111], v[190:191], s[30:31]
    v_pk_mul_f32 v[118:119], v[198:199], s[30:31]
    v_pk_mul_f32 v[126:127], v[206:207], s[30:31]
    v_exp_f32 v100, v100
    v_exp_f32 v108, v108
    v_exp_f32 v116, v116
    v_exp_f32 v124, v124
    v_exp_f32 v101, v101
    v_exp_f32 v109, v109
    v_exp_f32 v117, v117
    v_exp_f32 v125, v125
    s_waitcnt lgkmcnt(0)
    buffer_store_dwordx4 v[128:131], v18, s[44:47], s40 offen
    s_add_u32 s40, s40, 16384
    buffer_store_dwordx4 v[136:139], v18, s[44:47], s40 offen
    s_add_u32 s40, s40, 16384
    v_exp_f32 v102, v102
    v_exp_f32 v110, v110
    v_exp_f32 v118, v118
    v_exp_f32 v126, v126
    v_exp_f32 v103, v103
    v_exp_f32 v111, v111
    v_exp_f32 v119, v119
    v_exp_f32 v127, v127
    v_pk_add_f32 v[100:101], v[100:101], 1.0 op_sel_hi:[1,0]
    v_pk_add_f32 v[108:109], v[108:109], 1.0 op_sel_hi:[1,0]
    v_pk_add_f32 v[116:117], v[116:117], 1.0 op_sel_hi:[1,0]
    v_pk_add_f32 v[124:125], v[124:125], 1.0 op_sel_hi:[1,0]
    v_pk_add_f32 v[102:103], v[102:103], 1.0 op_sel_hi:[1,0]
    v_pk_add_f32 v[110:111], v[110:111], 1.0 op_sel_hi:[1,0]
    v_pk_add_f32 v[118:119], v[118:119], 1.0 op_sel_hi:[1,0]
    v_pk_add_f32 v[126:127], v[126:127], 1.0 op_sel_hi:[1,0]
    v_rcp_f32 v100, v100
    v_rcp_f32 v108, v108
    v_rcp_f32 v116, v116
    v_rcp_f32 v124, v124
    v_rcp_f32 v101, v101
    v_rcp_f32 v109, v109
    v_rcp_f32 v117, v117
    v_rcp_f32 v125, v125
    v_rcp_f32 v102, v102
    v_rcp_f32 v110, v110
    v_rcp_f32 v118, v118
    v_rcp_f32 v126, v126
    v_rcp_f32 v103, v103
    v_rcp_f32 v111, v111
    v_rcp_f32 v119, v119
    v_rcp_f32 v127, v127
    v_pk_mul_f32 v[100:101], v[100:101], v[180:181]
    v_pk_mul_f32 v[108:109], v[108:109], v[188:189]
    v_pk_mul_f32 v[116:117], v[116:117], v[196:197]
    v_pk_mul_f32 v[124:125], v[124:125], v[204:205]
    v_pk_mul_f32 v[102:103], v[102:103], v[182:183]
    v_pk_mul_f32 v[110:111], v[110:111], v[190:191]
    v_pk_mul_f32 v[118:119], v[118:119], v[198:199]
    v_pk_mul_f32 v[126:127], v[126:127], v[206:207]
    v_pk_fma_f32 v[100:101], v[100:101], v[132:133], v[228:229]
    v_pk_fma_f32 v[108:109], v[108:109], v[140:141], v[236:237]
    v_pk_fma_f32 v[116:117], v[116:117], v[148:149], v[244:245]
    v_pk_fma_f32 v[124:125], v[124:125], v[156:157], v[252:253]
    v_pk_fma_f32 v[102:103], v[102:103], v[134:135], v[230:231]
    v_pk_fma_f32 v[110:111], v[110:111], v[142:143], v[238:239]
    v_pk_fma_f32 v[118:119], v[118:119], v[150:151], v[246:247]
    v_pk_fma_f32 v[126:127], v[126:127], v[158:159], v[254:255]
    v_cvt_pk_bf16_f32 v100, v100, v101
    v_cvt_pk_bf16_f32 v108, v108, v109
    v_cvt_pk_bf16_f32 v116, v116, v117
    v_cvt_pk_bf16_f32 v124, v124, v125
    v_cvt_pk_bf16_f32 v101, v102, v103
    v_cvt_pk_bf16_f32 v109, v110, v111
    v_cvt_pk_bf16_f32 v117, v118, v119
    v_cvt_pk_bf16_f32 v125, v126, v127
    ds_write_b64 v2, v[100:101] offset:2048
    ds_write_b64 v3, v[108:109] offset:2048
    ds_write_b64 v4, v[116:117] offset:2048
    ds_write_b64 v5, v[124:125] offset:2048
    s_waitcnt lgkmcnt(0)
    ds_read_b128 v[144:147], v6 offset:2048
    ds_read_b128 v[152:155], v6 offset:3072
    s_waitcnt lgkmcnt(1)
    buffer_store_dwordx4 v[144:147], v18, s[44:47], s40 offen
    s_add_u32 s40, s40, 16384
    s_waitcnt lgkmcnt(0)
    buffer_store_dwordx4 v[152:155], v18, s[44:47], s40 offen
    s_endpgm
L_slow_h_1:
    s_sleep 1
    buffer_load_dword v5, v4, s[8:11], s67 offen sc1
    s_waitcnt vmcnt(0)
    v_cmp_gt_u32 vcc, 1, v5
    s_nop 0
    s_cbranch_vccnz L_slow_h_1
    s_branch L_back_h_1
L_slow_h_2:
    s_sleep 1
    buffer_load_dword v5, v4, s[8:11], s67 offen sc1
    s_waitcnt vmcnt(0)
    v_cmp_gt_u32 vcc, 2, v5
    s_nop 0
    s_cbranch_vccnz L_slow_h_2
    s_branch L_back_h_2
L_slow_h_3:
    s_sleep 1
    buffer_load_dword v22, v20, s[8:11], s66 offen sc1
    s_waitcnt vmcnt(0)
    v_cmp_gt_u32 vcc, 1, v22
    s_nop 0
    s_cbranch_vccnz L_slow_h_3
    s_branch L_back_h_3
L_slow_h_4:
    s_sleep 1
    buffer_load_dword v23, v31, s[8:11], s54 offen sc1
    s_waitcnt vmcnt(0)
    v_cmp_gt_u32 vcc, 1, v23
    s_nop 0
    s_cbranch_vccnz L_slow_h_4
    s_branch L_back_h_4
    s_endpgm
L_code_end:
.section .rodata,"a"
.p2align 6
.amdhsa_kernel recurrent_scan__linear_kernel_hedgehog__dense_activation_silu__prompt_kernel
  .amdhsa_next_free_vgpr 512
  .amdhsa_next_free_sgpr 102
  .amdhsa_accum_offset 256
  .amdhsa_group_segment_fixed_size 0
  .amdhsa_kernarg_size 80
  .amdhsa_user_sgpr_count 2
  .amdhsa_user_sgpr_kernarg_segment_ptr 1
  .amdhsa_system_sgpr_workgroup_id_x 1
  .amdhsa_float_denorm_mode_32 3
.end_amdhsa_kernel
```
